```python
import torch

def _softmax(x, axis=-1):
    return torch.softmax(x, dim=axis)

def _gelu(x):
    return torch.nn.functional.gelu(x, approximate='tanh')

def _silu(x):
    return torch.nn.functional.silu(x)

def _sigmoid(x):
    return torch.sigmoid(x)

def _layernorm(x, axis=-1, eps=1e-05):
    m = x.mean(dim=axis, keepdim=True)
    v = x.var(dim=axis, keepdim=True, unbiased=False)
    return (x - m) / torch.sqrt(v + eps)

def _scatter_add(tgt, idx, src, axis=0):
    return tgt.clone().index_add_(axis, idx, src)

def _segment_sum(src, seg, n):
    out = torch.zeros((n,) + src.shape[1:], dtype=src.dtype)
    return out.index_add_(0, seg, src)

def _pad(x, pw):
    flat = tuple((v for pair in reversed(pw) for v in pair))
    return torch.nn.functional.pad(x, flat)
kernel_name = 'gated_mix__linear_attn_block__mixer_gmlp__prompt'

def setup_inputs():

    _w = lambda a: (lambda t: t.to(torch.bfloat16) if t.is_floating_point() else t)(torch.as_tensor(a))

    def _A_setup():
        B, S, D = (1, 2048, 512)
        return {'x': _w((lambda *s: torch.randn(*s, dtype=torch.bfloat16) * 0.05)(B, S, D)), 'wqkv': _w((lambda *s: torch.randn(*s, dtype=torch.bfloat16) * 1.6)(D, 3 * D)), 'wo': _w((lambda *s: torch.randn(*s, dtype=torch.bfloat16) * 0.2)(D, D))}
    _A_in = _A_setup()

    def _B_setup():
        B, S, D, F = (1, 2048, 512, 1792)
        Fh = F // 2
        return {'x': _w((lambda *s: torch.randn(*s, dtype=torch.bfloat16) * 0.05)(B, S, D)), 'w_in': _w((lambda *s: torch.randn(*s, dtype=torch.bfloat16) * 0.4)(D, 2 * Fh)), 'w_sp': _w(0.01 * (lambda *s: torch.randn(*s, dtype=torch.bfloat16) * 0.4)(S, S)), 'b_sp': _w(1.0 + 0.01 * (lambda *s: torch.randn(*s, dtype=torch.bfloat16) * 0.05)(S)), 'w_out': _w((lambda *s: torch.randn(*s, dtype=torch.bfloat16) * 0.05)(Fh, D))}
    _B_in = _B_setup()
    return {'A_x': _A_in['x'], 'A_wqkv': _A_in['wqkv'], 'A_wo': _A_in['wo'], 'B_x': _B_in['x'], 'B_w_in': _B_in['w_in'], 'B_w_sp': _B_in['w_sp'], 'B_b_sp': _B_in['b_sp'], 'B_w_out': _B_in['w_out'], 'gate_w': _w((lambda *s: torch.randn(*s, dtype=torch.bfloat16) * 0.05)(512) * 16.0)}

def reference(A_x, A_wqkv, A_wo, B_x, B_w_in, B_w_sp, B_b_sp, B_w_out, gate_w):

    def _A_ref(x, wqkv, wo):
        B, S, D = x.shape
        H = 32
        Dh = D // H
        qkv = (lambda x, *d: x.permute(*d))((x @ wqkv).reshape(B, S, 3, H, Dh), 2, 0, 3, 1, 4)
        q, k, v = (qkv[0], qkv[1], qkv[2])
        phi = lambda t: torch.where(t > 0, t + 1, torch.exp(t)) + 1e-06
        pq, pk = (phi(q), phi(k))
        kv = torch.einsum('bhsd,bhse->bhde', pk, v)
        z = torch.einsum('bhsd->bhd', pk)
        num = torch.einsum('bhqd,bhde->bhqe', pq, kv)
        den = torch.einsum('bhqd,bhd->bhq', pq, z)[..., None] + 1e-06
        o = num / den
        return (lambda x, *d: x.permute(*d))(o, 0, 2, 1, 3).reshape(B, S, D) @ wo

    def _B_ref(x, w_in, w_sp, b_sp, w_out):
        B, S, D = x.shape
        F = w_in.shape[-1]
        Fh = F // 2
        z = _gelu(torch.einsum('bsd,df->bsf', x, w_in))
        z1 = z[..., :Fh].clone()
        z2 = _layernorm(z[..., Fh:], axis=-1)
        g = torch.einsum('ts,bsf->btf', w_sp, z2) + b_sp[None, :, None]
        return torch.einsum('bsf,fd->bsd', z1 * g, w_out)
    x = A_x
    g = _sigmoid((x * gate_w).sum(-1, keepdims=True))
    a = _A_ref(x, A_wqkv, A_wo)
    b = _B_ref(x, B_w_in, B_w_sp, B_b_sp, B_w_out)
    return g * a + (1 - g) * b
```

```asm
; @launch grid=(256,1,1) block=(256,1,1) lds=163840
.amdgcn_target "amdgcn-amd-amdhsa--gfx950"
.text
.globl gated_mix__linear_attn_block__mixer_gmlp__prompt_kernel
.p2align 8
.type gated_mix__linear_attn_block__mixer_gmlp__prompt_kernel,@function
gated_mix__linear_attn_block__mixer_gmlp__prompt_kernel:
    s_load_dwordx2 s[4:5], s[0:1], 0
    s_load_dwordx2 s[16:17], s[0:1], 32
    s_load_dwordx2 s[8:9], s[0:1], 8
    s_load_dwordx2 s[40:41], s[0:1], 88
    s_load_dwordx2 s[20:21], s[0:1], 40
    s_load_dwordx2 s[12:13], s[0:1], 16
    s_load_dwordx2 s[24:25], s[0:1], 48
    s_load_dwordx2 s[28:29], s[0:1], 56
    s_load_dwordx2 s[32:33], s[0:1], 64
    s_load_dwordx2 s[36:37], s[0:1], 72
    s_cmp_ge_u32 s2, 256
    s_cbranch_scc1 L_end
    v_lshrrev_b32 v196, 6, v0
    v_and_b32 v1, 63, v0
    v_readfirstlane_b32 s44, v196
    s_bfe_u32 s45, s2, 0x20001
    s_lshl_b32 s45, s45, 2
    s_lshr_b32 s61, s2, 6
    s_add_u32 s45, s45, s61
    s_and_b32 s48, s2, 1
    s_bfe_u32 s47, s2, 0x30003
    s_lshl_b32 s46, s47, 1
    s_add_u32 s46, s46, s48
    s_lshl_b32 s56, s44, 12
    s_lshr_b32 s52, s45, 2
    s_mul_i32 s59, s47, 1
    s_add_u32 s52, s52, s59
    s_mul_i32 s59, s45, 2
    s_add_u32 s52, s52, s59
    s_and_b32 s52, s52, 3
    s_mov_b32 s59, s48
    s_lshl_b32 s60, s59, 1
    s_xor_b32 s60, s60, s44
    s_lshl_b32 s60, s60, 5
    s_lshl_b32 s61, s52, 1
    s_add_u32 s61, s61, s59
    s_lshl_b32 s53, s61, 7
    s_lshl_b32 s92, s46, 7
    s_add_u32 s92, s92, 1792
    s_cmp_eq_u32 s46, 15
    s_cselect_b32 s92, 384, s92
    s_cmp_eq_u32 s46, 14
    s_cselect_b32 s92, 1920, s92
    s_movk_i32 s54, 3584
    s_cmp_ge_u32 s46, 14
    s_cselect_b32 s54, 3072, s54
    v_lshrrev_b32 v197, 3, v1
    v_and_b32 v198, 7, v1
    v_lshrrev_b32 v200, 2, v197
    v_and_b32 v201, 3, v197
    v_lshl_add_u32 v199, v200, 3, v201
    v_xor_b32 v202, v198, v197
    v_lshlrev_b32 v202, 4, v202
    v_and_b32 v200, 6, v197
    v_xor_b32 v203, v198, v200
    v_lshlrev_b32 v203, 4, v203
    s_lshl_b32 s59, s44, 5
    v_add_u32 v200, s59, v199
    v_add_u32 v206, s60, v199
    v_lshl_add_u32 v4, v200, 10, v202
    v_add_u32 v5, 15360, v4
    v_add_u32 v6, 2048, v4
    v_add_u32 v7, 17408, v4
    v_mad_u32_u24 v8, v206, s54, v203
    s_mul_i32 s59, s54, 4
    s_sub_u32 s59, s59, 1024
    v_add_u32 v9, s59, v8
    s_mul_i32 s59, s54, 16
    s_sub_u32 s59, s59, 2048
    v_add_u32 v10, s59, v8
    s_mul_i32 s59, s54, 20
    s_sub_u32 s59, s59, 3072
    v_add_u32 v11, s59, v8
    s_mov_b32 s6, 0x200000
    s_mov_b32 s7, 0x20000
    s_mov_b32 s19, 0x20000
    s_mov_b32 s18, 0x1c0000
    s_waitcnt lgkmcnt(0)
    s_mov_b32 s0, s53
    s_lshl_b32 s1, s54, 7
    s_add_u32 m0, s56, 0
    s_add_u32 s58, s0, 0
    s_and_b32 s58, s58, 1023
    s_lshl_b32 s62, s45, 17
    s_add_u32 s58, s58, s62
    buffer_load_dwordx4 v4, s[4:7], s58 offen lds
    buffer_load_dwordx4 v5, s[4:7], s58 offen offset:1024 lds
    buffer_load_dwordx4 v6, s[4:7], s58 offen offset:2048 lds
    buffer_load_dwordx4 v7, s[4:7], s58 offen offset:3072 lds
    s_cmp_ge_u32 s46, 14
    s_cselect_b32 s16, s8, s16
    s_cselect_b32 s17, s9, s17
    s_cselect_b32 s18, 0x180000, s18
    s_add_u32 m0, s56, 16384
    s_add_u32 s58, s52, 0
    s_and_b32 s58, s58, 3
    s_mul_i32 s58, s58, s1
    s_add_u32 s58, s58, s92
    buffer_load_dwordx4 v8, s[16:19], s58 offen lds
    buffer_load_dwordx4 v9, s[16:19], s58 offen offset:1024 lds
    buffer_load_dwordx4 v10, s[16:19], s58 offen offset:2048 lds
    buffer_load_dwordx4 v11, s[16:19], s58 offen offset:3072 lds
    v_and_b32 v2, 15, v1
    v_lshrrev_b32 v3, 4, v1
    v_bfe_u32 v204, v1, 2, 3
    v_lshrrev_b32 v205, 5, v1
    v_lshl_add_u32 v205, v205, 4, v204
    v_lshlrev_b32 v205, 7, v205
    v_and_b32 v200, 3, v1
    v_lshl_add_u32 v205, v200, 3, v205
    v_lshrrev_b32 v204, 1, v204
    v_xor_b32 v200, 0, v204
    v_lshl_add_u32 v24, v200, 5, v205
    v_add_u32 v28, 0x10000, v24
    v_add_u32 v32, 0x20000, v24
    v_xor_b32 v200, 1, v204
    v_lshl_add_u32 v25, v200, 5, v205
    v_add_u32 v29, 0x10000, v25
    v_add_u32 v33, 0x20000, v25
    v_xor_b32 v200, 2, v204
    v_lshl_add_u32 v26, v200, 5, v205
    v_add_u32 v30, 0x10000, v26
    v_add_u32 v34, 0x20000, v26
    v_xor_b32 v200, 3, v204
    v_lshl_add_u32 v27, v200, 5, v205
    v_add_u32 v31, 0x10000, v27
    v_add_u32 v35, 0x20000, v27
    v_and_b32 v204, 7, v2
    v_xor_b32 v204, v204, v3
    v_lshlrev_b32 v204, 4, v204
    v_lshl_add_u32 v204, v2, 7, v204
    v_add_u32 v42, s56, v204
    v_xor_b32 v43, 64, v42
    v_add_u32 v44, 0x10000, v42
    v_add_u32 v45, 0x10000, v43
    v_add_u32 v46, 0x20000, v42
    v_add_u32 v47, 0x20000, v43
    s_getpc_b64 s[96:97]
L_pc_1:
    s_add_u32 s96, s96, L_body-L_pc_1
    s_addc_u32 s97, s97, 0
    s_lshr_b32 s95, s2, 3
    s_lshl_b32 s95, s95, 2
    s_add_u32 s95, s95, s44
    s_lshl_b32 s95, s95, 6
    s_add_u32 s96, s96, s95
    s_addc_u32 s97, s97, 0
    s_load_dword s95, s[96:97], 0
    s_load_dword s95, s[96:97], 8192
    s_load_dword s95, s[96:97], 16384
    s_load_dword s95, s[96:97], 24576
    s_load_dword s95, s[96:97], 32768
    s_load_dword s95, s[96:97], 40960
    s_load_dword s95, s[96:97], 49152
    s_load_dword s95, s[96:97], 57344
    s_load_dword s95, s[96:97], 65536
    s_load_dword s95, s[96:97], 73728
    s_load_dword s95, s[96:97], 81920
    s_load_dword s95, s[96:97], 90112
    s_cmp_eq_u32 s46, 14
    s_cbranch_scc1 L_roleS0
    s_cmp_eq_u32 s46, 15
    s_cbranch_scc1 L_roleS1
    s_cmp_eq_u32 s48, 1
    s_cbranch_scc1 L_roleB
    s_branch L_body
L_hopA:
    s_cmp_eq_u32 s44, 1
    s_cbranch_scc1 H_A_1
    s_cmp_eq_u32 s44, 2
    s_cbranch_scc1 H_A_2
    s_cmp_eq_u32 s44, 3
    s_cbranch_scc1 H_A_3
    s_branch H_A_0
L_hopB:
    s_cmp_eq_u32 s44, 1
    s_cbranch_scc1 H_B_1
    s_cmp_eq_u32 s44, 2
    s_cbranch_scc1 H_B_2
    s_cmp_eq_u32 s44, 3
    s_cbranch_scc1 H_B_3
    s_branch H_B_0
L_hopS0:
    s_cmp_eq_u32 s44, 1
    s_cbranch_scc1 H_S0_1
    s_cmp_eq_u32 s44, 2
    s_cbranch_scc1 H_S0_2
    s_cmp_eq_u32 s44, 3
    s_cbranch_scc1 H_S0_3
    s_branch H_S0_0
L_hopS1:
    s_cmp_eq_u32 s44, 1
    s_cbranch_scc1 H_S1_1
    s_cmp_eq_u32 s44, 2
    s_cbranch_scc1 H_S1_2
    s_cmp_eq_u32 s44, 3
    s_cbranch_scc1 H_S1_3
    s_branch H_S1_0
L_hopret:
    s_setpc_b64 s[90:91]
.p2align 12
L_body:
H_A_0:
    s_cbranch_execz H_M_0
    s_mov_b64 exec, 0
    s_call_b64 s[90:91], L_hopA
    s_mov_b64 exec, -1
    s_nop 3
    s_add_u32 m0, s56, 32768
    s_xor_b32 s58, s0, 128
    s_add_u32 s58, s58, 0
    s_and_b32 s58, s58, 1023
    s_lshl_b32 s62, s45, 17
    s_add_u32 s58, s58, s62
    buffer_load_dwordx4 v4, s[4:7], s58 offen lds
    buffer_load_dwordx4 v5, s[4:7], s58 offen offset:1024 lds
    buffer_load_dwordx4 v6, s[4:7], s58 offen offset:2048 lds
    buffer_load_dwordx4 v7, s[4:7], s58 offen offset:3072 lds
    s_movk_i32 s60, 3072
    v_mad_u32_u24 v12, v206, s60, v203
    v_add_u32 v13, 11264, v12
    v_add_u32 v14, 47104, v12
    v_add_u32 v15, 58368, v12
    s_mov_b32 s42, 0x1180000
    s_mov_b32 s43, 0x20000
    s_mov_b32 s10, 0x180000
    s_mov_b32 s11, 0x20000
    s_mov_b32 s22, 0x800000
    s_mov_b32 s23, 0x20000
    s_mov_b32 s14, 0x80000
    s_mov_b32 s15, 0x20000
    s_mov_b32 s26, 0x1000
    s_mov_b32 s27, 0x20000
    s_mov_b32 s30, 0xe0000
    s_mov_b32 s31, 0x20000
    s_mov_b32 s34, 0x400
    s_mov_b32 s35, 0x20000
    s_mov_b32 s38, 0x200000
    s_mov_b32 s39, 0x20000
    s_mov_b32 s3, 4000000
    s_lshl_b32 s49, s45, 1
    s_add_u32 s49, s49, s48
    s_and_b32 s61, s47, 1
    s_lshl_b32 s96, s45, 1
    s_add_u32 s96, s96, s61
    s_lshl_b32 s97, s48, 2
    s_lshr_b32 s61, s47, 1
    s_add_u32 s97, s97, s61
    s_lshl_b32 s57, s45, 2
    s_add_u32 s57, s57, s44
    s_mul_i32 s61, s45, 8
    s_mul_i32 s53, s47, 2
    s_add_u32 s53, s53, s61
    s_and_b32 s53, s53, 7
    s_add_u32 s94, s53, 7
    s_and_b32 s94, s94, 7
    s_lshr_b32 s61, s94, 0
    s_lshl_b32 s61, s61, 0
    s_waitcnt lgkmcnt(0)
    s_add_u32 s54, s52, 0
    s_and_b32 s54, s54, 3
    s_mul_i32 s54, s54, 393216
    s_mul_i32 s62, s47, 128
    s_add_u32 s54, s54, s62
    s_add_u32 s55, s52, 1
    s_and_b32 s55, s55, 3
    s_mul_i32 s55, s55, 393216
    s_add_u32 s55, s55, s62
    s_add_u32 s93, s52, 2
    s_and_b32 s93, s93, 3
    s_mul_i32 s93, s93, 393216
    s_add_u32 s93, s93, s62
    s_add_u32 s95, s52, 3
    s_and_b32 s95, s95, 3
    s_mul_i32 s95, s95, 393216
    s_add_u32 s95, s95, s62
    s_waitcnt vmcnt(8)
    ds_read_b128 a[0:3], v42 offset:0
    ds_read_b128 a[4:7], v42 offset:2048
    ds_read_b128 a[8:11], v43 offset:0
    ds_read_b128 a[12:15], v43 offset:2048
    s_add_u32 m0, s56, 49152
    s_add_u32 s58, s52, 1
    s_and_b32 s58, s58, 3
    s_mul_i32 s58, s58, s1
    s_add_u32 s58, s58, s92
    buffer_load_dwordx4 v8, s[16:19], s58 offen lds
    buffer_load_dwordx4 v9, s[16:19], s58 offen offset:1024 lds
    buffer_load_dwordx4 v10, s[16:19], s58 offen offset:2048 lds
    buffer_load_dwordx4 v11, s[16:19], s58 offen offset:3072 lds
    s_waitcnt vmcnt(8) lgkmcnt(0)
    s_barrier
    ds_read_b64_tr_b16 v[132:133], v24 offset:16384
    ds_read_b64_tr_b16 v[134:135], v24 offset:17408
    ds_read_b64_tr_b16 v[136:137], v25 offset:16384
    ds_read_b64_tr_b16 v[138:139], v25 offset:17408
    ds_read_b64_tr_b16 v[140:141], v26 offset:16384
    ds_read_b64_tr_b16 v[142:143], v26 offset:17408
    ds_read_b64_tr_b16 v[144:145], v27 offset:16384
    ds_read_b64_tr_b16 v[146:147], v27 offset:17408
    s_waitcnt lgkmcnt(6)
    v_mfma_f32_16x16x32_bf16 v[68:71], a[0:3], v[132:135], 0
    ds_read_b64_tr_b16 v[148:149], v24 offset:20480
    s_add_u32 s94, s94, s61
    s_lshl_b32 s94, s94, 8
    s_xor_b32 s61, s48, 1
    v_mfma_f32_16x16x32_bf16 v[84:87], a[4:7], v[132:135], 0
    ds_read_b64_tr_b16 v[150:151], v24 offset:21504
    s_add_u32 m0, s56, 65536
    s_add_u32 s58, s0, 256
    s_and_b32 s58, s58, 1023
    s_lshl_b32 s62, s45, 17
    s_add_u32 s58, s58, s62
    buffer_load_dwordx4 v4, s[4:7], s58 offen lds
    s_lshl_b32 s61, s61, 18
    s_add_u32 s94, s94, s61
    v_mov_b32 v50, 0
    s_waitcnt lgkmcnt(6)
    v_mfma_f32_16x16x32_bf16 v[72:75], a[0:3], v[136:139], 0
    ds_read_b64_tr_b16 v[152:153], v25 offset:20480
    v_lshlrev_b32 v48, 4, v1
    v_lshlrev_b32 v49, 3, v2
    v_lshrrev_b32 v204, 2, v1
    v_mfma_f32_16x16x32_bf16 v[88:91], a[4:7], v[136:139], 0
    ds_read_b64_tr_b16 v[154:155], v25 offset:21504
    buffer_load_dwordx4 v5, s[4:7], s58 offen offset:1024 lds
    v_and_b32 v205, 3, v1
    v_lshlrev_b32 v205, 3, v205
    v_lshl_add_u32 v51, v204, 7, v205
    s_waitcnt lgkmcnt(6)
    v_mfma_f32_16x16x32_bf16 v[76:79], a[0:3], v[140:143], 0
    ds_read_b64_tr_b16 v[156:157], v26 offset:20480
    s_lshr_b32 s59, s44, 1
    s_lshl_b32 s59, s59, 17
    s_and_b32 s60, s44, 1
    v_mfma_f32_16x16x32_bf16 v[92:95], a[4:7], v[140:143], 0
    ds_read_b64_tr_b16 v[158:159], v26 offset:21504
    buffer_load_dwordx4 v6, s[4:7], s58 offen offset:2048 lds
    s_lshl_b32 s60, s60, 7
    s_add_u32 s59, s59, s60
    s_lshl_b32 s60, s45, 19
    s_waitcnt lgkmcnt(6)
    v_mfma_f32_16x16x32_bf16 v[80:83], a[0:3], v[144:147], 0
    ds_read_b64_tr_b16 v[160:161], v27 offset:20480
    s_add_u32 s59, s59, s60
    s_lshl_b32 s60, s48, 8
    s_add_u32 s59, s59, s60
    v_mfma_f32_16x16x32_bf16 v[96:99], a[4:7], v[144:147], 0
    ds_read_b64_tr_b16 v[162:163], v27 offset:21504
    buffer_load_dwordx4 v7, s[4:7], s58 offen offset:3072 lds
    v_lshrrev_b32 v204, 1, v197
    v_xor_b32 v204, v204, v198
    v_lshlrev_b32 v204, 4, v204
    s_waitcnt lgkmcnt(6)
    v_mfma_f32_16x16x32_bf16 v[68:71], a[8:11], v[148:151], v[68:71]
    ds_read_b64_tr_b16 v[132:133], v24 offset:24576
    v_lshl_add_u32 v204, v199, 12, v204
    v_add_u32 v16, s59, v204
    v_xor_b32 v204, 64, v16
    v_mfma_f32_16x16x32_bf16 v[84:87], a[12:15], v[148:151], v[84:87]
    ds_read_b64_tr_b16 v[134:135], v24 offset:25600
    s_add_u32 m0, s56, 81920
    s_xor_b32 s58, s0, 128
    s_add_u32 s58, s58, 256
    s_and_b32 s58, s58, 1023
    s_lshl_b32 s62, s45, 17
    s_add_u32 s58, s58, s62
    buffer_load_dwordx4 v4, s[4:7], s58 offen lds
    v_add_u32 v17, 64512, v204
    v_add_u32 v18, 14336, v16
    v_add_u32 v19, 78848, v204
    s_waitcnt lgkmcnt(6)
    v_mfma_f32_16x16x32_bf16 v[72:75], a[8:11], v[152:155], v[72:75]
    ds_read_b64_tr_b16 v[136:137], v25 offset:24576
    s_lshl_b32 s59, s44, 15
    s_lshl_b32 s60, s97, 7
    s_add_u32 s59, s59, s60
    v_mfma_f32_16x16x32_bf16 v[88:91], a[12:15], v[152:155], v[88:91]
    ds_read_b64_tr_b16 v[138:139], v25 offset:25600
    buffer_load_dwordx4 v5, s[4:7], s58 offen offset:1024 lds
    v_lshrrev_b32 v204, 2, v197
    v_lshl_add_u32 v204, v204, 3, v199
    v_and_b32 v205, 2, v197
    s_waitcnt lgkmcnt(6)
    v_mfma_f32_16x16x32_bf16 v[76:79], a[8:11], v[156:159], v[76:79]
    ds_read_b64_tr_b16 v[140:141], v26 offset:24576
    v_lshlrev_b32 v205, 1, v205
    v_xor_b32 v205, v205, v198
    v_lshlrev_b32 v205, 4, v205
    s_waitcnt vmcnt(10)
    ds_read_b128 a[16:19], v42 offset:32768
    ds_read_b128 a[20:23], v42 offset:34816
    ds_read_b128 a[24:27], v43 offset:32768
    ds_read_b128 a[28:31], v43 offset:34816
    v_mfma_f32_16x16x32_bf16 v[92:95], a[12:15], v[156:159], v[92:95]
    ds_read_b64_tr_b16 v[142:143], v26 offset:25600
    buffer_load_dwordx4 v6, s[4:7], s58 offen offset:2048 lds
    v_lshl_add_u32 v204, v204, 10, v205
    v_add_u32 v20, s59, v204
    v_add_u32 v21, 3072, v20
    s_waitcnt lgkmcnt(10)
    v_mfma_f32_16x16x32_bf16 v[80:83], a[8:11], v[160:163], v[80:83]
    ds_read_b64_tr_b16 v[144:145], v27 offset:24576
    v_add_u32 v22, 6144, v20
    v_add_u32 v23, 9216, v20
    v_lshlrev_b32 v204, 4, v2
    v_mfma_f32_16x16x32_bf16 v[96:99], a[12:15], v[160:163], v[96:99]
    ds_read_b64_tr_b16 v[146:147], v27 offset:25600
    buffer_load_dwordx4 v7, s[4:7], s58 offen offset:3072 lds
    v_lshl_add_u32 v36, v3, 9, v204
    v_and_b32 v204, 128, v204
    v_add_u32 v37, v36, v204
    s_waitcnt lgkmcnt(3)
    v_mfma_f32_16x16x32_bf16 v[68:71], a[16:19], v[132:135], v[68:71]
    ds_read_b64_tr_b16 v[148:149], v24 offset:28672
    v_mov_b32 v52, 0xc0135761
    v_mov_b32 v53, 0xc0135761
    v_mov_b32 v54, 0xbdd2d3e8
    v_mfma_f32_16x16x32_bf16 v[84:87], a[20:23], v[132:135], v[84:87]
    ds_read_b64_tr_b16 v[150:151], v24 offset:29696
    s_add_u32 m0, s56, 98304
    s_add_u32 s58, s52, 2
    s_and_b32 s58, s58, 3
    s_mul_i32 s58, s58, s1
    s_add_u32 s58, s58, s92
    buffer_load_dwordx4 v8, s[16:19], s58 offen lds
    v_mov_b32 v55, 0xbdd2d3e8
    v_mov_b32 v56, 0x3f800000
    v_mov_b32 v57, 0x3f800000
    v_mfma_f32_16x16x32_bf16 v[72:75], a[16:19], v[136:139], v[72:75]
    ds_read_b64_tr_b16 v[152:153], v25 offset:28672
    v_mov_b32 v58, 0x3fb8aa3b
    v_mov_b32 v59, 0x3fb8aa3b
    v_mov_b32 v60, 0x358637bd
    v_mfma_f32_16x16x32_bf16 v[88:91], a[20:23], v[136:139], v[88:91]
    ds_read_b64_tr_b16 v[154:155], v25 offset:29696
    buffer_load_dwordx4 v9, s[16:19], s58 offen offset:1024 lds
    v_mov_b32 v61, 0x358637bd
    s_waitcnt lgkmcnt(6)
    v_mfma_f32_16x16x32_bf16 v[76:79], a[16:19], v[140:143], v[76:79]
    ds_read_b64_tr_b16 v[156:157], v26 offset:28672
    v_mfma_f32_16x16x32_bf16 v[92:95], a[20:23], v[140:143], v[92:95]
    ds_read_b64_tr_b16 v[158:159], v26 offset:29696
    buffer_load_dwordx4 v10, s[16:19], s58 offen offset:2048 lds
    s_waitcnt lgkmcnt(6)
    v_mfma_f32_16x16x32_bf16 v[80:83], a[16:19], v[144:147], v[80:83]
    ds_read_b64_tr_b16 v[160:161], v27 offset:28672
    v_mfma_f32_16x16x32_bf16 v[96:99], a[20:23], v[144:147], v[96:99]
    ds_read_b64_tr_b16 v[162:163], v27 offset:29696
    buffer_load_dwordx4 v11, s[16:19], s58 offen offset:3072 lds
    s_waitcnt lgkmcnt(6)
    v_mfma_f32_16x16x32_bf16 v[68:71], a[24:27], v[148:151], v[68:71]
    v_mfma_f32_16x16x32_bf16 v[84:87], a[28:31], v[148:151], v[84:87]
    s_add_u32 m0, s56, 114688
    s_add_u32 s58, s0, 512
    s_and_b32 s58, s58, 1023
    s_lshl_b32 s62, s45, 17
    s_add_u32 s58, s58, s62
    buffer_load_dwordx4 v4, s[4:7], s58 offen lds
    s_waitcnt lgkmcnt(4)
    v_mfma_f32_16x16x32_bf16 v[72:75], a[24:27], v[152:155], v[72:75]
    v_mfma_f32_16x16x32_bf16 v[88:91], a[28:31], v[152:155], v[88:91]
    buffer_load_dwordx4 v5, s[4:7], s58 offen offset:1024 lds
    s_waitcnt vmcnt(14) lgkmcnt(0)
    s_barrier
    v_mfma_f32_16x16x32_bf16 v[76:79], a[24:27], v[156:159], v[76:79]
    ds_read_b64_tr_b16 v[132:133], v24 offset:49152
    ds_read_b64_tr_b16 v[134:135], v24 offset:50176
    s_waitcnt vmcnt(10)
    ds_read_b128 a[32:35], v44 offset:0
    ds_read_b128 a[36:39], v44 offset:2048
    ds_read_b128 a[40:43], v45 offset:0
    ds_read_b128 a[44:47], v45 offset:2048
    v_mfma_f32_16x16x32_bf16 v[92:95], a[28:31], v[156:159], v[92:95]
    ds_read_b64_tr_b16 v[136:137], v25 offset:49152
    ds_read_b64_tr_b16 v[138:139], v25 offset:50176
    buffer_load_dwordx4 v6, s[4:7], s58 offen offset:2048 lds
    v_mfma_f32_16x16x32_bf16 v[80:83], a[24:27], v[160:163], v[80:83]
    ds_read_b64_tr_b16 v[140:141], v26 offset:49152
    ds_read_b64_tr_b16 v[142:143], v26 offset:50176
    v_mfma_f32_16x16x32_bf16 v[96:99], a[28:31], v[160:163], v[96:99]
    ds_read_b64_tr_b16 v[144:145], v27 offset:49152
    ds_read_b64_tr_b16 v[146:147], v27 offset:50176
    buffer_load_dwordx4 v7, s[4:7], s58 offen offset:3072 lds
    buffer_load_dwordx2 v[66:67], v50, s[40:43], 0 offen sc1
    s_waitcnt lgkmcnt(6)
    v_mfma_f32_16x16x32_bf16 v[68:71], a[32:35], v[132:135], v[68:71]
    ds_read_b64_tr_b16 v[148:149], v24 offset:53248
    v_mfma_f32_16x16x32_bf16 v[84:87], a[36:39], v[132:135], v[84:87]
    ds_read_b64_tr_b16 v[150:151], v24 offset:54272
    s_add_u32 m0, s56, 131072
    s_xor_b32 s58, s0, 128
    s_add_u32 s58, s58, 512
    s_and_b32 s58, s58, 1023
    s_lshl_b32 s62, s45, 17
    s_add_u32 s58, s58, s62
    buffer_load_dwordx4 v4, s[4:7], s58 offen lds
    s_waitcnt lgkmcnt(6)
    v_mfma_f32_16x16x32_bf16 v[72:75], a[32:35], v[136:139], v[72:75]
    ds_read_b64_tr_b16 v[152:153], v25 offset:53248
    v_mfma_f32_16x16x32_bf16 v[88:91], a[36:39], v[136:139], v[88:91]
    ds_read_b64_tr_b16 v[154:155], v25 offset:54272
    buffer_load_dwordx4 v5, s[4:7], s58 offen offset:1024 lds
    s_waitcnt lgkmcnt(6)
    v_mfma_f32_16x16x32_bf16 v[76:79], a[32:35], v[140:143], v[76:79]
    ds_read_b64_tr_b16 v[156:157], v26 offset:53248
    v_mfma_f32_16x16x32_bf16 v[92:95], a[36:39], v[140:143], v[92:95]
    ds_read_b64_tr_b16 v[158:159], v26 offset:54272
    buffer_load_dwordx4 v6, s[4:7], s58 offen offset:2048 lds
    s_waitcnt lgkmcnt(6)
    v_mfma_f32_16x16x32_bf16 v[80:83], a[32:35], v[144:147], v[80:83]
    ds_read_b64_tr_b16 v[160:161], v27 offset:53248
    v_mfma_f32_16x16x32_bf16 v[96:99], a[36:39], v[144:147], v[96:99]
    ds_read_b64_tr_b16 v[162:163], v27 offset:54272
    buffer_load_dwordx4 v7, s[4:7], s58 offen offset:3072 lds
    s_waitcnt lgkmcnt(6)
    v_mfma_f32_16x16x32_bf16 v[68:71], a[40:43], v[148:151], v[68:71]
    ds_read_b64_tr_b16 v[132:133], v24 offset:57344
    v_mfma_f32_16x16x32_bf16 v[84:87], a[44:47], v[148:151], v[84:87]
    ds_read_b64_tr_b16 v[134:135], v24 offset:58368
    s_add_u32 m0, s56, 147456
    s_add_u32 s58, s52, 3
    s_and_b32 s58, s58, 3
    s_mul_i32 s58, s58, s1
    s_add_u32 s58, s58, s92
    buffer_load_dwordx4 v8, s[16:19], s58 offen lds
    s_waitcnt lgkmcnt(6)
    v_mfma_f32_16x16x32_bf16 v[72:75], a[40:43], v[152:155], v[72:75]
    ds_read_b64_tr_b16 v[136:137], v25 offset:57344
    v_mfma_f32_16x16x32_bf16 v[88:91], a[44:47], v[152:155], v[88:91]
    ds_read_b64_tr_b16 v[138:139], v25 offset:58368
    buffer_load_dwordx4 v9, s[16:19], s58 offen offset:1024 lds
    s_waitcnt lgkmcnt(6)
    v_mfma_f32_16x16x32_bf16 v[76:79], a[40:43], v[156:159], v[76:79]
    ds_read_b64_tr_b16 v[140:141], v26 offset:57344
    s_waitcnt vmcnt(15)
    ds_read_b128 a[48:51], v44 offset:16384
    ds_read_b128 a[52:55], v44 offset:18432
    ds_read_b128 a[56:59], v45 offset:16384
    ds_read_b128 a[60:63], v45 offset:18432
    v_mfma_f32_16x16x32_bf16 v[92:95], a[44:47], v[156:159], v[92:95]
    ds_read_b64_tr_b16 v[142:143], v26 offset:58368
    buffer_load_dwordx4 v10, s[16:19], s58 offen offset:2048 lds
    s_waitcnt lgkmcnt(10)
    v_mfma_f32_16x16x32_bf16 v[80:83], a[40:43], v[160:163], v[80:83]
    ds_read_b64_tr_b16 v[144:145], v27 offset:57344
    v_mfma_f32_16x16x32_bf16 v[96:99], a[44:47], v[160:163], v[96:99]
    ds_read_b64_tr_b16 v[146:147], v27 offset:58368
    buffer_load_dwordx4 v11, s[16:19], s58 offen offset:3072 lds
    s_waitcnt lgkmcnt(3)
    v_mfma_f32_16x16x32_bf16 v[68:71], a[48:51], v[132:135], v[68:71]
    ds_read_b64_tr_b16 v[148:149], v24 offset:61440
    v_mfma_f32_16x16x32_bf16 v[84:87], a[52:55], v[132:135], v[84:87]
    ds_read_b64_tr_b16 v[150:151], v24 offset:62464
    s_add_u32 m0, s56, 0
    s_add_u32 s58, s0, 768
    s_and_b32 s58, s58, 1023
    s_lshl_b32 s62, s45, 17
    s_add_u32 s58, s58, s62
    buffer_load_dwordx4 v4, s[4:7], s58 offen lds
    v_mfma_f32_16x16x32_bf16 v[72:75], a[48:51], v[136:139], v[72:75]
    ds_read_b64_tr_b16 v[152:153], v25 offset:61440
    v_mfma_f32_16x16x32_bf16 v[88:91], a[52:55], v[136:139], v[88:91]
    ds_read_b64_tr_b16 v[154:155], v25 offset:62464
    buffer_load_dwordx4 v5, s[4:7], s58 offen offset:1024 lds
    s_waitcnt lgkmcnt(6)
    v_mfma_f32_16x16x32_bf16 v[76:79], a[48:51], v[140:143], v[76:79]
    ds_read_b64_tr_b16 v[156:157], v26 offset:61440
    v_mfma_f32_16x16x32_bf16 v[92:95], a[52:55], v[140:143], v[92:95]
    ds_read_b64_tr_b16 v[158:159], v26 offset:62464
    buffer_load_dwordx4 v6, s[4:7], s58 offen offset:2048 lds
    s_waitcnt lgkmcnt(6)
    v_mfma_f32_16x16x32_bf16 v[80:83], a[48:51], v[144:147], v[80:83]
    ds_read_b64_tr_b16 v[160:161], v27 offset:61440
    v_mfma_f32_16x16x32_bf16 v[96:99], a[52:55], v[144:147], v[96:99]
    ds_read_b64_tr_b16 v[162:163], v27 offset:62464
    buffer_load_dwordx4 v7, s[4:7], s58 offen offset:3072 lds
    s_waitcnt lgkmcnt(6)
    v_mfma_f32_16x16x32_bf16 v[68:71], a[56:59], v[148:151], v[68:71]
    v_mfma_f32_16x16x32_bf16 v[84:87], a[60:63], v[148:151], v[84:87]
    s_add_u32 m0, s56, 32768
    s_xor_b32 s58, s0, 128
    s_add_u32 s58, s58, 768
    s_and_b32 s58, s58, 1023
    s_lshl_b32 s62, s45, 17
    s_add_u32 s58, s58, s62
    buffer_load_dwordx4 v4, s[4:7], s58 offen lds
    s_waitcnt lgkmcnt(4)
    v_mfma_f32_16x16x32_bf16 v[72:75], a[56:59], v[152:155], v[72:75]
    v_mfma_f32_16x16x32_bf16 v[88:91], a[60:63], v[152:155], v[88:91]
    buffer_load_dwordx4 v5, s[4:7], s58 offen offset:1024 lds
    s_waitcnt vmcnt(19) lgkmcnt(0)
    s_barrier
    v_mfma_f32_16x16x32_bf16 v[76:79], a[56:59], v[156:159], v[76:79]
    ds_read_b64_tr_b16 v[132:133], v28 offset:32768
    ds_read_b64_tr_b16 v[134:135], v28 offset:33792
    s_waitcnt vmcnt(15)
    ds_read_b128 a[64:67], v44 offset:49152
    ds_read_b128 a[68:71], v44 offset:51200
    ds_read_b128 a[72:75], v45 offset:49152
    ds_read_b128 a[76:79], v45 offset:51200
    v_mfma_f32_16x16x32_bf16 v[92:95], a[60:63], v[156:159], v[92:95]
    ds_read_b64_tr_b16 v[136:137], v29 offset:32768
    ds_read_b64_tr_b16 v[138:139], v29 offset:33792
    buffer_load_dwordx4 v6, s[4:7], s58 offen offset:2048 lds
    v_mfma_f32_16x16x32_bf16 v[80:83], a[56:59], v[160:163], v[80:83]
    ds_read_b64_tr_b16 v[140:141], v30 offset:32768
    ds_read_b64_tr_b16 v[142:143], v30 offset:33792
    v_mfma_f32_16x16x32_bf16 v[96:99], a[60:63], v[160:163], v[96:99]
    ds_read_b64_tr_b16 v[144:145], v31 offset:32768
    ds_read_b64_tr_b16 v[146:147], v31 offset:33792
    buffer_load_dwordx4 v7, s[4:7], s58 offen offset:3072 lds
    s_waitcnt lgkmcnt(6)
    v_mfma_f32_16x16x32_bf16 v[68:71], a[64:67], v[132:135], v[68:71]
    ds_read_b64_tr_b16 v[148:149], v28 offset:36864
    v_mfma_f32_16x16x32_bf16 v[84:87], a[68:71], v[132:135], v[84:87]
    ds_read_b64_tr_b16 v[150:151], v28 offset:37888
    s_waitcnt lgkmcnt(6)
    v_mfma_f32_16x16x32_bf16 v[72:75], a[64:67], v[136:139], v[72:75]
    ds_read_b64_tr_b16 v[152:153], v29 offset:36864
    v_mfma_f32_16x16x32_bf16 v[88:91], a[68:71], v[136:139], v[88:91]
    ds_read_b64_tr_b16 v[154:155], v29 offset:37888
    s_add_u32 m0, s56, 16384
    s_add_u32 s58, s54, 1024
    buffer_load_dwordx4 v12, s[8:11], s58 offen lds
    s_waitcnt lgkmcnt(6)
    v_mfma_f32_16x16x32_bf16 v[76:79], a[64:67], v[140:143], v[76:79]
    ds_read_b64_tr_b16 v[156:157], v30 offset:36864
    v_mfma_f32_16x16x32_bf16 v[92:95], a[68:71], v[140:143], v[92:95]
    ds_read_b64_tr_b16 v[158:159], v30 offset:37888
    s_waitcnt lgkmcnt(6)
    v_mfma_f32_16x16x32_bf16 v[80:83], a[64:67], v[144:147], v[80:83]
    ds_read_b64_tr_b16 v[160:161], v31 offset:36864
    v_mfma_f32_16x16x32_bf16 v[96:99], a[68:71], v[144:147], v[96:99]
    ds_read_b64_tr_b16 v[162:163], v31 offset:37888
    s_waitcnt lgkmcnt(6)
    v_mfma_f32_16x16x32_bf16 v[68:71], a[72:75], v[148:151], v[68:71]
    ds_read_b64_tr_b16 v[132:133], v28 offset:40960
    v_mfma_f32_16x16x32_bf16 v[84:87], a[76:79], v[148:151], v[84:87]
    ds_read_b64_tr_b16 v[134:135], v28 offset:41984
    s_waitcnt lgkmcnt(6)
    v_mfma_f32_16x16x32_bf16 v[72:75], a[72:75], v[152:155], v[72:75]
    ds_read_b64_tr_b16 v[136:137], v29 offset:40960
    v_mfma_f32_16x16x32_bf16 v[88:91], a[76:79], v[152:155], v[88:91]
    ds_read_b64_tr_b16 v[138:139], v29 offset:41984
    s_waitcnt lgkmcnt(6)
    v_mfma_f32_16x16x32_bf16 v[76:79], a[72:75], v[156:159], v[76:79]
    ds_read_b64_tr_b16 v[140:141], v30 offset:40960
    buffer_load_dwordx4 v13, s[8:11], s58 offen offset:1024 lds
    s_waitcnt vmcnt(14)
    ds_read_b128 a[80:83], v46 offset:0
    ds_read_b128 a[84:87], v46 offset:2048
    ds_read_b128 a[88:91], v47 offset:0
    ds_read_b128 a[92:95], v47 offset:2048
    v_mfma_f32_16x16x32_bf16 v[92:95], a[76:79], v[156:159], v[92:95]
    ds_read_b64_tr_b16 v[142:143], v30 offset:41984
    s_waitcnt lgkmcnt(10)
    v_mfma_f32_16x16x32_bf16 v[80:83], a[72:75], v[160:163], v[80:83]
    ds_read_b64_tr_b16 v[144:145], v31 offset:40960
    v_mfma_f32_16x16x32_bf16 v[96:99], a[76:79], v[160:163], v[96:99]
    ds_read_b64_tr_b16 v[146:147], v31 offset:41984
    s_waitcnt lgkmcnt(3)
    v_mfma_f32_16x16x32_bf16 v[68:71], a[80:83], v[132:135], v[68:71]
    ds_read_b64_tr_b16 v[148:149], v28 offset:45056
    v_mfma_f32_16x16x32_bf16 v[84:87], a[84:87], v[132:135], v[84:87]
    ds_read_b64_tr_b16 v[150:151], v28 offset:46080
    v_mfma_f32_16x16x32_bf16 v[72:75], a[80:83], v[136:139], v[72:75]
    ds_read_b64_tr_b16 v[152:153], v29 offset:45056
    v_mfma_f32_16x16x32_bf16 v[88:91], a[84:87], v[136:139], v[88:91]
    ds_read_b64_tr_b16 v[154:155], v29 offset:46080
    s_waitcnt lgkmcnt(6)
    v_mfma_f32_16x16x32_bf16 v[76:79], a[80:83], v[140:143], v[76:79]
    ds_read_b64_tr_b16 v[156:157], v30 offset:45056
    v_mfma_f32_16x16x32_bf16 v[92:95], a[84:87], v[140:143], v[92:95]
    ds_read_b64_tr_b16 v[158:159], v30 offset:46080
    buffer_load_dwordx4 v14, s[8:11], s58 offen offset:2048 lds
    s_waitcnt lgkmcnt(6)
    v_mfma_f32_16x16x32_bf16 v[80:83], a[80:83], v[144:147], v[80:83]
    ds_read_b64_tr_b16 v[160:161], v31 offset:45056
    v_mfma_f32_16x16x32_bf16 v[96:99], a[84:87], v[144:147], v[96:99]
    ds_read_b64_tr_b16 v[162:163], v31 offset:46080
    v_add_u32 v66, 0x9e3779b9, v66
    v_add_u32 v67, 0x7f4a7c15, v67
    v_readfirstlane_b32 s50, v66
    v_readfirstlane_b32 s51, v67
    s_waitcnt lgkmcnt(6)
    v_mfma_f32_16x16x32_bf16 v[68:71], a[88:91], v[148:151], v[68:71]
    v_mfma_f32_16x16x32_bf16 v[84:87], a[92:95], v[148:151], v[84:87]
    s_waitcnt lgkmcnt(4)
    v_mfma_f32_16x16x32_bf16 v[72:75], a[88:91], v[152:155], v[72:75]
    v_mfma_f32_16x16x32_bf16 v[88:91], a[92:95], v[152:155], v[88:91]
    s_waitcnt vmcnt(11) lgkmcnt(0)
    s_barrier
    v_mfma_f32_16x16x32_bf16 v[76:79], a[88:91], v[156:159], v[76:79]
    ds_read_b64_tr_b16 v[132:133], v32 offset:16384
    ds_read_b64_tr_b16 v[134:135], v32 offset:17408
    s_waitcnt vmcnt(7)
    ds_read_b128 a[96:99], v42 offset:0
    ds_read_b128 a[100:103], v42 offset:2048
    ds_read_b128 a[104:107], v43 offset:0
    ds_read_b128 a[108:111], v43 offset:2048
    v_mfma_f32_16x16x32_bf16 v[92:95], a[92:95], v[156:159], v[92:95]
    ds_read_b64_tr_b16 v[136:137], v33 offset:16384
    ds_read_b64_tr_b16 v[138:139], v33 offset:17408
    buffer_load_dwordx4 v15, s[8:11], s58 offen offset:3072 lds
    v_mfma_f32_16x16x32_bf16 v[80:83], a[88:91], v[160:163], v[80:83]
    ds_read_b64_tr_b16 v[140:141], v34 offset:16384
    ds_read_b64_tr_b16 v[142:143], v34 offset:17408
    v_mfma_f32_16x16x32_bf16 v[96:99], a[92:95], v[160:163], v[96:99]
    ds_read_b64_tr_b16 v[144:145], v35 offset:16384
    ds_read_b64_tr_b16 v[146:147], v35 offset:17408
    s_waitcnt lgkmcnt(6)
    v_mfma_f32_16x16x32_bf16 v[68:71], a[96:99], v[132:135], v[68:71]
    ds_read_b64_tr_b16 v[148:149], v32 offset:20480
    v_mfma_f32_16x16x32_bf16 v[84:87], a[100:103], v[132:135], v[84:87]
    ds_read_b64_tr_b16 v[150:151], v32 offset:21504
    s_waitcnt lgkmcnt(6)
    v_mfma_f32_16x16x32_bf16 v[72:75], a[96:99], v[136:139], v[72:75]
    ds_read_b64_tr_b16 v[152:153], v33 offset:20480
    v_mfma_f32_16x16x32_bf16 v[88:91], a[100:103], v[136:139], v[88:91]
    ds_read_b64_tr_b16 v[154:155], v33 offset:21504
    s_waitcnt lgkmcnt(6)
    v_mfma_f32_16x16x32_bf16 v[76:79], a[96:99], v[140:143], v[76:79]
    ds_read_b64_tr_b16 v[156:157], v34 offset:20480
    v_mfma_f32_16x16x32_bf16 v[92:95], a[100:103], v[140:143], v[92:95]
    ds_read_b64_tr_b16 v[158:159], v34 offset:21504
    s_add_u32 m0, s56, 65536
    s_add_u32 s58, s55, 1024
    buffer_load_dwordx4 v12, s[8:11], s58 offen lds
    s_waitcnt lgkmcnt(6)
    v_mfma_f32_16x16x32_bf16 v[80:83], a[96:99], v[144:147], v[80:83]
    ds_read_b64_tr_b16 v[160:161], v35 offset:20480
    v_mfma_f32_16x16x32_bf16 v[96:99], a[100:103], v[144:147], v[96:99]
    ds_read_b64_tr_b16 v[162:163], v35 offset:21504
    s_waitcnt lgkmcnt(6)
    v_mfma_f32_16x16x32_bf16 v[68:71], a[104:107], v[148:151], v[68:71]
    ds_read_b64_tr_b16 v[132:133], v32 offset:24576
    v_mfma_f32_16x16x32_bf16 v[84:87], a[108:111], v[148:151], v[84:87]
    ds_read_b64_tr_b16 v[134:135], v32 offset:25600
    buffer_load_dwordx4 v13, s[8:11], s58 offen offset:1024 lds
    s_waitcnt lgkmcnt(6)
    v_mfma_f32_16x16x32_bf16 v[72:75], a[104:107], v[152:155], v[72:75]
    ds_read_b64_tr_b16 v[136:137], v33 offset:24576
    v_mfma_f32_16x16x32_bf16 v[88:91], a[108:111], v[152:155], v[88:91]
    ds_read_b64_tr_b16 v[138:139], v33 offset:25600
    s_waitcnt lgkmcnt(6)
    v_mfma_f32_16x16x32_bf16 v[76:79], a[104:107], v[156:159], v[76:79]
    ds_read_b64_tr_b16 v[140:141], v34 offset:24576
    s_waitcnt vmcnt(6)
    ds_read_b128 a[112:115], v42 offset:32768
    ds_read_b128 a[116:119], v42 offset:34816
    ds_read_b128 a[120:123], v43 offset:32768
    ds_read_b128 a[124:127], v43 offset:34816
    v_mfma_f32_16x16x32_bf16 v[92:95], a[108:111], v[156:159], v[92:95]
    ds_read_b64_tr_b16 v[142:143], v34 offset:25600
    buffer_load_dwordx4 v14, s[8:11], s58 offen offset:2048 lds
    s_waitcnt lgkmcnt(10)
    v_mfma_f32_16x16x32_bf16 v[80:83], a[104:107], v[160:163], v[80:83]
    ds_read_b64_tr_b16 v[144:145], v35 offset:24576
    v_mfma_f32_16x16x32_bf16 v[96:99], a[108:111], v[160:163], v[96:99]
    ds_read_b64_tr_b16 v[146:147], v35 offset:25600
    s_waitcnt lgkmcnt(3)
    v_mfma_f32_16x16x32_bf16 v[68:71], a[112:115], v[132:135], v[68:71]
    ds_read_b64_tr_b16 v[148:149], v32 offset:28672
    buffer_load_dwordx4 v15, s[8:11], s58 offen offset:3072 lds
    v_mfma_f32_16x16x32_bf16 v[84:87], a[116:119], v[132:135], v[84:87]
    ds_read_b64_tr_b16 v[150:151], v32 offset:29696
    v_mfma_f32_16x16x32_bf16 v[72:75], a[112:115], v[136:139], v[72:75]
    ds_read_b64_tr_b16 v[152:153], v33 offset:28672
    v_mfma_f32_16x16x32_bf16 v[88:91], a[116:119], v[136:139], v[88:91]
    ds_read_b64_tr_b16 v[154:155], v33 offset:29696
    s_waitcnt lgkmcnt(6)
    v_mfma_f32_16x16x32_bf16 v[76:79], a[112:115], v[140:143], v[76:79]
    ds_read_b64_tr_b16 v[156:157], v34 offset:28672
    s_add_u32 m0, s56, 81920
    s_add_u32 s58, s93, 1024
    buffer_load_dwordx4 v12, s[8:11], s58 offen lds
    v_mfma_f32_16x16x32_bf16 v[92:95], a[116:119], v[140:143], v[92:95]
    ds_read_b64_tr_b16 v[158:159], v34 offset:29696
    s_waitcnt lgkmcnt(6)
    v_mfma_f32_16x16x32_bf16 v[80:83], a[112:115], v[144:147], v[80:83]
    ds_read_b64_tr_b16 v[160:161], v35 offset:28672
    v_mfma_f32_16x16x32_bf16 v[96:99], a[116:119], v[144:147], v[96:99]
    ds_read_b64_tr_b16 v[162:163], v35 offset:29696
    buffer_load_dwordx4 v13, s[8:11], s58 offen offset:1024 lds
    s_waitcnt lgkmcnt(6)
    v_mfma_f32_16x16x32_bf16 v[68:71], a[120:123], v[148:151], v[68:71]
    v_mfma_f32_16x16x32_bf16 v[84:87], a[124:127], v[148:151], v[84:87]
    s_waitcnt lgkmcnt(4)
    v_mfma_f32_16x16x32_bf16 v[72:75], a[120:123], v[152:155], v[72:75]
    v_mfma_f32_16x16x32_bf16 v[88:91], a[124:127], v[152:155], v[88:91]
    buffer_load_dwordx4 v14, s[8:11], s58 offen offset:2048 lds
    s_waitcnt lgkmcnt(0)
    s_barrier
    v_mfma_f32_16x16x32_bf16 v[76:79], a[120:123], v[156:159], v[76:79]
    v_mfma_f32_16x16x32_bf16 v[92:95], a[124:127], v[156:159], v[92:95]
    v_mfma_f32_16x16x32_bf16 v[80:83], a[120:123], v[160:163], v[80:83]
    v_mfma_f32_16x16x32_bf16 v[96:99], a[124:127], v[160:163], v[96:99]
    buffer_load_dwordx4 v15, s[8:11], s58 offen offset:3072 lds
    v_pk_mul_f32 v[196:197], v[68:69], v[68:69]
    v_pk_mul_f32 v[198:199], v[70:71], v[70:71]
    v_pk_mul_f32 v[200:201], v[72:73], v[72:73]
    v_pk_mul_f32 v[202:203], v[74:75], v[74:75]
H_A_1:
    s_cbranch_execz H_M_1
    v_pk_fma_f32 v[196:197], v[196:197], v[54:55], v[52:53]
    v_pk_fma_f32 v[198:199], v[198:199], v[54:55], v[52:53]
    v_pk_fma_f32 v[200:201], v[200:201], v[54:55], v[52:53]
    v_pk_fma_f32 v[202:203], v[202:203], v[54:55], v[52:53]
    v_pk_mul_f32 v[196:197], v[196:197], v[68:69]
    v_pk_mul_f32 v[198:199], v[198:199], v[70:71]
    v_pk_mul_f32 v[200:201], v[200:201], v[72:73]
    v_pk_mul_f32 v[202:203], v[202:203], v[74:75]
    s_add_u32 m0, s56, 49152
    s_add_u32 s58, s95, 1024
    buffer_load_dwordx4 v12, s[8:11], s58 offen lds
    v_exp_f32 v196, v196
    v_exp_f32 v197, v197
    v_exp_f32 v198, v198
    v_exp_f32 v199, v199
    v_exp_f32 v200, v200
    v_exp_f32 v201, v201
    v_exp_f32 v202, v202
    v_exp_f32 v203, v203
    buffer_load_dwordx4 v13, s[8:11], s58 offen offset:1024 lds
    v_pk_add_f32 v[196:197], v[196:197], v[56:57]
    v_pk_add_f32 v[198:199], v[198:199], v[56:57]
    v_pk_add_f32 v[200:201], v[200:201], v[56:57]
    v_pk_add_f32 v[202:203], v[202:203], v[56:57]
    v_rcp_f32 v196, v196
    v_rcp_f32 v197, v197
    v_rcp_f32 v198, v198
    v_rcp_f32 v199, v199
    v_rcp_f32 v200, v200
    v_rcp_f32 v201, v201
    v_rcp_f32 v202, v202
    v_rcp_f32 v203, v203
    buffer_load_dwordx4 v14, s[8:11], s58 offen offset:2048 lds
    v_pk_mul_f32 v[68:69], v[68:69], v[196:197]
    v_pk_mul_f32 v[70:71], v[70:71], v[198:199]
    v_pk_mul_f32 v[72:73], v[72:73], v[200:201]
    v_pk_mul_f32 v[74:75], v[74:75], v[202:203]
    v_pk_mul_f32 v[196:197], v[76:77], v[76:77]
    v_pk_mul_f32 v[198:199], v[78:79], v[78:79]
    v_pk_mul_f32 v[200:201], v[80:81], v[80:81]
    v_pk_mul_f32 v[202:203], v[82:83], v[82:83]
    v_pk_fma_f32 v[196:197], v[196:197], v[54:55], v[52:53]
    v_pk_fma_f32 v[198:199], v[198:199], v[54:55], v[52:53]
    v_pk_fma_f32 v[200:201], v[200:201], v[54:55], v[52:53]
    v_pk_fma_f32 v[202:203], v[202:203], v[54:55], v[52:53]
    v_pk_mul_f32 v[196:197], v[196:197], v[76:77]
    v_pk_mul_f32 v[198:199], v[198:199], v[78:79]
    v_pk_mul_f32 v[200:201], v[200:201], v[80:81]
    v_pk_mul_f32 v[202:203], v[202:203], v[82:83]
    buffer_load_dwordx4 v15, s[8:11], s58 offen offset:3072 lds
    v_exp_f32 v196, v196
    v_exp_f32 v197, v197
    v_exp_f32 v198, v198
    v_exp_f32 v199, v199
    v_exp_f32 v200, v200
    v_exp_f32 v201, v201
    v_exp_f32 v202, v202
    v_exp_f32 v203, v203
    s_add_u32 m0, s56, 114688
    s_add_u32 s58, s54, 2048
    buffer_load_dwordx4 v12, s[8:11], s58 offen lds
    v_pk_add_f32 v[196:197], v[196:197], v[56:57]
    v_pk_add_f32 v[198:199], v[198:199], v[56:57]
    v_pk_add_f32 v[200:201], v[200:201], v[56:57]
    v_pk_add_f32 v[202:203], v[202:203], v[56:57]
    v_rcp_f32 v196, v196
    v_rcp_f32 v197, v197
    v_rcp_f32 v198, v198
    v_rcp_f32 v199, v199
    v_rcp_f32 v200, v200
    v_rcp_f32 v201, v201
    v_rcp_f32 v202, v202
    v_rcp_f32 v203, v203
    v_pk_mul_f32 v[76:77], v[76:77], v[196:197]
    v_pk_mul_f32 v[78:79], v[78:79], v[198:199]
    v_pk_mul_f32 v[80:81], v[80:81], v[200:201]
    v_pk_mul_f32 v[82:83], v[82:83], v[202:203]
    v_pk_mul_f32 v[196:197], v[84:85], v[84:85]
    v_pk_mul_f32 v[198:199], v[86:87], v[86:87]
    v_pk_mul_f32 v[200:201], v[88:89], v[88:89]
    v_pk_mul_f32 v[202:203], v[90:91], v[90:91]
    v_pk_fma_f32 v[196:197], v[196:197], v[54:55], v[52:53]
    v_pk_fma_f32 v[198:199], v[198:199], v[54:55], v[52:53]
    v_pk_fma_f32 v[200:201], v[200:201], v[54:55], v[52:53]
    v_pk_fma_f32 v[202:203], v[202:203], v[54:55], v[52:53]
    v_pk_mul_f32 v[196:197], v[196:197], v[84:85]
    v_pk_mul_f32 v[198:199], v[198:199], v[86:87]
    v_pk_mul_f32 v[200:201], v[200:201], v[88:89]
    v_pk_mul_f32 v[202:203], v[202:203], v[90:91]
    buffer_load_dwordx4 v13, s[8:11], s58 offen offset:1024 lds
    v_exp_f32 v196, v196
    v_exp_f32 v197, v197
    v_exp_f32 v198, v198
    v_exp_f32 v199, v199
    v_exp_f32 v200, v200
    v_exp_f32 v201, v201
    v_exp_f32 v202, v202
    v_exp_f32 v203, v203
    v_pk_add_f32 v[196:197], v[196:197], v[56:57]
    v_pk_add_f32 v[198:199], v[198:199], v[56:57]
    v_pk_add_f32 v[200:201], v[200:201], v[56:57]
    v_pk_add_f32 v[202:203], v[202:203], v[56:57]
    v_rcp_f32 v196, v196
    v_rcp_f32 v197, v197
    v_rcp_f32 v198, v198
    v_rcp_f32 v199, v199
    v_rcp_f32 v200, v200
    v_rcp_f32 v201, v201
    v_rcp_f32 v202, v202
    v_rcp_f32 v203, v203
    buffer_load_dwordx4 v14, s[8:11], s58 offen offset:2048 lds
    v_pk_mul_f32 v[84:85], v[84:85], v[196:197]
    v_pk_mul_f32 v[86:87], v[86:87], v[198:199]
    v_pk_mul_f32 v[88:89], v[88:89], v[200:201]
    v_pk_mul_f32 v[90:91], v[90:91], v[202:203]
    v_pk_mul_f32 v[196:197], v[92:93], v[92:93]
    v_pk_mul_f32 v[198:199], v[94:95], v[94:95]
    v_pk_mul_f32 v[200:201], v[96:97], v[96:97]
    v_pk_mul_f32 v[202:203], v[98:99], v[98:99]
    v_pk_fma_f32 v[196:197], v[196:197], v[54:55], v[52:53]
    v_pk_fma_f32 v[198:199], v[198:199], v[54:55], v[52:53]
    v_pk_fma_f32 v[200:201], v[200:201], v[54:55], v[52:53]
    v_pk_fma_f32 v[202:203], v[202:203], v[54:55], v[52:53]
    v_pk_mul_f32 v[196:197], v[196:197], v[92:93]
    v_pk_mul_f32 v[198:199], v[198:199], v[94:95]
    v_pk_mul_f32 v[200:201], v[200:201], v[96:97]
    v_pk_mul_f32 v[202:203], v[202:203], v[98:99]
    v_exp_f32 v196, v196
    v_exp_f32 v197, v197
    v_exp_f32 v198, v198
    v_exp_f32 v199, v199
    v_exp_f32 v200, v200
    v_exp_f32 v201, v201
    v_exp_f32 v202, v202
    v_exp_f32 v203, v203
    v_pk_add_f32 v[196:197], v[196:197], v[56:57]
    v_pk_add_f32 v[198:199], v[198:199], v[56:57]
    v_pk_add_f32 v[200:201], v[200:201], v[56:57]
    v_pk_add_f32 v[202:203], v[202:203], v[56:57]
    v_rcp_f32 v196, v196
    v_rcp_f32 v197, v197
    v_rcp_f32 v198, v198
    v_rcp_f32 v199, v199
    v_rcp_f32 v200, v200
    v_rcp_f32 v201, v201
    v_rcp_f32 v202, v202
    v_rcp_f32 v203, v203
    buffer_load_dwordx4 v15, s[8:11], s58 offen offset:3072 lds
    v_pk_mul_f32 v[92:93], v[92:93], v[196:197]
    v_pk_mul_f32 v[94:95], v[94:95], v[198:199]
    v_pk_mul_f32 v[96:97], v[96:97], v[200:201]
    v_pk_mul_f32 v[98:99], v[98:99], v[202:203]
    v_pk_add_f32 v[204:205], v[68:69], v[72:73]
    v_pk_mul_f32 v[212:213], v[68:69], v[68:69]
    v_pk_add_f32 v[206:207], v[70:71], v[74:75]
    v_pk_mul_f32 v[214:215], v[70:71], v[70:71]
    v_pk_add_f32 v[208:209], v[84:85], v[88:89]
    v_pk_mul_f32 v[216:217], v[84:85], v[84:85]
    v_pk_add_f32 v[210:211], v[86:87], v[90:91]
    v_pk_mul_f32 v[218:219], v[86:87], v[86:87]
    v_pk_fma_f32 v[212:213], v[72:73], v[72:73], v[212:213]
    v_pk_fma_f32 v[214:215], v[74:75], v[74:75], v[214:215]
    v_pk_fma_f32 v[216:217], v[88:89], v[88:89], v[216:217]
    v_pk_fma_f32 v[218:219], v[90:91], v[90:91], v[218:219]
    v_pk_add_f32 v[204:205], v[204:205], v[76:77]
    v_pk_fma_f32 v[212:213], v[76:77], v[76:77], v[212:213]
    v_pk_add_f32 v[206:207], v[206:207], v[78:79]
    v_pk_fma_f32 v[214:215], v[78:79], v[78:79], v[214:215]
    v_pk_add_f32 v[208:209], v[208:209], v[92:93]
    v_pk_fma_f32 v[216:217], v[92:93], v[92:93], v[216:217]
    v_pk_add_f32 v[210:211], v[210:211], v[94:95]
    v_pk_fma_f32 v[218:219], v[94:95], v[94:95], v[218:219]
    v_pk_add_f32 v[204:205], v[204:205], v[80:81]
    v_pk_fma_f32 v[212:213], v[80:81], v[80:81], v[212:213]
    v_pk_add_f32 v[206:207], v[206:207], v[82:83]
    v_pk_fma_f32 v[214:215], v[82:83], v[82:83], v[214:215]
    v_pk_add_f32 v[208:209], v[208:209], v[96:97]
    v_pk_fma_f32 v[216:217], v[96:97], v[96:97], v[216:217]
    v_pk_add_f32 v[210:211], v[210:211], v[98:99]
    v_pk_fma_f32 v[218:219], v[98:99], v[98:99], v[218:219]
    s_add_u32 m0, s56, 131072
    s_add_u32 s58, s55, 2048
    buffer_load_dwordx4 v12, s[8:11], s58 offen lds
    v_add_f32_dpp v204, v204, v204 row_ror:8 row_mask:0xf bank_mask:0x3
    v_add_f32_dpp v205, v205, v205 row_ror:8 row_mask:0xf bank_mask:0x3
    v_add_f32_dpp v206, v206, v206 row_ror:8 row_mask:0xf bank_mask:0x3
    v_add_f32_dpp v207, v207, v207 row_ror:8 row_mask:0xf bank_mask:0x3
    v_add_f32_dpp v212, v212, v212 row_ror:8 row_mask:0xf bank_mask:0x3
    v_add_f32_dpp v213, v213, v213 row_ror:8 row_mask:0xf bank_mask:0x3
    v_add_f32_dpp v214, v214, v214 row_ror:8 row_mask:0xf bank_mask:0x3
    v_add_f32_dpp v215, v215, v215 row_ror:8 row_mask:0xf bank_mask:0x3
    v_add_f32_dpp v204, v208, v208 row_ror:8 row_mask:0xf bank_mask:0xc
    v_add_f32_dpp v205, v209, v209 row_ror:8 row_mask:0xf bank_mask:0xc
    v_add_f32_dpp v206, v210, v210 row_ror:8 row_mask:0xf bank_mask:0xc
    v_add_f32_dpp v207, v211, v211 row_ror:8 row_mask:0xf bank_mask:0xc
    v_add_f32_dpp v212, v216, v216 row_ror:8 row_mask:0xf bank_mask:0xc
    v_add_f32_dpp v213, v217, v217 row_ror:8 row_mask:0xf bank_mask:0xc
    v_add_f32_dpp v214, v218, v218 row_ror:8 row_mask:0xf bank_mask:0xc
    v_add_f32_dpp v215, v219, v219 row_ror:8 row_mask:0xf bank_mask:0xc
    v_add_f32_dpp v204, v204, v204 row_half_mirror row_mask:0xf bank_mask:0x5
    v_add_f32_dpp v205, v205, v205 row_half_mirror row_mask:0xf bank_mask:0x5
    v_add_f32_dpp v212, v212, v212 row_half_mirror row_mask:0xf bank_mask:0x5
    v_add_f32_dpp v213, v213, v213 row_half_mirror row_mask:0xf bank_mask:0x5
    v_add_f32_dpp v204, v206, v206 row_half_mirror row_mask:0xf bank_mask:0xa
    v_add_f32_dpp v205, v207, v207 row_half_mirror row_mask:0xf bank_mask:0xa
    v_add_f32_dpp v212, v214, v214 row_half_mirror row_mask:0xf bank_mask:0xa
    v_add_f32_dpp v213, v215, v215 row_half_mirror row_mask:0xf bank_mask:0xa
    v_add_f32_dpp v204, v204, v204 quad_perm:[1,0,3,2] row_mask:0xf bank_mask:0xf
    v_add_f32_dpp v205, v205, v205 quad_perm:[1,0,3,2] row_mask:0xf bank_mask:0xf
    v_add_f32_dpp v212, v212, v212 quad_perm:[1,0,3,2] row_mask:0xf bank_mask:0xf
    v_add_f32_dpp v213, v213, v213 quad_perm:[1,0,3,2] row_mask:0xf bank_mask:0xf
    v_add_f32_dpp v204, v204, v204 quad_perm:[2,3,0,1] row_mask:0xf bank_mask:0xf
    v_add_f32_dpp v205, v205, v205 quad_perm:[2,3,0,1] row_mask:0xf bank_mask:0xf
    v_add_f32_dpp v212, v212, v212 quad_perm:[2,3,0,1] row_mask:0xf bank_mask:0xf
    v_add_f32_dpp v213, v213, v213 quad_perm:[2,3,0,1] row_mask:0xf bank_mask:0xf
    v_and_b32 v196, 1, v1
    v_cmp_eq_u32 vcc, 1, v196
    v_lshrrev_b32 v197, 2, v1
    v_lshl_add_u32 v197, v197, 1, v196
    v_lshlrev_b32 v197, 4, v197
    v_cndmask_b32 v64, v204, v205, vcc
    v_cndmask_b32 v65, v212, v213, vcc
    s_mul_i32 s65, s57, 7168
    s_add_u32 s65, s65, 131072
    s_lshl_b32 s59, s46, 9
    s_add_u32 s59, s59, s65
    buffer_store_dwordx4 v[64:67], v197, s[40:43], s59 offen sc1
    s_waitcnt vmcnt(18)
    s_barrier
    ds_read_b64_tr_b16 v[132:133], v24 offset:16384
    ds_read_b64_tr_b16 v[134:135], v24 offset:17408
    ds_read_b64_tr_b16 v[136:137], v25 offset:16384
    ds_read_b64_tr_b16 v[138:139], v25 offset:17408
    ds_read_b64_tr_b16 v[140:141], v26 offset:16384
    ds_read_b64_tr_b16 v[142:143], v26 offset:17408
    ds_read_b64_tr_b16 v[144:145], v27 offset:16384
    ds_read_b64_tr_b16 v[146:147], v27 offset:17408
    s_waitcnt lgkmcnt(6)
    v_mfma_f32_16x16x32_bf16 v[100:103], a[0:3], v[132:135], 0
    ds_read_b64_tr_b16 v[148:149], v24 offset:20480
    buffer_load_dwordx4 v13, s[8:11], s58 offen offset:1024 lds
    v_mfma_f32_16x16x32_bf16 v[116:119], a[4:7], v[132:135], 0
    ds_read_b64_tr_b16 v[150:151], v24 offset:21504
    buffer_load_dwordx4 v14, s[8:11], s58 offen offset:2048 lds
    s_waitcnt lgkmcnt(6)
    v_mfma_f32_16x16x32_bf16 v[104:107], a[0:3], v[136:139], 0
    ds_read_b64_tr_b16 v[152:153], v25 offset:20480
    v_mfma_f32_16x16x32_bf16 v[120:123], a[4:7], v[136:139], 0
    ds_read_b64_tr_b16 v[154:155], v25 offset:21504
    s_waitcnt lgkmcnt(6)
    v_mfma_f32_16x16x32_bf16 v[108:111], a[0:3], v[140:143], 0
    ds_read_b64_tr_b16 v[156:157], v26 offset:20480
    buffer_load_dwordx4 v15, s[8:11], s58 offen offset:3072 lds
    v_mfma_f32_16x16x32_bf16 v[124:127], a[4:7], v[140:143], 0
    ds_read_b64_tr_b16 v[158:159], v26 offset:21504
    s_waitcnt lgkmcnt(6)
    v_mfma_f32_16x16x32_bf16 v[112:115], a[0:3], v[144:147], 0
    ds_read_b64_tr_b16 v[160:161], v27 offset:20480
    v_mfma_f32_16x16x32_bf16 v[128:131], a[4:7], v[144:147], 0
    ds_read_b64_tr_b16 v[162:163], v27 offset:21504
    s_waitcnt lgkmcnt(6)
    v_mfma_f32_16x16x32_bf16 v[100:103], a[8:11], v[148:151], v[100:103]
    ds_read_b64_tr_b16 v[132:133], v24 offset:24576
    v_mfma_f32_16x16x32_bf16 v[116:119], a[12:15], v[148:151], v[116:119]
    ds_read_b64_tr_b16 v[134:135], v24 offset:25600
    s_add_u32 m0, s56, 98304
    s_add_u32 s58, s93, 2048
    buffer_load_dwordx4 v12, s[8:11], s58 offen lds
    s_waitcnt lgkmcnt(6)
    v_mfma_f32_16x16x32_bf16 v[104:107], a[8:11], v[152:155], v[104:107]
    ds_read_b64_tr_b16 v[136:137], v25 offset:24576
    v_mfma_f32_16x16x32_bf16 v[120:123], a[12:15], v[152:155], v[120:123]
    ds_read_b64_tr_b16 v[138:139], v25 offset:25600
    s_waitcnt lgkmcnt(6)
    v_mfma_f32_16x16x32_bf16 v[108:111], a[8:11], v[156:159], v[108:111]
    ds_read_b64_tr_b16 v[140:141], v26 offset:24576
    buffer_load_dwordx4 v13, s[8:11], s58 offen offset:1024 lds
    v_mfma_f32_16x16x32_bf16 v[124:127], a[12:15], v[156:159], v[124:127]
    ds_read_b64_tr_b16 v[142:143], v26 offset:25600
    s_waitcnt lgkmcnt(6)
    v_mfma_f32_16x16x32_bf16 v[112:115], a[8:11], v[160:163], v[112:115]
    ds_read_b64_tr_b16 v[144:145], v27 offset:24576
    v_mfma_f32_16x16x32_bf16 v[128:131], a[12:15], v[160:163], v[128:131]
    ds_read_b64_tr_b16 v[146:147], v27 offset:25600
    buffer_load_dwordx4 v14, s[8:11], s58 offen offset:2048 lds
    s_waitcnt lgkmcnt(6)
    v_mfma_f32_16x16x32_bf16 v[100:103], a[16:19], v[132:135], v[100:103]
    ds_read_b64_tr_b16 v[148:149], v24 offset:28672
    v_mfma_f32_16x16x32_bf16 v[116:119], a[20:23], v[132:135], v[116:119]
    ds_read_b64_tr_b16 v[150:151], v24 offset:29696
    s_waitcnt lgkmcnt(6)
    v_mfma_f32_16x16x32_bf16 v[104:107], a[16:19], v[136:139], v[104:107]
    ds_read_b64_tr_b16 v[152:153], v25 offset:28672
    buffer_load_dwordx4 v15, s[8:11], s58 offen offset:3072 lds
    v_mfma_f32_16x16x32_bf16 v[120:123], a[20:23], v[136:139], v[120:123]
    ds_read_b64_tr_b16 v[154:155], v25 offset:29696
    s_waitcnt lgkmcnt(6)
    v_mfma_f32_16x16x32_bf16 v[108:111], a[16:19], v[140:143], v[108:111]
    ds_read_b64_tr_b16 v[156:157], v26 offset:28672
    v_mfma_f32_16x16x32_bf16 v[124:127], a[20:23], v[140:143], v[124:127]
    ds_read_b64_tr_b16 v[158:159], v26 offset:29696
    s_waitcnt lgkmcnt(6)
    v_mfma_f32_16x16x32_bf16 v[112:115], a[16:19], v[144:147], v[112:115]
    ds_read_b64_tr_b16 v[160:161], v27 offset:28672
    s_add_u32 m0, s56, 0
    s_add_u32 s58, s95, 2048
    buffer_load_dwordx4 v12, s[8:11], s58 offen lds
    v_mfma_f32_16x16x32_bf16 v[128:131], a[20:23], v[144:147], v[128:131]
    ds_read_b64_tr_b16 v[162:163], v27 offset:29696
    s_waitcnt lgkmcnt(6)
    v_mfma_f32_16x16x32_bf16 v[100:103], a[24:27], v[148:151], v[100:103]
    v_mfma_f32_16x16x32_bf16 v[116:119], a[28:31], v[148:151], v[116:119]
    buffer_load_dwordx4 v13, s[8:11], s58 offen offset:1024 lds
    s_waitcnt lgkmcnt(4)
    v_mfma_f32_16x16x32_bf16 v[104:107], a[24:27], v[152:155], v[104:107]
    v_mfma_f32_16x16x32_bf16 v[120:123], a[28:31], v[152:155], v[120:123]
    s_waitcnt vmcnt(23) lgkmcnt(0)
    s_barrier
    v_mfma_f32_16x16x32_bf16 v[108:111], a[24:27], v[156:159], v[108:111]
    ds_read_b64_tr_b16 v[132:133], v28 offset:0
    ds_read_b64_tr_b16 v[134:135], v28 offset:1024
    buffer_load_dwordx4 v14, s[8:11], s58 offen offset:2048 lds
    v_mfma_f32_16x16x32_bf16 v[124:127], a[28:31], v[156:159], v[124:127]
    ds_read_b64_tr_b16 v[136:137], v29 offset:0
    ds_read_b64_tr_b16 v[138:139], v29 offset:1024
    v_mfma_f32_16x16x32_bf16 v[112:115], a[24:27], v[160:163], v[112:115]
    ds_read_b64_tr_b16 v[140:141], v30 offset:0
    ds_read_b64_tr_b16 v[142:143], v30 offset:1024
    v_mfma_f32_16x16x32_bf16 v[128:131], a[28:31], v[160:163], v[128:131]
    ds_read_b64_tr_b16 v[144:145], v31 offset:0
    ds_read_b64_tr_b16 v[146:147], v31 offset:1024
    buffer_load_dwordx4 v15, s[8:11], s58 offen offset:3072 lds
    s_waitcnt lgkmcnt(6)
    v_mfma_f32_16x16x32_bf16 v[100:103], a[32:35], v[132:135], v[100:103]
    ds_read_b64_tr_b16 v[148:149], v28 offset:4096
    v_mfma_f32_16x16x32_bf16 v[116:119], a[36:39], v[132:135], v[116:119]
    ds_read_b64_tr_b16 v[150:151], v28 offset:5120
    s_waitcnt lgkmcnt(6)
    v_mfma_f32_16x16x32_bf16 v[104:107], a[32:35], v[136:139], v[104:107]
    ds_read_b64_tr_b16 v[152:153], v29 offset:4096
    s_add_u32 m0, s56, 32768
    s_add_u32 s94, s94, 512
    s_and_b32 s94, s94, 0x40eff
    buffer_load_dwordx4 v16, s[20:23], s94 offen lds
    v_mfma_f32_16x16x32_bf16 v[120:123], a[36:39], v[136:139], v[120:123]
    ds_read_b64_tr_b16 v[154:155], v29 offset:5120
    s_waitcnt lgkmcnt(6)
    v_mfma_f32_16x16x32_bf16 v[108:111], a[32:35], v[140:143], v[108:111]
    ds_read_b64_tr_b16 v[156:157], v30 offset:4096
    v_mfma_f32_16x16x32_bf16 v[124:127], a[36:39], v[140:143], v[124:127]
    ds_read_b64_tr_b16 v[158:159], v30 offset:5120
    s_waitcnt lgkmcnt(6)
    v_mfma_f32_16x16x32_bf16 v[112:115], a[32:35], v[144:147], v[112:115]
    ds_read_b64_tr_b16 v[160:161], v31 offset:4096
    v_mfma_f32_16x16x32_bf16 v[128:131], a[36:39], v[144:147], v[128:131]
    ds_read_b64_tr_b16 v[162:163], v31 offset:5120
    v_and_b32 v248, 7, v2
    v_lshl_add_u32 v248, v3, 3, v248
    v_lshlrev_b32 v248, 4, v248
    v_lshrrev_b32 v249, 3, v2
    v_lshl_add_u32 v248, v249, 9, v248
    v_add_u32 v249, 4096, v248
    buffer_load_dwordx4 v[220:223], v248, s[40:43], s65 offen sc1
    buffer_load_dwordx4 v[224:227], v248, s[40:43], s65 offen offset:1024 sc1
    buffer_load_dwordx4 v[228:231], v248, s[40:43], s65 offen offset:2048 sc1
    buffer_load_dwordx4 v[232:235], v248, s[40:43], s65 offen offset:3072 sc1
    buffer_load_dwordx4 v[236:239], v249, s[40:43], s65 offen sc1
    buffer_load_dwordx4 v[240:243], v249, s[40:43], s65 offen offset:1024 sc1
    buffer_load_dwordx4 v[244:247], v249, s[40:43], s65 offen offset:2048 sc1
    s_waitcnt lgkmcnt(6)
    v_mfma_f32_16x16x32_bf16 v[100:103], a[40:43], v[148:151], v[100:103]
    ds_read_b64_tr_b16 v[132:133], v28 offset:8192
    v_mfma_f32_16x16x32_bf16 v[116:119], a[44:47], v[148:151], v[116:119]
    ds_read_b64_tr_b16 v[134:135], v28 offset:9216
    s_waitcnt lgkmcnt(6)
    v_mfma_f32_16x16x32_bf16 v[104:107], a[40:43], v[152:155], v[104:107]
    ds_read_b64_tr_b16 v[136:137], v29 offset:8192
    v_mfma_f32_16x16x32_bf16 v[120:123], a[44:47], v[152:155], v[120:123]
    ds_read_b64_tr_b16 v[138:139], v29 offset:9216
    s_waitcnt lgkmcnt(6)
    v_mfma_f32_16x16x32_bf16 v[108:111], a[40:43], v[156:159], v[108:111]
    ds_read_b64_tr_b16 v[140:141], v30 offset:8192
    v_mfma_f32_16x16x32_bf16 v[124:127], a[44:47], v[156:159], v[124:127]
    ds_read_b64_tr_b16 v[142:143], v30 offset:9216
    s_waitcnt lgkmcnt(6)
    v_mfma_f32_16x16x32_bf16 v[112:115], a[40:43], v[160:163], v[112:115]
    ds_read_b64_tr_b16 v[144:145], v31 offset:8192
    v_mfma_f32_16x16x32_bf16 v[128:131], a[44:47], v[160:163], v[128:131]
    ds_read_b64_tr_b16 v[146:147], v31 offset:9216
    s_waitcnt lgkmcnt(6)
    v_mfma_f32_16x16x32_bf16 v[100:103], a[48:51], v[132:135], v[100:103]
    ds_read_b64_tr_b16 v[148:149], v28 offset:12288
    v_mfma_f32_16x16x32_bf16 v[116:119], a[52:55], v[132:135], v[116:119]
    ds_read_b64_tr_b16 v[150:151], v28 offset:13312
    s_waitcnt lgkmcnt(6)
    v_mfma_f32_16x16x32_bf16 v[104:107], a[48:51], v[136:139], v[104:107]
    ds_read_b64_tr_b16 v[152:153], v29 offset:12288
    v_mfma_f32_16x16x32_bf16 v[120:123], a[52:55], v[136:139], v[120:123]
    ds_read_b64_tr_b16 v[154:155], v29 offset:13312
    s_waitcnt lgkmcnt(6)
    v_mfma_f32_16x16x32_bf16 v[108:111], a[48:51], v[140:143], v[108:111]
    ds_read_b64_tr_b16 v[156:157], v30 offset:12288
    v_mfma_f32_16x16x32_bf16 v[124:127], a[52:55], v[140:143], v[124:127]
    ds_read_b64_tr_b16 v[158:159], v30 offset:13312
    s_waitcnt lgkmcnt(6)
    v_mfma_f32_16x16x32_bf16 v[112:115], a[48:51], v[144:147], v[112:115]
    ds_read_b64_tr_b16 v[160:161], v31 offset:12288
    v_mfma_f32_16x16x32_bf16 v[128:131], a[52:55], v[144:147], v[128:131]
    ds_read_b64_tr_b16 v[162:163], v31 offset:13312
    s_waitcnt lgkmcnt(6)
    v_mfma_f32_16x16x32_bf16 v[100:103], a[56:59], v[148:151], v[100:103]
    v_mfma_f32_16x16x32_bf16 v[116:119], a[60:63], v[148:151], v[116:119]
    buffer_load_dwordx4 v17, s[20:23], s94 offen offset:1024 lds
    s_waitcnt lgkmcnt(4)
    v_mfma_f32_16x16x32_bf16 v[104:107], a[56:59], v[152:155], v[104:107]
    v_mfma_f32_16x16x32_bf16 v[120:123], a[60:63], v[152:155], v[120:123]
    s_waitcnt vmcnt(30) lgkmcnt(0)
    s_barrier
    v_mfma_f32_16x16x32_bf16 v[108:111], a[56:59], v[156:159], v[108:111]
    ds_read_b64_tr_b16 v[132:133], v28 offset:16384
    ds_read_b64_tr_b16 v[134:135], v28 offset:17408
    v_mfma_f32_16x16x32_bf16 v[124:127], a[60:63], v[156:159], v[124:127]
    ds_read_b64_tr_b16 v[136:137], v29 offset:16384
    ds_read_b64_tr_b16 v[138:139], v29 offset:17408
    v_mfma_f32_16x16x32_bf16 v[112:115], a[56:59], v[160:163], v[112:115]
    ds_read_b64_tr_b16 v[140:141], v30 offset:16384
    ds_read_b64_tr_b16 v[142:143], v30 offset:17408
    v_mfma_f32_16x16x32_bf16 v[128:131], a[60:63], v[160:163], v[128:131]
    ds_read_b64_tr_b16 v[144:145], v31 offset:16384
    ds_read_b64_tr_b16 v[146:147], v31 offset:17408
    s_waitcnt lgkmcnt(6)
    v_mfma_f32_16x16x32_bf16 v[100:103], a[64:67], v[132:135], v[100:103]
    ds_read_b64_tr_b16 v[148:149], v28 offset:20480
    v_mfma_f32_16x16x32_bf16 v[116:119], a[68:71], v[132:135], v[116:119]
    ds_read_b64_tr_b16 v[150:151], v28 offset:21504
    s_waitcnt lgkmcnt(6)
    v_mfma_f32_16x16x32_bf16 v[104:107], a[64:67], v[136:139], v[104:107]
    ds_read_b64_tr_b16 v[152:153], v29 offset:20480
    v_mfma_f32_16x16x32_bf16 v[120:123], a[68:71], v[136:139], v[120:123]
    ds_read_b64_tr_b16 v[154:155], v29 offset:21504
    buffer_load_dwordx4 v18, s[20:23], s94 offen offset:2048 lds
    s_waitcnt lgkmcnt(6)
    v_mfma_f32_16x16x32_bf16 v[108:111], a[64:67], v[140:143], v[108:111]
    ds_read_b64_tr_b16 v[156:157], v30 offset:20480
    v_mfma_f32_16x16x32_bf16 v[124:127], a[68:71], v[140:143], v[124:127]
    ds_read_b64_tr_b16 v[158:159], v30 offset:21504
    s_waitcnt lgkmcnt(6)
    v_mfma_f32_16x16x32_bf16 v[112:115], a[64:67], v[144:147], v[112:115]
    ds_read_b64_tr_b16 v[160:161], v31 offset:20480
    v_mfma_f32_16x16x32_bf16 v[128:131], a[68:71], v[144:147], v[128:131]
    ds_read_b64_tr_b16 v[162:163], v31 offset:21504
    s_waitcnt lgkmcnt(6)
    v_mfma_f32_16x16x32_bf16 v[100:103], a[72:75], v[148:151], v[100:103]
    ds_read_b64_tr_b16 v[132:133], v28 offset:24576
    v_mfma_f32_16x16x32_bf16 v[116:119], a[76:79], v[148:151], v[116:119]
    ds_read_b64_tr_b16 v[134:135], v28 offset:25600
    s_waitcnt lgkmcnt(6)
    v_mfma_f32_16x16x32_bf16 v[104:107], a[72:75], v[152:155], v[104:107]
    ds_read_b64_tr_b16 v[136:137], v29 offset:24576
    v_mfma_f32_16x16x32_bf16 v[120:123], a[76:79], v[152:155], v[120:123]
    ds_read_b64_tr_b16 v[138:139], v29 offset:25600
    s_waitcnt lgkmcnt(6)
    v_mfma_f32_16x16x32_bf16 v[108:111], a[72:75], v[156:159], v[108:111]
    ds_read_b64_tr_b16 v[140:141], v30 offset:24576
    v_mfma_f32_16x16x32_bf16 v[124:127], a[76:79], v[156:159], v[124:127]
    ds_read_b64_tr_b16 v[142:143], v30 offset:25600
    s_waitcnt lgkmcnt(6)
    v_mfma_f32_16x16x32_bf16 v[112:115], a[72:75], v[160:163], v[112:115]
    ds_read_b64_tr_b16 v[144:145], v31 offset:24576
    buffer_load_dwordx4 v19, s[20:23], s94 offen offset:3072 lds
    v_mfma_f32_16x16x32_bf16 v[128:131], a[76:79], v[160:163], v[128:131]
    ds_read_b64_tr_b16 v[146:147], v31 offset:25600
    s_waitcnt vmcnt(3)
L_chk_250:
    v_xor_b32 v62, s50, v222
    v_xor_b32 v63, s51, v223
    v_bitop3_b32 v62, v226, s50, v62 bitop3:0xbe
    v_bitop3_b32 v63, v227, s51, v63 bitop3:0xbe
    v_bitop3_b32 v62, v230, s50, v62 bitop3:0xbe
    v_bitop3_b32 v63, v231, s51, v63 bitop3:0xbe
    v_bitop3_b32 v62, v234, s50, v62 bitop3:0xbe
    v_bitop3_b32 v63, v235, s51, v63 bitop3:0xbe
    v_bitop3_b32 v62, v238, s50, v62 bitop3:0xbe
    v_bitop3_b32 v63, v239, s51, v63 bitop3:0xbe
    v_bitop3_b32 v62, v242, s50, v62 bitop3:0xbe
    v_bitop3_b32 v63, v243, s51, v63 bitop3:0xbe
    v_bitop3_b32 v62, v246, s50, v62 bitop3:0xbe
    v_bitop3_b32 v63, v247, s51, v63 bitop3:0xbe
    v_or_b32 v62, v62, v63
    v_cmp_ne_u32 vcc, 0, v62
    s_nop 0
    s_cbranch_vccnz L_retry_251
L_cont_252:
    v_pk_add_f32 v[220:221], v[220:221], v[224:225]
    v_pk_add_f32 v[228:229], v[228:229], v[232:233]
    v_pk_add_f32 v[236:237], v[236:237], v[240:241]
    v_pk_add_f32 v[220:221], v[220:221], v[228:229]
    v_pk_add_f32 v[236:237], v[236:237], v[244:245]
    v_pk_add_f32 v[220:221], v[220:221], v[236:237]
    s_nop 1
    v_add_f32_dpp v220, v220, v220 row_ror:8 row_mask:0xf bank_mask:0xf
    v_add_f32_dpp v221, v221, v221 row_ror:8 row_mask:0xf bank_mask:0xf
    v_mul_f32 v224, 0x3a924925, v220
    v_mul_f32 v225, 0x3a924925, v221
    v_fma_f32 v225, -v224, v224, v225
    v_max_f32 v225, 0, v225
    v_add_f32 v225, 0x3727c5ac, v225
    v_rsq_f32 v226, v225
    s_nop 0
    v_mul_f32_e64 v227, -v224, v226
    v_mov_b32_dpp v196, v226 row_newbcast:0 row_mask:0xf bank_mask:0xf
    v_mov_b32_dpp v197, v226 row_newbcast:1 row_mask:0xf bank_mask:0xf
    v_mov_b32_dpp v198, v226 row_newbcast:2 row_mask:0xf bank_mask:0xf
    v_mov_b32_dpp v199, v226 row_newbcast:3 row_mask:0xf bank_mask:0xf
    v_mov_b32_dpp v200, v226 row_newbcast:4 row_mask:0xf bank_mask:0xf
    v_mov_b32_dpp v201, v226 row_newbcast:5 row_mask:0xf bank_mask:0xf
    v_mov_b32_dpp v202, v226 row_newbcast:6 row_mask:0xf bank_mask:0xf
    v_mov_b32_dpp v203, v226 row_newbcast:7 row_mask:0xf bank_mask:0xf
    v_mov_b32_dpp v204, v227 row_newbcast:0 row_mask:0xf bank_mask:0xf
    v_mov_b32_dpp v205, v227 row_newbcast:1 row_mask:0xf bank_mask:0xf
    v_mov_b32_dpp v206, v227 row_newbcast:2 row_mask:0xf bank_mask:0xf
    v_mov_b32_dpp v207, v227 row_newbcast:3 row_mask:0xf bank_mask:0xf
    v_mov_b32_dpp v208, v227 row_newbcast:4 row_mask:0xf bank_mask:0xf
    v_mov_b32_dpp v209, v227 row_newbcast:5 row_mask:0xf bank_mask:0xf
    v_mov_b32_dpp v210, v227 row_newbcast:6 row_mask:0xf bank_mask:0xf
    v_mov_b32_dpp v211, v227 row_newbcast:7 row_mask:0xf bank_mask:0xf
    v_pk_fma_f32 v[68:69], v[68:69], v[196:197], v[204:205]
    v_pk_fma_f32 v[70:71], v[70:71], v[198:199], v[206:207]
    v_pk_fma_f32 v[84:85], v[84:85], v[200:201], v[208:209]
    v_pk_fma_f32 v[86:87], v[86:87], v[202:203], v[210:211]
    v_pk_fma_f32 v[72:73], v[72:73], v[196:197], v[204:205]
    v_pk_fma_f32 v[74:75], v[74:75], v[198:199], v[206:207]
    v_pk_fma_f32 v[88:89], v[88:89], v[200:201], v[208:209]
    v_pk_fma_f32 v[90:91], v[90:91], v[202:203], v[210:211]
    v_pk_fma_f32 v[76:77], v[76:77], v[196:197], v[204:205]
    v_pk_fma_f32 v[78:79], v[78:79], v[198:199], v[206:207]
    v_pk_fma_f32 v[92:93], v[92:93], v[200:201], v[208:209]
    v_pk_fma_f32 v[94:95], v[94:95], v[202:203], v[210:211]
    v_pk_fma_f32 v[80:81], v[80:81], v[196:197], v[204:205]
    v_pk_fma_f32 v[82:83], v[82:83], v[198:199], v[206:207]
    v_pk_fma_f32 v[96:97], v[96:97], v[200:201], v[208:209]
    v_pk_fma_f32 v[98:99], v[98:99], v[202:203], v[210:211]
    v_cvt_pk_bf16_f32 v228, v68, v69
    v_cvt_pk_bf16_f32 v229, v70, v71
    v_cvt_pk_bf16_f32 v230, v84, v85
    v_cvt_pk_bf16_f32 v231, v86, v87
    v_cvt_pk_bf16_f32 v232, v72, v73
    v_cvt_pk_bf16_f32 v233, v74, v75
    v_cvt_pk_bf16_f32 v234, v88, v89
    v_cvt_pk_bf16_f32 v235, v90, v91
    v_cvt_pk_bf16_f32 v236, v76, v77
    v_cvt_pk_bf16_f32 v237, v78, v79
    v_cvt_pk_bf16_f32 v238, v92, v93
    v_cvt_pk_bf16_f32 v239, v94, v95
    v_cvt_pk_bf16_f32 v240, v80, v81
    v_cvt_pk_bf16_f32 v241, v82, v83
    v_cvt_pk_bf16_f32 v242, v96, v97
    v_cvt_pk_bf16_f32 v243, v98, v99
    s_lshr_b32 s61, s45, 1
    s_lshl_b32 s61, s61, 0
    s_and_b32 s60, s45, 0
    s_add_u32 s60, s60, s61
    s_bfe_u32 s61, s45, 0x10000
    s_lshl_b32 s61, s61, 3
    s_add_u32 s60, s60, s61
    s_lshr_b32 s59, s60, 3
    s_and_b32 s60, s60, 7
    s_lshl_b32 s60, s60, 2
    s_add_u32 s60, s60, s44
    s_lshl_b32 s60, s60, 11
    s_mul_i32 s59, s59, 14
    s_add_u32 s59, s59, s46
    s_mul_i32 s59, s59, 131072
    s_add_u32 s59, s59, s60
    s_add_u32 s59, s59, 1048576
    s_add_u32 s60, s59, 65536
    buffer_store_dwordx4 v[228:231], v37, s[40:43], s59 offen sc1
    buffer_store_dwordx4 v[232:235], v37, s[40:43], s59 offen offset:128 sc1
    buffer_store_dwordx4 v[236:239], v37, s[40:43], s60 offen sc1
    buffer_store_dwordx4 v[240:243], v37, s[40:43], s60 offen offset:128 sc1
    s_waitcnt lgkmcnt(6)
    v_mfma_f32_16x16x32_bf16 v[100:103], a[80:83], v[132:135], v[100:103]
    ds_read_b64_tr_b16 v[148:149], v28 offset:28672
    v_mfma_f32_16x16x32_bf16 v[116:119], a[84:87], v[132:135], v[116:119]
    ds_read_b64_tr_b16 v[150:151], v28 offset:29696
H_A_2:
    s_cbranch_execz H_M_2
    s_waitcnt lgkmcnt(6)
    v_mfma_f32_16x16x32_bf16 v[104:107], a[80:83], v[136:139], v[104:107]
    ds_read_b64_tr_b16 v[152:153], v29 offset:28672
    v_mfma_f32_16x16x32_bf16 v[120:123], a[84:87], v[136:139], v[120:123]
    ds_read_b64_tr_b16 v[154:155], v29 offset:29696
    s_waitcnt lgkmcnt(6)
    v_mfma_f32_16x16x32_bf16 v[108:111], a[80:83], v[140:143], v[108:111]
    ds_read_b64_tr_b16 v[156:157], v30 offset:28672
    v_mfma_f32_16x16x32_bf16 v[124:127], a[84:87], v[140:143], v[124:127]
    ds_read_b64_tr_b16 v[158:159], v30 offset:29696
    s_waitcnt lgkmcnt(6)
    v_mfma_f32_16x16x32_bf16 v[112:115], a[80:83], v[144:147], v[112:115]
    ds_read_b64_tr_b16 v[160:161], v31 offset:28672
    v_mfma_f32_16x16x32_bf16 v[128:131], a[84:87], v[144:147], v[128:131]
    ds_read_b64_tr_b16 v[162:163], v31 offset:29696
    s_waitcnt lgkmcnt(6)
    v_mfma_f32_16x16x32_bf16 v[100:103], a[88:91], v[148:151], v[100:103]
    v_mfma_f32_16x16x32_bf16 v[116:119], a[92:95], v[148:151], v[116:119]
    s_waitcnt lgkmcnt(4)
    v_mfma_f32_16x16x32_bf16 v[104:107], a[88:91], v[152:155], v[104:107]
    v_mfma_f32_16x16x32_bf16 v[120:123], a[92:95], v[152:155], v[120:123]
    s_waitcnt lgkmcnt(0)
    s_barrier
    v_mfma_f32_16x16x32_bf16 v[108:111], a[88:91], v[156:159], v[108:111]
    ds_read_b64_tr_b16 v[132:133], v24 offset:49152
    ds_read_b64_tr_b16 v[134:135], v24 offset:50176
    v_mfma_f32_16x16x32_bf16 v[124:127], a[92:95], v[156:159], v[124:127]
    ds_read_b64_tr_b16 v[136:137], v25 offset:49152
    ds_read_b64_tr_b16 v[138:139], v25 offset:50176
    v_mfma_f32_16x16x32_bf16 v[112:115], a[88:91], v[160:163], v[112:115]
    ds_read_b64_tr_b16 v[140:141], v26 offset:49152
    ds_read_b64_tr_b16 v[142:143], v26 offset:50176
    v_mfma_f32_16x16x32_bf16 v[128:131], a[92:95], v[160:163], v[128:131]
    ds_read_b64_tr_b16 v[144:145], v27 offset:49152
    ds_read_b64_tr_b16 v[146:147], v27 offset:50176
    s_waitcnt lgkmcnt(6)
    v_mfma_f32_16x16x32_bf16 v[100:103], a[96:99], v[132:135], v[100:103]
    ds_read_b64_tr_b16 v[148:149], v24 offset:53248
    v_mfma_f32_16x16x32_bf16 v[116:119], a[100:103], v[132:135], v[116:119]
    ds_read_b64_tr_b16 v[150:151], v24 offset:54272
    s_waitcnt lgkmcnt(6)
    v_mfma_f32_16x16x32_bf16 v[104:107], a[96:99], v[136:139], v[104:107]
    ds_read_b64_tr_b16 v[152:153], v25 offset:53248
    v_mfma_f32_16x16x32_bf16 v[120:123], a[100:103], v[136:139], v[120:123]
    ds_read_b64_tr_b16 v[154:155], v25 offset:54272
    s_waitcnt lgkmcnt(6)
    v_mfma_f32_16x16x32_bf16 v[108:111], a[96:99], v[140:143], v[108:111]
    ds_read_b64_tr_b16 v[156:157], v26 offset:53248
    v_mfma_f32_16x16x32_bf16 v[124:127], a[100:103], v[140:143], v[124:127]
    ds_read_b64_tr_b16 v[158:159], v26 offset:54272
    s_waitcnt lgkmcnt(6)
    v_mfma_f32_16x16x32_bf16 v[112:115], a[96:99], v[144:147], v[112:115]
    ds_read_b64_tr_b16 v[160:161], v27 offset:53248
    v_mfma_f32_16x16x32_bf16 v[128:131], a[100:103], v[144:147], v[128:131]
    ds_read_b64_tr_b16 v[162:163], v27 offset:54272
    s_waitcnt lgkmcnt(6)
    v_mfma_f32_16x16x32_bf16 v[100:103], a[104:107], v[148:151], v[100:103]
    ds_read_b64_tr_b16 v[132:133], v24 offset:57344
    v_mfma_f32_16x16x32_bf16 v[116:119], a[108:111], v[148:151], v[116:119]
    ds_read_b64_tr_b16 v[134:135], v24 offset:58368
    s_waitcnt lgkmcnt(6)
    v_mfma_f32_16x16x32_bf16 v[104:107], a[104:107], v[152:155], v[104:107]
    ds_read_b64_tr_b16 v[136:137], v25 offset:57344
    v_mfma_f32_16x16x32_bf16 v[120:123], a[108:111], v[152:155], v[120:123]
    ds_read_b64_tr_b16 v[138:139], v25 offset:58368
    s_waitcnt lgkmcnt(6)
    v_mfma_f32_16x16x32_bf16 v[108:111], a[104:107], v[156:159], v[108:111]
    ds_read_b64_tr_b16 v[140:141], v26 offset:57344
    v_mfma_f32_16x16x32_bf16 v[124:127], a[108:111], v[156:159], v[124:127]
    ds_read_b64_tr_b16 v[142:143], v26 offset:58368
    s_waitcnt lgkmcnt(6)
    v_mfma_f32_16x16x32_bf16 v[112:115], a[104:107], v[160:163], v[112:115]
    ds_read_b64_tr_b16 v[144:145], v27 offset:57344
    v_mfma_f32_16x16x32_bf16 v[128:131], a[108:111], v[160:163], v[128:131]
    ds_read_b64_tr_b16 v[146:147], v27 offset:58368
    s_waitcnt lgkmcnt(6)
    v_mfma_f32_16x16x32_bf16 v[100:103], a[112:115], v[132:135], v[100:103]
    ds_read_b64_tr_b16 v[148:149], v24 offset:61440
    v_mfma_f32_16x16x32_bf16 v[116:119], a[116:119], v[132:135], v[116:119]
    ds_read_b64_tr_b16 v[150:151], v24 offset:62464
    s_waitcnt lgkmcnt(6)
    v_mfma_f32_16x16x32_bf16 v[104:107], a[112:115], v[136:139], v[104:107]
    ds_read_b64_tr_b16 v[152:153], v25 offset:61440
    v_mfma_f32_16x16x32_bf16 v[120:123], a[116:119], v[136:139], v[120:123]
    ds_read_b64_tr_b16 v[154:155], v25 offset:62464
    s_waitcnt lgkmcnt(6)
    v_mfma_f32_16x16x32_bf16 v[108:111], a[112:115], v[140:143], v[108:111]
    ds_read_b64_tr_b16 v[156:157], v26 offset:61440
    v_mfma_f32_16x16x32_bf16 v[124:127], a[116:119], v[140:143], v[124:127]
    ds_read_b64_tr_b16 v[158:159], v26 offset:62464
    s_waitcnt lgkmcnt(6)
    v_mfma_f32_16x16x32_bf16 v[112:115], a[112:115], v[144:147], v[112:115]
    ds_read_b64_tr_b16 v[160:161], v27 offset:61440
    v_mfma_f32_16x16x32_bf16 v[128:131], a[116:119], v[144:147], v[128:131]
    ds_read_b64_tr_b16 v[162:163], v27 offset:62464
    s_waitcnt lgkmcnt(6)
    v_mfma_f32_16x16x32_bf16 v[100:103], a[120:123], v[148:151], v[100:103]
    v_mfma_f32_16x16x32_bf16 v[116:119], a[124:127], v[148:151], v[116:119]
    s_waitcnt lgkmcnt(4)
    v_mfma_f32_16x16x32_bf16 v[104:107], a[120:123], v[152:155], v[104:107]
    v_mfma_f32_16x16x32_bf16 v[120:123], a[124:127], v[152:155], v[120:123]
    s_add_u32 m0, s56, 147456
    s_add_u32 s94, s94, 512
    s_and_b32 s94, s94, 0x40eff
    buffer_load_dwordx4 v16, s[20:23], s94 offen lds
    s_waitcnt lgkmcnt(0)
    s_barrier
    v_mfma_f32_16x16x32_bf16 v[108:111], a[120:123], v[156:159], v[108:111]
    v_mfma_f32_16x16x32_bf16 v[124:127], a[124:127], v[156:159], v[124:127]
    v_mfma_f32_16x16x32_bf16 v[112:115], a[120:123], v[160:163], v[112:115]
    v_mfma_f32_16x16x32_bf16 v[128:131], a[124:127], v[160:163], v[128:131]
    ds_read_b64_tr_b16 v[132:133], v28 offset:49152
    ds_read_b64_tr_b16 v[134:135], v28 offset:50176
    ds_read_b64_tr_b16 v[136:137], v29 offset:49152
    ds_read_b64_tr_b16 v[138:139], v29 offset:50176
    ds_read_b64_tr_b16 v[140:141], v30 offset:49152
    ds_read_b64_tr_b16 v[142:143], v30 offset:50176
    ds_read_b64_tr_b16 v[144:145], v31 offset:49152
    ds_read_b64_tr_b16 v[146:147], v31 offset:50176
    s_waitcnt lgkmcnt(6)
    v_mfma_f32_16x16x32_bf16 v[164:167], a[0:3], v[132:135], 0
    ds_read_b64_tr_b16 v[148:149], v28 offset:53248
    v_mfma_f32_16x16x32_bf16 v[180:183], a[4:7], v[132:135], 0
    ds_read_b64_tr_b16 v[150:151], v28 offset:54272
    s_waitcnt lgkmcnt(6)
    v_mfma_f32_16x16x32_bf16 v[168:171], a[0:3], v[136:139], 0
    ds_read_b64_tr_b16 v[152:153], v29 offset:53248
    buffer_load_dwordx4 v17, s[20:23], s94 offen offset:1024 lds
    v_mfma_f32_16x16x32_bf16 v[184:187], a[4:7], v[136:139], 0
    ds_read_b64_tr_b16 v[154:155], v29 offset:54272
    s_waitcnt lgkmcnt(6)
    v_mfma_f32_16x16x32_bf16 v[172:175], a[0:3], v[140:143], 0
    ds_read_b64_tr_b16 v[156:157], v30 offset:53248
    v_mfma_f32_16x16x32_bf16 v[188:191], a[4:7], v[140:143], 0
    ds_read_b64_tr_b16 v[158:159], v30 offset:54272
    s_waitcnt lgkmcnt(6)
    v_mfma_f32_16x16x32_bf16 v[176:179], a[0:3], v[144:147], 0
    ds_read_b64_tr_b16 v[160:161], v31 offset:53248
    v_mfma_f32_16x16x32_bf16 v[192:195], a[4:7], v[144:147], 0
    ds_read_b64_tr_b16 v[162:163], v31 offset:54272
    s_lshl_b32 s59, s47, 9
    s_add_u32 s59, s59, 98304
    v_and_b32 v46, 0x1ff, v51
    v_add_u32 v46, s59, v46
    buffer_load_dwordx2 v[44:45], v46, s[40:43], 0 offen sc1
    s_waitcnt lgkmcnt(6)
    v_mfma_f32_16x16x32_bf16 v[164:167], a[8:11], v[148:151], v[164:167]
    ds_read_b64_tr_b16 v[132:133], v28 offset:57344
    v_mfma_f32_16x16x32_bf16 v[180:183], a[12:15], v[148:151], v[180:183]
    ds_read_b64_tr_b16 v[134:135], v28 offset:58368
    s_waitcnt lgkmcnt(6)
    v_mfma_f32_16x16x32_bf16 v[168:171], a[8:11], v[152:155], v[168:171]
    ds_read_b64_tr_b16 v[136:137], v29 offset:57344
    v_mfma_f32_16x16x32_bf16 v[184:187], a[12:15], v[152:155], v[184:187]
    ds_read_b64_tr_b16 v[138:139], v29 offset:58368
    s_waitcnt lgkmcnt(6)
    v_mfma_f32_16x16x32_bf16 v[172:175], a[8:11], v[156:159], v[172:175]
    ds_read_b64_tr_b16 v[140:141], v30 offset:57344
    v_mfma_f32_16x16x32_bf16 v[188:191], a[12:15], v[156:159], v[188:191]
    ds_read_b64_tr_b16 v[142:143], v30 offset:58368
    buffer_load_dwordx4 v18, s[20:23], s94 offen offset:2048 lds
    s_waitcnt lgkmcnt(6)
    v_mfma_f32_16x16x32_bf16 v[176:179], a[8:11], v[160:163], v[176:179]
    ds_read_b64_tr_b16 v[144:145], v31 offset:57344
    v_mfma_f32_16x16x32_bf16 v[192:195], a[12:15], v[160:163], v[192:195]
    ds_read_b64_tr_b16 v[146:147], v31 offset:58368
    s_lshr_b32 s61, s45, 1
    s_lshl_b32 s61, s61, 0
    s_and_b32 s60, s45, 0
    s_add_u32 s60, s60, s61
    s_bfe_u32 s61, s45, 0x10000
    s_lshl_b32 s61, s61, 3
    s_add_u32 s60, s60, s61
    s_lshl_b32 s59, s46, 4
    s_add_u32 s59, s59, s60
    s_lshl_b32 s59, s59, 4
    s_add_u32 s59, s59, s44
    s_lshl_b32 s59, s59, 3
    s_add_u32 s59, s59, 4096
    s_waitcnt vmcnt(4)
    buffer_store_dwordx2 v[66:67], v50, s[40:43], s59 offen sc1
    s_waitcnt lgkmcnt(6)
    v_mfma_f32_16x16x32_bf16 v[164:167], a[16:19], v[132:135], v[164:167]
    ds_read_b64_tr_b16 v[148:149], v28 offset:61440
    buffer_load_dwordx4 v19, s[20:23], s94 offen offset:3072 lds
    v_mfma_f32_16x16x32_bf16 v[180:183], a[20:23], v[132:135], v[180:183]
    ds_read_b64_tr_b16 v[150:151], v28 offset:62464
    s_waitcnt lgkmcnt(6)
    v_mfma_f32_16x16x32_bf16 v[168:171], a[16:19], v[136:139], v[168:171]
    ds_read_b64_tr_b16 v[152:153], v29 offset:61440
    v_mfma_f32_16x16x32_bf16 v[184:187], a[20:23], v[136:139], v[184:187]
    ds_read_b64_tr_b16 v[154:155], v29 offset:62464
    s_waitcnt lgkmcnt(6)
    v_mfma_f32_16x16x32_bf16 v[172:175], a[16:19], v[140:143], v[172:175]
    ds_read_b64_tr_b16 v[156:157], v30 offset:61440
    v_mfma_f32_16x16x32_bf16 v[188:191], a[20:23], v[140:143], v[188:191]
    ds_read_b64_tr_b16 v[158:159], v30 offset:62464
    s_waitcnt lgkmcnt(6)
    v_mfma_f32_16x16x32_bf16 v[176:179], a[16:19], v[144:147], v[176:179]
    ds_read_b64_tr_b16 v[160:161], v31 offset:61440
    v_mfma_f32_16x16x32_bf16 v[192:195], a[20:23], v[144:147], v[192:195]
    ds_read_b64_tr_b16 v[162:163], v31 offset:62464
    s_waitcnt lgkmcnt(6)
    v_mfma_f32_16x16x32_bf16 v[164:167], a[24:27], v[148:151], v[164:167]
    ds_read_b64_tr_b16 v[132:133], v32 offset:0
    s_add_u32 m0, s56, 16384
    s_add_u32 s94, s94, 512
    s_and_b32 s94, s94, 0x40eff
    buffer_load_dwordx4 v16, s[20:23], s94 offen lds
    v_mfma_f32_16x16x32_bf16 v[180:183], a[28:31], v[148:151], v[180:183]
    ds_read_b64_tr_b16 v[134:135], v32 offset:1024
    s_waitcnt lgkmcnt(6)
    v_mfma_f32_16x16x32_bf16 v[168:171], a[24:27], v[152:155], v[168:171]
    ds_read_b64_tr_b16 v[136:137], v33 offset:0
    v_mfma_f32_16x16x32_bf16 v[184:187], a[28:31], v[152:155], v[184:187]
    ds_read_b64_tr_b16 v[138:139], v33 offset:1024
    buffer_load_dwordx4 v17, s[20:23], s94 offen offset:1024 lds
    s_waitcnt lgkmcnt(6)
    v_mfma_f32_16x16x32_bf16 v[172:175], a[24:27], v[156:159], v[172:175]
    ds_read_b64_tr_b16 v[140:141], v34 offset:0
    v_mfma_f32_16x16x32_bf16 v[188:191], a[28:31], v[156:159], v[188:191]
    ds_read_b64_tr_b16 v[142:143], v34 offset:1024
    s_waitcnt lgkmcnt(6)
    v_mfma_f32_16x16x32_bf16 v[176:179], a[24:27], v[160:163], v[176:179]
    ds_read_b64_tr_b16 v[144:145], v35 offset:0
    buffer_load_dwordx4 v18, s[20:23], s94 offen offset:2048 lds
    v_mfma_f32_16x16x32_bf16 v[192:195], a[28:31], v[160:163], v[192:195]
    ds_read_b64_tr_b16 v[146:147], v35 offset:1024
    s_waitcnt lgkmcnt(6)
    v_mfma_f32_16x16x32_bf16 v[164:167], a[32:35], v[132:135], v[164:167]
    ds_read_b64_tr_b16 v[148:149], v32 offset:4096
    v_mfma_f32_16x16x32_bf16 v[180:183], a[36:39], v[132:135], v[180:183]
    ds_read_b64_tr_b16 v[150:151], v32 offset:5120
    s_waitcnt lgkmcnt(6)
    v_mfma_f32_16x16x32_bf16 v[168:171], a[32:35], v[136:139], v[168:171]
    ds_read_b64_tr_b16 v[152:153], v33 offset:4096
    buffer_load_dwordx4 v19, s[20:23], s94 offen offset:3072 lds
    v_mfma_f32_16x16x32_bf16 v[184:187], a[36:39], v[136:139], v[184:187]
    ds_read_b64_tr_b16 v[154:155], v33 offset:5120
    s_waitcnt lgkmcnt(6)
    v_mfma_f32_16x16x32_bf16 v[172:175], a[32:35], v[140:143], v[172:175]
    ds_read_b64_tr_b16 v[156:157], v34 offset:4096
    v_mfma_f32_16x16x32_bf16 v[188:191], a[36:39], v[140:143], v[188:191]
    ds_read_b64_tr_b16 v[158:159], v34 offset:5120
    s_add_u32 m0, s56, 65536
    s_add_u32 s94, s94, 512
    s_and_b32 s94, s94, 0x40eff
    buffer_load_dwordx4 v16, s[20:23], s94 offen lds
    s_waitcnt lgkmcnt(6)
    v_mfma_f32_16x16x32_bf16 v[176:179], a[32:35], v[144:147], v[176:179]
    ds_read_b64_tr_b16 v[160:161], v35 offset:4096
    v_mfma_f32_16x16x32_bf16 v[192:195], a[36:39], v[144:147], v[192:195]
    ds_read_b64_tr_b16 v[162:163], v35 offset:5120
    s_waitcnt lgkmcnt(6)
    v_mfma_f32_16x16x32_bf16 v[164:167], a[40:43], v[148:151], v[164:167]
    ds_read_b64_tr_b16 v[132:133], v32 offset:8192
    buffer_load_dwordx4 v17, s[20:23], s94 offen offset:1024 lds
    v_mfma_f32_16x16x32_bf16 v[180:183], a[44:47], v[148:151], v[180:183]
    ds_read_b64_tr_b16 v[134:135], v32 offset:9216
    s_waitcnt lgkmcnt(6)
    v_mfma_f32_16x16x32_bf16 v[168:171], a[40:43], v[152:155], v[168:171]
    ds_read_b64_tr_b16 v[136:137], v33 offset:8192
    v_mfma_f32_16x16x32_bf16 v[184:187], a[44:47], v[152:155], v[184:187]
    ds_read_b64_tr_b16 v[138:139], v33 offset:9216
    buffer_load_dwordx4 v18, s[20:23], s94 offen offset:2048 lds
    s_waitcnt lgkmcnt(6)
    v_mfma_f32_16x16x32_bf16 v[172:175], a[40:43], v[156:159], v[172:175]
    ds_read_b64_tr_b16 v[140:141], v34 offset:8192
    v_mfma_f32_16x16x32_bf16 v[188:191], a[44:47], v[156:159], v[188:191]
    ds_read_b64_tr_b16 v[142:143], v34 offset:9216
    s_waitcnt lgkmcnt(6)
    v_mfma_f32_16x16x32_bf16 v[176:179], a[40:43], v[160:163], v[176:179]
    ds_read_b64_tr_b16 v[144:145], v35 offset:8192
    v_mfma_f32_16x16x32_bf16 v[192:195], a[44:47], v[160:163], v[192:195]
    ds_read_b64_tr_b16 v[146:147], v35 offset:9216
    buffer_load_dwordx4 v19, s[20:23], s94 offen offset:3072 lds
    s_waitcnt lgkmcnt(6)
    v_mfma_f32_16x16x32_bf16 v[164:167], a[48:51], v[132:135], v[164:167]
    ds_read_b64_tr_b16 v[148:149], v32 offset:12288
    v_mfma_f32_16x16x32_bf16 v[180:183], a[52:55], v[132:135], v[180:183]
    ds_read_b64_tr_b16 v[150:151], v32 offset:13312
    s_waitcnt lgkmcnt(6)
    v_mfma_f32_16x16x32_bf16 v[168:171], a[48:51], v[136:139], v[168:171]
    ds_read_b64_tr_b16 v[152:153], v33 offset:12288
    s_add_u32 m0, s56, 81920
    s_add_u32 s94, s94, 512
    s_and_b32 s94, s94, 0x40eff
    buffer_load_dwordx4 v16, s[20:23], s94 offen lds
    v_mfma_f32_16x16x32_bf16 v[184:187], a[52:55], v[136:139], v[184:187]
    ds_read_b64_tr_b16 v[154:155], v33 offset:13312
    s_waitcnt lgkmcnt(6)
    v_mfma_f32_16x16x32_bf16 v[172:175], a[48:51], v[140:143], v[172:175]
    ds_read_b64_tr_b16 v[156:157], v34 offset:12288
    v_mfma_f32_16x16x32_bf16 v[188:191], a[52:55], v[140:143], v[188:191]
    ds_read_b64_tr_b16 v[158:159], v34 offset:13312
    buffer_load_dwordx4 v17, s[20:23], s94 offen offset:1024 lds
    s_waitcnt lgkmcnt(6)
    v_mfma_f32_16x16x32_bf16 v[176:179], a[48:51], v[144:147], v[176:179]
    ds_read_b64_tr_b16 v[160:161], v35 offset:12288
    v_mfma_f32_16x16x32_bf16 v[192:195], a[52:55], v[144:147], v[192:195]
    ds_read_b64_tr_b16 v[162:163], v35 offset:13312
    s_waitcnt lgkmcnt(6)
    v_mfma_f32_16x16x32_bf16 v[164:167], a[56:59], v[148:151], v[164:167]
    v_mfma_f32_16x16x32_bf16 v[180:183], a[60:63], v[148:151], v[180:183]
    buffer_load_dwordx4 v18, s[20:23], s94 offen offset:2048 lds
    s_waitcnt lgkmcnt(4)
    v_mfma_f32_16x16x32_bf16 v[168:171], a[56:59], v[152:155], v[168:171]
    v_mfma_f32_16x16x32_bf16 v[184:187], a[60:63], v[152:155], v[184:187]
    s_waitcnt lgkmcnt(0)
    s_barrier
    v_mfma_f32_16x16x32_bf16 v[172:175], a[56:59], v[156:159], v[172:175]
    ds_read_b64_tr_b16 v[132:133], v28 offset:32768
    ds_read_b64_tr_b16 v[134:135], v28 offset:33792
    buffer_load_dwordx4 v19, s[20:23], s94 offen offset:3072 lds
    v_mfma_f32_16x16x32_bf16 v[188:191], a[60:63], v[156:159], v[188:191]
    ds_read_b64_tr_b16 v[136:137], v29 offset:32768
    ds_read_b64_tr_b16 v[138:139], v29 offset:33792
    v_mfma_f32_16x16x32_bf16 v[176:179], a[56:59], v[160:163], v[176:179]
    ds_read_b64_tr_b16 v[140:141], v30 offset:32768
    ds_read_b64_tr_b16 v[142:143], v30 offset:33792
    v_mfma_f32_16x16x32_bf16 v[192:195], a[60:63], v[160:163], v[192:195]
    ds_read_b64_tr_b16 v[144:145], v31 offset:32768
    ds_read_b64_tr_b16 v[146:147], v31 offset:33792
    s_add_u32 m0, s56, 49152
    s_add_u32 s94, s94, 512
    s_and_b32 s94, s94, 0x40eff
    buffer_load_dwordx4 v16, s[20:23], s94 offen lds
    s_lshr_b32 s59, s44, 1
    s_lshl_b32 s60, s47, 1
    s_add_u32 s59, s59, s60
    s_lshl_b32 s59, s59, 11
    s_add_u32 s59, s59, 4096
    v_and_b32 v254, 0x3ff, v51
    v_add_u32 v254, s59, v254
    buffer_load_dwordx2 v[252:253], v254, s[40:43], 0 offen sc1
    s_lshl_b32 s59, s47, 2
    s_add_u32 s59, s59, s44
    s_mul_i32 s59, s59, 65536
    s_add_u32 s59, s59, 1048576
    v_add_u32 v38, s59, v48
    v_add_u32 v39, 4096, v38
    s_add_u32 s63, s53, 7
    s_lshl_b32 s63, s63, 13
    s_waitcnt lgkmcnt(6)
    v_mfma_f32_16x16x32_bf16 v[164:167], a[64:67], v[132:135], v[164:167]
    ds_read_b64_tr_b16 v[148:149], v28 offset:36864
    buffer_load_dwordx4 v17, s[20:23], s94 offen offset:1024 lds
    v_mfma_f32_16x16x32_bf16 v[180:183], a[68:71], v[132:135], v[180:183]
    ds_read_b64_tr_b16 v[150:151], v28 offset:37888
    s_waitcnt lgkmcnt(6)
    v_mfma_f32_16x16x32_bf16 v[168:171], a[64:67], v[136:139], v[168:171]
    ds_read_b64_tr_b16 v[152:153], v29 offset:36864
    buffer_load_dwordx4 v18, s[20:23], s94 offen offset:2048 lds
    v_mfma_f32_16x16x32_bf16 v[184:187], a[68:71], v[136:139], v[184:187]
    ds_read_b64_tr_b16 v[154:155], v29 offset:37888
    s_waitcnt lgkmcnt(6)
    v_mfma_f32_16x16x32_bf16 v[172:175], a[64:67], v[140:143], v[172:175]
    ds_read_b64_tr_b16 v[156:157], v30 offset:36864
    buffer_load_dwordx4 v19, s[20:23], s94 offen offset:3072 lds
    v_mfma_f32_16x16x32_bf16 v[188:191], a[68:71], v[140:143], v[188:191]
    ds_read_b64_tr_b16 v[158:159], v30 offset:37888
    s_waitcnt lgkmcnt(6)
    v_mfma_f32_16x16x32_bf16 v[176:179], a[64:67], v[144:147], v[176:179]
    ds_read_b64_tr_b16 v[160:161], v31 offset:36864
    s_add_u32 m0, s56, 114688
    s_add_u32 s94, s94, 512
    s_and_b32 s94, s94, 0x40eff
    buffer_load_dwordx4 v16, s[20:23], s94 offen lds
    v_mfma_f32_16x16x32_bf16 v[192:195], a[68:71], v[144:147], v[192:195]
    ds_read_b64_tr_b16 v[162:163], v31 offset:37888
    s_waitcnt lgkmcnt(6)
    v_mfma_f32_16x16x32_bf16 v[164:167], a[72:75], v[148:151], v[164:167]
    ds_read_b64_tr_b16 v[132:133], v28 offset:40960
    buffer_load_dwordx4 v17, s[20:23], s94 offen offset:1024 lds
    v_mfma_f32_16x16x32_bf16 v[180:183], a[76:79], v[148:151], v[180:183]
    ds_read_b64_tr_b16 v[134:135], v28 offset:41984
    s_waitcnt lgkmcnt(6)
    v_mfma_f32_16x16x32_bf16 v[168:171], a[72:75], v[152:155], v[168:171]
    ds_read_b64_tr_b16 v[136:137], v29 offset:40960
    buffer_load_dwordx4 v18, s[20:23], s94 offen offset:2048 lds
    v_mfma_f32_16x16x32_bf16 v[184:187], a[76:79], v[152:155], v[184:187]
    ds_read_b64_tr_b16 v[138:139], v29 offset:41984
    s_waitcnt lgkmcnt(6)
    v_mfma_f32_16x16x32_bf16 v[172:175], a[72:75], v[156:159], v[172:175]
    ds_read_b64_tr_b16 v[140:141], v30 offset:40960
    buffer_load_dwordx4 v19, s[20:23], s94 offen offset:3072 lds
    v_mfma_f32_16x16x32_bf16 v[188:191], a[76:79], v[156:159], v[188:191]
    ds_read_b64_tr_b16 v[142:143], v30 offset:41984
    s_waitcnt lgkmcnt(6)
    v_mfma_f32_16x16x32_bf16 v[176:179], a[72:75], v[160:163], v[176:179]
    ds_read_b64_tr_b16 v[144:145], v31 offset:40960
    s_add_u32 m0, s56, 131072
    s_add_u32 s94, s94, 512
    s_and_b32 s94, s94, 0x40eff
    buffer_load_dwordx4 v16, s[20:23], s94 offen lds
    v_mfma_f32_16x16x32_bf16 v[192:195], a[76:79], v[160:163], v[192:195]
    ds_read_b64_tr_b16 v[146:147], v31 offset:41984
    s_waitcnt lgkmcnt(6)
    v_mfma_f32_16x16x32_bf16 v[164:167], a[80:83], v[132:135], v[164:167]
    ds_read_b64_tr_b16 v[148:149], v28 offset:45056
    buffer_load_dwordx4 v17, s[20:23], s94 offen offset:1024 lds
    v_mfma_f32_16x16x32_bf16 v[180:183], a[84:87], v[132:135], v[180:183]
    ds_read_b64_tr_b16 v[150:151], v28 offset:46080
    s_waitcnt lgkmcnt(6)
    v_mfma_f32_16x16x32_bf16 v[168:171], a[80:83], v[136:139], v[168:171]
    ds_read_b64_tr_b16 v[152:153], v29 offset:45056
    buffer_load_dwordx4 v18, s[20:23], s94 offen offset:2048 lds
    v_mfma_f32_16x16x32_bf16 v[184:187], a[84:87], v[136:139], v[184:187]
    ds_read_b64_tr_b16 v[154:155], v29 offset:46080
    s_waitcnt lgkmcnt(6)
    v_mfma_f32_16x16x32_bf16 v[172:175], a[80:83], v[140:143], v[172:175]
    ds_read_b64_tr_b16 v[156:157], v30 offset:45056
    buffer_load_dwordx4 v19, s[20:23], s94 offen offset:3072 lds
    v_mfma_f32_16x16x32_bf16 v[188:191], a[84:87], v[140:143], v[188:191]
    ds_read_b64_tr_b16 v[158:159], v30 offset:46080
    s_waitcnt lgkmcnt(6)
    v_mfma_f32_16x16x32_bf16 v[176:179], a[80:83], v[144:147], v[176:179]
    ds_read_b64_tr_b16 v[160:161], v31 offset:45056
    v_mfma_f32_16x16x32_bf16 v[192:195], a[84:87], v[144:147], v[192:195]
    ds_read_b64_tr_b16 v[162:163], v31 offset:46080
    s_waitcnt lgkmcnt(6)
    v_mfma_f32_16x16x32_bf16 v[164:167], a[88:91], v[148:151], v[164:167]
    ds_read_b64_tr_b16 v[132:133], v24 offset:0
    v_mfma_f32_16x16x32_bf16 v[180:183], a[92:95], v[148:151], v[180:183]
    ds_read_b64_tr_b16 v[134:135], v24 offset:1024
    s_waitcnt lgkmcnt(6)
    v_mfma_f32_16x16x32_bf16 v[168:171], a[88:91], v[152:155], v[168:171]
    ds_read_b64_tr_b16 v[136:137], v25 offset:0
    v_mfma_f32_16x16x32_bf16 v[184:187], a[92:95], v[152:155], v[184:187]
    ds_read_b64_tr_b16 v[138:139], v25 offset:1024
    s_waitcnt lgkmcnt(6)
    v_mfma_f32_16x16x32_bf16 v[172:175], a[88:91], v[156:159], v[172:175]
    ds_read_b64_tr_b16 v[140:141], v26 offset:0
    v_mfma_f32_16x16x32_bf16 v[188:191], a[92:95], v[156:159], v[188:191]
    ds_read_b64_tr_b16 v[142:143], v26 offset:1024
    s_waitcnt lgkmcnt(6)
    v_mfma_f32_16x16x32_bf16 v[176:179], a[88:91], v[160:163], v[176:179]
    ds_read_b64_tr_b16 v[144:145], v27 offset:0
    v_mfma_f32_16x16x32_bf16 v[192:195], a[92:95], v[160:163], v[192:195]
    ds_read_b64_tr_b16 v[146:147], v27 offset:1024
    s_waitcnt vmcnt(11)
L_chk_397:
    v_xor_b32 v62, s50, v252
    v_bitop3_b32 v62, v253, s51, v62 bitop3:0xbe
    v_cmp_ne_u32 vcc, 0, v62
    s_nop 0
    s_cbranch_vccnz L_retry_398
L_cont_399:
    s_waitcnt lgkmcnt(6)
    v_mfma_f32_16x16x32_bf16 v[164:167], a[96:99], v[132:135], v[164:167]
    ds_read_b64_tr_b16 v[148:149], v24 offset:4096
    s_add_u32 s63, s63, 8192
    s_and_b32 s63, s63, 0xffff
    buffer_load_dwordx4 a[128:131], v38, s[40:43], s63 offen sc1
    v_mfma_f32_16x16x32_bf16 v[180:183], a[100:103], v[132:135], v[180:183]
    ds_read_b64_tr_b16 v[150:151], v24 offset:5120
    buffer_load_dwordx4 a[132:135], v38, s[40:43], s63 offen offset:1024 sc1
    s_waitcnt lgkmcnt(6)
    v_mfma_f32_16x16x32_bf16 v[168:171], a[96:99], v[136:139], v[168:171]
    ds_read_b64_tr_b16 v[152:153], v25 offset:4096
    buffer_load_dwordx4 a[136:139], v38, s[40:43], s63 offen offset:2048 sc1
    v_mfma_f32_16x16x32_bf16 v[184:187], a[100:103], v[136:139], v[184:187]
    ds_read_b64_tr_b16 v[154:155], v25 offset:5120
    buffer_load_dwordx4 a[140:143], v38, s[40:43], s63 offen offset:3072 sc1
    s_waitcnt lgkmcnt(6)
    v_mfma_f32_16x16x32_bf16 v[172:175], a[96:99], v[140:143], v[172:175]
    ds_read_b64_tr_b16 v[156:157], v26 offset:4096
    v_mfma_f32_16x16x32_bf16 v[188:191], a[100:103], v[140:143], v[188:191]
    ds_read_b64_tr_b16 v[158:159], v26 offset:5120
    s_waitcnt lgkmcnt(6)
    v_mfma_f32_16x16x32_bf16 v[176:179], a[96:99], v[144:147], v[176:179]
    ds_read_b64_tr_b16 v[160:161], v27 offset:4096
    v_mfma_f32_16x16x32_bf16 v[192:195], a[100:103], v[144:147], v[192:195]
    ds_read_b64_tr_b16 v[162:163], v27 offset:5120
    buffer_load_dwordx4 a[144:147], v39, s[40:43], s63 offen sc1
    s_waitcnt lgkmcnt(6)
    v_mfma_f32_16x16x32_bf16 v[164:167], a[104:107], v[148:151], v[164:167]
    ds_read_b64_tr_b16 v[132:133], v24 offset:8192
    v_mfma_f32_16x16x32_bf16 v[180:183], a[108:111], v[148:151], v[180:183]
    ds_read_b64_tr_b16 v[134:135], v24 offset:9216
    s_waitcnt lgkmcnt(6)
    v_mfma_f32_16x16x32_bf16 v[168:171], a[104:107], v[152:155], v[168:171]
    ds_read_b64_tr_b16 v[136:137], v25 offset:8192
    v_mfma_f32_16x16x32_bf16 v[184:187], a[108:111], v[152:155], v[184:187]
    ds_read_b64_tr_b16 v[138:139], v25 offset:9216
    buffer_load_dwordx4 a[148:151], v39, s[40:43], s63 offen offset:1024 sc1
    s_waitcnt lgkmcnt(6)
    v_mfma_f32_16x16x32_bf16 v[172:175], a[104:107], v[156:159], v[172:175]
    ds_read_b64_tr_b16 v[140:141], v26 offset:8192
    v_mfma_f32_16x16x32_bf16 v[188:191], a[108:111], v[156:159], v[188:191]
    ds_read_b64_tr_b16 v[142:143], v26 offset:9216
    s_waitcnt lgkmcnt(6)
    v_mfma_f32_16x16x32_bf16 v[176:179], a[104:107], v[160:163], v[176:179]
    ds_read_b64_tr_b16 v[144:145], v27 offset:8192
    v_mfma_f32_16x16x32_bf16 v[192:195], a[108:111], v[160:163], v[192:195]
    ds_read_b64_tr_b16 v[146:147], v27 offset:9216
    buffer_load_dwordx4 a[152:155], v39, s[40:43], s63 offen offset:2048 sc1
    s_waitcnt lgkmcnt(6)
    v_mfma_f32_16x16x32_bf16 v[164:167], a[112:115], v[132:135], v[164:167]
    ds_read_b64_tr_b16 v[148:149], v24 offset:12288
    v_mfma_f32_16x16x32_bf16 v[180:183], a[116:119], v[132:135], v[180:183]
    ds_read_b64_tr_b16 v[150:151], v24 offset:13312
    s_waitcnt lgkmcnt(6)
    v_mfma_f32_16x16x32_bf16 v[168:171], a[112:115], v[136:139], v[168:171]
    ds_read_b64_tr_b16 v[152:153], v25 offset:12288
    v_mfma_f32_16x16x32_bf16 v[184:187], a[116:119], v[136:139], v[184:187]
    ds_read_b64_tr_b16 v[154:155], v25 offset:13312
    s_waitcnt lgkmcnt(6)
    v_mfma_f32_16x16x32_bf16 v[172:175], a[112:115], v[140:143], v[172:175]
    ds_read_b64_tr_b16 v[156:157], v26 offset:12288
    buffer_load_dwordx4 a[156:159], v39, s[40:43], s63 offen offset:3072 sc1
    v_mfma_f32_16x16x32_bf16 v[188:191], a[116:119], v[140:143], v[188:191]
    ds_read_b64_tr_b16 v[158:159], v26 offset:13312
    s_waitcnt lgkmcnt(6)
    v_mfma_f32_16x16x32_bf16 v[176:179], a[112:115], v[144:147], v[176:179]
    ds_read_b64_tr_b16 v[160:161], v27 offset:12288
    v_mfma_f32_16x16x32_bf16 v[192:195], a[116:119], v[144:147], v[192:195]
    ds_read_b64_tr_b16 v[162:163], v27 offset:13312
    s_waitcnt lgkmcnt(6)
    v_mfma_f32_16x16x32_bf16 v[164:167], a[120:123], v[148:151], v[164:167]
    s_add_u32 s63, s63, 8192
    s_and_b32 s63, s63, 0xffff
    buffer_load_dwordx4 a[160:163], v38, s[40:43], s63 offen sc1
    v_mfma_f32_16x16x32_bf16 v[180:183], a[124:127], v[148:151], v[180:183]
    s_waitcnt lgkmcnt(4)
    v_mfma_f32_16x16x32_bf16 v[168:171], a[120:123], v[152:155], v[168:171]
    v_mfma_f32_16x16x32_bf16 v[184:187], a[124:127], v[152:155], v[184:187]
    s_waitcnt lgkmcnt(0)
    s_barrier
    v_mfma_f32_16x16x32_bf16 v[172:175], a[120:123], v[156:159], v[172:175]
    v_mfma_f32_16x16x32_bf16 v[188:191], a[124:127], v[156:159], v[188:191]
    buffer_load_dwordx4 a[164:167], v38, s[40:43], s63 offen offset:1024 sc1
    v_mfma_f32_16x16x32_bf16 v[176:179], a[120:123], v[160:163], v[176:179]
    v_mfma_f32_16x16x32_bf16 v[192:195], a[124:127], v[160:163], v[192:195]
    v_pk_mul_f32 v[196:197], v[100:101], v[58:59]
    v_pk_mul_f32 v[198:199], v[102:103], v[58:59]
    v_pk_mul_f32 v[200:201], v[104:105], v[58:59]
    v_pk_mul_f32 v[202:203], v[106:107], v[58:59]
    v_exp_f32_e64 v196, v196 clamp
    v_exp_f32_e64 v197, v197 clamp
    v_exp_f32_e64 v198, v198 clamp
    v_exp_f32_e64 v199, v199 clamp
    v_exp_f32_e64 v200, v200 clamp
    v_exp_f32_e64 v201, v201 clamp
    v_exp_f32_e64 v202, v202 clamp
    v_exp_f32_e64 v203, v203 clamp
    buffer_load_dwordx4 a[168:171], v38, s[40:43], s63 offen offset:2048 sc1
    v_max_f32 v100, 0, v100
    v_max_f32 v101, 0, v101
    v_max_f32 v102, 0, v102
    v_max_f32 v103, 0, v103
    v_max_f32 v104, 0, v104
    v_max_f32 v105, 0, v105
    v_max_f32 v106, 0, v106
    v_max_f32 v107, 0, v107
    v_pk_add_f32 v[100:101], v[100:101], v[196:197]
    v_pk_add_f32 v[102:103], v[102:103], v[198:199]
    v_pk_add_f32 v[104:105], v[104:105], v[200:201]
    v_pk_add_f32 v[106:107], v[106:107], v[202:203]
    v_pk_add_f32 v[100:101], v[100:101], v[60:61]
    v_pk_add_f32 v[102:103], v[102:103], v[60:61]
    v_pk_add_f32 v[104:105], v[104:105], v[60:61]
    v_pk_add_f32 v[106:107], v[106:107], v[60:61]
    buffer_load_dwordx4 a[172:175], v38, s[40:43], s63 offen offset:3072 sc1
    v_pk_mul_f32 v[196:197], v[108:109], v[58:59]
    v_pk_mul_f32 v[198:199], v[110:111], v[58:59]
    v_pk_mul_f32 v[200:201], v[112:113], v[58:59]
    v_pk_mul_f32 v[202:203], v[114:115], v[58:59]
    v_exp_f32_e64 v196, v196 clamp
    v_exp_f32_e64 v197, v197 clamp
    v_exp_f32_e64 v198, v198 clamp
    v_exp_f32_e64 v199, v199 clamp
    v_exp_f32_e64 v200, v200 clamp
    v_exp_f32_e64 v201, v201 clamp
    v_exp_f32_e64 v202, v202 clamp
    v_exp_f32_e64 v203, v203 clamp
H_A_3:
    s_cbranch_execz H_M_3
    buffer_load_dwordx4 a[176:179], v39, s[40:43], s63 offen sc1
    v_max_f32 v108, 0, v108
    v_max_f32 v109, 0, v109
    v_max_f32 v110, 0, v110
    v_max_f32 v111, 0, v111
    v_max_f32 v112, 0, v112
    v_max_f32 v113, 0, v113
    v_max_f32 v114, 0, v114
    v_max_f32 v115, 0, v115
    v_pk_add_f32 v[108:109], v[108:109], v[196:197]
    v_pk_add_f32 v[110:111], v[110:111], v[198:199]
    v_pk_add_f32 v[112:113], v[112:113], v[200:201]
    v_pk_add_f32 v[114:115], v[114:115], v[202:203]
    v_pk_add_f32 v[108:109], v[108:109], v[60:61]
    v_pk_add_f32 v[110:111], v[110:111], v[60:61]
    v_pk_add_f32 v[112:113], v[112:113], v[60:61]
    v_pk_add_f32 v[114:115], v[114:115], v[60:61]
    buffer_load_dwordx4 a[180:183], v39, s[40:43], s63 offen offset:1024 sc1
    v_pk_mul_f32 v[196:197], v[116:117], v[58:59]
    v_pk_mul_f32 v[198:199], v[118:119], v[58:59]
    v_pk_mul_f32 v[200:201], v[120:121], v[58:59]
    v_pk_mul_f32 v[202:203], v[122:123], v[58:59]
    v_exp_f32_e64 v196, v196 clamp
    v_exp_f32_e64 v197, v197 clamp
    v_exp_f32_e64 v198, v198 clamp
    v_exp_f32_e64 v199, v199 clamp
    v_exp_f32_e64 v200, v200 clamp
    v_exp_f32_e64 v201, v201 clamp
    v_exp_f32_e64 v202, v202 clamp
    v_exp_f32_e64 v203, v203 clamp
    buffer_load_dwordx4 a[184:187], v39, s[40:43], s63 offen offset:2048 sc1
    v_max_f32 v116, 0, v116
    v_max_f32 v117, 0, v117
    v_max_f32 v118, 0, v118
    v_max_f32 v119, 0, v119
    v_max_f32 v120, 0, v120
    v_max_f32 v121, 0, v121
    v_max_f32 v122, 0, v122
    v_max_f32 v123, 0, v123
    v_pk_add_f32 v[116:117], v[116:117], v[196:197]
    v_pk_add_f32 v[118:119], v[118:119], v[198:199]
    v_pk_add_f32 v[120:121], v[120:121], v[200:201]
    v_pk_add_f32 v[122:123], v[122:123], v[202:203]
    v_pk_add_f32 v[116:117], v[116:117], v[60:61]
    v_pk_add_f32 v[118:119], v[118:119], v[60:61]
    v_pk_add_f32 v[120:121], v[120:121], v[60:61]
    v_pk_add_f32 v[122:123], v[122:123], v[60:61]
    buffer_load_dwordx4 a[188:191], v39, s[40:43], s63 offen offset:3072 sc1
    v_pk_mul_f32 v[196:197], v[124:125], v[58:59]
    v_pk_mul_f32 v[198:199], v[126:127], v[58:59]
    v_pk_mul_f32 v[200:201], v[128:129], v[58:59]
    v_pk_mul_f32 v[202:203], v[130:131], v[58:59]
    v_exp_f32_e64 v196, v196 clamp
    v_exp_f32_e64 v197, v197 clamp
    v_exp_f32_e64 v198, v198 clamp
    v_exp_f32_e64 v199, v199 clamp
    v_exp_f32_e64 v200, v200 clamp
    v_exp_f32_e64 v201, v201 clamp
    v_exp_f32_e64 v202, v202 clamp
    v_exp_f32_e64 v203, v203 clamp
    s_add_u32 s63, s63, 8192
    s_and_b32 s63, s63, 0xffff
    buffer_load_dwordx4 a[192:195], v38, s[40:43], s63 offen sc1
    v_max_f32 v124, 0, v124
    v_max_f32 v125, 0, v125
    v_max_f32 v126, 0, v126
    v_max_f32 v127, 0, v127
    v_max_f32 v128, 0, v128
    v_max_f32 v129, 0, v129
    v_max_f32 v130, 0, v130
    v_max_f32 v131, 0, v131
    v_pk_add_f32 v[124:125], v[124:125], v[196:197]
    v_pk_add_f32 v[126:127], v[126:127], v[198:199]
    v_pk_add_f32 v[128:129], v[128:129], v[200:201]
    v_pk_add_f32 v[130:131], v[130:131], v[202:203]
    v_pk_add_f32 v[124:125], v[124:125], v[60:61]
    v_pk_add_f32 v[126:127], v[126:127], v[60:61]
    v_pk_add_f32 v[128:129], v[128:129], v[60:61]
    v_pk_add_f32 v[130:131], v[130:131], v[60:61]
    buffer_load_dwordx4 a[196:199], v38, s[40:43], s63 offen offset:1024 sc1
    v_cvt_pk_bf16_f32 v204, v100, v101
    v_cvt_pk_bf16_f32 v205, v102, v103
    v_cvt_pk_bf16_f32 v206, v116, v117
    v_cvt_pk_bf16_f32 v207, v118, v119
    v_cvt_pk_bf16_f32 v208, v104, v105
    v_cvt_pk_bf16_f32 v209, v106, v107
    v_cvt_pk_bf16_f32 v210, v120, v121
    v_cvt_pk_bf16_f32 v211, v122, v123
    v_cvt_pk_bf16_f32 v212, v108, v109
    v_cvt_pk_bf16_f32 v213, v110, v111
    v_cvt_pk_bf16_f32 v214, v124, v125
    v_cvt_pk_bf16_f32 v215, v126, v127
    v_cvt_pk_bf16_f32 v216, v112, v113
    v_cvt_pk_bf16_f32 v217, v114, v115
    v_cvt_pk_bf16_f32 v218, v128, v129
    v_cvt_pk_bf16_f32 v219, v130, v131
    v_mov_b32 v100, v204
    v_mov_b32 v101, v205
    v_mov_b32 v102, v206
    v_mov_b32 v103, v207
    v_mov_b32 v104, v208
    v_mov_b32 v105, v209
    v_mov_b32 v106, v210
    v_mov_b32 v107, v211
    v_mov_b32 v108, v212
    v_mov_b32 v109, v213
    v_mov_b32 v110, v214
    v_mov_b32 v111, v215
    v_mov_b32 v112, v216
    v_mov_b32 v113, v217
    v_mov_b32 v114, v218
    v_mov_b32 v115, v219
    v_cvt_pk_bf16_f32 v220, v164, v165
    v_cvt_pk_bf16_f32 v221, v166, v167
    v_cvt_pk_bf16_f32 v222, v180, v181
    v_cvt_pk_bf16_f32 v223, v182, v183
    v_cvt_pk_bf16_f32 v224, v168, v169
    v_cvt_pk_bf16_f32 v225, v170, v171
    v_cvt_pk_bf16_f32 v226, v184, v185
    v_cvt_pk_bf16_f32 v227, v186, v187
    v_cvt_pk_bf16_f32 v228, v172, v173
    v_cvt_pk_bf16_f32 v229, v174, v175
    v_cvt_pk_bf16_f32 v230, v188, v189
    v_cvt_pk_bf16_f32 v231, v190, v191
    v_cvt_pk_bf16_f32 v232, v176, v177
    v_cvt_pk_bf16_f32 v233, v178, v179
    v_cvt_pk_bf16_f32 v234, v192, v193
    v_cvt_pk_bf16_f32 v235, v194, v195
    v_mov_b32 v240, 0x3f803f80
    v_and_b32 v241, 3, v2
    v_cmp_eq_u32 vcc, 0, v241
    s_nop 1
    v_cndmask_b32 v236, v50, v240, vcc
    v_cndmask_b32 v237, v50, v240, vcc
    v_cndmask_b32 v238, v50, v240, vcc
    v_cndmask_b32 v239, v50, v240, vcc
    v_mfma_f32_16x16x32_bf16 v[68:71], v[100:103], v[220:223], 0
    s_nop 0
    v_mfma_f32_16x16x32_bf16 v[84:87], v[100:103], v[236:239], 0
    v_cmp_eq_u32 vcc, 1, v241
    s_nop 1
    v_cndmask_b32 v244, v50, v240, vcc
    v_cndmask_b32 v245, v50, v240, vcc
    v_cndmask_b32 v246, v50, v240, vcc
    v_cndmask_b32 v247, v50, v240, vcc
    v_mfma_f32_16x16x32_bf16 v[72:75], v[104:107], v[224:227], 0
    s_nop 0
    v_mfma_f32_16x16x32_bf16 v[84:87], v[104:107], v[244:247], v[84:87]
    v_cmp_eq_u32 vcc, 2, v241
    s_nop 1
    v_cndmask_b32 v236, v50, v240, vcc
    v_cndmask_b32 v237, v50, v240, vcc
    v_cndmask_b32 v238, v50, v240, vcc
    v_cndmask_b32 v239, v50, v240, vcc
    v_mfma_f32_16x16x32_bf16 v[76:79], v[108:111], v[228:231], 0
    s_nop 0
    v_mfma_f32_16x16x32_bf16 v[84:87], v[108:111], v[236:239], v[84:87]
    v_cmp_eq_u32 vcc, 3, v241
    s_nop 1
    v_cndmask_b32 v244, v50, v240, vcc
    v_cndmask_b32 v245, v50, v240, vcc
    v_cndmask_b32 v246, v50, v240, vcc
    v_cndmask_b32 v247, v50, v240, vcc
    v_mfma_f32_16x16x32_bf16 v[80:83], v[112:115], v[232:235], 0
    s_nop 0
    v_mfma_f32_16x16x32_bf16 v[84:87], v[112:115], v[244:247], v[84:87]
    s_lshl_b32 s59, s44, 10
    s_add_u32 s59, s59, 0
    v_add_u32 v243, s59, v48
    s_add_u32 s59, s56, 0
    v_lshlrev_b32 v249, 2, v1
    v_add_u32 v248, s59, v249
    ds_write_b128 v243, v[68:71] offset:0
    ds_write_b128 v243, v[72:75] offset:4096
    ds_write_b128 v243, v[76:79] offset:8192
    ds_write_b128 v243, v[80:83] offset:12288
    v_lshrrev_b32 v240, 2, v2
    v_lshl_add_u32 v242, v3, 2, v240
    v_lshl_add_u32 v242, v241, 4, v242
    v_lshlrev_b32 v242, 2, v242
    v_cmp_eq_u32 vcc, 1, v240
    s_nop 1
    v_cndmask_b32 v84, v84, v85, vcc
    v_cmp_eq_u32 vcc, 2, v240
    s_nop 1
    v_cndmask_b32 v84, v84, v86, vcc
    v_cmp_eq_u32 vcc, 3, v240
    s_nop 1
    v_cndmask_b32 v84, v84, v87, vcc
    s_lshl_b32 s59, s44, 8
    s_add_u32 s59, s59, 98304
    v_add_u32 v243, s59, v249
    ds_write_b32 v243, v84
    v_add_u32 v243, 98304, v249
L_chk_429:
    v_xor_b32 v62, s50, v44
    v_bitop3_b32 v62, v45, s51, v62 bitop3:0xbe
    v_cmp_ne_u32 vcc, 0, v62
    s_nop 0
    s_cbranch_vccnz L_retry_430
L_cont_431:
    s_waitcnt lgkmcnt(0)
    s_barrier
    ds_read2st64_b32 v[84:85], v243 offset0:0 offset1:1
    ds_read2st64_b32 v[86:87], v243 offset0:2 offset1:3
    ds_read2st64_b32 v[68:69], v248 offset0:0 offset1:1
    ds_read2st64_b32 v[70:71], v248 offset0:2 offset1:3
    ds_read2st64_b32 v[72:73], v248 offset0:4 offset1:5
    ds_read2st64_b32 v[74:75], v248 offset0:6 offset1:7
    ds_read2st64_b32 v[76:77], v248 offset0:8 offset1:9
    ds_read2st64_b32 v[78:79], v248 offset0:10 offset1:11
    ds_read2st64_b32 v[80:81], v248 offset0:12 offset1:13
    ds_read2st64_b32 v[82:83], v248 offset0:14 offset1:15
    s_lshl_b32 s59, s47, 2
    s_add_u32 s59, s59, s44
    s_lshl_b32 s59, s59, 10
    s_add_u32 s59, s59, 720896
    s_waitcnt lgkmcnt(0)
    v_pk_add_f32 v[68:69], v[68:69], v[72:73]
    v_pk_add_f32 v[70:71], v[70:71], v[74:75]
    v_pk_add_f32 v[76:77], v[76:77], v[80:81]
    v_pk_add_f32 v[78:79], v[78:79], v[82:83]
    v_pk_add_f32 v[68:69], v[68:69], v[76:77]
    v_pk_add_f32 v[70:71], v[70:71], v[78:79]
    buffer_atomic_add_f32 v68, v249, s[40:43], s59 offen sc1
    buffer_atomic_add_f32 v69, v249, s[40:43], s59 offen offset:256 sc1
    buffer_atomic_add_f32 v70, v249, s[40:43], s59 offen offset:512 sc1
    buffer_atomic_add_f32 v71, v249, s[40:43], s59 offen offset:768 sc1
    v_pk_add_f32 v[84:85], v[84:85], v[86:87]
    v_add_f32 v84, v84, v85
    s_lshl_b32 s59, s47, 8
    s_add_u32 s59, s59, 589824
    s_lshl_b32 s64, s47, 2
    s_lshr_b32 s60, s45, 2
    s_add_u32 s64, s64, s60
    s_lshl_b32 s64, s64, 4
    s_and_b32 s60, s45, 3
    s_add_u32 s64, s64, s60
    s_lshl_b32 s64, s64, 3
    s_add_u32 s64, s64, 32768
    s_cmp_eq_u32 s44, 0
    s_cselect_b32 s64, s64, 0x1180000
    s_cselect_b32 s59, s59, 0x1180000
    buffer_atomic_add_f32 v84, v242, s[40:43], s59 offen sc1
    buffer_load_dwordx4 a[200:203], v38, s[40:43], s63 offen offset:2048 sc1
    buffer_load_dwordx4 a[204:207], v38, s[40:43], s63 offen offset:3072 sc1
    buffer_load_dwordx4 a[208:211], v39, s[40:43], s63 offen sc1
    buffer_load_dwordx4 a[212:215], v39, s[40:43], s63 offen offset:1024 sc1
    buffer_load_dwordx4 a[216:219], v39, s[40:43], s63 offen offset:2048 sc1
    buffer_load_dwordx4 a[220:223], v39, s[40:43], s63 offen offset:3072 sc1
    s_add_u32 s63, s63, 8192
    s_and_b32 s63, s63, 0xffff
    buffer_load_dwordx4 a[224:227], v38, s[40:43], s63 offen sc1
    buffer_load_dwordx4 a[228:231], v38, s[40:43], s63 offen offset:1024 sc1
    buffer_load_dwordx4 a[232:235], v38, s[40:43], s63 offen offset:2048 sc1
    buffer_load_dwordx4 a[236:239], v38, s[40:43], s63 offen offset:3072 sc1
    buffer_load_dwordx4 a[240:243], v39, s[40:43], s63 offen sc1
    buffer_load_dwordx4 a[244:247], v39, s[40:43], s63 offen offset:1024 sc1
    s_nop 7
    s_branch L_P2
L_roleB:
H_B_0:
    s_cbranch_execz H_M_0
    s_mov_b64 exec, 0
    s_call_b64 s[90:91], L_hopB
    s_mov_b64 exec, -1
    s_nop 3
    s_add_u32 m0, s56, 32768
    s_xor_b32 s58, s0, 128
    s_add_u32 s58, s58, 0
    s_and_b32 s58, s58, 1023
    s_lshl_b32 s62, s45, 17
    s_add_u32 s58, s58, s62
    buffer_load_dwordx4 v4, s[4:7], s58 offen lds
    buffer_load_dwordx4 v5, s[4:7], s58 offen offset:1024 lds
    buffer_load_dwordx4 v6, s[4:7], s58 offen offset:2048 lds
    buffer_load_dwordx4 v7, s[4:7], s58 offen offset:3072 lds
    s_movk_i32 s60, 3072
    v_mad_u32_u24 v12, v206, s60, v203
    v_add_u32 v13, 11264, v12
    v_add_u32 v14, 47104, v12
    v_add_u32 v15, 58368, v12
    s_mov_b32 s42, 0x1180000
    s_mov_b32 s43, 0x20000
    s_mov_b32 s10, 0x180000
    s_mov_b32 s11, 0x20000
    s_mov_b32 s22, 0x800000
    s_mov_b32 s23, 0x20000
    s_mov_b32 s14, 0x80000
    s_mov_b32 s15, 0x20000
    s_mov_b32 s26, 0x1000
    s_mov_b32 s27, 0x20000
    s_mov_b32 s30, 0xe0000
    s_mov_b32 s31, 0x20000
    s_mov_b32 s34, 0x400
    s_mov_b32 s35, 0x20000
    s_mov_b32 s38, 0x200000
    s_mov_b32 s39, 0x20000
    s_mov_b32 s3, 4000000
    s_lshl_b32 s49, s45, 1
    s_add_u32 s49, s49, s48
    s_and_b32 s61, s47, 1
    s_lshl_b32 s96, s45, 1
    s_add_u32 s96, s96, s61
    s_lshl_b32 s97, s48, 2
    s_lshr_b32 s61, s47, 1
    s_add_u32 s97, s97, s61
    s_lshl_b32 s57, s45, 2
    s_add_u32 s57, s57, s44
    s_mul_i32 s61, s45, 8
    s_mul_i32 s53, s47, 2
    s_add_u32 s53, s53, s61
    s_and_b32 s53, s53, 7
    s_add_u32 s94, s53, 7
    s_and_b32 s94, s94, 7
    s_lshr_b32 s61, s94, 0
    s_lshl_b32 s61, s61, 0
    s_waitcnt lgkmcnt(0)
    s_add_u32 s54, s52, 0
    s_and_b32 s54, s54, 3
    s_mul_i32 s54, s54, 458752
    s_mul_i32 s62, s47, 256
    s_add_u32 s54, s54, s62
    s_add_u32 s55, s52, 1
    s_and_b32 s55, s55, 3
    s_mul_i32 s55, s55, 458752
    s_add_u32 s55, s55, s62
    s_add_u32 s93, s52, 2
    s_and_b32 s93, s93, 3
    s_mul_i32 s93, s93, 458752
    s_add_u32 s93, s93, s62
    s_add_u32 s95, s52, 3
    s_and_b32 s95, s95, 3
    s_mul_i32 s95, s95, 458752
    s_add_u32 s95, s95, s62
    s_waitcnt vmcnt(8)
    ds_read_b128 a[0:3], v42 offset:0
    ds_read_b128 a[4:7], v42 offset:2048
    ds_read_b128 a[8:11], v43 offset:0
    ds_read_b128 a[12:15], v43 offset:2048
    s_add_u32 m0, s56, 49152
    s_add_u32 s58, s52, 1
    s_and_b32 s58, s58, 3
    s_mul_i32 s58, s58, s1
    s_add_u32 s58, s58, s92
    buffer_load_dwordx4 v8, s[16:19], s58 offen lds
    buffer_load_dwordx4 v9, s[16:19], s58 offen offset:1024 lds
    buffer_load_dwordx4 v10, s[16:19], s58 offen offset:2048 lds
    buffer_load_dwordx4 v11, s[16:19], s58 offen offset:3072 lds
    s_waitcnt vmcnt(8) lgkmcnt(0)
    s_barrier
    ds_read_b64_tr_b16 v[132:133], v24 offset:16384
    ds_read_b64_tr_b16 v[134:135], v24 offset:17408
    ds_read_b64_tr_b16 v[136:137], v25 offset:16384
    ds_read_b64_tr_b16 v[138:139], v25 offset:17408
    ds_read_b64_tr_b16 v[140:141], v26 offset:16384
    ds_read_b64_tr_b16 v[142:143], v26 offset:17408
    ds_read_b64_tr_b16 v[144:145], v27 offset:16384
    ds_read_b64_tr_b16 v[146:147], v27 offset:17408
    s_waitcnt lgkmcnt(6)
    v_mfma_f32_16x16x32_bf16 v[68:71], a[0:3], v[132:135], 0
    ds_read_b64_tr_b16 v[148:149], v24 offset:20480
    s_add_u32 s94, s94, s61
    s_lshl_b32 s94, s94, 8
    s_xor_b32 s61, s48, 1
    v_mfma_f32_16x16x32_bf16 v[84:87], a[4:7], v[132:135], 0
    ds_read_b64_tr_b16 v[150:151], v24 offset:21504
    s_add_u32 m0, s56, 65536
    s_add_u32 s58, s0, 256
    s_and_b32 s58, s58, 1023
    s_lshl_b32 s62, s45, 17
    s_add_u32 s58, s58, s62
    buffer_load_dwordx4 v4, s[4:7], s58 offen lds
    s_lshl_b32 s61, s61, 18
    s_add_u32 s94, s94, s61
    v_mov_b32 v50, 0
    s_waitcnt lgkmcnt(6)
    v_mfma_f32_16x16x32_bf16 v[72:75], a[0:3], v[136:139], 0
    ds_read_b64_tr_b16 v[152:153], v25 offset:20480
    v_lshlrev_b32 v48, 4, v1
    v_lshlrev_b32 v49, 3, v2
    v_lshrrev_b32 v204, 2, v1
    v_mfma_f32_16x16x32_bf16 v[88:91], a[4:7], v[136:139], 0
    ds_read_b64_tr_b16 v[154:155], v25 offset:21504
    buffer_load_dwordx4 v5, s[4:7], s58 offen offset:1024 lds
    v_and_b32 v205, 3, v1
    v_lshlrev_b32 v205, 3, v205
    v_lshl_add_u32 v51, v204, 7, v205
    s_waitcnt lgkmcnt(6)
    v_mfma_f32_16x16x32_bf16 v[76:79], a[0:3], v[140:143], 0
    ds_read_b64_tr_b16 v[156:157], v26 offset:20480
    s_lshr_b32 s59, s44, 1
    s_lshl_b32 s59, s59, 17
    s_and_b32 s60, s44, 1
    v_mfma_f32_16x16x32_bf16 v[92:95], a[4:7], v[140:143], 0
    ds_read_b64_tr_b16 v[158:159], v26 offset:21504
    buffer_load_dwordx4 v6, s[4:7], s58 offen offset:2048 lds
    s_lshl_b32 s60, s60, 7
    s_add_u32 s59, s59, s60
    s_lshl_b32 s60, s45, 19
    s_waitcnt lgkmcnt(6)
    v_mfma_f32_16x16x32_bf16 v[80:83], a[0:3], v[144:147], 0
    ds_read_b64_tr_b16 v[160:161], v27 offset:20480
    s_add_u32 s59, s59, s60
    s_lshl_b32 s60, s48, 8
    s_add_u32 s59, s59, s60
    v_mfma_f32_16x16x32_bf16 v[96:99], a[4:7], v[144:147], 0
    ds_read_b64_tr_b16 v[162:163], v27 offset:21504
    buffer_load_dwordx4 v7, s[4:7], s58 offen offset:3072 lds
    v_lshrrev_b32 v204, 1, v197
    v_xor_b32 v204, v204, v198
    v_lshlrev_b32 v204, 4, v204
    s_waitcnt lgkmcnt(6)
    v_mfma_f32_16x16x32_bf16 v[68:71], a[8:11], v[148:151], v[68:71]
    ds_read_b64_tr_b16 v[132:133], v24 offset:24576
    v_lshl_add_u32 v204, v199, 12, v204
    v_add_u32 v16, s59, v204
    v_xor_b32 v204, 64, v16
    v_mfma_f32_16x16x32_bf16 v[84:87], a[12:15], v[148:151], v[84:87]
    ds_read_b64_tr_b16 v[134:135], v24 offset:25600
    s_add_u32 m0, s56, 81920
    s_xor_b32 s58, s0, 128
    s_add_u32 s58, s58, 256
    s_and_b32 s58, s58, 1023
    s_lshl_b32 s62, s45, 17
    s_add_u32 s58, s58, s62
    buffer_load_dwordx4 v4, s[4:7], s58 offen lds
    v_add_u32 v17, 64512, v204
    v_add_u32 v18, 14336, v16
    v_add_u32 v19, 78848, v204
    s_waitcnt lgkmcnt(6)
    v_mfma_f32_16x16x32_bf16 v[72:75], a[8:11], v[152:155], v[72:75]
    ds_read_b64_tr_b16 v[136:137], v25 offset:24576
    s_lshl_b32 s59, s44, 15
    s_lshl_b32 s60, s97, 7
    s_add_u32 s59, s59, s60
    v_mfma_f32_16x16x32_bf16 v[88:91], a[12:15], v[152:155], v[88:91]
    ds_read_b64_tr_b16 v[138:139], v25 offset:25600
    buffer_load_dwordx4 v5, s[4:7], s58 offen offset:1024 lds
    v_lshrrev_b32 v204, 2, v197
    v_lshl_add_u32 v204, v204, 3, v199
    v_and_b32 v205, 2, v197
    s_waitcnt lgkmcnt(6)
    v_mfma_f32_16x16x32_bf16 v[76:79], a[8:11], v[156:159], v[76:79]
    ds_read_b64_tr_b16 v[140:141], v26 offset:24576
    v_lshlrev_b32 v205, 1, v205
    v_xor_b32 v205, v205, v198
    v_lshlrev_b32 v205, 4, v205
    s_waitcnt vmcnt(10)
    ds_read_b128 a[16:19], v42 offset:32768
    ds_read_b128 a[20:23], v42 offset:34816
    ds_read_b128 a[24:27], v43 offset:32768
    ds_read_b128 a[28:31], v43 offset:34816
    v_mfma_f32_16x16x32_bf16 v[92:95], a[12:15], v[156:159], v[92:95]
    ds_read_b64_tr_b16 v[142:143], v26 offset:25600
    buffer_load_dwordx4 v6, s[4:7], s58 offen offset:2048 lds
    v_lshl_add_u32 v204, v204, 10, v205
    v_add_u32 v20, s59, v204
    v_add_u32 v21, 3072, v20
    s_waitcnt lgkmcnt(10)
    v_mfma_f32_16x16x32_bf16 v[80:83], a[8:11], v[160:163], v[80:83]
    ds_read_b64_tr_b16 v[144:145], v27 offset:24576
    v_add_u32 v22, 6144, v20
    v_add_u32 v23, 9216, v20
    v_lshlrev_b32 v204, 4, v2
    v_mfma_f32_16x16x32_bf16 v[96:99], a[12:15], v[160:163], v[96:99]
    ds_read_b64_tr_b16 v[146:147], v27 offset:25600
    buffer_load_dwordx4 v7, s[4:7], s58 offen offset:3072 lds
    v_lshl_add_u32 v36, v3, 9, v204
    v_and_b32 v204, 128, v204
    v_add_u32 v37, v36, v204
    s_waitcnt lgkmcnt(3)
    v_mfma_f32_16x16x32_bf16 v[68:71], a[16:19], v[132:135], v[68:71]
    ds_read_b64_tr_b16 v[148:149], v24 offset:28672
    v_mov_b32 v52, 0xc0135761
    v_mov_b32 v53, 0xc0135761
    v_mov_b32 v54, 0xbdd2d3e8
    v_mfma_f32_16x16x32_bf16 v[84:87], a[20:23], v[132:135], v[84:87]
    ds_read_b64_tr_b16 v[150:151], v24 offset:29696
    s_add_u32 m0, s56, 98304
    s_add_u32 s58, s52, 2
    s_and_b32 s58, s58, 3
    s_mul_i32 s58, s58, s1
    s_add_u32 s58, s58, s92
    buffer_load_dwordx4 v8, s[16:19], s58 offen lds
    v_mov_b32 v55, 0xbdd2d3e8
    v_mov_b32 v56, 0x3f800000
    v_mov_b32 v57, 0x3f800000
    v_mfma_f32_16x16x32_bf16 v[72:75], a[16:19], v[136:139], v[72:75]
    ds_read_b64_tr_b16 v[152:153], v25 offset:28672
    v_mov_b32 v58, 0x3fb8aa3b
    v_mov_b32 v59, 0x3fb8aa3b
    v_mov_b32 v60, 0x358637bd
    v_mfma_f32_16x16x32_bf16 v[88:91], a[20:23], v[136:139], v[88:91]
    ds_read_b64_tr_b16 v[154:155], v25 offset:29696
    buffer_load_dwordx4 v9, s[16:19], s58 offen offset:1024 lds
    v_mov_b32 v61, 0x358637bd
    s_waitcnt lgkmcnt(6)
    v_mfma_f32_16x16x32_bf16 v[76:79], a[16:19], v[140:143], v[76:79]
    ds_read_b64_tr_b16 v[156:157], v26 offset:28672
    v_mfma_f32_16x16x32_bf16 v[92:95], a[20:23], v[140:143], v[92:95]
    ds_read_b64_tr_b16 v[158:159], v26 offset:29696
    buffer_load_dwordx4 v10, s[16:19], s58 offen offset:2048 lds
    s_waitcnt lgkmcnt(6)
    v_mfma_f32_16x16x32_bf16 v[80:83], a[16:19], v[144:147], v[80:83]
    ds_read_b64_tr_b16 v[160:161], v27 offset:28672
    v_mfma_f32_16x16x32_bf16 v[96:99], a[20:23], v[144:147], v[96:99]
    ds_read_b64_tr_b16 v[162:163], v27 offset:29696
    buffer_load_dwordx4 v11, s[16:19], s58 offen offset:3072 lds
    s_waitcnt lgkmcnt(6)
    v_mfma_f32_16x16x32_bf16 v[68:71], a[24:27], v[148:151], v[68:71]
    v_mfma_f32_16x16x32_bf16 v[84:87], a[28:31], v[148:151], v[84:87]
    s_add_u32 m0, s56, 114688
    s_add_u32 s58, s0, 512
    s_and_b32 s58, s58, 1023
    s_lshl_b32 s62, s45, 17
    s_add_u32 s58, s58, s62
    buffer_load_dwordx4 v4, s[4:7], s58 offen lds
    s_waitcnt lgkmcnt(4)
    v_mfma_f32_16x16x32_bf16 v[72:75], a[24:27], v[152:155], v[72:75]
    v_mfma_f32_16x16x32_bf16 v[88:91], a[28:31], v[152:155], v[88:91]
    buffer_load_dwordx4 v5, s[4:7], s58 offen offset:1024 lds
    s_waitcnt vmcnt(14) lgkmcnt(0)
    s_barrier
    v_mfma_f32_16x16x32_bf16 v[76:79], a[24:27], v[156:159], v[76:79]
    ds_read_b64_tr_b16 v[132:133], v24 offset:49152
    ds_read_b64_tr_b16 v[134:135], v24 offset:50176
    s_waitcnt vmcnt(10)
    ds_read_b128 a[32:35], v44 offset:0
    ds_read_b128 a[36:39], v44 offset:2048
    ds_read_b128 a[40:43], v45 offset:0
    ds_read_b128 a[44:47], v45 offset:2048
    v_mfma_f32_16x16x32_bf16 v[92:95], a[28:31], v[156:159], v[92:95]
    ds_read_b64_tr_b16 v[136:137], v25 offset:49152
    ds_read_b64_tr_b16 v[138:139], v25 offset:50176
    buffer_load_dwordx4 v6, s[4:7], s58 offen offset:2048 lds
    v_mfma_f32_16x16x32_bf16 v[80:83], a[24:27], v[160:163], v[80:83]
    ds_read_b64_tr_b16 v[140:141], v26 offset:49152
    ds_read_b64_tr_b16 v[142:143], v26 offset:50176
    v_mfma_f32_16x16x32_bf16 v[96:99], a[28:31], v[160:163], v[96:99]
    ds_read_b64_tr_b16 v[144:145], v27 offset:49152
    ds_read_b64_tr_b16 v[146:147], v27 offset:50176
    buffer_load_dwordx4 v7, s[4:7], s58 offen offset:3072 lds
    buffer_load_dwordx2 v[66:67], v50, s[40:43], 0 offen sc1
    s_waitcnt lgkmcnt(6)
    v_mfma_f32_16x16x32_bf16 v[68:71], a[32:35], v[132:135], v[68:71]
    ds_read_b64_tr_b16 v[148:149], v24 offset:53248
    v_mfma_f32_16x16x32_bf16 v[84:87], a[36:39], v[132:135], v[84:87]
    ds_read_b64_tr_b16 v[150:151], v24 offset:54272
    s_add_u32 m0, s56, 131072
    s_xor_b32 s58, s0, 128
    s_add_u32 s58, s58, 512
    s_and_b32 s58, s58, 1023
    s_lshl_b32 s62, s45, 17
    s_add_u32 s58, s58, s62
    buffer_load_dwordx4 v4, s[4:7], s58 offen lds
    s_waitcnt lgkmcnt(6)
    v_mfma_f32_16x16x32_bf16 v[72:75], a[32:35], v[136:139], v[72:75]
    ds_read_b64_tr_b16 v[152:153], v25 offset:53248
    v_mfma_f32_16x16x32_bf16 v[88:91], a[36:39], v[136:139], v[88:91]
    ds_read_b64_tr_b16 v[154:155], v25 offset:54272
    buffer_load_dwordx4 v5, s[4:7], s58 offen offset:1024 lds
    s_waitcnt lgkmcnt(6)
    v_mfma_f32_16x16x32_bf16 v[76:79], a[32:35], v[140:143], v[76:79]
    ds_read_b64_tr_b16 v[156:157], v26 offset:53248
    v_mfma_f32_16x16x32_bf16 v[92:95], a[36:39], v[140:143], v[92:95]
    ds_read_b64_tr_b16 v[158:159], v26 offset:54272
    buffer_load_dwordx4 v6, s[4:7], s58 offen offset:2048 lds
    s_waitcnt lgkmcnt(6)
    v_mfma_f32_16x16x32_bf16 v[80:83], a[32:35], v[144:147], v[80:83]
    ds_read_b64_tr_b16 v[160:161], v27 offset:53248
    v_mfma_f32_16x16x32_bf16 v[96:99], a[36:39], v[144:147], v[96:99]
    ds_read_b64_tr_b16 v[162:163], v27 offset:54272
    buffer_load_dwordx4 v7, s[4:7], s58 offen offset:3072 lds
    s_waitcnt lgkmcnt(6)
    v_mfma_f32_16x16x32_bf16 v[68:71], a[40:43], v[148:151], v[68:71]
    ds_read_b64_tr_b16 v[132:133], v24 offset:57344
    v_mfma_f32_16x16x32_bf16 v[84:87], a[44:47], v[148:151], v[84:87]
    ds_read_b64_tr_b16 v[134:135], v24 offset:58368
    s_add_u32 m0, s56, 147456
    s_add_u32 s58, s52, 3
    s_and_b32 s58, s58, 3
    s_mul_i32 s58, s58, s1
    s_add_u32 s58, s58, s92
    buffer_load_dwordx4 v8, s[16:19], s58 offen lds
    s_waitcnt lgkmcnt(6)
    v_mfma_f32_16x16x32_bf16 v[72:75], a[40:43], v[152:155], v[72:75]
    ds_read_b64_tr_b16 v[136:137], v25 offset:57344
    v_mfma_f32_16x16x32_bf16 v[88:91], a[44:47], v[152:155], v[88:91]
    ds_read_b64_tr_b16 v[138:139], v25 offset:58368
    buffer_load_dwordx4 v9, s[16:19], s58 offen offset:1024 lds
    s_waitcnt lgkmcnt(6)
    v_mfma_f32_16x16x32_bf16 v[76:79], a[40:43], v[156:159], v[76:79]
    ds_read_b64_tr_b16 v[140:141], v26 offset:57344
    s_waitcnt vmcnt(15)
    ds_read_b128 a[48:51], v44 offset:16384
    ds_read_b128 a[52:55], v44 offset:18432
    ds_read_b128 a[56:59], v45 offset:16384
    ds_read_b128 a[60:63], v45 offset:18432
    v_mfma_f32_16x16x32_bf16 v[92:95], a[44:47], v[156:159], v[92:95]
    ds_read_b64_tr_b16 v[142:143], v26 offset:58368
    buffer_load_dwordx4 v10, s[16:19], s58 offen offset:2048 lds
    s_waitcnt lgkmcnt(10)
    v_mfma_f32_16x16x32_bf16 v[80:83], a[40:43], v[160:163], v[80:83]
    ds_read_b64_tr_b16 v[144:145], v27 offset:57344
    v_mfma_f32_16x16x32_bf16 v[96:99], a[44:47], v[160:163], v[96:99]
    ds_read_b64_tr_b16 v[146:147], v27 offset:58368
    buffer_load_dwordx4 v11, s[16:19], s58 offen offset:3072 lds
    s_waitcnt lgkmcnt(3)
    v_mfma_f32_16x16x32_bf16 v[68:71], a[48:51], v[132:135], v[68:71]
    ds_read_b64_tr_b16 v[148:149], v24 offset:61440
    v_mfma_f32_16x16x32_bf16 v[84:87], a[52:55], v[132:135], v[84:87]
    ds_read_b64_tr_b16 v[150:151], v24 offset:62464
    s_add_u32 m0, s56, 0
    s_add_u32 s58, s0, 768
    s_and_b32 s58, s58, 1023
    s_lshl_b32 s62, s45, 17
    s_add_u32 s58, s58, s62
    buffer_load_dwordx4 v4, s[4:7], s58 offen lds
    v_mfma_f32_16x16x32_bf16 v[72:75], a[48:51], v[136:139], v[72:75]
    ds_read_b64_tr_b16 v[152:153], v25 offset:61440
    v_mfma_f32_16x16x32_bf16 v[88:91], a[52:55], v[136:139], v[88:91]
    ds_read_b64_tr_b16 v[154:155], v25 offset:62464
    buffer_load_dwordx4 v5, s[4:7], s58 offen offset:1024 lds
    s_waitcnt lgkmcnt(6)
    v_mfma_f32_16x16x32_bf16 v[76:79], a[48:51], v[140:143], v[76:79]
    ds_read_b64_tr_b16 v[156:157], v26 offset:61440
    v_mfma_f32_16x16x32_bf16 v[92:95], a[52:55], v[140:143], v[92:95]
    ds_read_b64_tr_b16 v[158:159], v26 offset:62464
    buffer_load_dwordx4 v6, s[4:7], s58 offen offset:2048 lds
    s_waitcnt lgkmcnt(6)
    v_mfma_f32_16x16x32_bf16 v[80:83], a[48:51], v[144:147], v[80:83]
    ds_read_b64_tr_b16 v[160:161], v27 offset:61440
    v_mfma_f32_16x16x32_bf16 v[96:99], a[52:55], v[144:147], v[96:99]
    ds_read_b64_tr_b16 v[162:163], v27 offset:62464
    buffer_load_dwordx4 v7, s[4:7], s58 offen offset:3072 lds
    s_waitcnt lgkmcnt(6)
H_B_1:
    s_cbranch_execz H_M_1
    v_mfma_f32_16x16x32_bf16 v[68:71], a[56:59], v[148:151], v[68:71]
    v_mfma_f32_16x16x32_bf16 v[84:87], a[60:63], v[148:151], v[84:87]
    s_add_u32 m0, s56, 32768
    s_xor_b32 s58, s0, 128
    s_add_u32 s58, s58, 768
    s_and_b32 s58, s58, 1023
    s_lshl_b32 s62, s45, 17
    s_add_u32 s58, s58, s62
    buffer_load_dwordx4 v4, s[4:7], s58 offen lds
    s_waitcnt lgkmcnt(4)
    v_mfma_f32_16x16x32_bf16 v[72:75], a[56:59], v[152:155], v[72:75]
    v_mfma_f32_16x16x32_bf16 v[88:91], a[60:63], v[152:155], v[88:91]
    buffer_load_dwordx4 v5, s[4:7], s58 offen offset:1024 lds
    s_waitcnt vmcnt(19) lgkmcnt(0)
    s_barrier
    v_mfma_f32_16x16x32_bf16 v[76:79], a[56:59], v[156:159], v[76:79]
    ds_read_b64_tr_b16 v[132:133], v28 offset:32768
    ds_read_b64_tr_b16 v[134:135], v28 offset:33792
    s_waitcnt vmcnt(15)
    ds_read_b128 a[64:67], v44 offset:49152
    ds_read_b128 a[68:71], v44 offset:51200
    ds_read_b128 a[72:75], v45 offset:49152
    ds_read_b128 a[76:79], v45 offset:51200
    v_mfma_f32_16x16x32_bf16 v[92:95], a[60:63], v[156:159], v[92:95]
    ds_read_b64_tr_b16 v[136:137], v29 offset:32768
    ds_read_b64_tr_b16 v[138:139], v29 offset:33792
    buffer_load_dwordx4 v6, s[4:7], s58 offen offset:2048 lds
    v_mfma_f32_16x16x32_bf16 v[80:83], a[56:59], v[160:163], v[80:83]
    ds_read_b64_tr_b16 v[140:141], v30 offset:32768
    ds_read_b64_tr_b16 v[142:143], v30 offset:33792
    v_mfma_f32_16x16x32_bf16 v[96:99], a[60:63], v[160:163], v[96:99]
    ds_read_b64_tr_b16 v[144:145], v31 offset:32768
    ds_read_b64_tr_b16 v[146:147], v31 offset:33792
    buffer_load_dwordx4 v7, s[4:7], s58 offen offset:3072 lds
    s_waitcnt lgkmcnt(6)
    v_mfma_f32_16x16x32_bf16 v[68:71], a[64:67], v[132:135], v[68:71]
    ds_read_b64_tr_b16 v[148:149], v28 offset:36864
    v_mfma_f32_16x16x32_bf16 v[84:87], a[68:71], v[132:135], v[84:87]
    ds_read_b64_tr_b16 v[150:151], v28 offset:37888
    s_waitcnt lgkmcnt(6)
    v_mfma_f32_16x16x32_bf16 v[72:75], a[64:67], v[136:139], v[72:75]
    ds_read_b64_tr_b16 v[152:153], v29 offset:36864
    v_mfma_f32_16x16x32_bf16 v[88:91], a[68:71], v[136:139], v[88:91]
    ds_read_b64_tr_b16 v[154:155], v29 offset:37888
    s_add_u32 m0, s56, 16384
    s_add_u32 s58, s54, 0
    buffer_load_dwordx4 v8, s[16:19], s58 offen lds
    s_waitcnt lgkmcnt(6)
    v_mfma_f32_16x16x32_bf16 v[76:79], a[64:67], v[140:143], v[76:79]
    ds_read_b64_tr_b16 v[156:157], v30 offset:36864
    v_mfma_f32_16x16x32_bf16 v[92:95], a[68:71], v[140:143], v[92:95]
    ds_read_b64_tr_b16 v[158:159], v30 offset:37888
    s_waitcnt lgkmcnt(6)
    v_mfma_f32_16x16x32_bf16 v[80:83], a[64:67], v[144:147], v[80:83]
    ds_read_b64_tr_b16 v[160:161], v31 offset:36864
    v_mfma_f32_16x16x32_bf16 v[96:99], a[68:71], v[144:147], v[96:99]
    ds_read_b64_tr_b16 v[162:163], v31 offset:37888
    s_waitcnt lgkmcnt(6)
    v_mfma_f32_16x16x32_bf16 v[68:71], a[72:75], v[148:151], v[68:71]
    ds_read_b64_tr_b16 v[132:133], v28 offset:40960
    v_mfma_f32_16x16x32_bf16 v[84:87], a[76:79], v[148:151], v[84:87]
    ds_read_b64_tr_b16 v[134:135], v28 offset:41984
    s_waitcnt lgkmcnt(6)
    v_mfma_f32_16x16x32_bf16 v[72:75], a[72:75], v[152:155], v[72:75]
    ds_read_b64_tr_b16 v[136:137], v29 offset:40960
    v_mfma_f32_16x16x32_bf16 v[88:91], a[76:79], v[152:155], v[88:91]
    ds_read_b64_tr_b16 v[138:139], v29 offset:41984
    s_waitcnt lgkmcnt(6)
    v_mfma_f32_16x16x32_bf16 v[76:79], a[72:75], v[156:159], v[76:79]
    ds_read_b64_tr_b16 v[140:141], v30 offset:40960
    buffer_load_dwordx4 v9, s[16:19], s58 offen offset:1024 lds
    s_waitcnt vmcnt(14)
    ds_read_b128 a[80:83], v46 offset:0
    ds_read_b128 a[84:87], v46 offset:2048
    ds_read_b128 a[88:91], v47 offset:0
    ds_read_b128 a[92:95], v47 offset:2048
    v_mfma_f32_16x16x32_bf16 v[92:95], a[76:79], v[156:159], v[92:95]
    ds_read_b64_tr_b16 v[142:143], v30 offset:41984
    s_waitcnt lgkmcnt(10)
    v_mfma_f32_16x16x32_bf16 v[80:83], a[72:75], v[160:163], v[80:83]
    ds_read_b64_tr_b16 v[144:145], v31 offset:40960
    v_mfma_f32_16x16x32_bf16 v[96:99], a[76:79], v[160:163], v[96:99]
    ds_read_b64_tr_b16 v[146:147], v31 offset:41984
    s_waitcnt lgkmcnt(3)
    v_mfma_f32_16x16x32_bf16 v[68:71], a[80:83], v[132:135], v[68:71]
    ds_read_b64_tr_b16 v[148:149], v28 offset:45056
    v_mfma_f32_16x16x32_bf16 v[84:87], a[84:87], v[132:135], v[84:87]
    ds_read_b64_tr_b16 v[150:151], v28 offset:46080
    v_mfma_f32_16x16x32_bf16 v[72:75], a[80:83], v[136:139], v[72:75]
    ds_read_b64_tr_b16 v[152:153], v29 offset:45056
    v_mfma_f32_16x16x32_bf16 v[88:91], a[84:87], v[136:139], v[88:91]
    ds_read_b64_tr_b16 v[154:155], v29 offset:46080
    s_waitcnt lgkmcnt(6)
    v_mfma_f32_16x16x32_bf16 v[76:79], a[80:83], v[140:143], v[76:79]
    ds_read_b64_tr_b16 v[156:157], v30 offset:45056
    v_mfma_f32_16x16x32_bf16 v[92:95], a[84:87], v[140:143], v[92:95]
    ds_read_b64_tr_b16 v[158:159], v30 offset:46080
    buffer_load_dwordx4 v10, s[16:19], s58 offen offset:2048 lds
    s_waitcnt lgkmcnt(6)
    v_mfma_f32_16x16x32_bf16 v[80:83], a[80:83], v[144:147], v[80:83]
    ds_read_b64_tr_b16 v[160:161], v31 offset:45056
    v_mfma_f32_16x16x32_bf16 v[96:99], a[84:87], v[144:147], v[96:99]
    ds_read_b64_tr_b16 v[162:163], v31 offset:46080
    v_add_u32 v66, 0x9e3779b9, v66
    v_add_u32 v67, 0x7f4a7c15, v67
    v_readfirstlane_b32 s50, v66
    v_readfirstlane_b32 s51, v67
    s_waitcnt lgkmcnt(6)
    v_mfma_f32_16x16x32_bf16 v[68:71], a[88:91], v[148:151], v[68:71]
    v_mfma_f32_16x16x32_bf16 v[84:87], a[92:95], v[148:151], v[84:87]
    s_waitcnt lgkmcnt(4)
    v_mfma_f32_16x16x32_bf16 v[72:75], a[88:91], v[152:155], v[72:75]
    v_mfma_f32_16x16x32_bf16 v[88:91], a[92:95], v[152:155], v[88:91]
    s_waitcnt vmcnt(11) lgkmcnt(0)
    s_barrier
    v_mfma_f32_16x16x32_bf16 v[76:79], a[88:91], v[156:159], v[76:79]
    ds_read_b64_tr_b16 v[132:133], v32 offset:16384
    ds_read_b64_tr_b16 v[134:135], v32 offset:17408
    s_waitcnt vmcnt(7)
    ds_read_b128 a[96:99], v42 offset:0
    ds_read_b128 a[100:103], v42 offset:2048
    ds_read_b128 a[104:107], v43 offset:0
    ds_read_b128 a[108:111], v43 offset:2048
    v_mfma_f32_16x16x32_bf16 v[92:95], a[92:95], v[156:159], v[92:95]
    ds_read_b64_tr_b16 v[136:137], v33 offset:16384
    ds_read_b64_tr_b16 v[138:139], v33 offset:17408
    buffer_load_dwordx4 v11, s[16:19], s58 offen offset:3072 lds
    v_mfma_f32_16x16x32_bf16 v[80:83], a[88:91], v[160:163], v[80:83]
    ds_read_b64_tr_b16 v[140:141], v34 offset:16384
    ds_read_b64_tr_b16 v[142:143], v34 offset:17408
    v_mfma_f32_16x16x32_bf16 v[96:99], a[92:95], v[160:163], v[96:99]
    ds_read_b64_tr_b16 v[144:145], v35 offset:16384
    ds_read_b64_tr_b16 v[146:147], v35 offset:17408
    s_waitcnt lgkmcnt(6)
    v_mfma_f32_16x16x32_bf16 v[68:71], a[96:99], v[132:135], v[68:71]
    ds_read_b64_tr_b16 v[148:149], v32 offset:20480
    v_mfma_f32_16x16x32_bf16 v[84:87], a[100:103], v[132:135], v[84:87]
    ds_read_b64_tr_b16 v[150:151], v32 offset:21504
    s_waitcnt lgkmcnt(6)
    v_mfma_f32_16x16x32_bf16 v[72:75], a[96:99], v[136:139], v[72:75]
    ds_read_b64_tr_b16 v[152:153], v33 offset:20480
    v_mfma_f32_16x16x32_bf16 v[88:91], a[100:103], v[136:139], v[88:91]
    ds_read_b64_tr_b16 v[154:155], v33 offset:21504
    s_waitcnt lgkmcnt(6)
    v_mfma_f32_16x16x32_bf16 v[76:79], a[96:99], v[140:143], v[76:79]
    ds_read_b64_tr_b16 v[156:157], v34 offset:20480
    v_mfma_f32_16x16x32_bf16 v[92:95], a[100:103], v[140:143], v[92:95]
    ds_read_b64_tr_b16 v[158:159], v34 offset:21504
    s_add_u32 m0, s56, 65536
    s_add_u32 s58, s55, 0
    buffer_load_dwordx4 v8, s[16:19], s58 offen lds
    s_waitcnt lgkmcnt(6)
    v_mfma_f32_16x16x32_bf16 v[80:83], a[96:99], v[144:147], v[80:83]
    ds_read_b64_tr_b16 v[160:161], v35 offset:20480
    v_mfma_f32_16x16x32_bf16 v[96:99], a[100:103], v[144:147], v[96:99]
    ds_read_b64_tr_b16 v[162:163], v35 offset:21504
    s_waitcnt lgkmcnt(6)
    v_mfma_f32_16x16x32_bf16 v[68:71], a[104:107], v[148:151], v[68:71]
    ds_read_b64_tr_b16 v[132:133], v32 offset:24576
    v_mfma_f32_16x16x32_bf16 v[84:87], a[108:111], v[148:151], v[84:87]
    ds_read_b64_tr_b16 v[134:135], v32 offset:25600
    buffer_load_dwordx4 v9, s[16:19], s58 offen offset:1024 lds
    s_waitcnt lgkmcnt(6)
    v_mfma_f32_16x16x32_bf16 v[72:75], a[104:107], v[152:155], v[72:75]
    ds_read_b64_tr_b16 v[136:137], v33 offset:24576
    v_mfma_f32_16x16x32_bf16 v[88:91], a[108:111], v[152:155], v[88:91]
    ds_read_b64_tr_b16 v[138:139], v33 offset:25600
    s_waitcnt lgkmcnt(6)
    v_mfma_f32_16x16x32_bf16 v[76:79], a[104:107], v[156:159], v[76:79]
    ds_read_b64_tr_b16 v[140:141], v34 offset:24576
    s_waitcnt vmcnt(6)
    ds_read_b128 a[112:115], v42 offset:32768
    ds_read_b128 a[116:119], v42 offset:34816
    ds_read_b128 a[120:123], v43 offset:32768
    ds_read_b128 a[124:127], v43 offset:34816
    v_mfma_f32_16x16x32_bf16 v[92:95], a[108:111], v[156:159], v[92:95]
    ds_read_b64_tr_b16 v[142:143], v34 offset:25600
    buffer_load_dwordx4 v10, s[16:19], s58 offen offset:2048 lds
    s_waitcnt lgkmcnt(10)
    v_mfma_f32_16x16x32_bf16 v[80:83], a[104:107], v[160:163], v[80:83]
    ds_read_b64_tr_b16 v[144:145], v35 offset:24576
    v_mfma_f32_16x16x32_bf16 v[96:99], a[108:111], v[160:163], v[96:99]
    ds_read_b64_tr_b16 v[146:147], v35 offset:25600
    s_waitcnt lgkmcnt(3)
    v_mfma_f32_16x16x32_bf16 v[68:71], a[112:115], v[132:135], v[68:71]
    ds_read_b64_tr_b16 v[148:149], v32 offset:28672
    buffer_load_dwordx4 v11, s[16:19], s58 offen offset:3072 lds
    v_mfma_f32_16x16x32_bf16 v[84:87], a[116:119], v[132:135], v[84:87]
    ds_read_b64_tr_b16 v[150:151], v32 offset:29696
    v_mfma_f32_16x16x32_bf16 v[72:75], a[112:115], v[136:139], v[72:75]
    ds_read_b64_tr_b16 v[152:153], v33 offset:28672
    v_mfma_f32_16x16x32_bf16 v[88:91], a[116:119], v[136:139], v[88:91]
    ds_read_b64_tr_b16 v[154:155], v33 offset:29696
    s_waitcnt lgkmcnt(6)
    v_mfma_f32_16x16x32_bf16 v[76:79], a[112:115], v[140:143], v[76:79]
    ds_read_b64_tr_b16 v[156:157], v34 offset:28672
    s_add_u32 m0, s56, 81920
    s_add_u32 s58, s93, 0
    buffer_load_dwordx4 v8, s[16:19], s58 offen lds
    v_mfma_f32_16x16x32_bf16 v[92:95], a[116:119], v[140:143], v[92:95]
    ds_read_b64_tr_b16 v[158:159], v34 offset:29696
    s_waitcnt lgkmcnt(6)
    v_mfma_f32_16x16x32_bf16 v[80:83], a[112:115], v[144:147], v[80:83]
    ds_read_b64_tr_b16 v[160:161], v35 offset:28672
    v_mfma_f32_16x16x32_bf16 v[96:99], a[116:119], v[144:147], v[96:99]
    ds_read_b64_tr_b16 v[162:163], v35 offset:29696
    buffer_load_dwordx4 v9, s[16:19], s58 offen offset:1024 lds
    s_waitcnt lgkmcnt(6)
    v_mfma_f32_16x16x32_bf16 v[68:71], a[120:123], v[148:151], v[68:71]
    v_mfma_f32_16x16x32_bf16 v[84:87], a[124:127], v[148:151], v[84:87]
    s_waitcnt lgkmcnt(4)
    v_mfma_f32_16x16x32_bf16 v[72:75], a[120:123], v[152:155], v[72:75]
    v_mfma_f32_16x16x32_bf16 v[88:91], a[124:127], v[152:155], v[88:91]
    buffer_load_dwordx4 v10, s[16:19], s58 offen offset:2048 lds
    s_waitcnt lgkmcnt(0)
    s_barrier
    v_mfma_f32_16x16x32_bf16 v[76:79], a[120:123], v[156:159], v[76:79]
    v_mfma_f32_16x16x32_bf16 v[92:95], a[124:127], v[156:159], v[92:95]
    v_mfma_f32_16x16x32_bf16 v[80:83], a[120:123], v[160:163], v[80:83]
    v_mfma_f32_16x16x32_bf16 v[96:99], a[124:127], v[160:163], v[96:99]
    buffer_load_dwordx4 v11, s[16:19], s58 offen offset:3072 lds
    v_pk_mul_f32 v[196:197], v[68:69], v[68:69]
    v_pk_mul_f32 v[198:199], v[70:71], v[70:71]
    v_pk_mul_f32 v[200:201], v[72:73], v[72:73]
    v_pk_mul_f32 v[202:203], v[74:75], v[74:75]
    v_pk_fma_f32 v[196:197], v[196:197], v[54:55], v[52:53]
    v_pk_fma_f32 v[198:199], v[198:199], v[54:55], v[52:53]
    v_pk_fma_f32 v[200:201], v[200:201], v[54:55], v[52:53]
    v_pk_fma_f32 v[202:203], v[202:203], v[54:55], v[52:53]
    v_pk_mul_f32 v[196:197], v[196:197], v[68:69]
    v_pk_mul_f32 v[198:199], v[198:199], v[70:71]
    v_pk_mul_f32 v[200:201], v[200:201], v[72:73]
    v_pk_mul_f32 v[202:203], v[202:203], v[74:75]
    s_add_u32 m0, s56, 49152
    s_add_u32 s58, s95, 0
    buffer_load_dwordx4 v8, s[16:19], s58 offen lds
    v_exp_f32 v196, v196
    v_exp_f32 v197, v197
    v_exp_f32 v198, v198
    v_exp_f32 v199, v199
    v_exp_f32 v200, v200
    v_exp_f32 v201, v201
    v_exp_f32 v202, v202
    v_exp_f32 v203, v203
    buffer_load_dwordx4 v9, s[16:19], s58 offen offset:1024 lds
    v_pk_add_f32 v[196:197], v[196:197], v[56:57]
    v_pk_add_f32 v[198:199], v[198:199], v[56:57]
    v_pk_add_f32 v[200:201], v[200:201], v[56:57]
    v_pk_add_f32 v[202:203], v[202:203], v[56:57]
    v_rcp_f32 v196, v196
    v_rcp_f32 v197, v197
    v_rcp_f32 v198, v198
    v_rcp_f32 v199, v199
    v_rcp_f32 v200, v200
    v_rcp_f32 v201, v201
    v_rcp_f32 v202, v202
    v_rcp_f32 v203, v203
    buffer_load_dwordx4 v10, s[16:19], s58 offen offset:2048 lds
    v_pk_mul_f32 v[68:69], v[68:69], v[196:197]
    v_pk_mul_f32 v[70:71], v[70:71], v[198:199]
    v_pk_mul_f32 v[72:73], v[72:73], v[200:201]
    v_pk_mul_f32 v[74:75], v[74:75], v[202:203]
    v_pk_mul_f32 v[196:197], v[76:77], v[76:77]
    v_pk_mul_f32 v[198:199], v[78:79], v[78:79]
    v_pk_mul_f32 v[200:201], v[80:81], v[80:81]
    v_pk_mul_f32 v[202:203], v[82:83], v[82:83]
    v_pk_fma_f32 v[196:197], v[196:197], v[54:55], v[52:53]
    v_pk_fma_f32 v[198:199], v[198:199], v[54:55], v[52:53]
    v_pk_fma_f32 v[200:201], v[200:201], v[54:55], v[52:53]
    v_pk_fma_f32 v[202:203], v[202:203], v[54:55], v[52:53]
    v_pk_mul_f32 v[196:197], v[196:197], v[76:77]
    v_pk_mul_f32 v[198:199], v[198:199], v[78:79]
    v_pk_mul_f32 v[200:201], v[200:201], v[80:81]
    v_pk_mul_f32 v[202:203], v[202:203], v[82:83]
    buffer_load_dwordx4 v11, s[16:19], s58 offen offset:3072 lds
    v_exp_f32 v196, v196
    v_exp_f32 v197, v197
    v_exp_f32 v198, v198
    v_exp_f32 v199, v199
    v_exp_f32 v200, v200
    v_exp_f32 v201, v201
    v_exp_f32 v202, v202
    v_exp_f32 v203, v203
    s_add_u32 m0, s56, 114688
    s_add_u32 s58, s54, 128
    buffer_load_dwordx4 v8, s[16:19], s58 offen lds
    v_pk_add_f32 v[196:197], v[196:197], v[56:57]
    v_pk_add_f32 v[198:199], v[198:199], v[56:57]
    v_pk_add_f32 v[200:201], v[200:201], v[56:57]
    v_pk_add_f32 v[202:203], v[202:203], v[56:57]
    v_rcp_f32 v196, v196
    v_rcp_f32 v197, v197
    v_rcp_f32 v198, v198
    v_rcp_f32 v199, v199
    v_rcp_f32 v200, v200
    v_rcp_f32 v201, v201
    v_rcp_f32 v202, v202
    v_rcp_f32 v203, v203
    v_pk_mul_f32 v[76:77], v[76:77], v[196:197]
    v_pk_mul_f32 v[78:79], v[78:79], v[198:199]
    v_pk_mul_f32 v[80:81], v[80:81], v[200:201]
    v_pk_mul_f32 v[82:83], v[82:83], v[202:203]
    v_pk_mul_f32 v[196:197], v[84:85], v[84:85]
    v_pk_mul_f32 v[198:199], v[86:87], v[86:87]
    v_pk_mul_f32 v[200:201], v[88:89], v[88:89]
    v_pk_mul_f32 v[202:203], v[90:91], v[90:91]
    v_pk_fma_f32 v[196:197], v[196:197], v[54:55], v[52:53]
    v_pk_fma_f32 v[198:199], v[198:199], v[54:55], v[52:53]
    v_pk_fma_f32 v[200:201], v[200:201], v[54:55], v[52:53]
    v_pk_fma_f32 v[202:203], v[202:203], v[54:55], v[52:53]
    v_pk_mul_f32 v[196:197], v[196:197], v[84:85]
    v_pk_mul_f32 v[198:199], v[198:199], v[86:87]
    v_pk_mul_f32 v[200:201], v[200:201], v[88:89]
    v_pk_mul_f32 v[202:203], v[202:203], v[90:91]
    buffer_load_dwordx4 v9, s[16:19], s58 offen offset:1024 lds
    v_exp_f32 v196, v196
    v_exp_f32 v197, v197
    v_exp_f32 v198, v198
    v_exp_f32 v199, v199
    v_exp_f32 v200, v200
    v_exp_f32 v201, v201
    v_exp_f32 v202, v202
    v_exp_f32 v203, v203
    v_pk_add_f32 v[196:197], v[196:197], v[56:57]
    v_pk_add_f32 v[198:199], v[198:199], v[56:57]
    v_pk_add_f32 v[200:201], v[200:201], v[56:57]
    v_pk_add_f32 v[202:203], v[202:203], v[56:57]
    v_rcp_f32 v196, v196
    v_rcp_f32 v197, v197
    v_rcp_f32 v198, v198
    v_rcp_f32 v199, v199
    v_rcp_f32 v200, v200
    v_rcp_f32 v201, v201
    v_rcp_f32 v202, v202
    v_rcp_f32 v203, v203
    buffer_load_dwordx4 v10, s[16:19], s58 offen offset:2048 lds
    v_pk_mul_f32 v[84:85], v[84:85], v[196:197]
    v_pk_mul_f32 v[86:87], v[86:87], v[198:199]
    v_pk_mul_f32 v[88:89], v[88:89], v[200:201]
    v_pk_mul_f32 v[90:91], v[90:91], v[202:203]
    v_pk_mul_f32 v[196:197], v[92:93], v[92:93]
    v_pk_mul_f32 v[198:199], v[94:95], v[94:95]
    v_pk_mul_f32 v[200:201], v[96:97], v[96:97]
    v_pk_mul_f32 v[202:203], v[98:99], v[98:99]
    v_pk_fma_f32 v[196:197], v[196:197], v[54:55], v[52:53]
    v_pk_fma_f32 v[198:199], v[198:199], v[54:55], v[52:53]
    v_pk_fma_f32 v[200:201], v[200:201], v[54:55], v[52:53]
    v_pk_fma_f32 v[202:203], v[202:203], v[54:55], v[52:53]
    v_pk_mul_f32 v[196:197], v[196:197], v[92:93]
    v_pk_mul_f32 v[198:199], v[198:199], v[94:95]
    v_pk_mul_f32 v[200:201], v[200:201], v[96:97]
    v_pk_mul_f32 v[202:203], v[202:203], v[98:99]
    v_exp_f32 v196, v196
    v_exp_f32 v197, v197
    v_exp_f32 v198, v198
    v_exp_f32 v199, v199
    v_exp_f32 v200, v200
    v_exp_f32 v201, v201
    v_exp_f32 v202, v202
    v_exp_f32 v203, v203
    v_pk_add_f32 v[196:197], v[196:197], v[56:57]
    v_pk_add_f32 v[198:199], v[198:199], v[56:57]
    v_pk_add_f32 v[200:201], v[200:201], v[56:57]
    v_pk_add_f32 v[202:203], v[202:203], v[56:57]
    v_rcp_f32 v196, v196
    v_rcp_f32 v197, v197
    v_rcp_f32 v198, v198
    v_rcp_f32 v199, v199
    v_rcp_f32 v200, v200
    v_rcp_f32 v201, v201
    v_rcp_f32 v202, v202
    v_rcp_f32 v203, v203
    buffer_load_dwordx4 v11, s[16:19], s58 offen offset:3072 lds
    v_pk_mul_f32 v[92:93], v[92:93], v[196:197]
    v_pk_mul_f32 v[94:95], v[94:95], v[198:199]
    v_pk_mul_f32 v[96:97], v[96:97], v[200:201]
    v_pk_mul_f32 v[98:99], v[98:99], v[202:203]
    v_pk_add_f32 v[204:205], v[68:69], v[72:73]
    v_pk_mul_f32 v[212:213], v[68:69], v[68:69]
    v_pk_add_f32 v[206:207], v[70:71], v[74:75]
    v_pk_mul_f32 v[214:215], v[70:71], v[70:71]
    v_pk_add_f32 v[208:209], v[84:85], v[88:89]
    v_pk_mul_f32 v[216:217], v[84:85], v[84:85]
    v_pk_add_f32 v[210:211], v[86:87], v[90:91]
    v_pk_mul_f32 v[218:219], v[86:87], v[86:87]
    v_pk_fma_f32 v[212:213], v[72:73], v[72:73], v[212:213]
    v_pk_fma_f32 v[214:215], v[74:75], v[74:75], v[214:215]
    v_pk_fma_f32 v[216:217], v[88:89], v[88:89], v[216:217]
    v_pk_fma_f32 v[218:219], v[90:91], v[90:91], v[218:219]
    v_pk_add_f32 v[204:205], v[204:205], v[76:77]
    v_pk_fma_f32 v[212:213], v[76:77], v[76:77], v[212:213]
    v_pk_add_f32 v[206:207], v[206:207], v[78:79]
    v_pk_fma_f32 v[214:215], v[78:79], v[78:79], v[214:215]
    v_pk_add_f32 v[208:209], v[208:209], v[92:93]
    v_pk_fma_f32 v[216:217], v[92:93], v[92:93], v[216:217]
    v_pk_add_f32 v[210:211], v[210:211], v[94:95]
    v_pk_fma_f32 v[218:219], v[94:95], v[94:95], v[218:219]
    v_pk_add_f32 v[204:205], v[204:205], v[80:81]
    v_pk_fma_f32 v[212:213], v[80:81], v[80:81], v[212:213]
    v_pk_add_f32 v[206:207], v[206:207], v[82:83]
    v_pk_fma_f32 v[214:215], v[82:83], v[82:83], v[214:215]
    v_pk_add_f32 v[208:209], v[208:209], v[96:97]
    v_pk_fma_f32 v[216:217], v[96:97], v[96:97], v[216:217]
    v_pk_add_f32 v[210:211], v[210:211], v[98:99]
    v_pk_fma_f32 v[218:219], v[98:99], v[98:99], v[218:219]
    s_add_u32 m0, s56, 131072
    s_add_u32 s58, s55, 128
    buffer_load_dwordx4 v8, s[16:19], s58 offen lds
    v_add_f32_dpp v204, v204, v204 row_ror:8 row_mask:0xf bank_mask:0x3
    v_add_f32_dpp v205, v205, v205 row_ror:8 row_mask:0xf bank_mask:0x3
    v_add_f32_dpp v206, v206, v206 row_ror:8 row_mask:0xf bank_mask:0x3
    v_add_f32_dpp v207, v207, v207 row_ror:8 row_mask:0xf bank_mask:0x3
    v_add_f32_dpp v212, v212, v212 row_ror:8 row_mask:0xf bank_mask:0x3
    v_add_f32_dpp v213, v213, v213 row_ror:8 row_mask:0xf bank_mask:0x3
    v_add_f32_dpp v214, v214, v214 row_ror:8 row_mask:0xf bank_mask:0x3
    v_add_f32_dpp v215, v215, v215 row_ror:8 row_mask:0xf bank_mask:0x3
    v_add_f32_dpp v204, v208, v208 row_ror:8 row_mask:0xf bank_mask:0xc
    v_add_f32_dpp v205, v209, v209 row_ror:8 row_mask:0xf bank_mask:0xc
    v_add_f32_dpp v206, v210, v210 row_ror:8 row_mask:0xf bank_mask:0xc
    v_add_f32_dpp v207, v211, v211 row_ror:8 row_mask:0xf bank_mask:0xc
    v_add_f32_dpp v212, v216, v216 row_ror:8 row_mask:0xf bank_mask:0xc
    v_add_f32_dpp v213, v217, v217 row_ror:8 row_mask:0xf bank_mask:0xc
    v_add_f32_dpp v214, v218, v218 row_ror:8 row_mask:0xf bank_mask:0xc
    v_add_f32_dpp v215, v219, v219 row_ror:8 row_mask:0xf bank_mask:0xc
    v_add_f32_dpp v204, v204, v204 row_half_mirror row_mask:0xf bank_mask:0x5
    v_add_f32_dpp v205, v205, v205 row_half_mirror row_mask:0xf bank_mask:0x5
    v_add_f32_dpp v212, v212, v212 row_half_mirror row_mask:0xf bank_mask:0x5
    v_add_f32_dpp v213, v213, v213 row_half_mirror row_mask:0xf bank_mask:0x5
    v_add_f32_dpp v204, v206, v206 row_half_mirror row_mask:0xf bank_mask:0xa
    v_add_f32_dpp v205, v207, v207 row_half_mirror row_mask:0xf bank_mask:0xa
    v_add_f32_dpp v212, v214, v214 row_half_mirror row_mask:0xf bank_mask:0xa
    v_add_f32_dpp v213, v215, v215 row_half_mirror row_mask:0xf bank_mask:0xa
    v_add_f32_dpp v204, v204, v204 quad_perm:[1,0,3,2] row_mask:0xf bank_mask:0xf
    v_add_f32_dpp v205, v205, v205 quad_perm:[1,0,3,2] row_mask:0xf bank_mask:0xf
    v_add_f32_dpp v212, v212, v212 quad_perm:[1,0,3,2] row_mask:0xf bank_mask:0xf
    v_add_f32_dpp v213, v213, v213 quad_perm:[1,0,3,2] row_mask:0xf bank_mask:0xf
    v_add_f32_dpp v204, v204, v204 quad_perm:[2,3,0,1] row_mask:0xf bank_mask:0xf
    v_add_f32_dpp v205, v205, v205 quad_perm:[2,3,0,1] row_mask:0xf bank_mask:0xf
    v_add_f32_dpp v212, v212, v212 quad_perm:[2,3,0,1] row_mask:0xf bank_mask:0xf
    v_add_f32_dpp v213, v213, v213 quad_perm:[2,3,0,1] row_mask:0xf bank_mask:0xf
    v_and_b32 v196, 1, v1
    v_cmp_eq_u32 vcc, 1, v196
    v_lshrrev_b32 v197, 2, v1
    v_lshl_add_u32 v197, v197, 1, v196
    v_lshlrev_b32 v197, 4, v197
    v_cndmask_b32 v64, v204, v205, vcc
    v_cndmask_b32 v65, v212, v213, vcc
    s_mul_i32 s65, s57, 7168
    s_add_u32 s65, s65, 131072
    s_lshl_b32 s59, s46, 9
    s_add_u32 s59, s59, s65
    buffer_store_dwordx4 v[64:67], v197, s[40:43], s59 offen sc1
    s_waitcnt vmcnt(18)
    s_barrier
    ds_read_b64_tr_b16 v[132:133], v24 offset:16384
    ds_read_b64_tr_b16 v[134:135], v24 offset:17408
    ds_read_b64_tr_b16 v[136:137], v25 offset:16384
    ds_read_b64_tr_b16 v[138:139], v25 offset:17408
    ds_read_b64_tr_b16 v[140:141], v26 offset:16384
    ds_read_b64_tr_b16 v[142:143], v26 offset:17408
    ds_read_b64_tr_b16 v[144:145], v27 offset:16384
    ds_read_b64_tr_b16 v[146:147], v27 offset:17408
    s_waitcnt lgkmcnt(6)
    v_mfma_f32_16x16x32_bf16 v[100:103], v[132:135], a[0:3], 0
    ds_read_b64_tr_b16 v[148:149], v24 offset:20480
    buffer_load_dwordx4 v9, s[16:19], s58 offen offset:1024 lds
    v_mfma_f32_16x16x32_bf16 v[116:119], v[132:135], a[4:7], 0
    ds_read_b64_tr_b16 v[150:151], v24 offset:21504
    buffer_load_dwordx4 v10, s[16:19], s58 offen offset:2048 lds
    s_waitcnt lgkmcnt(6)
    v_mfma_f32_16x16x32_bf16 v[104:107], v[136:139], a[0:3], 0
    ds_read_b64_tr_b16 v[152:153], v25 offset:20480
    v_mfma_f32_16x16x32_bf16 v[120:123], v[136:139], a[4:7], 0
    ds_read_b64_tr_b16 v[154:155], v25 offset:21504
    s_waitcnt lgkmcnt(6)
    v_mfma_f32_16x16x32_bf16 v[108:111], v[140:143], a[0:3], 0
    ds_read_b64_tr_b16 v[156:157], v26 offset:20480
    buffer_load_dwordx4 v11, s[16:19], s58 offen offset:3072 lds
    v_mfma_f32_16x16x32_bf16 v[124:127], v[140:143], a[4:7], 0
    ds_read_b64_tr_b16 v[158:159], v26 offset:21504
    s_waitcnt lgkmcnt(6)
    v_mfma_f32_16x16x32_bf16 v[112:115], v[144:147], a[0:3], 0
    ds_read_b64_tr_b16 v[160:161], v27 offset:20480
    v_mfma_f32_16x16x32_bf16 v[128:131], v[144:147], a[4:7], 0
    ds_read_b64_tr_b16 v[162:163], v27 offset:21504
    s_waitcnt lgkmcnt(6)
    v_mfma_f32_16x16x32_bf16 v[100:103], v[148:151], a[8:11], v[100:103]
    ds_read_b64_tr_b16 v[132:133], v24 offset:24576
    v_mfma_f32_16x16x32_bf16 v[116:119], v[148:151], a[12:15], v[116:119]
    ds_read_b64_tr_b16 v[134:135], v24 offset:25600
    s_add_u32 m0, s56, 98304
    s_add_u32 s58, s93, 128
    buffer_load_dwordx4 v8, s[16:19], s58 offen lds
    s_waitcnt lgkmcnt(6)
    v_mfma_f32_16x16x32_bf16 v[104:107], v[152:155], a[8:11], v[104:107]
    ds_read_b64_tr_b16 v[136:137], v25 offset:24576
    v_mfma_f32_16x16x32_bf16 v[120:123], v[152:155], a[12:15], v[120:123]
    ds_read_b64_tr_b16 v[138:139], v25 offset:25600
    s_waitcnt lgkmcnt(6)
    v_mfma_f32_16x16x32_bf16 v[108:111], v[156:159], a[8:11], v[108:111]
    ds_read_b64_tr_b16 v[140:141], v26 offset:24576
    buffer_load_dwordx4 v9, s[16:19], s58 offen offset:1024 lds
    v_mfma_f32_16x16x32_bf16 v[124:127], v[156:159], a[12:15], v[124:127]
    ds_read_b64_tr_b16 v[142:143], v26 offset:25600
    s_waitcnt lgkmcnt(6)
    v_mfma_f32_16x16x32_bf16 v[112:115], v[160:163], a[8:11], v[112:115]
    ds_read_b64_tr_b16 v[144:145], v27 offset:24576
    v_mfma_f32_16x16x32_bf16 v[128:131], v[160:163], a[12:15], v[128:131]
    ds_read_b64_tr_b16 v[146:147], v27 offset:25600
    buffer_load_dwordx4 v10, s[16:19], s58 offen offset:2048 lds
    s_waitcnt lgkmcnt(6)
    v_mfma_f32_16x16x32_bf16 v[100:103], v[132:135], a[16:19], v[100:103]
    ds_read_b64_tr_b16 v[148:149], v24 offset:28672
    v_mfma_f32_16x16x32_bf16 v[116:119], v[132:135], a[20:23], v[116:119]
    ds_read_b64_tr_b16 v[150:151], v24 offset:29696
    s_waitcnt lgkmcnt(6)
    v_mfma_f32_16x16x32_bf16 v[104:107], v[136:139], a[16:19], v[104:107]
    ds_read_b64_tr_b16 v[152:153], v25 offset:28672
    buffer_load_dwordx4 v11, s[16:19], s58 offen offset:3072 lds
    v_mfma_f32_16x16x32_bf16 v[120:123], v[136:139], a[20:23], v[120:123]
    ds_read_b64_tr_b16 v[154:155], v25 offset:29696
    s_waitcnt lgkmcnt(6)
    v_mfma_f32_16x16x32_bf16 v[108:111], v[140:143], a[16:19], v[108:111]
    ds_read_b64_tr_b16 v[156:157], v26 offset:28672
    v_mfma_f32_16x16x32_bf16 v[124:127], v[140:143], a[20:23], v[124:127]
    ds_read_b64_tr_b16 v[158:159], v26 offset:29696
    s_waitcnt lgkmcnt(6)
    v_mfma_f32_16x16x32_bf16 v[112:115], v[144:147], a[16:19], v[112:115]
    ds_read_b64_tr_b16 v[160:161], v27 offset:28672
    s_add_u32 m0, s56, 0
    s_add_u32 s58, s95, 128
    buffer_load_dwordx4 v8, s[16:19], s58 offen lds
    v_mfma_f32_16x16x32_bf16 v[128:131], v[144:147], a[20:23], v[128:131]
    ds_read_b64_tr_b16 v[162:163], v27 offset:29696
    s_waitcnt lgkmcnt(6)
    v_mfma_f32_16x16x32_bf16 v[100:103], v[148:151], a[24:27], v[100:103]
    v_mfma_f32_16x16x32_bf16 v[116:119], v[148:151], a[28:31], v[116:119]
    buffer_load_dwordx4 v9, s[16:19], s58 offen offset:1024 lds
    s_waitcnt lgkmcnt(4)
    v_mfma_f32_16x16x32_bf16 v[104:107], v[152:155], a[24:27], v[104:107]
    v_mfma_f32_16x16x32_bf16 v[120:123], v[152:155], a[28:31], v[120:123]
    s_waitcnt vmcnt(23) lgkmcnt(0)
    s_barrier
    v_mfma_f32_16x16x32_bf16 v[108:111], v[156:159], a[24:27], v[108:111]
    ds_read_b64_tr_b16 v[132:133], v28 offset:0
    ds_read_b64_tr_b16 v[134:135], v28 offset:1024
    buffer_load_dwordx4 v10, s[16:19], s58 offen offset:2048 lds
    v_mfma_f32_16x16x32_bf16 v[124:127], v[156:159], a[28:31], v[124:127]
    ds_read_b64_tr_b16 v[136:137], v29 offset:0
    ds_read_b64_tr_b16 v[138:139], v29 offset:1024
    v_mfma_f32_16x16x32_bf16 v[112:115], v[160:163], a[24:27], v[112:115]
    ds_read_b64_tr_b16 v[140:141], v30 offset:0
    ds_read_b64_tr_b16 v[142:143], v30 offset:1024
    v_mfma_f32_16x16x32_bf16 v[128:131], v[160:163], a[28:31], v[128:131]
    ds_read_b64_tr_b16 v[144:145], v31 offset:0
    ds_read_b64_tr_b16 v[146:147], v31 offset:1024
    buffer_load_dwordx4 v11, s[16:19], s58 offen offset:3072 lds
    s_waitcnt lgkmcnt(6)
    v_mfma_f32_16x16x32_bf16 v[100:103], v[132:135], a[32:35], v[100:103]
    ds_read_b64_tr_b16 v[148:149], v28 offset:4096
    v_mfma_f32_16x16x32_bf16 v[116:119], v[132:135], a[36:39], v[116:119]
    ds_read_b64_tr_b16 v[150:151], v28 offset:5120
    s_waitcnt lgkmcnt(6)
    v_mfma_f32_16x16x32_bf16 v[104:107], v[136:139], a[32:35], v[104:107]
    ds_read_b64_tr_b16 v[152:153], v29 offset:4096
    s_add_u32 m0, s56, 32768
    s_add_u32 s94, s94, 512
    s_and_b32 s94, s94, 0x40eff
    buffer_load_dwordx4 v16, s[20:23], s94 offen lds
    v_mfma_f32_16x16x32_bf16 v[120:123], v[136:139], a[36:39], v[120:123]
    ds_read_b64_tr_b16 v[154:155], v29 offset:5120
    s_waitcnt lgkmcnt(6)
    v_mfma_f32_16x16x32_bf16 v[108:111], v[140:143], a[32:35], v[108:111]
    ds_read_b64_tr_b16 v[156:157], v30 offset:4096
    v_mfma_f32_16x16x32_bf16 v[124:127], v[140:143], a[36:39], v[124:127]
    ds_read_b64_tr_b16 v[158:159], v30 offset:5120
    s_waitcnt lgkmcnt(6)
    v_mfma_f32_16x16x32_bf16 v[112:115], v[144:147], a[32:35], v[112:115]
    ds_read_b64_tr_b16 v[160:161], v31 offset:4096
    v_mfma_f32_16x16x32_bf16 v[128:131], v[144:147], a[36:39], v[128:131]
    ds_read_b64_tr_b16 v[162:163], v31 offset:5120
    v_and_b32 v248, 7, v2
H_B_2:
    s_cbranch_execz H_M_2
    v_lshl_add_u32 v248, v3, 3, v248
    v_lshlrev_b32 v248, 4, v248
    v_lshrrev_b32 v249, 3, v2
    v_lshl_add_u32 v248, v249, 9, v248
    v_add_u32 v249, 4096, v248
    buffer_load_dwordx4 v[220:223], v248, s[40:43], s65 offen sc1
    buffer_load_dwordx4 v[224:227], v248, s[40:43], s65 offen offset:1024 sc1
    buffer_load_dwordx4 v[228:231], v248, s[40:43], s65 offen offset:2048 sc1
    buffer_load_dwordx4 v[232:235], v248, s[40:43], s65 offen offset:3072 sc1
    buffer_load_dwordx4 v[236:239], v249, s[40:43], s65 offen sc1
    buffer_load_dwordx4 v[240:243], v249, s[40:43], s65 offen offset:1024 sc1
    buffer_load_dwordx4 v[244:247], v249, s[40:43], s65 offen offset:2048 sc1
    s_waitcnt lgkmcnt(6)
    v_mfma_f32_16x16x32_bf16 v[100:103], v[148:151], a[40:43], v[100:103]
    ds_read_b64_tr_b16 v[132:133], v28 offset:8192
    v_mfma_f32_16x16x32_bf16 v[116:119], v[148:151], a[44:47], v[116:119]
    ds_read_b64_tr_b16 v[134:135], v28 offset:9216
    s_waitcnt lgkmcnt(6)
    v_mfma_f32_16x16x32_bf16 v[104:107], v[152:155], a[40:43], v[104:107]
    ds_read_b64_tr_b16 v[136:137], v29 offset:8192
    v_mfma_f32_16x16x32_bf16 v[120:123], v[152:155], a[44:47], v[120:123]
    ds_read_b64_tr_b16 v[138:139], v29 offset:9216
    s_waitcnt lgkmcnt(6)
    v_mfma_f32_16x16x32_bf16 v[108:111], v[156:159], a[40:43], v[108:111]
    ds_read_b64_tr_b16 v[140:141], v30 offset:8192
    v_mfma_f32_16x16x32_bf16 v[124:127], v[156:159], a[44:47], v[124:127]
    ds_read_b64_tr_b16 v[142:143], v30 offset:9216
    s_waitcnt lgkmcnt(6)
    v_mfma_f32_16x16x32_bf16 v[112:115], v[160:163], a[40:43], v[112:115]
    ds_read_b64_tr_b16 v[144:145], v31 offset:8192
    v_mfma_f32_16x16x32_bf16 v[128:131], v[160:163], a[44:47], v[128:131]
    ds_read_b64_tr_b16 v[146:147], v31 offset:9216
    s_waitcnt lgkmcnt(6)
    v_mfma_f32_16x16x32_bf16 v[100:103], v[132:135], a[48:51], v[100:103]
    ds_read_b64_tr_b16 v[148:149], v28 offset:12288
    v_mfma_f32_16x16x32_bf16 v[116:119], v[132:135], a[52:55], v[116:119]
    ds_read_b64_tr_b16 v[150:151], v28 offset:13312
    s_waitcnt lgkmcnt(6)
    v_mfma_f32_16x16x32_bf16 v[104:107], v[136:139], a[48:51], v[104:107]
    ds_read_b64_tr_b16 v[152:153], v29 offset:12288
    v_mfma_f32_16x16x32_bf16 v[120:123], v[136:139], a[52:55], v[120:123]
    ds_read_b64_tr_b16 v[154:155], v29 offset:13312
    s_waitcnt lgkmcnt(6)
    v_mfma_f32_16x16x32_bf16 v[108:111], v[140:143], a[48:51], v[108:111]
    ds_read_b64_tr_b16 v[156:157], v30 offset:12288
    v_mfma_f32_16x16x32_bf16 v[124:127], v[140:143], a[52:55], v[124:127]
    ds_read_b64_tr_b16 v[158:159], v30 offset:13312
    s_waitcnt lgkmcnt(6)
    v_mfma_f32_16x16x32_bf16 v[112:115], v[144:147], a[48:51], v[112:115]
    ds_read_b64_tr_b16 v[160:161], v31 offset:12288
    v_mfma_f32_16x16x32_bf16 v[128:131], v[144:147], a[52:55], v[128:131]
    ds_read_b64_tr_b16 v[162:163], v31 offset:13312
    s_waitcnt lgkmcnt(6)
    v_mfma_f32_16x16x32_bf16 v[100:103], v[148:151], a[56:59], v[100:103]
    v_mfma_f32_16x16x32_bf16 v[116:119], v[148:151], a[60:63], v[116:119]
    buffer_load_dwordx4 v17, s[20:23], s94 offen offset:1024 lds
    s_waitcnt lgkmcnt(4)
    v_mfma_f32_16x16x32_bf16 v[104:107], v[152:155], a[56:59], v[104:107]
    v_mfma_f32_16x16x32_bf16 v[120:123], v[152:155], a[60:63], v[120:123]
    s_waitcnt vmcnt(30) lgkmcnt(0)
    s_barrier
    v_mfma_f32_16x16x32_bf16 v[108:111], v[156:159], a[56:59], v[108:111]
    ds_read_b64_tr_b16 v[132:133], v28 offset:16384
    ds_read_b64_tr_b16 v[134:135], v28 offset:17408
    v_mfma_f32_16x16x32_bf16 v[124:127], v[156:159], a[60:63], v[124:127]
    ds_read_b64_tr_b16 v[136:137], v29 offset:16384
    ds_read_b64_tr_b16 v[138:139], v29 offset:17408
    v_mfma_f32_16x16x32_bf16 v[112:115], v[160:163], a[56:59], v[112:115]
    ds_read_b64_tr_b16 v[140:141], v30 offset:16384
    ds_read_b64_tr_b16 v[142:143], v30 offset:17408
    v_mfma_f32_16x16x32_bf16 v[128:131], v[160:163], a[60:63], v[128:131]
    ds_read_b64_tr_b16 v[144:145], v31 offset:16384
    ds_read_b64_tr_b16 v[146:147], v31 offset:17408
    s_waitcnt lgkmcnt(6)
    v_mfma_f32_16x16x32_bf16 v[100:103], v[132:135], a[64:67], v[100:103]
    ds_read_b64_tr_b16 v[148:149], v28 offset:20480
    v_mfma_f32_16x16x32_bf16 v[116:119], v[132:135], a[68:71], v[116:119]
    ds_read_b64_tr_b16 v[150:151], v28 offset:21504
    s_waitcnt lgkmcnt(6)
    v_mfma_f32_16x16x32_bf16 v[104:107], v[136:139], a[64:67], v[104:107]
    ds_read_b64_tr_b16 v[152:153], v29 offset:20480
    v_mfma_f32_16x16x32_bf16 v[120:123], v[136:139], a[68:71], v[120:123]
    ds_read_b64_tr_b16 v[154:155], v29 offset:21504
    buffer_load_dwordx4 v18, s[20:23], s94 offen offset:2048 lds
    s_waitcnt lgkmcnt(6)
    v_mfma_f32_16x16x32_bf16 v[108:111], v[140:143], a[64:67], v[108:111]
    ds_read_b64_tr_b16 v[156:157], v30 offset:20480
    v_mfma_f32_16x16x32_bf16 v[124:127], v[140:143], a[68:71], v[124:127]
    ds_read_b64_tr_b16 v[158:159], v30 offset:21504
    s_waitcnt lgkmcnt(6)
    v_mfma_f32_16x16x32_bf16 v[112:115], v[144:147], a[64:67], v[112:115]
    ds_read_b64_tr_b16 v[160:161], v31 offset:20480
    v_mfma_f32_16x16x32_bf16 v[128:131], v[144:147], a[68:71], v[128:131]
    ds_read_b64_tr_b16 v[162:163], v31 offset:21504
    s_waitcnt lgkmcnt(6)
    v_mfma_f32_16x16x32_bf16 v[100:103], v[148:151], a[72:75], v[100:103]
    ds_read_b64_tr_b16 v[132:133], v28 offset:24576
    v_mfma_f32_16x16x32_bf16 v[116:119], v[148:151], a[76:79], v[116:119]
    ds_read_b64_tr_b16 v[134:135], v28 offset:25600
    s_waitcnt lgkmcnt(6)
    v_mfma_f32_16x16x32_bf16 v[104:107], v[152:155], a[72:75], v[104:107]
    ds_read_b64_tr_b16 v[136:137], v29 offset:24576
    v_mfma_f32_16x16x32_bf16 v[120:123], v[152:155], a[76:79], v[120:123]
    ds_read_b64_tr_b16 v[138:139], v29 offset:25600
    s_waitcnt lgkmcnt(6)
    v_mfma_f32_16x16x32_bf16 v[108:111], v[156:159], a[72:75], v[108:111]
    ds_read_b64_tr_b16 v[140:141], v30 offset:24576
    v_mfma_f32_16x16x32_bf16 v[124:127], v[156:159], a[76:79], v[124:127]
    ds_read_b64_tr_b16 v[142:143], v30 offset:25600
    s_waitcnt lgkmcnt(6)
    v_mfma_f32_16x16x32_bf16 v[112:115], v[160:163], a[72:75], v[112:115]
    ds_read_b64_tr_b16 v[144:145], v31 offset:24576
    buffer_load_dwordx4 v19, s[20:23], s94 offen offset:3072 lds
    v_mfma_f32_16x16x32_bf16 v[128:131], v[160:163], a[76:79], v[128:131]
    ds_read_b64_tr_b16 v[146:147], v31 offset:25600
    s_waitcnt vmcnt(3)
L_chk_690:
    v_xor_b32 v62, s50, v222
    v_xor_b32 v63, s51, v223
    v_bitop3_b32 v62, v226, s50, v62 bitop3:0xbe
    v_bitop3_b32 v63, v227, s51, v63 bitop3:0xbe
    v_bitop3_b32 v62, v230, s50, v62 bitop3:0xbe
    v_bitop3_b32 v63, v231, s51, v63 bitop3:0xbe
    v_bitop3_b32 v62, v234, s50, v62 bitop3:0xbe
    v_bitop3_b32 v63, v235, s51, v63 bitop3:0xbe
    v_bitop3_b32 v62, v238, s50, v62 bitop3:0xbe
    v_bitop3_b32 v63, v239, s51, v63 bitop3:0xbe
    v_bitop3_b32 v62, v242, s50, v62 bitop3:0xbe
    v_bitop3_b32 v63, v243, s51, v63 bitop3:0xbe
    v_bitop3_b32 v62, v246, s50, v62 bitop3:0xbe
    v_bitop3_b32 v63, v247, s51, v63 bitop3:0xbe
    v_or_b32 v62, v62, v63
    v_cmp_ne_u32 vcc, 0, v62
    s_nop 0
    s_cbranch_vccnz L_retry_691
L_cont_692:
    v_pk_add_f32 v[220:221], v[220:221], v[224:225]
    v_pk_add_f32 v[228:229], v[228:229], v[232:233]
    v_pk_add_f32 v[236:237], v[236:237], v[240:241]
    v_pk_add_f32 v[220:221], v[220:221], v[228:229]
    v_pk_add_f32 v[236:237], v[236:237], v[244:245]
    v_pk_add_f32 v[220:221], v[220:221], v[236:237]
    s_nop 1
    v_add_f32_dpp v220, v220, v220 row_ror:8 row_mask:0xf bank_mask:0xf
    v_add_f32_dpp v221, v221, v221 row_ror:8 row_mask:0xf bank_mask:0xf
    v_mul_f32 v224, 0x3a924925, v220
    v_mul_f32 v225, 0x3a924925, v221
    v_fma_f32 v225, -v224, v224, v225
    v_max_f32 v225, 0, v225
    v_add_f32 v225, 0x3727c5ac, v225
    v_rsq_f32 v226, v225
    s_nop 0
    v_mul_f32_e64 v227, -v224, v226
    v_mov_b32_dpp v196, v226 row_newbcast:0 row_mask:0xf bank_mask:0xf
    v_mov_b32_dpp v197, v226 row_newbcast:1 row_mask:0xf bank_mask:0xf
    v_mov_b32_dpp v198, v226 row_newbcast:2 row_mask:0xf bank_mask:0xf
    v_mov_b32_dpp v199, v226 row_newbcast:3 row_mask:0xf bank_mask:0xf
    v_mov_b32_dpp v200, v226 row_newbcast:4 row_mask:0xf bank_mask:0xf
    v_mov_b32_dpp v201, v226 row_newbcast:5 row_mask:0xf bank_mask:0xf
    v_mov_b32_dpp v202, v226 row_newbcast:6 row_mask:0xf bank_mask:0xf
    v_mov_b32_dpp v203, v226 row_newbcast:7 row_mask:0xf bank_mask:0xf
    v_mov_b32_dpp v204, v227 row_newbcast:0 row_mask:0xf bank_mask:0xf
    v_mov_b32_dpp v205, v227 row_newbcast:1 row_mask:0xf bank_mask:0xf
    v_mov_b32_dpp v206, v227 row_newbcast:2 row_mask:0xf bank_mask:0xf
    v_mov_b32_dpp v207, v227 row_newbcast:3 row_mask:0xf bank_mask:0xf
    v_mov_b32_dpp v208, v227 row_newbcast:4 row_mask:0xf bank_mask:0xf
    v_mov_b32_dpp v209, v227 row_newbcast:5 row_mask:0xf bank_mask:0xf
    v_mov_b32_dpp v210, v227 row_newbcast:6 row_mask:0xf bank_mask:0xf
    v_mov_b32_dpp v211, v227 row_newbcast:7 row_mask:0xf bank_mask:0xf
    v_pk_fma_f32 v[68:69], v[68:69], v[196:197], v[204:205]
    v_pk_fma_f32 v[70:71], v[70:71], v[198:199], v[206:207]
    v_pk_fma_f32 v[84:85], v[84:85], v[200:201], v[208:209]
    v_pk_fma_f32 v[86:87], v[86:87], v[202:203], v[210:211]
    v_pk_fma_f32 v[72:73], v[72:73], v[196:197], v[204:205]
    v_pk_fma_f32 v[74:75], v[74:75], v[198:199], v[206:207]
    v_pk_fma_f32 v[88:89], v[88:89], v[200:201], v[208:209]
    v_pk_fma_f32 v[90:91], v[90:91], v[202:203], v[210:211]
    v_pk_fma_f32 v[76:77], v[76:77], v[196:197], v[204:205]
    v_pk_fma_f32 v[78:79], v[78:79], v[198:199], v[206:207]
    v_pk_fma_f32 v[92:93], v[92:93], v[200:201], v[208:209]
    v_pk_fma_f32 v[94:95], v[94:95], v[202:203], v[210:211]
    v_pk_fma_f32 v[80:81], v[80:81], v[196:197], v[204:205]
    v_pk_fma_f32 v[82:83], v[82:83], v[198:199], v[206:207]
    v_pk_fma_f32 v[96:97], v[96:97], v[200:201], v[208:209]
    v_pk_fma_f32 v[98:99], v[98:99], v[202:203], v[210:211]
    v_cvt_pk_bf16_f32 v228, v68, v69
    v_cvt_pk_bf16_f32 v229, v70, v71
    v_cvt_pk_bf16_f32 v230, v84, v85
    v_cvt_pk_bf16_f32 v231, v86, v87
    v_cvt_pk_bf16_f32 v232, v72, v73
    v_cvt_pk_bf16_f32 v233, v74, v75
    v_cvt_pk_bf16_f32 v234, v88, v89
    v_cvt_pk_bf16_f32 v235, v90, v91
    v_cvt_pk_bf16_f32 v236, v76, v77
    v_cvt_pk_bf16_f32 v237, v78, v79
    v_cvt_pk_bf16_f32 v238, v92, v93
    v_cvt_pk_bf16_f32 v239, v94, v95
    v_cvt_pk_bf16_f32 v240, v80, v81
    v_cvt_pk_bf16_f32 v241, v82, v83
    v_cvt_pk_bf16_f32 v242, v96, v97
    v_cvt_pk_bf16_f32 v243, v98, v99
    s_lshr_b32 s61, s45, 1
    s_lshl_b32 s61, s61, 0
    s_and_b32 s60, s45, 0
    s_add_u32 s60, s60, s61
    s_bfe_u32 s61, s45, 0x10000
    s_lshl_b32 s61, s61, 3
    s_add_u32 s60, s60, s61
    s_lshr_b32 s59, s60, 3
    s_and_b32 s60, s60, 7
    s_lshl_b32 s60, s60, 2
    s_add_u32 s60, s60, s44
    s_lshl_b32 s60, s60, 11
    s_mul_i32 s59, s59, 14
    s_add_u32 s59, s59, s46
    s_mul_i32 s59, s59, 131072
    s_add_u32 s59, s59, s60
    s_add_u32 s59, s59, 1048576
    s_add_u32 s60, s59, 65536
    buffer_store_dwordx4 v[228:231], v37, s[40:43], s59 offen sc1
    buffer_store_dwordx4 v[232:235], v37, s[40:43], s59 offen offset:128 sc1
    buffer_store_dwordx4 v[236:239], v37, s[40:43], s60 offen sc1
    buffer_store_dwordx4 v[240:243], v37, s[40:43], s60 offen offset:128 sc1
    s_waitcnt lgkmcnt(6)
    v_mfma_f32_16x16x32_bf16 v[100:103], v[132:135], a[80:83], v[100:103]
    ds_read_b64_tr_b16 v[148:149], v28 offset:28672
    v_mfma_f32_16x16x32_bf16 v[116:119], v[132:135], a[84:87], v[116:119]
    ds_read_b64_tr_b16 v[150:151], v28 offset:29696
    s_waitcnt lgkmcnt(6)
    v_mfma_f32_16x16x32_bf16 v[104:107], v[136:139], a[80:83], v[104:107]
    ds_read_b64_tr_b16 v[152:153], v29 offset:28672
    v_mfma_f32_16x16x32_bf16 v[120:123], v[136:139], a[84:87], v[120:123]
    ds_read_b64_tr_b16 v[154:155], v29 offset:29696
    s_waitcnt lgkmcnt(6)
    v_mfma_f32_16x16x32_bf16 v[108:111], v[140:143], a[80:83], v[108:111]
    ds_read_b64_tr_b16 v[156:157], v30 offset:28672
    v_mfma_f32_16x16x32_bf16 v[124:127], v[140:143], a[84:87], v[124:127]
    ds_read_b64_tr_b16 v[158:159], v30 offset:29696
    s_waitcnt lgkmcnt(6)
    v_mfma_f32_16x16x32_bf16 v[112:115], v[144:147], a[80:83], v[112:115]
    ds_read_b64_tr_b16 v[160:161], v31 offset:28672
    v_mfma_f32_16x16x32_bf16 v[128:131], v[144:147], a[84:87], v[128:131]
    ds_read_b64_tr_b16 v[162:163], v31 offset:29696
    s_waitcnt lgkmcnt(6)
    v_mfma_f32_16x16x32_bf16 v[100:103], v[148:151], a[88:91], v[100:103]
    v_mfma_f32_16x16x32_bf16 v[116:119], v[148:151], a[92:95], v[116:119]
    s_waitcnt lgkmcnt(4)
    v_mfma_f32_16x16x32_bf16 v[104:107], v[152:155], a[88:91], v[104:107]
    v_mfma_f32_16x16x32_bf16 v[120:123], v[152:155], a[92:95], v[120:123]
    s_waitcnt lgkmcnt(0)
    s_barrier
    v_mfma_f32_16x16x32_bf16 v[108:111], v[156:159], a[88:91], v[108:111]
    ds_read_b64_tr_b16 v[132:133], v24 offset:49152
    ds_read_b64_tr_b16 v[134:135], v24 offset:50176
    v_mfma_f32_16x16x32_bf16 v[124:127], v[156:159], a[92:95], v[124:127]
    ds_read_b64_tr_b16 v[136:137], v25 offset:49152
    ds_read_b64_tr_b16 v[138:139], v25 offset:50176
    v_mfma_f32_16x16x32_bf16 v[112:115], v[160:163], a[88:91], v[112:115]
    ds_read_b64_tr_b16 v[140:141], v26 offset:49152
    ds_read_b64_tr_b16 v[142:143], v26 offset:50176
    v_mfma_f32_16x16x32_bf16 v[128:131], v[160:163], a[92:95], v[128:131]
    ds_read_b64_tr_b16 v[144:145], v27 offset:49152
    ds_read_b64_tr_b16 v[146:147], v27 offset:50176
    s_waitcnt lgkmcnt(6)
    v_mfma_f32_16x16x32_bf16 v[100:103], v[132:135], a[96:99], v[100:103]
    ds_read_b64_tr_b16 v[148:149], v24 offset:53248
    v_mfma_f32_16x16x32_bf16 v[116:119], v[132:135], a[100:103], v[116:119]
    ds_read_b64_tr_b16 v[150:151], v24 offset:54272
    s_waitcnt lgkmcnt(6)
    v_mfma_f32_16x16x32_bf16 v[104:107], v[136:139], a[96:99], v[104:107]
    ds_read_b64_tr_b16 v[152:153], v25 offset:53248
    v_mfma_f32_16x16x32_bf16 v[120:123], v[136:139], a[100:103], v[120:123]
    ds_read_b64_tr_b16 v[154:155], v25 offset:54272
    s_waitcnt lgkmcnt(6)
    v_mfma_f32_16x16x32_bf16 v[108:111], v[140:143], a[96:99], v[108:111]
    ds_read_b64_tr_b16 v[156:157], v26 offset:53248
    v_mfma_f32_16x16x32_bf16 v[124:127], v[140:143], a[100:103], v[124:127]
    ds_read_b64_tr_b16 v[158:159], v26 offset:54272
    s_waitcnt lgkmcnt(6)
    v_mfma_f32_16x16x32_bf16 v[112:115], v[144:147], a[96:99], v[112:115]
    ds_read_b64_tr_b16 v[160:161], v27 offset:53248
    v_mfma_f32_16x16x32_bf16 v[128:131], v[144:147], a[100:103], v[128:131]
    ds_read_b64_tr_b16 v[162:163], v27 offset:54272
    s_waitcnt lgkmcnt(6)
    v_mfma_f32_16x16x32_bf16 v[100:103], v[148:151], a[104:107], v[100:103]
    ds_read_b64_tr_b16 v[132:133], v24 offset:57344
    v_mfma_f32_16x16x32_bf16 v[116:119], v[148:151], a[108:111], v[116:119]
    ds_read_b64_tr_b16 v[134:135], v24 offset:58368
    s_waitcnt lgkmcnt(6)
    v_mfma_f32_16x16x32_bf16 v[104:107], v[152:155], a[104:107], v[104:107]
    ds_read_b64_tr_b16 v[136:137], v25 offset:57344
    v_mfma_f32_16x16x32_bf16 v[120:123], v[152:155], a[108:111], v[120:123]
    ds_read_b64_tr_b16 v[138:139], v25 offset:58368
    s_waitcnt lgkmcnt(6)
    v_mfma_f32_16x16x32_bf16 v[108:111], v[156:159], a[104:107], v[108:111]
    ds_read_b64_tr_b16 v[140:141], v26 offset:57344
    v_mfma_f32_16x16x32_bf16 v[124:127], v[156:159], a[108:111], v[124:127]
    ds_read_b64_tr_b16 v[142:143], v26 offset:58368
    s_waitcnt lgkmcnt(6)
    v_mfma_f32_16x16x32_bf16 v[112:115], v[160:163], a[104:107], v[112:115]
    ds_read_b64_tr_b16 v[144:145], v27 offset:57344
    v_mfma_f32_16x16x32_bf16 v[128:131], v[160:163], a[108:111], v[128:131]
    ds_read_b64_tr_b16 v[146:147], v27 offset:58368
    s_waitcnt lgkmcnt(6)
    v_mfma_f32_16x16x32_bf16 v[100:103], v[132:135], a[112:115], v[100:103]
    ds_read_b64_tr_b16 v[148:149], v24 offset:61440
    v_mfma_f32_16x16x32_bf16 v[116:119], v[132:135], a[116:119], v[116:119]
    ds_read_b64_tr_b16 v[150:151], v24 offset:62464
    s_waitcnt lgkmcnt(6)
    v_mfma_f32_16x16x32_bf16 v[104:107], v[136:139], a[112:115], v[104:107]
    ds_read_b64_tr_b16 v[152:153], v25 offset:61440
    v_mfma_f32_16x16x32_bf16 v[120:123], v[136:139], a[116:119], v[120:123]
    ds_read_b64_tr_b16 v[154:155], v25 offset:62464
    s_waitcnt lgkmcnt(6)
    v_mfma_f32_16x16x32_bf16 v[108:111], v[140:143], a[112:115], v[108:111]
    ds_read_b64_tr_b16 v[156:157], v26 offset:61440
    v_mfma_f32_16x16x32_bf16 v[124:127], v[140:143], a[116:119], v[124:127]
    ds_read_b64_tr_b16 v[158:159], v26 offset:62464
    s_waitcnt lgkmcnt(6)
    v_mfma_f32_16x16x32_bf16 v[112:115], v[144:147], a[112:115], v[112:115]
    ds_read_b64_tr_b16 v[160:161], v27 offset:61440
    v_mfma_f32_16x16x32_bf16 v[128:131], v[144:147], a[116:119], v[128:131]
    ds_read_b64_tr_b16 v[162:163], v27 offset:62464
    s_waitcnt lgkmcnt(6)
    v_mfma_f32_16x16x32_bf16 v[100:103], v[148:151], a[120:123], v[100:103]
    v_mfma_f32_16x16x32_bf16 v[116:119], v[148:151], a[124:127], v[116:119]
    s_waitcnt lgkmcnt(4)
    v_mfma_f32_16x16x32_bf16 v[104:107], v[152:155], a[120:123], v[104:107]
    v_mfma_f32_16x16x32_bf16 v[120:123], v[152:155], a[124:127], v[120:123]
    s_add_u32 m0, s56, 147456
    s_add_u32 s94, s94, 512
    s_and_b32 s94, s94, 0x40eff
    buffer_load_dwordx4 v16, s[20:23], s94 offen lds
    s_waitcnt lgkmcnt(0)
    s_barrier
    v_mfma_f32_16x16x32_bf16 v[108:111], v[156:159], a[120:123], v[108:111]
    v_mfma_f32_16x16x32_bf16 v[124:127], v[156:159], a[124:127], v[124:127]
    v_mfma_f32_16x16x32_bf16 v[112:115], v[160:163], a[120:123], v[112:115]
    v_mfma_f32_16x16x32_bf16 v[128:131], v[160:163], a[124:127], v[128:131]
    ds_read_b64_tr_b16 v[132:133], v28 offset:49152
    ds_read_b64_tr_b16 v[134:135], v28 offset:50176
    ds_read_b64_tr_b16 v[136:137], v29 offset:49152
    ds_read_b64_tr_b16 v[138:139], v29 offset:50176
    ds_read_b64_tr_b16 v[140:141], v30 offset:49152
    ds_read_b64_tr_b16 v[142:143], v30 offset:50176
    ds_read_b64_tr_b16 v[144:145], v31 offset:49152
    ds_read_b64_tr_b16 v[146:147], v31 offset:50176
    s_waitcnt lgkmcnt(6)
    v_mfma_f32_16x16x32_bf16 v[164:167], v[132:135], a[0:3], 0
    ds_read_b64_tr_b16 v[148:149], v28 offset:53248
    v_mfma_f32_16x16x32_bf16 v[180:183], v[132:135], a[4:7], 0
    ds_read_b64_tr_b16 v[150:151], v28 offset:54272
    s_waitcnt lgkmcnt(6)
    v_mfma_f32_16x16x32_bf16 v[168:171], v[136:139], a[0:3], 0
    ds_read_b64_tr_b16 v[152:153], v29 offset:53248
    buffer_load_dwordx4 v17, s[20:23], s94 offen offset:1024 lds
    v_mfma_f32_16x16x32_bf16 v[184:187], v[136:139], a[4:7], 0
    ds_read_b64_tr_b16 v[154:155], v29 offset:54272
    s_waitcnt lgkmcnt(6)
    v_mfma_f32_16x16x32_bf16 v[172:175], v[140:143], a[0:3], 0
    ds_read_b64_tr_b16 v[156:157], v30 offset:53248
    v_mfma_f32_16x16x32_bf16 v[188:191], v[140:143], a[4:7], 0
    ds_read_b64_tr_b16 v[158:159], v30 offset:54272
    s_waitcnt lgkmcnt(6)
    v_mfma_f32_16x16x32_bf16 v[176:179], v[144:147], a[0:3], 0
    ds_read_b64_tr_b16 v[160:161], v31 offset:53248
    v_mfma_f32_16x16x32_bf16 v[192:195], v[144:147], a[4:7], 0
    ds_read_b64_tr_b16 v[162:163], v31 offset:54272
    s_waitcnt lgkmcnt(6)
    v_mfma_f32_16x16x32_bf16 v[164:167], v[148:151], a[8:11], v[164:167]
    ds_read_b64_tr_b16 v[132:133], v28 offset:57344
    v_mfma_f32_16x16x32_bf16 v[180:183], v[148:151], a[12:15], v[180:183]
    ds_read_b64_tr_b16 v[134:135], v28 offset:58368
    s_waitcnt lgkmcnt(6)
    v_mfma_f32_16x16x32_bf16 v[168:171], v[152:155], a[8:11], v[168:171]
    ds_read_b64_tr_b16 v[136:137], v29 offset:57344
    v_mfma_f32_16x16x32_bf16 v[184:187], v[152:155], a[12:15], v[184:187]
    ds_read_b64_tr_b16 v[138:139], v29 offset:58368
    s_waitcnt lgkmcnt(6)
    v_mfma_f32_16x16x32_bf16 v[172:175], v[156:159], a[8:11], v[172:175]
    ds_read_b64_tr_b16 v[140:141], v30 offset:57344
    v_mfma_f32_16x16x32_bf16 v[188:191], v[156:159], a[12:15], v[188:191]
    ds_read_b64_tr_b16 v[142:143], v30 offset:58368
    buffer_load_dwordx4 v18, s[20:23], s94 offen offset:2048 lds
    s_waitcnt lgkmcnt(6)
    v_mfma_f32_16x16x32_bf16 v[176:179], v[160:163], a[8:11], v[176:179]
    ds_read_b64_tr_b16 v[144:145], v31 offset:57344
    v_mfma_f32_16x16x32_bf16 v[192:195], v[160:163], a[12:15], v[192:195]
    ds_read_b64_tr_b16 v[146:147], v31 offset:58368
    s_lshr_b32 s61, s45, 1
    s_lshl_b32 s61, s61, 0
    s_and_b32 s60, s45, 0
    s_add_u32 s60, s60, s61
    s_bfe_u32 s61, s45, 0x10000
    s_lshl_b32 s61, s61, 3
    s_add_u32 s60, s60, s61
    s_lshl_b32 s59, s46, 4
    s_add_u32 s59, s59, s60
    s_lshl_b32 s59, s59, 4
    s_add_u32 s59, s59, s44
    s_lshl_b32 s59, s59, 3
    s_add_u32 s59, s59, 4096
    s_waitcnt vmcnt(3)
    buffer_store_dwordx2 v[66:67], v50, s[40:43], s59 offen sc1
    s_waitcnt lgkmcnt(6)
    v_mfma_f32_16x16x32_bf16 v[164:167], v[132:135], a[16:19], v[164:167]
    ds_read_b64_tr_b16 v[148:149], v28 offset:61440
    buffer_load_dwordx4 v19, s[20:23], s94 offen offset:3072 lds
    v_mfma_f32_16x16x32_bf16 v[180:183], v[132:135], a[20:23], v[180:183]
    ds_read_b64_tr_b16 v[150:151], v28 offset:62464
    s_waitcnt lgkmcnt(6)
    v_mfma_f32_16x16x32_bf16 v[168:171], v[136:139], a[16:19], v[168:171]
    ds_read_b64_tr_b16 v[152:153], v29 offset:61440
    v_mfma_f32_16x16x32_bf16 v[184:187], v[136:139], a[20:23], v[184:187]
    ds_read_b64_tr_b16 v[154:155], v29 offset:62464
    s_waitcnt lgkmcnt(6)
    v_mfma_f32_16x16x32_bf16 v[172:175], v[140:143], a[16:19], v[172:175]
    ds_read_b64_tr_b16 v[156:157], v30 offset:61440
    v_mfma_f32_16x16x32_bf16 v[188:191], v[140:143], a[20:23], v[188:191]
    ds_read_b64_tr_b16 v[158:159], v30 offset:62464
    s_waitcnt lgkmcnt(6)
    v_mfma_f32_16x16x32_bf16 v[176:179], v[144:147], a[16:19], v[176:179]
    ds_read_b64_tr_b16 v[160:161], v31 offset:61440
    v_mfma_f32_16x16x32_bf16 v[192:195], v[144:147], a[20:23], v[192:195]
    ds_read_b64_tr_b16 v[162:163], v31 offset:62464
    s_add_u32 m0, s56, 16384
    s_add_u32 s94, s94, 512
    s_and_b32 s94, s94, 0x40eff
    buffer_load_dwordx4 v16, s[20:23], s94 offen lds
    s_waitcnt lgkmcnt(6)
    v_mfma_f32_16x16x32_bf16 v[164:167], v[148:151], a[24:27], v[164:167]
    ds_read_b64_tr_b16 v[132:133], v32 offset:0
    v_mfma_f32_16x16x32_bf16 v[180:183], v[148:151], a[28:31], v[180:183]
    ds_read_b64_tr_b16 v[134:135], v32 offset:1024
    buffer_load_dwordx4 v17, s[20:23], s94 offen offset:1024 lds
    s_waitcnt lgkmcnt(6)
    v_mfma_f32_16x16x32_bf16 v[168:171], v[152:155], a[24:27], v[168:171]
    ds_read_b64_tr_b16 v[136:137], v33 offset:0
    v_mfma_f32_16x16x32_bf16 v[184:187], v[152:155], a[28:31], v[184:187]
    ds_read_b64_tr_b16 v[138:139], v33 offset:1024
    s_waitcnt lgkmcnt(6)
    v_mfma_f32_16x16x32_bf16 v[172:175], v[156:159], a[24:27], v[172:175]
    ds_read_b64_tr_b16 v[140:141], v34 offset:0
    v_mfma_f32_16x16x32_bf16 v[188:191], v[156:159], a[28:31], v[188:191]
    ds_read_b64_tr_b16 v[142:143], v34 offset:1024
    buffer_load_dwordx4 v18, s[20:23], s94 offen offset:2048 lds
    s_waitcnt lgkmcnt(6)
    v_mfma_f32_16x16x32_bf16 v[176:179], v[160:163], a[24:27], v[176:179]
    ds_read_b64_tr_b16 v[144:145], v35 offset:0
    v_mfma_f32_16x16x32_bf16 v[192:195], v[160:163], a[28:31], v[192:195]
    ds_read_b64_tr_b16 v[146:147], v35 offset:1024
    s_waitcnt lgkmcnt(6)
    v_mfma_f32_16x16x32_bf16 v[164:167], v[132:135], a[32:35], v[164:167]
    ds_read_b64_tr_b16 v[148:149], v32 offset:4096
    buffer_load_dwordx4 v19, s[20:23], s94 offen offset:3072 lds
    v_mfma_f32_16x16x32_bf16 v[180:183], v[132:135], a[36:39], v[180:183]
    ds_read_b64_tr_b16 v[150:151], v32 offset:5120
    s_waitcnt lgkmcnt(6)
    v_mfma_f32_16x16x32_bf16 v[168:171], v[136:139], a[32:35], v[168:171]
    ds_read_b64_tr_b16 v[152:153], v33 offset:4096
    v_mfma_f32_16x16x32_bf16 v[184:187], v[136:139], a[36:39], v[184:187]
    ds_read_b64_tr_b16 v[154:155], v33 offset:5120
    s_add_u32 m0, s56, 65536
    s_add_u32 s94, s94, 512
    s_and_b32 s94, s94, 0x40eff
    buffer_load_dwordx4 v16, s[20:23], s94 offen lds
    s_waitcnt lgkmcnt(6)
    v_mfma_f32_16x16x32_bf16 v[172:175], v[140:143], a[32:35], v[172:175]
    ds_read_b64_tr_b16 v[156:157], v34 offset:4096
    v_mfma_f32_16x16x32_bf16 v[188:191], v[140:143], a[36:39], v[188:191]
    ds_read_b64_tr_b16 v[158:159], v34 offset:5120
    s_waitcnt lgkmcnt(6)
    v_mfma_f32_16x16x32_bf16 v[176:179], v[144:147], a[32:35], v[176:179]
    ds_read_b64_tr_b16 v[160:161], v35 offset:4096
    buffer_load_dwordx4 v17, s[20:23], s94 offen offset:1024 lds
    v_mfma_f32_16x16x32_bf16 v[192:195], v[144:147], a[36:39], v[192:195]
    ds_read_b64_tr_b16 v[162:163], v35 offset:5120
    s_waitcnt lgkmcnt(6)
    v_mfma_f32_16x16x32_bf16 v[164:167], v[148:151], a[40:43], v[164:167]
    ds_read_b64_tr_b16 v[132:133], v32 offset:8192
    v_mfma_f32_16x16x32_bf16 v[180:183], v[148:151], a[44:47], v[180:183]
    ds_read_b64_tr_b16 v[134:135], v32 offset:9216
    s_waitcnt lgkmcnt(6)
    v_mfma_f32_16x16x32_bf16 v[168:171], v[152:155], a[40:43], v[168:171]
    ds_read_b64_tr_b16 v[136:137], v33 offset:8192
    buffer_load_dwordx4 v18, s[20:23], s94 offen offset:2048 lds
    v_mfma_f32_16x16x32_bf16 v[184:187], v[152:155], a[44:47], v[184:187]
    ds_read_b64_tr_b16 v[138:139], v33 offset:9216
    s_waitcnt lgkmcnt(6)
    v_mfma_f32_16x16x32_bf16 v[172:175], v[156:159], a[40:43], v[172:175]
    ds_read_b64_tr_b16 v[140:141], v34 offset:8192
    v_mfma_f32_16x16x32_bf16 v[188:191], v[156:159], a[44:47], v[188:191]
    ds_read_b64_tr_b16 v[142:143], v34 offset:9216
    buffer_load_dwordx4 v19, s[20:23], s94 offen offset:3072 lds
    s_waitcnt lgkmcnt(6)
    v_mfma_f32_16x16x32_bf16 v[176:179], v[160:163], a[40:43], v[176:179]
    ds_read_b64_tr_b16 v[144:145], v35 offset:8192
    v_mfma_f32_16x16x32_bf16 v[192:195], v[160:163], a[44:47], v[192:195]
    ds_read_b64_tr_b16 v[146:147], v35 offset:9216
    s_waitcnt lgkmcnt(6)
    v_mfma_f32_16x16x32_bf16 v[164:167], v[132:135], a[48:51], v[164:167]
    ds_read_b64_tr_b16 v[148:149], v32 offset:12288
    s_add_u32 m0, s56, 81920
    s_add_u32 s94, s94, 512
    s_and_b32 s94, s94, 0x40eff
    buffer_load_dwordx4 v16, s[20:23], s94 offen lds
    v_mfma_f32_16x16x32_bf16 v[180:183], v[132:135], a[52:55], v[180:183]
    ds_read_b64_tr_b16 v[150:151], v32 offset:13312
    s_waitcnt lgkmcnt(6)
    v_mfma_f32_16x16x32_bf16 v[168:171], v[136:139], a[48:51], v[168:171]
    ds_read_b64_tr_b16 v[152:153], v33 offset:12288
    v_mfma_f32_16x16x32_bf16 v[184:187], v[136:139], a[52:55], v[184:187]
    ds_read_b64_tr_b16 v[154:155], v33 offset:13312
    buffer_load_dwordx4 v17, s[20:23], s94 offen offset:1024 lds
    s_waitcnt lgkmcnt(6)
    v_mfma_f32_16x16x32_bf16 v[172:175], v[140:143], a[48:51], v[172:175]
    ds_read_b64_tr_b16 v[156:157], v34 offset:12288
    v_mfma_f32_16x16x32_bf16 v[188:191], v[140:143], a[52:55], v[188:191]
    ds_read_b64_tr_b16 v[158:159], v34 offset:13312
    s_waitcnt lgkmcnt(6)
    v_mfma_f32_16x16x32_bf16 v[176:179], v[144:147], a[48:51], v[176:179]
    ds_read_b64_tr_b16 v[160:161], v35 offset:12288
    v_mfma_f32_16x16x32_bf16 v[192:195], v[144:147], a[52:55], v[192:195]
    ds_read_b64_tr_b16 v[162:163], v35 offset:13312
    buffer_load_dwordx4 v18, s[20:23], s94 offen offset:2048 lds
    s_waitcnt lgkmcnt(6)
    v_mfma_f32_16x16x32_bf16 v[164:167], v[148:151], a[56:59], v[164:167]
    v_mfma_f32_16x16x32_bf16 v[180:183], v[148:151], a[60:63], v[180:183]
    s_waitcnt lgkmcnt(4)
    v_mfma_f32_16x16x32_bf16 v[168:171], v[152:155], a[56:59], v[168:171]
    buffer_load_dwordx4 v19, s[20:23], s94 offen offset:3072 lds
    v_mfma_f32_16x16x32_bf16 v[184:187], v[152:155], a[60:63], v[184:187]
    s_waitcnt lgkmcnt(0)
    s_barrier
    v_mfma_f32_16x16x32_bf16 v[172:175], v[156:159], a[56:59], v[172:175]
    ds_read_b64_tr_b16 v[132:133], v28 offset:32768
    ds_read_b64_tr_b16 v[134:135], v28 offset:33792
    v_mfma_f32_16x16x32_bf16 v[188:191], v[156:159], a[60:63], v[188:191]
    ds_read_b64_tr_b16 v[136:137], v29 offset:32768
    ds_read_b64_tr_b16 v[138:139], v29 offset:33792
    s_add_u32 m0, s56, 49152
    s_add_u32 s94, s94, 512
    s_and_b32 s94, s94, 0x40eff
    buffer_load_dwordx4 v16, s[20:23], s94 offen lds
    v_mfma_f32_16x16x32_bf16 v[176:179], v[160:163], a[56:59], v[176:179]
    ds_read_b64_tr_b16 v[140:141], v30 offset:32768
    ds_read_b64_tr_b16 v[142:143], v30 offset:33792
    v_mfma_f32_16x16x32_bf16 v[192:195], v[160:163], a[60:63], v[192:195]
    ds_read_b64_tr_b16 v[144:145], v31 offset:32768
    ds_read_b64_tr_b16 v[146:147], v31 offset:33792
    s_lshr_b32 s59, s44, 1
    s_lshl_b32 s60, s47, 1
    s_add_u32 s59, s59, s60
    s_lshl_b32 s59, s59, 11
    s_add_u32 s59, s59, 5120
    v_and_b32 v254, 0x3ff, v51
    v_add_u32 v254, s59, v254
    buffer_load_dwordx2 v[252:253], v254, s[40:43], 0 offen sc1
    s_lshl_b32 s59, s47, 2
    s_add_u32 s59, s59, s44
    s_mul_i32 s59, s59, 65536
    s_add_u32 s59, s59, 2883584
    v_add_u32 v38, s59, v48
    v_add_u32 v39, 4096, v38
    s_add_u32 s63, s53, 7
    s_lshl_b32 s63, s63, 13
    s_waitcnt lgkmcnt(6)
    v_mfma_f32_16x16x32_bf16 v[164:167], v[132:135], a[64:67], v[164:167]
    ds_read_b64_tr_b16 v[148:149], v28 offset:36864
    buffer_load_dwordx4 v17, s[20:23], s94 offen offset:1024 lds
    v_mfma_f32_16x16x32_bf16 v[180:183], v[132:135], a[68:71], v[180:183]
    ds_read_b64_tr_b16 v[150:151], v28 offset:37888
    buffer_load_dwordx4 v18, s[20:23], s94 offen offset:2048 lds
    s_waitcnt lgkmcnt(6)
    v_mfma_f32_16x16x32_bf16 v[168:171], v[136:139], a[64:67], v[168:171]
    ds_read_b64_tr_b16 v[152:153], v29 offset:36864
    v_mfma_f32_16x16x32_bf16 v[184:187], v[136:139], a[68:71], v[184:187]
H_B_3:
    s_cbranch_execz H_M_3
    ds_read_b64_tr_b16 v[154:155], v29 offset:37888
    buffer_load_dwordx4 v19, s[20:23], s94 offen offset:3072 lds
    s_waitcnt lgkmcnt(6)
    v_mfma_f32_16x16x32_bf16 v[172:175], v[140:143], a[64:67], v[172:175]
    ds_read_b64_tr_b16 v[156:157], v30 offset:36864
    v_mfma_f32_16x16x32_bf16 v[188:191], v[140:143], a[68:71], v[188:191]
    ds_read_b64_tr_b16 v[158:159], v30 offset:37888
    s_add_u32 m0, s56, 114688
    s_add_u32 s94, s94, 512
    s_and_b32 s94, s94, 0x40eff
    buffer_load_dwordx4 v16, s[20:23], s94 offen lds
    s_waitcnt lgkmcnt(6)
    v_mfma_f32_16x16x32_bf16 v[176:179], v[144:147], a[64:67], v[176:179]
    ds_read_b64_tr_b16 v[160:161], v31 offset:36864
    v_mfma_f32_16x16x32_bf16 v[192:195], v[144:147], a[68:71], v[192:195]
    ds_read_b64_tr_b16 v[162:163], v31 offset:37888
    buffer_load_dwordx4 v17, s[20:23], s94 offen offset:1024 lds
    s_waitcnt lgkmcnt(6)
    v_mfma_f32_16x16x32_bf16 v[164:167], v[148:151], a[72:75], v[164:167]
    ds_read_b64_tr_b16 v[132:133], v28 offset:40960
    v_mfma_f32_16x16x32_bf16 v[180:183], v[148:151], a[76:79], v[180:183]
    ds_read_b64_tr_b16 v[134:135], v28 offset:41984
    buffer_load_dwordx4 v18, s[20:23], s94 offen offset:2048 lds
    s_waitcnt lgkmcnt(6)
    v_mfma_f32_16x16x32_bf16 v[168:171], v[152:155], a[72:75], v[168:171]
    ds_read_b64_tr_b16 v[136:137], v29 offset:40960
    v_mfma_f32_16x16x32_bf16 v[184:187], v[152:155], a[76:79], v[184:187]
    ds_read_b64_tr_b16 v[138:139], v29 offset:41984
    buffer_load_dwordx4 v19, s[20:23], s94 offen offset:3072 lds
    s_waitcnt lgkmcnt(6)
    v_mfma_f32_16x16x32_bf16 v[172:175], v[156:159], a[72:75], v[172:175]
    ds_read_b64_tr_b16 v[140:141], v30 offset:40960
    v_mfma_f32_16x16x32_bf16 v[188:191], v[156:159], a[76:79], v[188:191]
    ds_read_b64_tr_b16 v[142:143], v30 offset:41984
    s_add_u32 m0, s56, 131072
    s_add_u32 s94, s94, 512
    s_and_b32 s94, s94, 0x40eff
    buffer_load_dwordx4 v16, s[20:23], s94 offen lds
    s_waitcnt lgkmcnt(6)
    v_mfma_f32_16x16x32_bf16 v[176:179], v[160:163], a[72:75], v[176:179]
    ds_read_b64_tr_b16 v[144:145], v31 offset:40960
    v_mfma_f32_16x16x32_bf16 v[192:195], v[160:163], a[76:79], v[192:195]
    ds_read_b64_tr_b16 v[146:147], v31 offset:41984
    buffer_load_dwordx4 v17, s[20:23], s94 offen offset:1024 lds
    s_waitcnt lgkmcnt(6)
    v_mfma_f32_16x16x32_bf16 v[164:167], v[132:135], a[80:83], v[164:167]
    ds_read_b64_tr_b16 v[148:149], v28 offset:45056
    v_mfma_f32_16x16x32_bf16 v[180:183], v[132:135], a[84:87], v[180:183]
    ds_read_b64_tr_b16 v[150:151], v28 offset:46080
    buffer_load_dwordx4 v18, s[20:23], s94 offen offset:2048 lds
    s_waitcnt lgkmcnt(6)
    v_mfma_f32_16x16x32_bf16 v[168:171], v[136:139], a[80:83], v[168:171]
    ds_read_b64_tr_b16 v[152:153], v29 offset:45056
    v_mfma_f32_16x16x32_bf16 v[184:187], v[136:139], a[84:87], v[184:187]
    ds_read_b64_tr_b16 v[154:155], v29 offset:46080
    buffer_load_dwordx4 v19, s[20:23], s94 offen offset:3072 lds
    s_waitcnt lgkmcnt(6)
    v_mfma_f32_16x16x32_bf16 v[172:175], v[140:143], a[80:83], v[172:175]
    ds_read_b64_tr_b16 v[156:157], v30 offset:45056
    v_mfma_f32_16x16x32_bf16 v[188:191], v[140:143], a[84:87], v[188:191]
    ds_read_b64_tr_b16 v[158:159], v30 offset:46080
    s_waitcnt lgkmcnt(6)
    v_mfma_f32_16x16x32_bf16 v[176:179], v[144:147], a[80:83], v[176:179]
    ds_read_b64_tr_b16 v[160:161], v31 offset:45056
    v_mfma_f32_16x16x32_bf16 v[192:195], v[144:147], a[84:87], v[192:195]
    ds_read_b64_tr_b16 v[162:163], v31 offset:46080
    s_waitcnt lgkmcnt(6)
    v_mfma_f32_16x16x32_bf16 v[164:167], v[148:151], a[88:91], v[164:167]
    ds_read_b64_tr_b16 v[132:133], v24 offset:0
    v_mfma_f32_16x16x32_bf16 v[180:183], v[148:151], a[92:95], v[180:183]
    ds_read_b64_tr_b16 v[134:135], v24 offset:1024
    s_waitcnt lgkmcnt(6)
    v_mfma_f32_16x16x32_bf16 v[168:171], v[152:155], a[88:91], v[168:171]
    ds_read_b64_tr_b16 v[136:137], v25 offset:0
    v_mfma_f32_16x16x32_bf16 v[184:187], v[152:155], a[92:95], v[184:187]
    ds_read_b64_tr_b16 v[138:139], v25 offset:1024
    s_waitcnt lgkmcnt(6)
    v_mfma_f32_16x16x32_bf16 v[172:175], v[156:159], a[88:91], v[172:175]
    ds_read_b64_tr_b16 v[140:141], v26 offset:0
    v_mfma_f32_16x16x32_bf16 v[188:191], v[156:159], a[92:95], v[188:191]
    ds_read_b64_tr_b16 v[142:143], v26 offset:1024
    s_waitcnt lgkmcnt(6)
    v_mfma_f32_16x16x32_bf16 v[176:179], v[160:163], a[88:91], v[176:179]
    ds_read_b64_tr_b16 v[144:145], v27 offset:0
    v_mfma_f32_16x16x32_bf16 v[192:195], v[160:163], a[92:95], v[192:195]
    ds_read_b64_tr_b16 v[146:147], v27 offset:1024
    s_waitcnt vmcnt(11)
L_chk_837:
    v_xor_b32 v62, s50, v252
    v_bitop3_b32 v62, v253, s51, v62 bitop3:0xbe
    v_cmp_ne_u32 vcc, 0, v62
    s_nop 0
    s_cbranch_vccnz L_retry_838
L_cont_839:
    s_waitcnt lgkmcnt(6)
    v_mfma_f32_16x16x32_bf16 v[164:167], v[132:135], a[96:99], v[164:167]
    ds_read_b64_tr_b16 v[148:149], v24 offset:4096
    s_add_u32 s63, s63, 8192
    s_and_b32 s63, s63, 0xffff
    buffer_load_dwordx4 a[128:131], v38, s[40:43], s63 offen sc1
    v_mfma_f32_16x16x32_bf16 v[180:183], v[132:135], a[100:103], v[180:183]
    ds_read_b64_tr_b16 v[150:151], v24 offset:5120
    buffer_load_dwordx4 a[132:135], v38, s[40:43], s63 offen offset:1024 sc1
    s_waitcnt lgkmcnt(6)
    v_mfma_f32_16x16x32_bf16 v[168:171], v[136:139], a[96:99], v[168:171]
    ds_read_b64_tr_b16 v[152:153], v25 offset:4096
    buffer_load_dwordx4 a[136:139], v38, s[40:43], s63 offen offset:2048 sc1
    v_mfma_f32_16x16x32_bf16 v[184:187], v[136:139], a[100:103], v[184:187]
    ds_read_b64_tr_b16 v[154:155], v25 offset:5120
    buffer_load_dwordx4 a[140:143], v38, s[40:43], s63 offen offset:3072 sc1
    s_waitcnt lgkmcnt(6)
    v_mfma_f32_16x16x32_bf16 v[172:175], v[140:143], a[96:99], v[172:175]
    ds_read_b64_tr_b16 v[156:157], v26 offset:4096
    v_mfma_f32_16x16x32_bf16 v[188:191], v[140:143], a[100:103], v[188:191]
    ds_read_b64_tr_b16 v[158:159], v26 offset:5120
    s_waitcnt lgkmcnt(6)
    v_mfma_f32_16x16x32_bf16 v[176:179], v[144:147], a[96:99], v[176:179]
    ds_read_b64_tr_b16 v[160:161], v27 offset:4096
    buffer_load_dwordx4 a[144:147], v39, s[40:43], s63 offen sc1
    v_mfma_f32_16x16x32_bf16 v[192:195], v[144:147], a[100:103], v[192:195]
    ds_read_b64_tr_b16 v[162:163], v27 offset:5120
    s_waitcnt lgkmcnt(6)
    v_mfma_f32_16x16x32_bf16 v[164:167], v[148:151], a[104:107], v[164:167]
    ds_read_b64_tr_b16 v[132:133], v24 offset:8192
    v_mfma_f32_16x16x32_bf16 v[180:183], v[148:151], a[108:111], v[180:183]
    ds_read_b64_tr_b16 v[134:135], v24 offset:9216
    s_waitcnt lgkmcnt(6)
    v_mfma_f32_16x16x32_bf16 v[168:171], v[152:155], a[104:107], v[168:171]
    ds_read_b64_tr_b16 v[136:137], v25 offset:8192
    buffer_load_dwordx4 a[148:151], v39, s[40:43], s63 offen offset:1024 sc1
    v_mfma_f32_16x16x32_bf16 v[184:187], v[152:155], a[108:111], v[184:187]
    ds_read_b64_tr_b16 v[138:139], v25 offset:9216
    s_waitcnt lgkmcnt(6)
    v_mfma_f32_16x16x32_bf16 v[172:175], v[156:159], a[104:107], v[172:175]
    ds_read_b64_tr_b16 v[140:141], v26 offset:8192
    v_mfma_f32_16x16x32_bf16 v[188:191], v[156:159], a[108:111], v[188:191]
    ds_read_b64_tr_b16 v[142:143], v26 offset:9216
    s_waitcnt lgkmcnt(6)
    v_mfma_f32_16x16x32_bf16 v[176:179], v[160:163], a[104:107], v[176:179]
    ds_read_b64_tr_b16 v[144:145], v27 offset:8192
    buffer_load_dwordx4 a[152:155], v39, s[40:43], s63 offen offset:2048 sc1
    v_mfma_f32_16x16x32_bf16 v[192:195], v[160:163], a[108:111], v[192:195]
    ds_read_b64_tr_b16 v[146:147], v27 offset:9216
    s_waitcnt lgkmcnt(6)
    v_mfma_f32_16x16x32_bf16 v[164:167], v[132:135], a[112:115], v[164:167]
    ds_read_b64_tr_b16 v[148:149], v24 offset:12288
    v_mfma_f32_16x16x32_bf16 v[180:183], v[132:135], a[116:119], v[180:183]
    ds_read_b64_tr_b16 v[150:151], v24 offset:13312
    s_waitcnt lgkmcnt(6)
    v_mfma_f32_16x16x32_bf16 v[168:171], v[136:139], a[112:115], v[168:171]
    ds_read_b64_tr_b16 v[152:153], v25 offset:12288
    v_mfma_f32_16x16x32_bf16 v[184:187], v[136:139], a[116:119], v[184:187]
    ds_read_b64_tr_b16 v[154:155], v25 offset:13312
    buffer_load_dwordx4 a[156:159], v39, s[40:43], s63 offen offset:3072 sc1
    s_waitcnt lgkmcnt(6)
    v_mfma_f32_16x16x32_bf16 v[172:175], v[140:143], a[112:115], v[172:175]
    ds_read_b64_tr_b16 v[156:157], v26 offset:12288
    v_mfma_f32_16x16x32_bf16 v[188:191], v[140:143], a[116:119], v[188:191]
    ds_read_b64_tr_b16 v[158:159], v26 offset:13312
    s_waitcnt lgkmcnt(6)
    v_mfma_f32_16x16x32_bf16 v[176:179], v[144:147], a[112:115], v[176:179]
    ds_read_b64_tr_b16 v[160:161], v27 offset:12288
    v_mfma_f32_16x16x32_bf16 v[192:195], v[144:147], a[116:119], v[192:195]
    ds_read_b64_tr_b16 v[162:163], v27 offset:13312
    s_add_u32 s63, s63, 8192
    s_and_b32 s63, s63, 0xffff
    buffer_load_dwordx4 a[160:163], v38, s[40:43], s63 offen sc1
    s_waitcnt lgkmcnt(6)
    v_mfma_f32_16x16x32_bf16 v[164:167], v[148:151], a[120:123], v[164:167]
    v_mfma_f32_16x16x32_bf16 v[180:183], v[148:151], a[124:127], v[180:183]
    s_waitcnt lgkmcnt(4)
    v_mfma_f32_16x16x32_bf16 v[168:171], v[152:155], a[120:123], v[168:171]
    v_mfma_f32_16x16x32_bf16 v[184:187], v[152:155], a[124:127], v[184:187]
    buffer_load_dwordx4 a[164:167], v38, s[40:43], s63 offen offset:1024 sc1
    s_waitcnt lgkmcnt(0)
    s_barrier
    v_mfma_f32_16x16x32_bf16 v[172:175], v[156:159], a[120:123], v[172:175]
    v_mfma_f32_16x16x32_bf16 v[188:191], v[156:159], a[124:127], v[188:191]
    v_mfma_f32_16x16x32_bf16 v[176:179], v[160:163], a[120:123], v[176:179]
    v_mfma_f32_16x16x32_bf16 v[192:195], v[160:163], a[124:127], v[192:195]
    v_pk_mul_f32 v[196:197], v[100:101], v[100:101]
    v_pk_mul_f32 v[198:199], v[102:103], v[102:103]
    v_pk_mul_f32 v[200:201], v[104:105], v[104:105]
    v_pk_mul_f32 v[202:203], v[106:107], v[106:107]
    v_pk_fma_f32 v[196:197], v[196:197], v[54:55], v[52:53]
    v_pk_fma_f32 v[198:199], v[198:199], v[54:55], v[52:53]
    v_pk_fma_f32 v[200:201], v[200:201], v[54:55], v[52:53]
    v_pk_fma_f32 v[202:203], v[202:203], v[54:55], v[52:53]
    v_pk_mul_f32 v[196:197], v[196:197], v[100:101]
    v_pk_mul_f32 v[198:199], v[198:199], v[102:103]
    v_pk_mul_f32 v[200:201], v[200:201], v[104:105]
    v_pk_mul_f32 v[202:203], v[202:203], v[106:107]
    buffer_load_dwordx4 a[168:171], v38, s[40:43], s63 offen offset:2048 sc1
    v_exp_f32 v196, v196
    v_exp_f32 v197, v197
    v_exp_f32 v198, v198
    v_exp_f32 v199, v199
    v_exp_f32 v200, v200
    v_exp_f32 v201, v201
    v_exp_f32 v202, v202
    v_exp_f32 v203, v203
    buffer_load_dwordx4 a[172:175], v38, s[40:43], s63 offen offset:3072 sc1
    v_pk_add_f32 v[196:197], v[196:197], v[56:57]
    v_pk_add_f32 v[198:199], v[198:199], v[56:57]
    v_pk_add_f32 v[200:201], v[200:201], v[56:57]
    v_pk_add_f32 v[202:203], v[202:203], v[56:57]
    v_rcp_f32 v196, v196
    v_rcp_f32 v197, v197
    v_rcp_f32 v198, v198
    v_rcp_f32 v199, v199
    v_rcp_f32 v200, v200
    v_rcp_f32 v201, v201
    v_rcp_f32 v202, v202
    v_rcp_f32 v203, v203
    buffer_load_dwordx4 a[176:179], v39, s[40:43], s63 offen sc1
    v_pk_mul_f32 v[100:101], v[100:101], v[196:197]
    v_pk_mul_f32 v[102:103], v[102:103], v[198:199]
    v_pk_mul_f32 v[104:105], v[104:105], v[200:201]
    v_pk_mul_f32 v[106:107], v[106:107], v[202:203]
    v_pk_mul_f32 v[196:197], v[108:109], v[108:109]
    v_pk_mul_f32 v[198:199], v[110:111], v[110:111]
    v_pk_mul_f32 v[200:201], v[112:113], v[112:113]
    v_pk_mul_f32 v[202:203], v[114:115], v[114:115]
    v_pk_fma_f32 v[196:197], v[196:197], v[54:55], v[52:53]
    v_pk_fma_f32 v[198:199], v[198:199], v[54:55], v[52:53]
    v_pk_fma_f32 v[200:201], v[200:201], v[54:55], v[52:53]
    v_pk_fma_f32 v[202:203], v[202:203], v[54:55], v[52:53]
    v_pk_mul_f32 v[196:197], v[196:197], v[108:109]
    v_pk_mul_f32 v[198:199], v[198:199], v[110:111]
    v_pk_mul_f32 v[200:201], v[200:201], v[112:113]
    v_pk_mul_f32 v[202:203], v[202:203], v[114:115]
    buffer_load_dwordx4 a[180:183], v39, s[40:43], s63 offen offset:1024 sc1
    v_exp_f32 v196, v196
    v_exp_f32 v197, v197
    v_exp_f32 v198, v198
    v_exp_f32 v199, v199
    v_exp_f32 v200, v200
    v_exp_f32 v201, v201
    v_exp_f32 v202, v202
    v_exp_f32 v203, v203
    buffer_load_dwordx4 a[184:187], v39, s[40:43], s63 offen offset:2048 sc1
    v_pk_add_f32 v[196:197], v[196:197], v[56:57]
    v_pk_add_f32 v[198:199], v[198:199], v[56:57]
    v_pk_add_f32 v[200:201], v[200:201], v[56:57]
    v_pk_add_f32 v[202:203], v[202:203], v[56:57]
    v_rcp_f32 v196, v196
    v_rcp_f32 v197, v197
    v_rcp_f32 v198, v198
    v_rcp_f32 v199, v199
    v_rcp_f32 v200, v200
    v_rcp_f32 v201, v201
    v_rcp_f32 v202, v202
    v_rcp_f32 v203, v203
    buffer_load_dwordx4 a[188:191], v39, s[40:43], s63 offen offset:3072 sc1
    v_pk_mul_f32 v[108:109], v[108:109], v[196:197]
    v_pk_mul_f32 v[110:111], v[110:111], v[198:199]
    v_pk_mul_f32 v[112:113], v[112:113], v[200:201]
    v_pk_mul_f32 v[114:115], v[114:115], v[202:203]
    v_pk_mul_f32 v[196:197], v[116:117], v[116:117]
    v_pk_mul_f32 v[198:199], v[118:119], v[118:119]
    v_pk_mul_f32 v[200:201], v[120:121], v[120:121]
    v_pk_mul_f32 v[202:203], v[122:123], v[122:123]
    v_pk_fma_f32 v[196:197], v[196:197], v[54:55], v[52:53]
    v_pk_fma_f32 v[198:199], v[198:199], v[54:55], v[52:53]
    v_pk_fma_f32 v[200:201], v[200:201], v[54:55], v[52:53]
    v_pk_fma_f32 v[202:203], v[202:203], v[54:55], v[52:53]
    v_pk_mul_f32 v[196:197], v[196:197], v[116:117]
    v_pk_mul_f32 v[198:199], v[198:199], v[118:119]
    v_pk_mul_f32 v[200:201], v[200:201], v[120:121]
    v_pk_mul_f32 v[202:203], v[202:203], v[122:123]
    s_add_u32 s63, s63, 8192
    s_and_b32 s63, s63, 0xffff
    buffer_load_dwordx4 a[192:195], v38, s[40:43], s63 offen sc1
    v_exp_f32 v196, v196
    v_exp_f32 v197, v197
    v_exp_f32 v198, v198
    v_exp_f32 v199, v199
    v_exp_f32 v200, v200
    v_exp_f32 v201, v201
    v_exp_f32 v202, v202
    v_exp_f32 v203, v203
    buffer_load_dwordx4 a[196:199], v38, s[40:43], s63 offen offset:1024 sc1
    v_pk_add_f32 v[196:197], v[196:197], v[56:57]
    v_pk_add_f32 v[198:199], v[198:199], v[56:57]
    v_pk_add_f32 v[200:201], v[200:201], v[56:57]
    v_pk_add_f32 v[202:203], v[202:203], v[56:57]
    v_rcp_f32 v196, v196
    v_rcp_f32 v197, v197
    v_rcp_f32 v198, v198
    v_rcp_f32 v199, v199
    v_rcp_f32 v200, v200
    v_rcp_f32 v201, v201
    v_rcp_f32 v202, v202
    v_rcp_f32 v203, v203
    buffer_load_dwordx4 a[200:203], v38, s[40:43], s63 offen offset:2048 sc1
    v_pk_mul_f32 v[116:117], v[116:117], v[196:197]
    v_pk_mul_f32 v[118:119], v[118:119], v[198:199]
    v_pk_mul_f32 v[120:121], v[120:121], v[200:201]
    v_pk_mul_f32 v[122:123], v[122:123], v[202:203]
    v_pk_mul_f32 v[196:197], v[124:125], v[124:125]
    v_pk_mul_f32 v[198:199], v[126:127], v[126:127]
    v_pk_mul_f32 v[200:201], v[128:129], v[128:129]
    v_pk_mul_f32 v[202:203], v[130:131], v[130:131]
    v_pk_fma_f32 v[196:197], v[196:197], v[54:55], v[52:53]
    v_pk_fma_f32 v[198:199], v[198:199], v[54:55], v[52:53]
    v_pk_fma_f32 v[200:201], v[200:201], v[54:55], v[52:53]
    v_pk_fma_f32 v[202:203], v[202:203], v[54:55], v[52:53]
    v_pk_mul_f32 v[196:197], v[196:197], v[124:125]
    v_pk_mul_f32 v[198:199], v[198:199], v[126:127]
    v_pk_mul_f32 v[200:201], v[200:201], v[128:129]
    v_pk_mul_f32 v[202:203], v[202:203], v[130:131]
    buffer_load_dwordx4 a[204:207], v38, s[40:43], s63 offen offset:3072 sc1
    v_exp_f32 v196, v196
    v_exp_f32 v197, v197
    v_exp_f32 v198, v198
    v_exp_f32 v199, v199
    v_exp_f32 v200, v200
    v_exp_f32 v201, v201
    v_exp_f32 v202, v202
    v_exp_f32 v203, v203
    buffer_load_dwordx4 a[208:211], v39, s[40:43], s63 offen sc1
    v_pk_add_f32 v[196:197], v[196:197], v[56:57]
    v_pk_add_f32 v[198:199], v[198:199], v[56:57]
    v_pk_add_f32 v[200:201], v[200:201], v[56:57]
    v_pk_add_f32 v[202:203], v[202:203], v[56:57]
    v_rcp_f32 v196, v196
    v_rcp_f32 v197, v197
    v_rcp_f32 v198, v198
    v_rcp_f32 v199, v199
    v_rcp_f32 v200, v200
    v_rcp_f32 v201, v201
    v_rcp_f32 v202, v202
    v_rcp_f32 v203, v203
    buffer_load_dwordx4 a[212:215], v39, s[40:43], s63 offen offset:1024 sc1
    v_pk_mul_f32 v[124:125], v[124:125], v[196:197]
    v_pk_mul_f32 v[126:127], v[126:127], v[198:199]
    v_pk_mul_f32 v[128:129], v[128:129], v[200:201]
    v_pk_mul_f32 v[130:131], v[130:131], v[202:203]
    v_cvt_pk_bf16_f32 v204, v100, v101
    v_cvt_pk_bf16_f32 v205, v102, v103
    v_cvt_pk_bf16_f32 v206, v104, v105
    v_cvt_pk_bf16_f32 v207, v106, v107
    v_cvt_pk_bf16_f32 v208, v108, v109
    v_cvt_pk_bf16_f32 v209, v110, v111
    v_cvt_pk_bf16_f32 v210, v112, v113
    v_cvt_pk_bf16_f32 v211, v114, v115
    v_cvt_pk_bf16_f32 v212, v116, v117
    v_cvt_pk_bf16_f32 v213, v118, v119
    v_cvt_pk_bf16_f32 v214, v120, v121
    v_cvt_pk_bf16_f32 v215, v122, v123
    v_cvt_pk_bf16_f32 v216, v124, v125
    v_cvt_pk_bf16_f32 v217, v126, v127
    v_cvt_pk_bf16_f32 v218, v128, v129
    v_cvt_pk_bf16_f32 v219, v130, v131
    v_mov_b32 v100, v204
    v_mov_b32 v101, v205
    v_mov_b32 v102, v206
    v_mov_b32 v103, v207
    v_mov_b32 v104, v208
    v_mov_b32 v105, v209
    v_mov_b32 v106, v210
    v_mov_b32 v107, v211
    v_mov_b32 v108, v212
    v_mov_b32 v109, v213
    v_mov_b32 v110, v214
    v_mov_b32 v111, v215
    v_mov_b32 v112, v216
    v_mov_b32 v113, v217
    v_mov_b32 v114, v218
    v_mov_b32 v115, v219
    s_mul_i32 s59, s57, 57344
    s_lshl_b32 s60, s47, 13
    s_add_u32 s59, s59, s60
    s_add_u32 s59, s59, 5242880
    s_and_b32 s61, s44, 1
    s_lshl_b32 s61, s61, 11
    s_add_u32 s61, s61, 0
    v_add_u32 v220, s61, v36
    s_cmp_ge_u32 s44, 2
    s_cbranch_scc1 L_z1own_864
    buffer_store_dwordx4 v[100:103], v36, s[40:43], s59 offen sc1
    buffer_store_dwordx4 v[104:107], v36, s[40:43], s59 offen offset:2048 sc1
    buffer_store_dwordx4 v[108:111], v36, s[40:43], s59 offen offset:256 sc1
    buffer_store_dwordx4 v[112:115], v36, s[40:43], s59 offen offset:2304 sc1
    s_branch L_z1done_865
L_z1own_864:
    ds_write_b128 v220, v[100:103] offset:0
    ds_write_b128 v220, v[104:107] offset:4096
    ds_write_b128 v220, v[108:111] offset:256
    ds_write_b128 v220, v[112:115] offset:4352
    s_waitcnt lgkmcnt(0)
L_z1done_865:
    s_nop 1
    v_pk_mul_f32 v[196:197], v[164:165], v[164:165]
    v_pk_mul_f32 v[198:199], v[166:167], v[166:167]
    v_pk_mul_f32 v[200:201], v[168:169], v[168:169]
    v_pk_mul_f32 v[202:203], v[170:171], v[170:171]
    v_pk_fma_f32 v[196:197], v[196:197], v[54:55], v[52:53]
    v_pk_fma_f32 v[198:199], v[198:199], v[54:55], v[52:53]
    v_pk_fma_f32 v[200:201], v[200:201], v[54:55], v[52:53]
    v_pk_fma_f32 v[202:203], v[202:203], v[54:55], v[52:53]
    v_pk_mul_f32 v[196:197], v[196:197], v[164:165]
    v_pk_mul_f32 v[198:199], v[198:199], v[166:167]
    v_pk_mul_f32 v[200:201], v[200:201], v[168:169]
    v_pk_mul_f32 v[202:203], v[202:203], v[170:171]
    v_exp_f32 v196, v196
    v_exp_f32 v197, v197
    v_exp_f32 v198, v198
    v_exp_f32 v199, v199
    v_exp_f32 v200, v200
    v_exp_f32 v201, v201
    v_exp_f32 v202, v202
    v_exp_f32 v203, v203
    v_pk_add_f32 v[196:197], v[196:197], v[56:57]
    v_pk_add_f32 v[198:199], v[198:199], v[56:57]
    v_pk_add_f32 v[200:201], v[200:201], v[56:57]
    v_pk_add_f32 v[202:203], v[202:203], v[56:57]
    v_rcp_f32 v196, v196
    v_rcp_f32 v197, v197
    v_rcp_f32 v198, v198
    v_rcp_f32 v199, v199
    v_rcp_f32 v200, v200
    v_rcp_f32 v201, v201
    v_rcp_f32 v202, v202
    v_rcp_f32 v203, v203
    v_pk_mul_f32 v[164:165], v[164:165], v[196:197]
    v_pk_mul_f32 v[166:167], v[166:167], v[198:199]
    v_pk_mul_f32 v[168:169], v[168:169], v[200:201]
    v_pk_mul_f32 v[170:171], v[170:171], v[202:203]
    v_pk_mul_f32 v[196:197], v[172:173], v[172:173]
    v_pk_mul_f32 v[198:199], v[174:175], v[174:175]
    v_pk_mul_f32 v[200:201], v[176:177], v[176:177]
    v_pk_mul_f32 v[202:203], v[178:179], v[178:179]
    v_pk_fma_f32 v[196:197], v[196:197], v[54:55], v[52:53]
    v_pk_fma_f32 v[198:199], v[198:199], v[54:55], v[52:53]
    v_pk_fma_f32 v[200:201], v[200:201], v[54:55], v[52:53]
    v_pk_fma_f32 v[202:203], v[202:203], v[54:55], v[52:53]
    v_pk_mul_f32 v[196:197], v[196:197], v[172:173]
    v_pk_mul_f32 v[198:199], v[198:199], v[174:175]
    v_pk_mul_f32 v[200:201], v[200:201], v[176:177]
    v_pk_mul_f32 v[202:203], v[202:203], v[178:179]
    v_exp_f32 v196, v196
    v_exp_f32 v197, v197
    v_exp_f32 v198, v198
    v_exp_f32 v199, v199
    v_exp_f32 v200, v200
    v_exp_f32 v201, v201
    v_exp_f32 v202, v202
    v_exp_f32 v203, v203
    buffer_load_dwordx4 a[216:219], v39, s[40:43], s63 offen offset:2048 sc1
    v_pk_add_f32 v[196:197], v[196:197], v[56:57]
    v_pk_add_f32 v[198:199], v[198:199], v[56:57]
    v_pk_add_f32 v[200:201], v[200:201], v[56:57]
    v_pk_add_f32 v[202:203], v[202:203], v[56:57]
    v_rcp_f32 v196, v196
    v_rcp_f32 v197, v197
    v_rcp_f32 v198, v198
    v_rcp_f32 v199, v199
    v_rcp_f32 v200, v200
    v_rcp_f32 v201, v201
    v_rcp_f32 v202, v202
    v_rcp_f32 v203, v203
    buffer_load_dwordx4 a[220:223], v39, s[40:43], s63 offen offset:3072 sc1
    v_pk_mul_f32 v[172:173], v[172:173], v[196:197]
    v_pk_mul_f32 v[174:175], v[174:175], v[198:199]
    v_pk_mul_f32 v[176:177], v[176:177], v[200:201]
    v_pk_mul_f32 v[178:179], v[178:179], v[202:203]
    v_pk_mul_f32 v[196:197], v[180:181], v[180:181]
    v_pk_mul_f32 v[198:199], v[182:183], v[182:183]
    v_pk_mul_f32 v[200:201], v[184:185], v[184:185]
    v_pk_mul_f32 v[202:203], v[186:187], v[186:187]
    v_pk_fma_f32 v[196:197], v[196:197], v[54:55], v[52:53]
    v_pk_fma_f32 v[198:199], v[198:199], v[54:55], v[52:53]
    v_pk_fma_f32 v[200:201], v[200:201], v[54:55], v[52:53]
    v_pk_fma_f32 v[202:203], v[202:203], v[54:55], v[52:53]
    v_pk_mul_f32 v[196:197], v[196:197], v[180:181]
    v_pk_mul_f32 v[198:199], v[198:199], v[182:183]
    v_pk_mul_f32 v[200:201], v[200:201], v[184:185]
    v_pk_mul_f32 v[202:203], v[202:203], v[186:187]
    s_add_u32 s63, s63, 8192
    s_and_b32 s63, s63, 0xffff
    buffer_load_dwordx4 a[224:227], v38, s[40:43], s63 offen sc1
    v_exp_f32 v196, v196
    v_exp_f32 v197, v197
    v_exp_f32 v198, v198
    v_exp_f32 v199, v199
    v_exp_f32 v200, v200
    v_exp_f32 v201, v201
    v_exp_f32 v202, v202
    v_exp_f32 v203, v203
    buffer_load_dwordx4 a[228:231], v38, s[40:43], s63 offen offset:1024 sc1
    v_pk_add_f32 v[196:197], v[196:197], v[56:57]
    v_pk_add_f32 v[198:199], v[198:199], v[56:57]
    v_pk_add_f32 v[200:201], v[200:201], v[56:57]
    v_pk_add_f32 v[202:203], v[202:203], v[56:57]
    v_rcp_f32 v196, v196
    v_rcp_f32 v197, v197
    v_rcp_f32 v198, v198
    v_rcp_f32 v199, v199
    v_rcp_f32 v200, v200
    v_rcp_f32 v201, v201
    v_rcp_f32 v202, v202
    v_rcp_f32 v203, v203
    buffer_load_dwordx4 a[232:235], v38, s[40:43], s63 offen offset:2048 sc1
    v_pk_mul_f32 v[180:181], v[180:181], v[196:197]
    v_pk_mul_f32 v[182:183], v[182:183], v[198:199]
    v_pk_mul_f32 v[184:185], v[184:185], v[200:201]
    v_pk_mul_f32 v[186:187], v[186:187], v[202:203]
    v_pk_mul_f32 v[196:197], v[188:189], v[188:189]
    v_pk_mul_f32 v[198:199], v[190:191], v[190:191]
    v_pk_mul_f32 v[200:201], v[192:193], v[192:193]
    v_pk_mul_f32 v[202:203], v[194:195], v[194:195]
    v_pk_fma_f32 v[196:197], v[196:197], v[54:55], v[52:53]
    v_pk_fma_f32 v[198:199], v[198:199], v[54:55], v[52:53]
    v_pk_fma_f32 v[200:201], v[200:201], v[54:55], v[52:53]
    v_pk_fma_f32 v[202:203], v[202:203], v[54:55], v[52:53]
    v_pk_mul_f32 v[196:197], v[196:197], v[188:189]
    v_pk_mul_f32 v[198:199], v[198:199], v[190:191]
    v_pk_mul_f32 v[200:201], v[200:201], v[192:193]
    v_pk_mul_f32 v[202:203], v[202:203], v[194:195]
    buffer_load_dwordx4 a[236:239], v38, s[40:43], s63 offen offset:3072 sc1
    v_exp_f32 v196, v196
    v_exp_f32 v197, v197
    v_exp_f32 v198, v198
    v_exp_f32 v199, v199
    v_exp_f32 v200, v200
    v_exp_f32 v201, v201
    v_exp_f32 v202, v202
    v_exp_f32 v203, v203
    buffer_load_dwordx4 a[240:243], v39, s[40:43], s63 offen sc1
    v_pk_add_f32 v[196:197], v[196:197], v[56:57]
    v_pk_add_f32 v[198:199], v[198:199], v[56:57]
    v_pk_add_f32 v[200:201], v[200:201], v[56:57]
    v_pk_add_f32 v[202:203], v[202:203], v[56:57]
    v_rcp_f32 v196, v196
    v_rcp_f32 v197, v197
    v_rcp_f32 v198, v198
    v_rcp_f32 v199, v199
    v_rcp_f32 v200, v200
    v_rcp_f32 v201, v201
    v_rcp_f32 v202, v202
    v_rcp_f32 v203, v203
    buffer_load_dwordx4 a[244:247], v39, s[40:43], s63 offen offset:1024 sc1
    v_pk_mul_f32 v[188:189], v[188:189], v[196:197]
    v_pk_mul_f32 v[190:191], v[190:191], v[198:199]
    v_pk_mul_f32 v[192:193], v[192:193], v[200:201]
    v_pk_mul_f32 v[194:195], v[194:195], v[202:203]
    v_cvt_pk_bf16_f32 v204, v164, v165
    v_cvt_pk_bf16_f32 v205, v166, v167
    v_cvt_pk_bf16_f32 v206, v168, v169
    v_cvt_pk_bf16_f32 v207, v170, v171
    v_cvt_pk_bf16_f32 v208, v172, v173
    v_cvt_pk_bf16_f32 v209, v174, v175
    v_cvt_pk_bf16_f32 v210, v176, v177
    v_cvt_pk_bf16_f32 v211, v178, v179
    v_cvt_pk_bf16_f32 v212, v180, v181
    v_cvt_pk_bf16_f32 v213, v182, v183
    v_cvt_pk_bf16_f32 v214, v184, v185
    v_cvt_pk_bf16_f32 v215, v186, v187
    v_cvt_pk_bf16_f32 v216, v188, v189
    v_cvt_pk_bf16_f32 v217, v190, v191
    v_cvt_pk_bf16_f32 v218, v192, v193
    v_cvt_pk_bf16_f32 v219, v194, v195
    s_mul_i32 s59, s57, 57344
    s_lshl_b32 s60, s47, 13
    s_add_u32 s59, s59, s60
    s_add_u32 s59, s59, 5246976
    s_and_b32 s61, s44, 1
    s_lshl_b32 s61, s61, 11
    s_add_u32 s61, s61, 8192
    v_add_u32 v220, s61, v36
    s_cmp_ge_u32 s44, 2
    s_cbranch_scc1 L_z1own_866
    buffer_store_dwordx4 v[204:207], v36, s[40:43], s59 offen sc1
    buffer_store_dwordx4 v[208:211], v36, s[40:43], s59 offen offset:2048 sc1
    buffer_store_dwordx4 v[212:215], v36, s[40:43], s59 offen offset:256 sc1
    buffer_store_dwordx4 v[216:219], v36, s[40:43], s59 offen offset:2304 sc1
    s_branch L_z1done_867
L_z1own_866:
    ds_write_b128 v220, v[204:207] offset:0
    ds_write_b128 v220, v[208:211] offset:4096
    ds_write_b128 v220, v[212:215] offset:256
    ds_write_b128 v220, v[216:219] offset:4352
    s_waitcnt lgkmcnt(0)
L_z1done_867:
    s_nop 1
    s_barrier
    s_add_u32 s59, s56, 0
    v_add_u32 v220, s59, v48
    ds_read_b128 v[164:167], v220 offset:0
    ds_read_b128 v[168:171], v220 offset:1024
    ds_read_b128 v[172:175], v220 offset:2048
    ds_read_b128 v[176:179], v220 offset:3072
    s_lshl_b32 s64, s45, 3
    s_add_u32 s64, s64, s47
    s_lshl_b32 s64, s64, 7
    s_lshl_b32 s60, s44, 3
    s_add_u32 s64, s64, s60
    s_add_u32 s64, s64, 81920
    s_nop 7
L_P2:
H_M_0:
    s_cbranch_execz H_T_0
    v_and_b32 v198, 31, v1
    v_bfe_u32 v199, v1, 1, 3
    v_lshrrev_b32 v4, 5, v1
    v_xor_b32 v199, v199, v4
    v_lshlrev_b32 v199, 4, v199
    v_lshl_add_u32 v4, v198, 7, v199
    v_xor_b32 v5, 32, v4
    v_xor_b32 v6, 64, v4
    v_xor_b32 v7, 96, v4
    v_add_u32 v8, 0x10000, v4
    v_add_u32 v9, 0x10000, v5
    v_add_u32 v10, 0x10000, v6
    v_add_u32 v11, 0x10000, v7
    v_add_u32 v12, 0x20000, v4
    v_add_u32 v13, 0x20000, v5
    v_add_u32 v14, 0x20000, v6
    v_add_u32 v15, 0x20000, v7
    s_waitcnt lgkmcnt(0)
    s_barrier
    ds_read_b128 v[132:135], v4 offset:32768
    ds_read_b128 v[136:139], v4 offset:40960
    ds_read_b128 v[140:143], v5 offset:32768
    ds_read_b128 v[144:147], v5 offset:40960
    s_waitcnt vmcnt(28)
    s_waitcnt lgkmcnt(2)
    v_mfma_f32_32x32x16_bf16 v[68:83], a[128:131], v[132:135], 0
    ds_read_b128 v[148:151], v6 offset:32768
H_M_1:
    s_cbranch_execz H_T_1
    buffer_load_dwordx4 a[248:251], v39, s[40:43], s63 offen offset:2048 sc1
    v_mfma_f32_32x32x16_bf16 v[84:99], a[128:131], v[136:139], 0
    ds_read_b128 v[152:155], v6 offset:40960
    buffer_load_dwordx4 a[252:255], v39, s[40:43], s63 offen offset:3072 sc1
    s_waitcnt lgkmcnt(2)
    v_mfma_f32_32x32x16_bf16 v[68:83], a[132:135], v[140:143], v[68:83]
    ds_read_b128 v[156:159], v7 offset:32768
    v_mfma_f32_32x32x16_bf16 v[84:99], a[132:135], v[144:147], v[84:99]
    ds_read_b128 v[160:163], v7 offset:40960
    s_waitcnt vmcnt(28)
    s_waitcnt lgkmcnt(2)
    v_mfma_f32_32x32x16_bf16 v[68:83], a[136:139], v[148:151], v[68:83]
    ds_read_b128 v[132:135], v4 offset:36864
    s_add_u32 m0, s56, 98304
    s_add_u32 s94, s94, 262656
    s_and_b32 s94, s94, 0x40eff
    buffer_load_dwordx4 v16, s[20:23], s94 offen lds
    v_mfma_f32_32x32x16_bf16 v[84:99], a[136:139], v[152:155], v[84:99]
    ds_read_b128 v[136:139], v4 offset:45056
    s_waitcnt lgkmcnt(2)
    v_mfma_f32_32x32x16_bf16 v[68:83], a[140:143], v[156:159], v[68:83]
    ds_read_b128 v[140:143], v5 offset:36864
    v_mfma_f32_32x32x16_bf16 v[84:99], a[140:143], v[160:163], v[84:99]
    ds_read_b128 v[144:147], v5 offset:45056
    s_waitcnt vmcnt(27)
    s_waitcnt lgkmcnt(2)
    v_mfma_f32_32x32x16_bf16 v[68:83], a[144:147], v[132:135], v[68:83]
    ds_read_b128 v[148:151], v6 offset:36864
    buffer_load_dwordx4 v17, s[20:23], s94 offen offset:1024 lds
    v_mfma_f32_32x32x16_bf16 v[84:99], a[144:147], v[136:139], v[84:99]
    ds_read_b128 v[152:155], v6 offset:45056
    buffer_load_dwordx4 v18, s[20:23], s94 offen offset:2048 lds
    s_waitcnt lgkmcnt(2)
    v_mfma_f32_32x32x16_bf16 v[68:83], a[148:151], v[140:143], v[68:83]
    ds_read_b128 v[156:159], v7 offset:36864
    v_mfma_f32_32x32x16_bf16 v[84:99], a[148:151], v[144:147], v[84:99]
    ds_read_b128 v[160:163], v7 offset:45056
    s_waitcnt vmcnt(5)
    s_waitcnt lgkmcnt(2)
    v_mfma_f32_32x32x16_bf16 v[68:83], a[152:155], v[148:151], v[68:83]
    buffer_load_dwordx4 v19, s[20:23], s94 offen offset:3072 lds
    v_mfma_f32_32x32x16_bf16 v[84:99], a[152:155], v[152:155], v[84:99]
    s_waitcnt lgkmcnt(0)
    s_barrier
    v_mfma_f32_32x32x16_bf16 v[68:83], a[156:159], v[156:159], v[68:83]
    ds_read_b128 v[132:135], v12 offset:16384
    ds_read_b128 v[136:139], v12 offset:24576
    v_mfma_f32_32x32x16_bf16 v[84:99], a[156:159], v[160:163], v[84:99]
    ds_read_b128 v[140:143], v13 offset:16384
    ds_read_b128 v[144:147], v13 offset:24576
    buffer_store_dwordx2 v[66:67], v50, s[40:43], s64 offen sc1
    s_waitcnt lgkmcnt(2)
    v_mfma_f32_32x32x16_bf16 v[68:83], a[160:163], v[132:135], v[68:83]
    ds_read_b128 v[148:151], v14 offset:16384
    s_add_u32 m0, s56, 0
    s_add_u32 s94, s94, 512
    s_and_b32 s94, s94, 0x40eff
    buffer_load_dwordx4 v16, s[20:23], s94 offen lds
    v_mfma_f32_32x32x16_bf16 v[84:99], a[160:163], v[136:139], v[84:99]
    ds_read_b128 v[152:155], v14 offset:24576
    buffer_load_dwordx4 v17, s[20:23], s94 offen offset:1024 lds
    s_waitcnt lgkmcnt(2)
    v_mfma_f32_32x32x16_bf16 v[68:83], a[164:167], v[140:143], v[68:83]
    ds_read_b128 v[156:159], v15 offset:16384
    v_mfma_f32_32x32x16_bf16 v[84:99], a[164:167], v[144:147], v[84:99]
    ds_read_b128 v[160:163], v15 offset:24576
    s_waitcnt lgkmcnt(2)
    v_mfma_f32_32x32x16_bf16 v[68:83], a[168:171], v[148:151], v[68:83]
    ds_read_b128 v[132:135], v12 offset:20480
    buffer_load_dwordx4 v18, s[20:23], s94 offen offset:2048 lds
    v_mfma_f32_32x32x16_bf16 v[84:99], a[168:171], v[152:155], v[84:99]
    ds_read_b128 v[136:139], v12 offset:28672
    s_waitcnt lgkmcnt(2)
    v_mfma_f32_32x32x16_bf16 v[68:83], a[172:175], v[156:159], v[68:83]
    ds_read_b128 v[140:143], v13 offset:20480
    v_mfma_f32_32x32x16_bf16 v[84:99], a[172:175], v[160:163], v[84:99]
    ds_read_b128 v[144:147], v13 offset:28672
    s_waitcnt lgkmcnt(2)
    v_mfma_f32_32x32x16_bf16 v[68:83], a[176:179], v[132:135], v[68:83]
    ds_read_b128 v[148:151], v14 offset:20480
    buffer_load_dwordx4 v19, s[20:23], s94 offen offset:3072 lds
    v_mfma_f32_32x32x16_bf16 v[84:99], a[176:179], v[136:139], v[84:99]
    ds_read_b128 v[152:155], v14 offset:28672
    s_add_u32 s63, s63, 8192
    s_and_b32 s63, s63, 0xffff
    buffer_load_dwordx4 a[0:3], v38, s[40:43], s63 offen sc1
    s_waitcnt lgkmcnt(2)
    v_mfma_f32_32x32x16_bf16 v[68:83], a[180:183], v[140:143], v[68:83]
    ds_read_b128 v[156:159], v15 offset:20480
    v_mfma_f32_32x32x16_bf16 v[84:99], a[180:183], v[144:147], v[84:99]
    ds_read_b128 v[160:163], v15 offset:28672
    s_waitcnt lgkmcnt(2)
    v_mfma_f32_32x32x16_bf16 v[68:83], a[184:187], v[148:151], v[68:83]
    ds_read_b128 v[132:135], v4 offset:16384
    buffer_load_dwordx4 a[4:7], v38, s[40:43], s63 offen offset:1024 sc1
    v_mfma_f32_32x32x16_bf16 v[84:99], a[184:187], v[152:155], v[84:99]
    ds_read_b128 v[136:139], v4 offset:24576
    s_waitcnt lgkmcnt(2)
    v_mfma_f32_32x32x16_bf16 v[68:83], a[188:191], v[156:159], v[68:83]
    ds_read_b128 v[140:143], v5 offset:16384
    v_mfma_f32_32x32x16_bf16 v[84:99], a[188:191], v[160:163], v[84:99]
    ds_read_b128 v[144:147], v5 offset:24576
    s_waitcnt lgkmcnt(2)
    v_mfma_f32_32x32x16_bf16 v[68:83], a[192:195], v[132:135], v[68:83]
    ds_read_b128 v[148:151], v6 offset:16384
    buffer_load_dwordx4 a[8:11], v38, s[40:43], s63 offen offset:2048 sc1
    v_mfma_f32_32x32x16_bf16 v[84:99], a[192:195], v[136:139], v[84:99]
    ds_read_b128 v[152:155], v6 offset:24576
    buffer_load_dwordx4 a[12:15], v38, s[40:43], s63 offen offset:3072 sc1
    s_waitcnt lgkmcnt(2)
    v_mfma_f32_32x32x16_bf16 v[68:83], a[196:199], v[140:143], v[68:83]
    ds_read_b128 v[156:159], v7 offset:16384
    v_mfma_f32_32x32x16_bf16 v[84:99], a[196:199], v[144:147], v[84:99]
    ds_read_b128 v[160:163], v7 offset:24576
    s_waitcnt lgkmcnt(2)
    v_mfma_f32_32x32x16_bf16 v[68:83], a[200:203], v[148:151], v[68:83]
    ds_read_b128 v[132:135], v4 offset:20480
    buffer_load_dwordx4 a[16:19], v39, s[40:43], s63 offen sc1
    v_mfma_f32_32x32x16_bf16 v[84:99], a[200:203], v[152:155], v[84:99]
    ds_read_b128 v[136:139], v4 offset:28672
    s_waitcnt lgkmcnt(2)
    v_mfma_f32_32x32x16_bf16 v[68:83], a[204:207], v[156:159], v[68:83]
    ds_read_b128 v[140:143], v5 offset:20480
    v_mfma_f32_32x32x16_bf16 v[84:99], a[204:207], v[160:163], v[84:99]
    ds_read_b128 v[144:147], v5 offset:28672
    s_waitcnt lgkmcnt(2)
    v_mfma_f32_32x32x16_bf16 v[68:83], a[208:211], v[132:135], v[68:83]
    ds_read_b128 v[148:151], v6 offset:20480
    buffer_load_dwordx4 a[20:23], v39, s[40:43], s63 offen offset:1024 sc1
    v_mfma_f32_32x32x16_bf16 v[84:99], a[208:211], v[136:139], v[84:99]
    ds_read_b128 v[152:155], v6 offset:28672
    buffer_load_dwordx4 a[24:27], v39, s[40:43], s63 offen offset:2048 sc1
    s_waitcnt lgkmcnt(2)
    v_mfma_f32_32x32x16_bf16 v[68:83], a[212:215], v[140:143], v[68:83]
    ds_read_b128 v[156:159], v7 offset:20480
    v_mfma_f32_32x32x16_bf16 v[84:99], a[212:215], v[144:147], v[84:99]
    ds_read_b128 v[160:163], v7 offset:28672
    s_waitcnt lgkmcnt(2)
    v_mfma_f32_32x32x16_bf16 v[68:83], a[216:219], v[148:151], v[68:83]
    ds_read_b128 v[132:135], v8 offset:0
    buffer_load_dwordx4 a[28:31], v39, s[40:43], s63 offen offset:3072 sc1
    v_mfma_f32_32x32x16_bf16 v[84:99], a[216:219], v[152:155], v[84:99]
    ds_read_b128 v[136:139], v8 offset:8192
    s_waitcnt lgkmcnt(2)
    v_mfma_f32_32x32x16_bf16 v[68:83], a[220:223], v[156:159], v[68:83]
    ds_read_b128 v[140:143], v9 offset:0
    v_mfma_f32_32x32x16_bf16 v[84:99], a[220:223], v[160:163], v[84:99]
    ds_read_b128 v[144:147], v9 offset:8192
    s_waitcnt lgkmcnt(2)
    v_mfma_f32_32x32x16_bf16 v[68:83], a[224:227], v[132:135], v[68:83]
    ds_read_b128 v[148:151], v10 offset:0
    s_add_u32 s63, s63, 8192
    s_and_b32 s63, s63, 0xffff
    buffer_load_dwordx4 a[32:35], v38, s[40:43], s63 offen sc1
    v_mfma_f32_32x32x16_bf16 v[84:99], a[224:227], v[136:139], v[84:99]
    ds_read_b128 v[152:155], v10 offset:8192
    buffer_load_dwordx4 a[36:39], v38, s[40:43], s63 offen offset:1024 sc1
    s_waitcnt lgkmcnt(2)
    v_mfma_f32_32x32x16_bf16 v[68:83], a[228:231], v[140:143], v[68:83]
    ds_read_b128 v[156:159], v11 offset:0
    v_mfma_f32_32x32x16_bf16 v[84:99], a[228:231], v[144:147], v[84:99]
    ds_read_b128 v[160:163], v11 offset:8192
    s_waitcnt lgkmcnt(2)
    v_mfma_f32_32x32x16_bf16 v[68:83], a[232:235], v[148:151], v[68:83]
    ds_read_b128 v[132:135], v8 offset:4096
    buffer_load_dwordx4 a[40:43], v38, s[40:43], s63 offen offset:2048 sc1
    v_mfma_f32_32x32x16_bf16 v[84:99], a[232:235], v[152:155], v[84:99]
    ds_read_b128 v[136:139], v8 offset:12288
    s_waitcnt lgkmcnt(2)
    v_mfma_f32_32x32x16_bf16 v[68:83], a[236:239], v[156:159], v[68:83]
    ds_read_b128 v[140:143], v9 offset:4096
    v_mfma_f32_32x32x16_bf16 v[84:99], a[236:239], v[160:163], v[84:99]
    ds_read_b128 v[144:147], v9 offset:12288
    v_lshrrev_b32 v198, 2, v2
    v_and_b32 v199, 3, v2
    v_lshl_add_u32 v198, v198, 3, v199
    v_and_b32 v199, 1, v3
    v_lshl_add_u32 v198, v199, 2, v198
    v_lshlrev_b32 v198, 1, v198
    s_lshl_b32 s59, s49, 7
    buffer_load_ushort v200, v198, s[24:27], s59 offen
    buffer_load_ushort v201, v198, s[24:27], s59 offen offset:64
    s_waitcnt lgkmcnt(2)
    v_mfma_f32_32x32x16_bf16 v[68:83], a[240:243], v[132:135], v[68:83]
    ds_read_b128 v[148:151], v10 offset:4096
    buffer_load_dwordx4 a[44:47], v38, s[40:43], s63 offen offset:3072 sc1
    v_mfma_f32_32x32x16_bf16 v[84:99], a[240:243], v[136:139], v[84:99]
    ds_read_b128 v[152:155], v10 offset:12288
    buffer_load_dwordx4 a[48:51], v39, s[40:43], s63 offen sc1
    s_waitcnt lgkmcnt(2)
    v_mfma_f32_32x32x16_bf16 v[68:83], a[244:247], v[140:143], v[68:83]
    ds_read_b128 v[156:159], v11 offset:4096
    v_mfma_f32_32x32x16_bf16 v[84:99], a[244:247], v[144:147], v[84:99]
    ds_read_b128 v[160:163], v11 offset:12288
    s_waitcnt vmcnt(24)
    s_waitcnt lgkmcnt(2)
    v_mfma_f32_32x32x16_bf16 v[68:83], a[248:251], v[148:151], v[68:83]
    buffer_load_dwordx4 a[52:55], v39, s[40:43], s63 offen offset:1024 sc1
    v_mfma_f32_32x32x16_bf16 v[84:99], a[248:251], v[152:155], v[84:99]
    s_waitcnt lgkmcnt(0)
    s_barrier
    v_mfma_f32_32x32x16_bf16 v[68:83], a[252:255], v[156:159], v[68:83]
    ds_read_b128 v[132:135], v8 offset:16384
    ds_read_b128 v[136:139], v8 offset:24576
    v_mfma_f32_32x32x16_bf16 v[84:99], a[252:255], v[160:163], v[84:99]
    ds_read_b128 v[140:143], v9 offset:16384
    ds_read_b128 v[144:147], v9 offset:24576
    s_waitcnt vmcnt(14)
    s_waitcnt lgkmcnt(2)
    v_mfma_f32_32x32x16_bf16 v[68:83], a[0:3], v[132:135], v[68:83]
    ds_read_b128 v[148:151], v10 offset:16384
    buffer_load_dwordx4 a[56:59], v39, s[40:43], s63 offen offset:2048 sc1
    v_mfma_f32_32x32x16_bf16 v[84:99], a[0:3], v[136:139], v[84:99]
    ds_read_b128 v[152:155], v10 offset:24576
    buffer_load_dwordx4 a[60:63], v39, s[40:43], s63 offen offset:3072 sc1
    s_waitcnt lgkmcnt(2)
    v_mfma_f32_32x32x16_bf16 v[68:83], a[4:7], v[140:143], v[68:83]
    ds_read_b128 v[156:159], v11 offset:16384
    v_mfma_f32_32x32x16_bf16 v[84:99], a[4:7], v[144:147], v[84:99]
    ds_read_b128 v[160:163], v11 offset:24576
    s_waitcnt vmcnt(14)
    s_waitcnt lgkmcnt(2)
    v_mfma_f32_32x32x16_bf16 v[68:83], a[8:11], v[148:151], v[68:83]
    ds_read_b128 v[132:135], v8 offset:20480
    s_add_u32 s63, s63, 8192
    s_and_b32 s63, s63, 0xffff
    buffer_load_dwordx4 a[64:67], v38, s[40:43], s63 offen sc1
    v_mfma_f32_32x32x16_bf16 v[84:99], a[8:11], v[152:155], v[84:99]
    ds_read_b128 v[136:139], v8 offset:28672
    s_waitcnt lgkmcnt(2)
    v_mfma_f32_32x32x16_bf16 v[68:83], a[12:15], v[156:159], v[68:83]
    ds_read_b128 v[140:143], v9 offset:20480
    v_mfma_f32_32x32x16_bf16 v[84:99], a[12:15], v[160:163], v[84:99]
    ds_read_b128 v[144:147], v9 offset:28672
    s_waitcnt vmcnt(13)
    s_waitcnt lgkmcnt(2)
    v_mfma_f32_32x32x16_bf16 v[68:83], a[16:19], v[132:135], v[68:83]
    ds_read_b128 v[148:151], v10 offset:20480
    buffer_load_dwordx4 a[68:71], v38, s[40:43], s63 offen offset:1024 sc1
    v_mfma_f32_32x32x16_bf16 v[84:99], a[16:19], v[136:139], v[84:99]
    ds_read_b128 v[152:155], v10 offset:28672
    buffer_load_dwordx4 a[72:75], v38, s[40:43], s63 offen offset:2048 sc1
    s_waitcnt lgkmcnt(2)
    v_mfma_f32_32x32x16_bf16 v[68:83], a[20:23], v[140:143], v[68:83]
    ds_read_b128 v[156:159], v11 offset:20480
    v_mfma_f32_32x32x16_bf16 v[84:99], a[20:23], v[144:147], v[84:99]
    ds_read_b128 v[160:163], v11 offset:28672
    s_waitcnt vmcnt(13)
    s_waitcnt lgkmcnt(2)
    v_mfma_f32_32x32x16_bf16 v[68:83], a[24:27], v[148:151], v[68:83]
    ds_read_b128 v[132:135], v4 offset:49152
    buffer_load_dwordx4 a[76:79], v38, s[40:43], s63 offen offset:3072 sc1
    v_mfma_f32_32x32x16_bf16 v[84:99], a[24:27], v[152:155], v[84:99]
    ds_read_b128 v[136:139], v4 offset:57344
    s_waitcnt lgkmcnt(2)
    v_mfma_f32_32x32x16_bf16 v[68:83], a[28:31], v[156:159], v[68:83]
    ds_read_b128 v[140:143], v5 offset:49152
    v_mfma_f32_32x32x16_bf16 v[84:99], a[28:31], v[160:163], v[84:99]
    ds_read_b128 v[144:147], v5 offset:57344
    s_waitcnt vmcnt(12)
    s_waitcnt lgkmcnt(2)
    v_mfma_f32_32x32x16_bf16 v[68:83], a[32:35], v[132:135], v[68:83]
    ds_read_b128 v[148:151], v6 offset:49152
    buffer_load_dwordx4 a[80:83], v39, s[40:43], s63 offen sc1
    v_mfma_f32_32x32x16_bf16 v[84:99], a[32:35], v[136:139], v[84:99]
    ds_read_b128 v[152:155], v6 offset:57344
    buffer_load_dwordx4 a[84:87], v39, s[40:43], s63 offen offset:1024 sc1
    s_waitcnt lgkmcnt(2)
    v_mfma_f32_32x32x16_bf16 v[68:83], a[36:39], v[140:143], v[68:83]
    ds_read_b128 v[156:159], v7 offset:49152
    v_mfma_f32_32x32x16_bf16 v[84:99], a[36:39], v[144:147], v[84:99]
    ds_read_b128 v[160:163], v7 offset:57344
    s_waitcnt vmcnt(10)
    s_waitcnt lgkmcnt(2)
    v_mfma_f32_32x32x16_bf16 v[68:83], a[40:43], v[148:151], v[68:83]
    ds_read_b128 v[132:135], v4 offset:53248
    buffer_load_dwordx4 a[88:91], v39, s[40:43], s63 offen offset:2048 sc1
    v_mfma_f32_32x32x16_bf16 v[84:99], a[40:43], v[152:155], v[84:99]
    ds_read_b128 v[136:139], v4 offset:61440
    s_waitcnt lgkmcnt(2)
    v_mfma_f32_32x32x16_bf16 v[68:83], a[44:47], v[156:159], v[68:83]
    ds_read_b128 v[140:143], v5 offset:53248
    v_mfma_f32_32x32x16_bf16 v[84:99], a[44:47], v[160:163], v[84:99]
    ds_read_b128 v[144:147], v5 offset:61440
    s_waitcnt vmcnt(9)
    s_waitcnt lgkmcnt(2)
    v_mfma_f32_32x32x16_bf16 v[68:83], a[48:51], v[132:135], v[68:83]
    ds_read_b128 v[148:151], v6 offset:53248
    buffer_load_dwordx4 a[92:95], v39, s[40:43], s63 offen offset:3072 sc1
    v_mfma_f32_32x32x16_bf16 v[84:99], a[48:51], v[136:139], v[84:99]
    ds_read_b128 v[152:155], v6 offset:61440
    s_add_u32 s63, s63, 8192
    s_and_b32 s63, s63, 0xffff
    buffer_load_dwordx4 a[96:99], v38, s[40:43], s63 offen sc1
    s_waitcnt lgkmcnt(2)
    v_mfma_f32_32x32x16_bf16 v[68:83], a[52:55], v[140:143], v[68:83]
    ds_read_b128 v[156:159], v7 offset:53248
    v_mfma_f32_32x32x16_bf16 v[84:99], a[52:55], v[144:147], v[84:99]
    ds_read_b128 v[160:163], v7 offset:61440
    s_waitcnt vmcnt(9)
    s_waitcnt lgkmcnt(2)
    v_mfma_f32_32x32x16_bf16 v[68:83], a[56:59], v[148:151], v[68:83]
    ds_read_b128 v[132:135], v8 offset:49152
    buffer_load_dwordx4 a[100:103], v38, s[40:43], s63 offen offset:1024 sc1
    v_mfma_f32_32x32x16_bf16 v[84:99], a[56:59], v[152:155], v[84:99]
    ds_read_b128 v[136:139], v8 offset:57344
    s_waitcnt lgkmcnt(2)
    v_mfma_f32_32x32x16_bf16 v[68:83], a[60:63], v[156:159], v[68:83]
    ds_read_b128 v[140:143], v9 offset:49152
    v_mfma_f32_32x32x16_bf16 v[84:99], a[60:63], v[160:163], v[84:99]
    ds_read_b128 v[144:147], v9 offset:57344
    s_waitcnt vmcnt(8)
    s_waitcnt lgkmcnt(2)
    v_mfma_f32_32x32x16_bf16 v[68:83], a[64:67], v[132:135], v[68:83]
    ds_read_b128 v[148:151], v10 offset:49152
    buffer_load_dwordx4 a[104:107], v38, s[40:43], s63 offen offset:2048 sc1
    v_mfma_f32_32x32x16_bf16 v[84:99], a[64:67], v[136:139], v[84:99]
    ds_read_b128 v[152:155], v10 offset:57344
    buffer_load_dwordx4 a[108:111], v38, s[40:43], s63 offen offset:3072 sc1
    s_waitcnt lgkmcnt(2)
    v_mfma_f32_32x32x16_bf16 v[68:83], a[68:71], v[140:143], v[68:83]
    ds_read_b128 v[156:159], v11 offset:49152
    v_mfma_f32_32x32x16_bf16 v[84:99], a[68:71], v[144:147], v[84:99]
    ds_read_b128 v[160:163], v11 offset:57344
    s_waitcnt vmcnt(8)
    s_waitcnt lgkmcnt(2)
    v_mfma_f32_32x32x16_bf16 v[68:83], a[72:75], v[148:151], v[68:83]
    ds_read_b128 v[132:135], v8 offset:53248
    buffer_load_dwordx4 a[112:115], v39, s[40:43], s63 offen sc1
    v_mfma_f32_32x32x16_bf16 v[84:99], a[72:75], v[152:155], v[84:99]
    ds_read_b128 v[136:139], v8 offset:61440
    s_waitcnt lgkmcnt(2)
    v_mfma_f32_32x32x16_bf16 v[68:83], a[76:79], v[156:159], v[68:83]
    ds_read_b128 v[140:143], v9 offset:53248
    buffer_load_dwordx4 a[116:119], v39, s[40:43], s63 offen offset:1024 sc1
    v_mfma_f32_32x32x16_bf16 v[84:99], a[76:79], v[160:163], v[84:99]
    ds_read_b128 v[144:147], v9 offset:61440
    s_lshl_b32 s61, s45, 3
    s_add_u32 s61, s61, s47
    s_lshl_b32 s61, s61, 7
    s_add_u32 s61, s61, 81920
    v_and_b32 v254, 8, v51
    v_add_u32 v254, s61, v254
    buffer_load_dwordx2 v[252:253], v254, s[40:43], 0 offen sc1
    s_waitcnt vmcnt(9)
    s_waitcnt lgkmcnt(2)
    v_mfma_f32_32x32x16_bf16 v[68:83], a[80:83], v[132:135], v[68:83]
    ds_read_b128 v[148:151], v10 offset:53248
    buffer_load_dwordx4 a[120:123], v39, s[40:43], s63 offen offset:2048 sc1
    v_mfma_f32_32x32x16_bf16 v[84:99], a[80:83], v[136:139], v[84:99]
    ds_read_b128 v[152:155], v10 offset:61440
    buffer_load_dwordx4 a[124:127], v39, s[40:43], s63 offen offset:3072 sc1
    s_waitcnt lgkmcnt(2)
    v_mfma_f32_32x32x16_bf16 v[68:83], a[84:87], v[140:143], v[68:83]
    ds_read_b128 v[156:159], v11 offset:53248
    v_mfma_f32_32x32x16_bf16 v[84:99], a[84:87], v[144:147], v[84:99]
    ds_read_b128 v[160:163], v11 offset:61440
    s_waitcnt vmcnt(9)
    s_waitcnt lgkmcnt(2)
    v_mfma_f32_32x32x16_bf16 v[68:83], a[88:91], v[148:151], v[68:83]
    s_add_u32 m0, s56, 32768
    s_add_u32 s94, s94, 512
    s_and_b32 s94, s94, 0x40eff
    buffer_load_dwordx4 v16, s[20:23], s94 offen lds
    v_lshlrev_b32 v100, 16, v200
    v_lshlrev_b32 v101, 16, v200
    v_lshlrev_b32 v102, 16, v200
    v_mfma_f32_32x32x16_bf16 v[84:99], a[88:91], v[152:155], v[84:99]
    v_lshlrev_b32 v103, 16, v200
    v_lshlrev_b32 v104, 16, v200
    v_lshlrev_b32 v105, 16, v200
    s_waitcnt lgkmcnt(0)
    s_barrier
    v_mfma_f32_32x32x16_bf16 v[68:83], a[92:95], v[156:159], v[68:83]
    ds_read_b128 v[132:135], v12 offset:0
    ds_read_b128 v[136:139], v12 offset:8192
    buffer_load_dwordx4 v17, s[20:23], s94 offen offset:1024 lds
    v_lshlrev_b32 v106, 16, v200
    v_lshlrev_b32 v107, 16, v200
    v_lshlrev_b32 v108, 16, v200
    v_mfma_f32_32x32x16_bf16 v[84:99], a[92:95], v[160:163], v[84:99]
    ds_read_b128 v[140:143], v13 offset:0
    ds_read_b128 v[144:147], v13 offset:8192
    v_lshlrev_b32 v109, 16, v200
    v_lshlrev_b32 v110, 16, v200
    v_lshlrev_b32 v111, 16, v200
    s_waitcnt vmcnt(9)
    s_waitcnt lgkmcnt(2)
    v_mfma_f32_32x32x16_bf16 v[68:83], a[96:99], v[132:135], v[68:83]
    ds_read_b128 v[148:151], v14 offset:0
    buffer_load_dwordx4 v18, s[20:23], s94 offen offset:2048 lds
    v_lshlrev_b32 v112, 16, v200
    v_lshlrev_b32 v113, 16, v200
    v_lshlrev_b32 v114, 16, v200
    v_mfma_f32_32x32x16_bf16 v[84:99], a[96:99], v[136:139], v[84:99]
    ds_read_b128 v[152:155], v14 offset:8192
    buffer_load_dwordx4 v19, s[20:23], s94 offen offset:3072 lds
    v_lshlrev_b32 v115, 16, v200
    v_lshlrev_b32 v116, 16, v201
    v_lshlrev_b32 v117, 16, v201
    s_waitcnt lgkmcnt(2)
    v_mfma_f32_32x32x16_bf16 v[68:83], a[100:103], v[140:143], v[68:83]
    ds_read_b128 v[156:159], v15 offset:0
    v_lshlrev_b32 v118, 16, v201
    v_lshlrev_b32 v119, 16, v201
    v_lshlrev_b32 v120, 16, v201
    v_mfma_f32_32x32x16_bf16 v[84:99], a[100:103], v[144:147], v[84:99]
    ds_read_b128 v[160:163], v15 offset:8192
    s_add_u32 m0, s56, 147456
    s_add_u32 s94, s94, 512
    s_and_b32 s94, s94, 0x40eff
    buffer_load_dwordx4 v16, s[20:23], s94 offen lds
    v_lshlrev_b32 v121, 16, v201
    v_lshlrev_b32 v122, 16, v201
    v_lshlrev_b32 v123, 16, v201
    s_waitcnt vmcnt(10)
    s_waitcnt lgkmcnt(2)
    v_mfma_f32_32x32x16_bf16 v[68:83], a[104:107], v[148:151], v[68:83]
    ds_read_b128 v[132:135], v12 offset:4096
    buffer_load_dwordx4 v17, s[20:23], s94 offen offset:1024 lds
    v_lshlrev_b32 v124, 16, v201
    v_lshlrev_b32 v125, 16, v201
    v_lshlrev_b32 v126, 16, v201
    v_mfma_f32_32x32x16_bf16 v[84:99], a[104:107], v[152:155], v[84:99]
    ds_read_b128 v[136:139], v12 offset:12288
    v_lshlrev_b32 v127, 16, v201
    v_lshlrev_b32 v128, 16, v201
    v_lshlrev_b32 v129, 16, v201
    s_waitcnt lgkmcnt(2)
    v_mfma_f32_32x32x16_bf16 v[68:83], a[108:111], v[156:159], v[68:83]
    ds_read_b128 v[140:143], v13 offset:4096
    buffer_load_dwordx4 v18, s[20:23], s94 offen offset:2048 lds
    v_lshlrev_b32 v130, 16, v201
    v_lshlrev_b32 v131, 16, v201
    v_mfma_f32_32x32x16_bf16 v[84:99], a[108:111], v[160:163], v[84:99]
    ds_read_b128 v[144:147], v13 offset:12288
    s_waitcnt vmcnt(10)
    s_waitcnt lgkmcnt(2)
    v_mfma_f32_32x32x16_bf16 v[68:83], a[112:115], v[132:135], v[68:83]
    ds_read_b128 v[148:151], v14 offset:4096
    buffer_load_dwordx4 v19, s[20:23], s94 offen offset:3072 lds
    v_mfma_f32_32x32x16_bf16 v[84:99], a[112:115], v[136:139], v[84:99]
    ds_read_b128 v[152:155], v14 offset:12288
    s_add_u32 m0, s56, 16384
    s_add_u32 s94, s94, 512
    s_and_b32 s94, s94, 0x40eff
    buffer_load_dwordx4 v16, s[20:23], s94 offen lds
    s_waitcnt lgkmcnt(2)
    v_mfma_f32_32x32x16_bf16 v[68:83], a[116:119], v[140:143], v[68:83]
    ds_read_b128 v[156:159], v15 offset:4096
    v_mfma_f32_32x32x16_bf16 v[84:99], a[116:119], v[144:147], v[84:99]
    ds_read_b128 v[160:163], v15 offset:12288
    s_waitcnt vmcnt(9)
    s_waitcnt lgkmcnt(2)
    v_mfma_f32_32x32x16_bf16 v[68:83], a[120:123], v[148:151], v[68:83]
    ds_read_b128 v[132:135], v8 offset:32768
    buffer_load_dwordx4 v17, s[20:23], s94 offen offset:1024 lds
    v_mfma_f32_32x32x16_bf16 v[84:99], a[120:123], v[152:155], v[84:99]
    ds_read_b128 v[136:139], v8 offset:40960
    buffer_load_dwordx4 v18, s[20:23], s94 offen offset:2048 lds
    s_waitcnt lgkmcnt(2)
    v_mfma_f32_32x32x16_bf16 v[68:83], a[124:127], v[156:159], v[68:83]
    ds_read_b128 v[140:143], v9 offset:32768
    buffer_load_dwordx4 v19, s[20:23], s94 offen offset:3072 lds
    v_mfma_f32_32x32x16_bf16 v[84:99], a[124:127], v[160:163], v[84:99]
    ds_read_b128 v[144:147], v9 offset:40960
    s_cmp_eq_u32 s48, 1
    s_cbranch_scc1 L_z1skip_1004
L_chk_1005:
    v_xor_b32 v62, s50, v252
    v_bitop3_b32 v62, v253, s51, v62 bitop3:0xbe
    v_cmp_ne_u32 vcc, 0, v62
    s_nop 0
    s_cbranch_vccnz L_retry_1006
L_cont_1007:
    s_xor_b32 s59, s49, 0
    s_mul_i32 s59, s59, 56
    s_lshl_b32 s60, s47, 2
    s_add_u32 s59, s59, s60
    s_add_u32 s59, s59, s44
    s_lshl_b32 s59, s59, 11
    s_add_u32 s59, s59, 5242880
    s_add_u32 s60, s59, 57344
    buffer_load_dwordx4 v[164:167], v48, s[40:43], s59 offen sc1
    buffer_load_dwordx4 v[168:171], v48, s[40:43], s59 offen offset:1024 sc1
    buffer_load_dwordx4 v[172:175], v48, s[40:43], s60 offen sc1
    buffer_load_dwordx4 v[176:179], v48, s[40:43], s60 offen offset:1024 sc1
L_z1skip_1004:
    s_waitcnt lgkmcnt(2)
    v_mfma_f32_32x32x16_bf16 v[100:115], a[128:131], v[132:135], v[100:115]
    ds_read_b128 v[148:151], v10 offset:32768
    v_mfma_f32_32x32x16_bf16 v[116:131], a[128:131], v[136:139], v[116:131]
    ds_read_b128 v[152:155], v10 offset:40960
    s_waitcnt lgkmcnt(2)
    v_mfma_f32_32x32x16_bf16 v[100:115], a[132:135], v[140:143], v[100:115]
    ds_read_b128 v[156:159], v11 offset:32768
    v_mfma_f32_32x32x16_bf16 v[116:131], a[132:135], v[144:147], v[116:131]
    ds_read_b128 v[160:163], v11 offset:40960
    s_waitcnt lgkmcnt(2)
    v_mfma_f32_32x32x16_bf16 v[100:115], a[136:139], v[148:151], v[100:115]
    ds_read_b128 v[132:135], v8 offset:36864
    s_add_u32 m0, s56, 65536
    s_add_u32 s94, s94, 512
    s_and_b32 s94, s94, 0x40eff
    buffer_load_dwordx4 v16, s[20:23], s94 offen lds
    v_cvt_pk_bf16_f32 v180, v68, v69
    v_cvt_pk_bf16_f32 v181, v70, v71
    v_cvt_pk_bf16_f32 v182, v72, v73
    v_mfma_f32_32x32x16_bf16 v[116:131], a[136:139], v[152:155], v[116:131]
    ds_read_b128 v[136:139], v8 offset:45056
    v_cvt_pk_bf16_f32 v183, v74, v75
    v_cvt_pk_bf16_f32 v184, v76, v77
    v_cvt_pk_bf16_f32 v185, v78, v79
    s_waitcnt lgkmcnt(2)
    v_mfma_f32_32x32x16_bf16 v[100:115], a[140:143], v[156:159], v[100:115]
    ds_read_b128 v[140:143], v9 offset:36864
    buffer_load_dwordx4 v17, s[20:23], s94 offen offset:1024 lds
    v_cvt_pk_bf16_f32 v186, v80, v81
    v_cvt_pk_bf16_f32 v187, v82, v83
    v_cvt_pk_bf16_f32 v188, v84, v85
    v_mfma_f32_32x32x16_bf16 v[116:131], a[140:143], v[160:163], v[116:131]
    ds_read_b128 v[144:147], v9 offset:45056
    v_cvt_pk_bf16_f32 v189, v86, v87
    v_cvt_pk_bf16_f32 v190, v88, v89
    v_cvt_pk_bf16_f32 v191, v90, v91
    s_waitcnt lgkmcnt(2)
    v_mfma_f32_32x32x16_bf16 v[100:115], a[144:147], v[132:135], v[100:115]
    ds_read_b128 v[148:151], v10 offset:36864
    buffer_load_dwordx4 v18, s[20:23], s94 offen offset:2048 lds
    v_cvt_pk_bf16_f32 v192, v92, v93
    v_cvt_pk_bf16_f32 v193, v94, v95
    v_cvt_pk_bf16_f32 v194, v96, v97
    v_mfma_f32_32x32x16_bf16 v[116:131], a[144:147], v[136:139], v[116:131]
    ds_read_b128 v[152:155], v10 offset:45056
    v_cvt_pk_bf16_f32 v195, v98, v99
    s_waitcnt lgkmcnt(2)
    v_mfma_f32_32x32x16_bf16 v[100:115], a[148:151], v[140:143], v[100:115]
    ds_read_b128 v[156:159], v11 offset:36864
    buffer_load_dwordx4 v19, s[20:23], s94 offen offset:3072 lds
    v_mfma_f32_32x32x16_bf16 v[116:131], a[148:151], v[144:147], v[116:131]
    ds_read_b128 v[160:163], v11 offset:45056
    s_xor_b32 s59, s49, 1
    s_mul_i32 s59, s59, 56
    s_lshl_b32 s60, s47, 2
    s_add_u32 s59, s59, s60
    s_add_u32 s59, s59, s44
    s_lshl_b32 s59, s59, 11
    s_add_u32 s59, s59, 8912896
    s_add_u32 s60, s59, 57344
    s_waitcnt lgkmcnt(2)
    v_mfma_f32_32x32x16_bf16 v[100:115], a[152:155], v[148:151], v[100:115]
    ds_read_b128 v[132:135], v4 offset:0
    buffer_store_dwordx4 v[180:183], v48, s[40:43], s59 offen sc1
    v_mfma_f32_32x32x16_bf16 v[116:131], a[152:155], v[152:155], v[116:131]
    ds_read_b128 v[136:139], v4 offset:8192
    buffer_store_dwordx4 v[184:187], v48, s[40:43], s59 offen offset:1024 sc1
    s_waitcnt lgkmcnt(2)
    v_mfma_f32_32x32x16_bf16 v[100:115], a[156:159], v[156:159], v[100:115]
    ds_read_b128 v[140:143], v5 offset:0
    buffer_store_dwordx4 v[188:191], v48, s[40:43], s60 offen sc1
    v_mfma_f32_32x32x16_bf16 v[116:131], a[156:159], v[160:163], v[116:131]
    ds_read_b128 v[144:147], v5 offset:8192
    buffer_store_dwordx4 v[192:195], v48, s[40:43], s60 offen offset:1024 sc1
    s_waitcnt lgkmcnt(2)
    v_mfma_f32_32x32x16_bf16 v[100:115], a[160:163], v[132:135], v[100:115]
    ds_read_b128 v[148:151], v6 offset:0
    v_mfma_f32_32x32x16_bf16 v[116:131], a[160:163], v[136:139], v[116:131]
    ds_read_b128 v[152:155], v6 offset:8192
    s_waitcnt lgkmcnt(2)
    v_mfma_f32_32x32x16_bf16 v[100:115], a[164:167], v[140:143], v[100:115]
    ds_read_b128 v[156:159], v7 offset:0
    v_mfma_f32_32x32x16_bf16 v[116:131], a[164:167], v[144:147], v[116:131]
    ds_read_b128 v[160:163], v7 offset:8192
    s_waitcnt lgkmcnt(2)
    v_mfma_f32_32x32x16_bf16 v[100:115], a[168:171], v[148:151], v[100:115]
    ds_read_b128 v[132:135], v4 offset:4096
    s_and_b32 s1, s44, 1
    s_lshl_b32 s92, s1, 13
    v_lshrrev_b32 v42, 5, v1
    v_mfma_f32_32x32x16_bf16 v[116:131], a[168:171], v[152:155], v[116:131]
    ds_read_b128 v[136:139], v4 offset:12288
    v_bfe_u32 v43, v1, 2, 2
    v_lshl_add_u32 v42, v42, 3, v43
    v_lshlrev_b32 v42, 7, v42
    s_waitcnt lgkmcnt(2)
    v_mfma_f32_32x32x16_bf16 v[100:115], a[172:175], v[156:159], v[100:115]
    ds_read_b128 v[140:143], v5 offset:4096
    v_and_b32 v43, 8, v1
    v_lshl_add_u32 v42, v43, 3, v42
    v_and_b32 v43, 16, v1
    v_mfma_f32_32x32x16_bf16 v[116:131], a[172:175], v[160:163], v[116:131]
    ds_read_b128 v[144:147], v5 offset:12288
    v_lshl_add_u32 v42, v43, 1, v42
    v_and_b32 v43, 3, v1
    v_lshl_add_u32 v42, v43, 3, v42
    s_waitcnt lgkmcnt(2)
    v_mfma_f32_32x32x16_bf16 v[100:115], a[176:179], v[132:135], v[100:115]
    ds_read_b128 v[148:151], v6 offset:4096
H_M_2:
    s_cbranch_execz L_hopret
    v_add_u32 v24, s92, v42
    v_xor_b32 v25, 64, v24
    v_add_u32 v26, 0x10000, v24
    v_mfma_f32_32x32x16_bf16 v[116:131], a[176:179], v[136:139], v[116:131]
    ds_read_b128 v[152:155], v6 offset:12288
    v_add_u32 v27, 0x10000, v25
    v_add_u32 v28, 0x20000, v24
    v_add_u32 v29, 0x20000, v25
    s_waitcnt lgkmcnt(2)
    v_mfma_f32_32x32x16_bf16 v[100:115], a[180:183], v[140:143], v[100:115]
    ds_read_b128 v[156:159], v7 offset:4096
    s_lshl_b32 s65, s96, 1
    s_lshr_b32 s92, s44, 1
    s_add_u32 s65, s65, s92
    v_mfma_f32_32x32x16_bf16 v[116:131], a[180:183], v[144:147], v[116:131]
    ds_read_b128 v[160:163], v7 offset:12288
    v_and_b32 v42, 31, v1
    s_lshl_b32 s95, s65, 7
    s_add_u32 s95, s95, 102400
    s_waitcnt lgkmcnt(2)
    v_mfma_f32_32x32x16_bf16 v[100:115], a[184:187], v[148:151], v[100:115]
    v_lshl_add_u32 v34, v42, 2, s95
    v_mul_u32_u24 v35, 272, v42
    v_lshrrev_b32 v43, 5, v1
    v_mfma_f32_32x32x16_bf16 v[116:131], a[184:187], v[152:155], v[116:131]
    v_lshl_add_u32 v35, v43, 4, v35
    s_mul_i32 s95, s44, 8704
    v_add_u32 v35, s95, v35
    s_waitcnt vmcnt(16) lgkmcnt(0)
    s_barrier
    v_mfma_f32_32x32x16_bf16 v[100:115], a[188:191], v[156:159], v[100:115]
    ds_read_b128 v[132:135], v4 offset:32768
    ds_read_b128 v[136:139], v4 offset:40960
    v_lshrrev_b32 v43, 3, v1
    v_and_b32 v42, 7, v1
    v_mul_u32_u24 v47, 272, v43
    v_mfma_f32_32x32x16_bf16 v[116:131], a[188:191], v[160:163], v[116:131]
    ds_read_b128 v[140:143], v5 offset:32768
    ds_read_b128 v[144:147], v5 offset:40960
    v_lshl_add_u32 v47, v42, 5, v47
    s_mul_i32 s92, s92, 17408
    s_mul_i32 s95, s1, 4352
    s_waitcnt lgkmcnt(2)
    v_mfma_f32_32x32x16_bf16 v[100:115], a[192:195], v[132:135], v[100:115]
    ds_read_b128 v[148:151], v6 offset:32768
    s_add_u32 s92, s92, s95
    v_add_u32 v47, s92, v47
    v_lshrrev_b32 v40, 2, v43
    v_mfma_f32_32x32x16_bf16 v[116:131], a[192:195], v[136:139], v[116:131]
    ds_read_b128 v[152:155], v6 offset:40960
    v_and_b32 v43, 3, v43
    v_lshl_add_u32 v40, v40, 3, v43
    v_lshlrev_b32 v40, 10, v40
    s_waitcnt lgkmcnt(2)
    v_mfma_f32_32x32x16_bf16 v[100:115], a[196:199], v[140:143], v[100:115]
    ds_read_b128 v[156:159], v7 offset:32768
    v_lshl_add_u32 v40, v42, 4, v40
    s_lshl_b32 s92, s65, 15
    s_lshl_b32 s1, s1, 12
    v_mfma_f32_32x32x16_bf16 v[116:131], a[196:199], v[144:147], v[116:131]
    ds_read_b128 v[160:163], v7 offset:40960
    s_add_u32 s92, s92, s1
    s_lshl_b32 s95, s97, 7
    s_add_u32 s92, s92, s95
    s_waitcnt lgkmcnt(2)
    v_mfma_f32_32x32x16_bf16 v[100:115], a[200:203], v[148:151], v[100:115]
    ds_read_b128 v[132:135], v4 offset:36864
    v_add_u32 v40, s92, v40
    v_add_u32 v41, 16384, v40
    s_mul_i32 s65, s65, 90112
    v_mfma_f32_32x32x16_bf16 v[116:131], a[200:203], v[152:155], v[116:131]
    ds_read_b128 v[136:139], v4 offset:45056
    s_add_u32 s65, s65, s1
    s_add_u32 s65, s65, 12582912
    s_waitcnt lgkmcnt(2)
    v_mfma_f32_32x32x16_bf16 v[100:115], a[204:207], v[156:159], v[100:115]
    ds_read_b128 v[140:143], v5 offset:36864
    v_mfma_f32_32x32x16_bf16 v[116:131], a[204:207], v[160:163], v[116:131]
    ds_read_b128 v[144:147], v5 offset:45056
    s_waitcnt lgkmcnt(2)
    v_mfma_f32_32x32x16_bf16 v[100:115], a[208:211], v[132:135], v[100:115]
    ds_read_b128 v[148:151], v6 offset:36864
    v_mfma_f32_32x32x16_bf16 v[116:131], a[208:211], v[136:139], v[116:131]
    ds_read_b128 v[152:155], v6 offset:45056
    s_waitcnt lgkmcnt(2)
    v_mfma_f32_32x32x16_bf16 v[100:115], a[212:215], v[140:143], v[100:115]
    ds_read_b128 v[156:159], v7 offset:36864
    v_mfma_f32_32x32x16_bf16 v[116:131], a[212:215], v[144:147], v[116:131]
    ds_read_b128 v[160:163], v7 offset:45056
    s_waitcnt lgkmcnt(2)
    v_mfma_f32_32x32x16_bf16 v[100:115], a[216:219], v[148:151], v[100:115]
    v_mfma_f32_32x32x16_bf16 v[116:131], a[216:219], v[152:155], v[116:131]
    s_waitcnt vmcnt(12) lgkmcnt(0)
    s_barrier
    v_mfma_f32_32x32x16_bf16 v[100:115], a[220:223], v[156:159], v[100:115]
    ds_read_b128 v[132:135], v12 offset:16384
    ds_read_b128 v[136:139], v12 offset:24576
    s_add_u32 m0, s56, 81920
    s_add_u32 s94, s94, 512
    s_and_b32 s94, s94, 0x40eff
    buffer_load_dwordx4 v16, s[20:23], s94 offen lds
    v_mfma_f32_32x32x16_bf16 v[116:131], a[220:223], v[160:163], v[116:131]
    ds_read_b128 v[140:143], v13 offset:16384
    ds_read_b128 v[144:147], v13 offset:24576
    buffer_load_dwordx4 v17, s[20:23], s94 offen offset:1024 lds
    s_xor_b32 s59, s49, 1
    s_lshl_b32 s59, s59, 3
    s_add_u32 s59, s59, s47
    s_lshl_b32 s59, s59, 4
    s_add_u32 s59, s59, s44
    s_lshl_b32 s59, s59, 3
    s_add_u32 s59, s59, 753664
    s_waitcnt vmcnt(2)
    buffer_store_dwordx2 v[66:67], v50, s[40:43], s59 offen sc1
    s_waitcnt lgkmcnt(2)
    v_mfma_f32_32x32x16_bf16 v[100:115], a[224:227], v[132:135], v[100:115]
    ds_read_b128 v[148:151], v14 offset:16384
    buffer_load_dwordx4 v18, s[20:23], s94 offen offset:2048 lds
    v_mfma_f32_32x32x16_bf16 v[116:131], a[224:227], v[136:139], v[116:131]
    ds_read_b128 v[152:155], v14 offset:24576
    buffer_load_dwordx4 v19, s[20:23], s94 offen offset:3072 lds
    s_waitcnt lgkmcnt(2)
    v_mfma_f32_32x32x16_bf16 v[100:115], a[228:231], v[140:143], v[100:115]
    ds_read_b128 v[156:159], v15 offset:16384
    s_add_u32 m0, s56, 49152
    s_add_u32 s94, s94, 512
    s_and_b32 s94, s94, 0x40eff
    buffer_load_dwordx4 v16, s[20:23], s94 offen lds
    v_mfma_f32_32x32x16_bf16 v[116:131], a[228:231], v[144:147], v[116:131]
    ds_read_b128 v[160:163], v15 offset:24576
    buffer_load_dwordx4 v17, s[20:23], s94 offen offset:1024 lds
    s_waitcnt lgkmcnt(2)
    v_mfma_f32_32x32x16_bf16 v[100:115], a[232:235], v[148:151], v[100:115]
    ds_read_b128 v[132:135], v12 offset:20480
    buffer_load_dwordx4 v18, s[20:23], s94 offen offset:2048 lds
    v_mfma_f32_32x32x16_bf16 v[116:131], a[232:235], v[152:155], v[116:131]
    ds_read_b128 v[136:139], v12 offset:28672
    buffer_load_dwordx4 v19, s[20:23], s94 offen offset:3072 lds
    s_waitcnt lgkmcnt(2)
    v_mfma_f32_32x32x16_bf16 v[100:115], a[236:239], v[156:159], v[100:115]
    ds_read_b128 v[140:143], v13 offset:20480
    s_add_u32 m0, s56, 114688
    s_mov_b32 s58, 0
    buffer_load_dwordx4 v20, s[12:15], s58 offen lds
    v_mfma_f32_32x32x16_bf16 v[116:131], a[236:239], v[160:163], v[116:131]
    ds_read_b128 v[144:147], v13 offset:28672
    buffer_load_dwordx4 v21, s[12:15], s58 offen offset:1024 lds
    s_waitcnt lgkmcnt(2)
    v_mfma_f32_32x32x16_bf16 v[100:115], a[240:243], v[132:135], v[100:115]
    ds_read_b128 v[148:151], v14 offset:20480
    v_lshlrev_b32 v212, 16, v164
    v_and_b32 v213, 0xffff0000, v164
    v_lshlrev_b32 v214, 16, v165
    v_mfma_f32_32x32x16_bf16 v[116:131], a[240:243], v[136:139], v[116:131]
    ds_read_b128 v[152:155], v14 offset:28672
    v_and_b32 v215, 0xffff0000, v165
    v_lshlrev_b32 v216, 16, v166
    v_and_b32 v217, 0xffff0000, v166
    s_waitcnt lgkmcnt(2)
    v_mfma_f32_32x32x16_bf16 v[100:115], a[244:247], v[140:143], v[100:115]
    ds_read_b128 v[156:159], v15 offset:20480
    buffer_load_dwordx4 v22, s[12:15], s58 offen offset:2048 lds
    v_lshlrev_b32 v218, 16, v167
    v_and_b32 v219, 0xffff0000, v167
    v_lshlrev_b32 v220, 16, v168
    v_mfma_f32_32x32x16_bf16 v[116:131], a[244:247], v[144:147], v[116:131]
    ds_read_b128 v[160:163], v15 offset:28672
    v_and_b32 v221, 0xffff0000, v168
    v_lshlrev_b32 v222, 16, v169
    v_and_b32 v223, 0xffff0000, v169
    s_waitcnt lgkmcnt(2)
    v_mfma_f32_32x32x16_bf16 v[100:115], a[248:251], v[148:151], v[100:115]
    buffer_load_dwordx4 v23, s[12:15], s58 offen offset:3072 lds
    v_lshlrev_b32 v224, 16, v170
    v_and_b32 v225, 0xffff0000, v170
    v_lshlrev_b32 v226, 16, v171
    v_mfma_f32_32x32x16_bf16 v[116:131], a[248:251], v[152:155], v[116:131]
    v_and_b32 v227, 0xffff0000, v171
    v_lshlrev_b32 v228, 16, v172
    v_and_b32 v229, 0xffff0000, v172
    s_waitcnt lgkmcnt(0)
    s_barrier
    v_mfma_f32_32x32x16_bf16 v[100:115], a[252:255], v[156:159], v[100:115]
    ds_read_b128 v[132:135], v4 offset:16384
    ds_read_b128 v[136:139], v4 offset:24576
    s_add_u32 m0, s56, 131072
    s_mov_b32 s58, 131072
    buffer_load_dwordx4 v20, s[12:15], s58 offen lds
    v_lshlrev_b32 v230, 16, v173
    v_and_b32 v231, 0xffff0000, v173
    v_lshlrev_b32 v232, 16, v174
    v_mfma_f32_32x32x16_bf16 v[116:131], a[252:255], v[160:163], v[116:131]
    ds_read_b128 v[140:143], v5 offset:16384
    ds_read_b128 v[144:147], v5 offset:24576
    buffer_load_dwordx4 v21, s[12:15], s58 offen offset:1024 lds
    v_and_b32 v233, 0xffff0000, v174
    v_lshlrev_b32 v234, 16, v175
    v_and_b32 v235, 0xffff0000, v175
    s_waitcnt lgkmcnt(2)
    v_mfma_f32_32x32x16_bf16 v[100:115], a[0:3], v[132:135], v[100:115]
    ds_read_b128 v[148:151], v6 offset:16384
    v_lshlrev_b32 v236, 16, v176
    v_and_b32 v237, 0xffff0000, v176
    v_lshlrev_b32 v238, 16, v177
    v_mfma_f32_32x32x16_bf16 v[116:131], a[0:3], v[136:139], v[116:131]
    ds_read_b128 v[152:155], v6 offset:24576
    buffer_load_dwordx4 v22, s[12:15], s58 offen offset:2048 lds
    v_and_b32 v239, 0xffff0000, v177
    v_lshlrev_b32 v240, 16, v178
    v_and_b32 v241, 0xffff0000, v178
    s_waitcnt lgkmcnt(2)
    v_mfma_f32_32x32x16_bf16 v[100:115], a[4:7], v[140:143], v[100:115]
    ds_read_b128 v[156:159], v7 offset:16384
    v_lshlrev_b32 v242, 16, v179
    v_and_b32 v243, 0xffff0000, v179
    v_mfma_f32_32x32x16_bf16 v[116:131], a[4:7], v[144:147], v[116:131]
    ds_read_b128 v[160:163], v7 offset:24576
    buffer_load_dwordx4 v23, s[12:15], s58 offen offset:3072 lds
    s_waitcnt lgkmcnt(2)
    v_mfma_f32_32x32x16_bf16 v[100:115], a[8:11], v[148:151], v[100:115]
    ds_read_b128 v[132:135], v4 offset:20480
    v_mfma_f32_32x32x16_bf16 v[116:131], a[8:11], v[152:155], v[116:131]
    ds_read_b128 v[136:139], v4 offset:28672
    s_add_u32 m0, s56, 98304
    s_mov_b32 s58, 262144
    buffer_load_dwordx4 v20, s[12:15], s58 offen lds
    s_waitcnt lgkmcnt(2)
    v_mfma_f32_32x32x16_bf16 v[100:115], a[12:15], v[156:159], v[100:115]
    ds_read_b128 v[140:143], v5 offset:20480
    v_mfma_f32_32x32x16_bf16 v[116:131], a[12:15], v[160:163], v[116:131]
    ds_read_b128 v[144:147], v5 offset:28672
    buffer_load_dwordx4 v21, s[12:15], s58 offen offset:1024 lds
    s_waitcnt lgkmcnt(2)
    v_mfma_f32_32x32x16_bf16 v[100:115], a[16:19], v[132:135], v[100:115]
    ds_read_b128 v[148:151], v6 offset:20480
    v_mfma_f32_32x32x16_bf16 v[116:131], a[16:19], v[136:139], v[116:131]
    ds_read_b128 v[152:155], v6 offset:28672
    s_waitcnt lgkmcnt(2)
    v_mfma_f32_32x32x16_bf16 v[100:115], a[20:23], v[140:143], v[100:115]
    ds_read_b128 v[156:159], v7 offset:20480
    buffer_load_dwordx4 v22, s[12:15], s58 offen offset:2048 lds
    v_mfma_f32_32x32x16_bf16 v[116:131], a[20:23], v[144:147], v[116:131]
    ds_read_b128 v[160:163], v7 offset:28672
    s_xor_b32 s59, s49, 0
    s_lshl_b32 s59, s59, 3
    s_add_u32 s59, s59, s47
    s_lshl_b32 s59, s59, 4
    s_add_u32 s59, s59, s44
    s_lshl_b32 s59, s59, 3
    s_add_u32 s59, s59, 753664
    v_mov_b32 v254, s59
    buffer_load_dwordx2 v[252:253], v254, s[40:43], 0 offen sc1
    s_waitcnt lgkmcnt(2)
    v_mfma_f32_32x32x16_bf16 v[100:115], a[24:27], v[148:151], v[100:115]
    ds_read_b128 v[132:135], v8 offset:0
    buffer_load_dwordx4 v23, s[12:15], s58 offen offset:3072 lds
    v_mfma_f32_32x32x16_bf16 v[116:131], a[24:27], v[152:155], v[116:131]
    ds_read_b128 v[136:139], v8 offset:8192
    s_waitcnt lgkmcnt(2)
    v_mfma_f32_32x32x16_bf16 v[100:115], a[28:31], v[156:159], v[100:115]
    ds_read_b128 v[140:143], v9 offset:0
    s_add_u32 m0, s56, 0
    s_mov_b32 s58, 393216
    buffer_load_dwordx4 v20, s[12:15], s58 offen lds
    v_mfma_f32_32x32x16_bf16 v[116:131], a[28:31], v[160:163], v[116:131]
    ds_read_b128 v[144:147], v9 offset:8192
    s_waitcnt lgkmcnt(2)
    v_mfma_f32_32x32x16_bf16 v[100:115], a[32:35], v[132:135], v[100:115]
    ds_read_b128 v[148:151], v10 offset:0
    buffer_load_dwordx4 v21, s[12:15], s58 offen offset:1024 lds
    v_mfma_f32_32x32x16_bf16 v[116:131], a[32:35], v[136:139], v[116:131]
    ds_read_b128 v[152:155], v10 offset:8192
    s_waitcnt lgkmcnt(2)
    v_mfma_f32_32x32x16_bf16 v[100:115], a[36:39], v[140:143], v[100:115]
    ds_read_b128 v[156:159], v11 offset:0
    buffer_load_dwordx4 v22, s[12:15], s58 offen offset:2048 lds
    v_mfma_f32_32x32x16_bf16 v[116:131], a[36:39], v[144:147], v[116:131]
    ds_read_b128 v[160:163], v11 offset:8192
    s_waitcnt lgkmcnt(2)
    v_mfma_f32_32x32x16_bf16 v[100:115], a[40:43], v[148:151], v[100:115]
    ds_read_b128 v[132:135], v8 offset:4096
    buffer_load_dwordx4 v23, s[12:15], s58 offen offset:3072 lds
    v_mfma_f32_32x32x16_bf16 v[116:131], a[40:43], v[152:155], v[116:131]
    ds_read_b128 v[136:139], v8 offset:12288
    s_waitcnt lgkmcnt(2)
    v_mfma_f32_32x32x16_bf16 v[100:115], a[44:47], v[156:159], v[100:115]
    ds_read_b128 v[140:143], v9 offset:4096
    s_add_u32 m0, s56, 32768
    s_mov_b32 s58, 0
    buffer_load_dwordx4 v20, s[28:31], s58 offen lds
    v_mfma_f32_32x32x16_bf16 v[116:131], a[44:47], v[160:163], v[116:131]
    ds_read_b128 v[144:147], v9 offset:12288
    s_waitcnt lgkmcnt(2)
    v_mfma_f32_32x32x16_bf16 v[100:115], a[48:51], v[132:135], v[100:115]
    ds_read_b128 v[148:151], v10 offset:4096
    buffer_load_dwordx4 v21, s[28:31], s58 offen offset:1024 lds
    v_mfma_f32_32x32x16_bf16 v[116:131], a[48:51], v[136:139], v[116:131]
    ds_read_b128 v[152:155], v10 offset:12288
    s_waitcnt lgkmcnt(2)
    v_mfma_f32_32x32x16_bf16 v[100:115], a[52:55], v[140:143], v[100:115]
    ds_read_b128 v[156:159], v11 offset:4096
    buffer_load_dwordx4 v22, s[28:31], s58 offen offset:2048 lds
    v_mfma_f32_32x32x16_bf16 v[116:131], a[52:55], v[144:147], v[116:131]
    ds_read_b128 v[160:163], v11 offset:12288
    s_waitcnt lgkmcnt(2)
    v_mfma_f32_32x32x16_bf16 v[100:115], a[56:59], v[148:151], v[100:115]
    buffer_load_dwordx4 v23, s[28:31], s58 offen offset:3072 lds
    v_mfma_f32_32x32x16_bf16 v[116:131], a[56:59], v[152:155], v[116:131]
    s_waitcnt vmcnt(25) lgkmcnt(0)
    s_barrier
    v_mfma_f32_32x32x16_bf16 v[100:115], a[60:63], v[156:159], v[100:115]
    ds_read_b128 v[132:135], v8 offset:16384
    ds_read_b128 v[136:139], v8 offset:24576
    s_add_u32 m0, s56, 147456
    s_mov_b32 s58, 131072
    buffer_load_dwordx4 v20, s[28:31], s58 offen lds
    v_mfma_f32_32x32x16_bf16 v[116:131], a[60:63], v[160:163], v[116:131]
    ds_read_b128 v[140:143], v9 offset:16384
    ds_read_b128 v[144:147], v9 offset:24576
    s_waitcnt vmcnt(10)
L_chk_1104:
    v_xor_b32 v62, s50, v252
    v_bitop3_b32 v62, v253, s51, v62 bitop3:0xbe
    v_cmp_ne_u32 vcc, 0, v62
    s_nop 0
    s_cbranch_vccnz L_retry_1105
L_cont_1106:
    s_xor_b32 s59, s49, 0
    s_mul_i32 s59, s59, 56
    s_lshl_b32 s60, s47, 2
    s_add_u32 s59, s59, s60
    s_add_u32 s59, s59, s44
    s_lshl_b32 s59, s59, 11
    s_add_u32 s59, s59, 8912896
    s_add_u32 s60, s59, 57344
    buffer_load_dwordx4 v[180:183], v48, s[40:43], s59 offen sc1
    buffer_load_dwordx4 v[184:187], v48, s[40:43], s59 offen offset:1024 sc1
    buffer_load_dwordx4 v[188:191], v48, s[40:43], s60 offen sc1
    buffer_load_dwordx4 v[192:195], v48, s[40:43], s60 offen offset:1024 sc1
    s_waitcnt lgkmcnt(2)
    v_mfma_f32_32x32x16_bf16 v[100:115], a[64:67], v[132:135], v[100:115]
    ds_read_b128 v[148:151], v10 offset:16384
    v_mfma_f32_32x32x16_bf16 v[116:131], a[64:67], v[136:139], v[116:131]
    ds_read_b128 v[152:155], v10 offset:24576
    s_waitcnt lgkmcnt(2)
    v_mfma_f32_32x32x16_bf16 v[100:115], a[68:71], v[140:143], v[100:115]
    ds_read_b128 v[156:159], v11 offset:16384
    v_mfma_f32_32x32x16_bf16 v[116:131], a[68:71], v[144:147], v[116:131]
    ds_read_b128 v[160:163], v11 offset:24576
    s_waitcnt lgkmcnt(2)
    v_mfma_f32_32x32x16_bf16 v[100:115], a[72:75], v[148:151], v[100:115]
    ds_read_b128 v[132:135], v8 offset:20480
    buffer_load_dwordx4 v21, s[28:31], s58 offen offset:1024 lds
    v_mfma_f32_32x32x16_bf16 v[116:131], a[72:75], v[152:155], v[116:131]
    ds_read_b128 v[136:139], v8 offset:28672
    s_waitcnt lgkmcnt(2)
    v_mfma_f32_32x32x16_bf16 v[100:115], a[76:79], v[156:159], v[100:115]
    ds_read_b128 v[140:143], v9 offset:20480
    buffer_load_dwordx4 v22, s[28:31], s58 offen offset:2048 lds
    v_mfma_f32_32x32x16_bf16 v[116:131], a[76:79], v[160:163], v[116:131]
    ds_read_b128 v[144:147], v9 offset:28672
    s_waitcnt lgkmcnt(2)
    v_mfma_f32_32x32x16_bf16 v[100:115], a[80:83], v[132:135], v[100:115]
    ds_read_b128 v[148:151], v10 offset:20480
    v_mfma_f32_32x32x16_bf16 v[116:131], a[80:83], v[136:139], v[116:131]
    ds_read_b128 v[152:155], v10 offset:28672
    buffer_load_dwordx4 v23, s[28:31], s58 offen offset:3072 lds
    s_waitcnt lgkmcnt(2)
    v_mfma_f32_32x32x16_bf16 v[100:115], a[84:87], v[140:143], v[100:115]
    ds_read_b128 v[156:159], v11 offset:20480
    v_mfma_f32_32x32x16_bf16 v[116:131], a[84:87], v[144:147], v[116:131]
    ds_read_b128 v[160:163], v11 offset:28672
    s_add_u32 m0, s56, 16384
    s_mov_b32 s58, 262144
    buffer_load_dwordx4 v20, s[28:31], s58 offen lds
    s_waitcnt lgkmcnt(2)
    v_mfma_f32_32x32x16_bf16 v[100:115], a[88:91], v[148:151], v[100:115]
    v_mfma_f32_32x32x16_bf16 v[116:131], a[88:91], v[152:155], v[116:131]
    buffer_load_dwordx4 v21, s[28:31], s58 offen offset:1024 lds
    s_waitcnt lgkmcnt(0)
    s_barrier
    v_mfma_f32_32x32x16_bf16 v[100:115], a[92:95], v[156:159], v[100:115]
    ds_read_b128 v[132:135], v4 offset:49152
    ds_read_b128 v[136:139], v4 offset:57344
    v_mfma_f32_32x32x16_bf16 v[116:131], a[92:95], v[160:163], v[116:131]
    ds_read_b128 v[140:143], v5 offset:49152
    ds_read_b128 v[144:147], v5 offset:57344
    buffer_load_dwordx4 v22, s[28:31], s58 offen offset:2048 lds
    s_lshl_b32 s61, s96, 10
    s_add_u32 s61, s61, 50048
    v_and_b32 v46, 24, v51
    v_add_u32 v46, s61, v46
    buffer_load_dwordx2 v[44:45], v46, s[40:43], 0 offen sc1
    s_waitcnt lgkmcnt(2)
    v_mfma_f32_32x32x16_bf16 v[100:115], a[96:99], v[132:135], v[100:115]
    ds_read_b128 v[148:151], v6 offset:49152
    v_mfma_f32_32x32x16_bf16 v[116:131], a[96:99], v[136:139], v[116:131]
    ds_read_b128 v[152:155], v6 offset:57344
    s_waitcnt lgkmcnt(2)
    v_mfma_f32_32x32x16_bf16 v[100:115], a[100:103], v[140:143], v[100:115]
    ds_read_b128 v[156:159], v7 offset:49152
    buffer_load_dwordx4 v23, s[28:31], s58 offen offset:3072 lds
    v_mfma_f32_32x32x16_bf16 v[116:131], a[100:103], v[144:147], v[116:131]
    ds_read_b128 v[160:163], v7 offset:57344
    s_waitcnt vmcnt(8)
    s_waitcnt lgkmcnt(2)
    v_mfma_f32_32x32x16_bf16 v[100:115], a[104:107], v[148:151], v[100:115]
    ds_read_b128 v[132:135], v4 offset:53248
    s_add_u32 m0, s56, 65536
    s_mov_b32 s58, 393216
    buffer_load_dwordx4 v20, s[28:31], s58 offen lds
    v_lshlrev_b32 v68, 16, v180
    v_and_b32 v69, 0xffff0000, v180
    v_lshlrev_b32 v70, 16, v181
    v_mfma_f32_32x32x16_bf16 v[116:131], a[104:107], v[152:155], v[116:131]
    ds_read_b128 v[136:139], v4 offset:61440
    buffer_load_dwordx4 v21, s[28:31], s58 offen offset:1024 lds
    v_and_b32 v71, 0xffff0000, v181
    v_lshlrev_b32 v72, 16, v182
    v_and_b32 v73, 0xffff0000, v182
    s_waitcnt lgkmcnt(2)
    v_mfma_f32_32x32x16_bf16 v[100:115], a[108:111], v[156:159], v[100:115]
    ds_read_b128 v[140:143], v5 offset:53248
    buffer_load_dwordx4 v22, s[28:31], s58 offen offset:2048 lds
    v_lshlrev_b32 v74, 16, v183
    v_and_b32 v75, 0xffff0000, v183
    v_lshlrev_b32 v76, 16, v184
    v_mfma_f32_32x32x16_bf16 v[116:131], a[108:111], v[160:163], v[116:131]
    ds_read_b128 v[144:147], v5 offset:61440
    buffer_load_dwordx4 v23, s[28:31], s58 offen offset:3072 lds
    v_and_b32 v77, 0xffff0000, v184
    v_lshlrev_b32 v78, 16, v185
    v_and_b32 v79, 0xffff0000, v185
    s_waitcnt lgkmcnt(2)
    v_mfma_f32_32x32x16_bf16 v[100:115], a[112:115], v[132:135], v[100:115]
    ds_read_b128 v[148:151], v6 offset:53248
    s_add_u32 m0, s56, 81920
    s_mov_b32 s58, 524288
    buffer_load_dwordx4 v20, s[28:31], s58 offen lds
    v_lshlrev_b32 v80, 16, v186
    v_and_b32 v81, 0xffff0000, v186
    v_lshlrev_b32 v82, 16, v187
    v_mfma_f32_32x32x16_bf16 v[116:131], a[112:115], v[136:139], v[116:131]
    ds_read_b128 v[152:155], v6 offset:61440
    buffer_load_dwordx4 v21, s[28:31], s58 offen offset:1024 lds
    v_and_b32 v83, 0xffff0000, v187
    v_lshlrev_b32 v84, 16, v188
    v_and_b32 v85, 0xffff0000, v188
    s_waitcnt lgkmcnt(2)
    v_mfma_f32_32x32x16_bf16 v[100:115], a[116:119], v[140:143], v[100:115]
    ds_read_b128 v[156:159], v7 offset:53248
    buffer_load_dwordx4 v22, s[28:31], s58 offen offset:2048 lds
    v_lshlrev_b32 v86, 16, v189
    v_and_b32 v87, 0xffff0000, v189
    v_lshlrev_b32 v88, 16, v190
    v_mfma_f32_32x32x16_bf16 v[116:131], a[116:119], v[144:147], v[116:131]
    ds_read_b128 v[160:163], v7 offset:61440
    buffer_load_dwordx4 v23, s[28:31], s58 offen offset:3072 lds
    v_and_b32 v89, 0xffff0000, v190
    v_lshlrev_b32 v90, 16, v191
    v_and_b32 v91, 0xffff0000, v191
    s_xor_b32 s59, s49, 0
    s_mul_i32 s59, s59, 88
    s_lshl_b32 s60, s47, 2
    s_add_u32 s59, s59, s60
    s_add_u32 s59, s59, s44
    s_lshl_b32 s59, s59, 11
    s_add_u32 s59, s59, 12615680
    s_add_u32 s60, s59, 90112
    s_xor_b32 s64, s49, 0
    s_lshl_b32 s64, s64, 3
    s_add_u32 s64, s64, s47
    s_lshl_b32 s64, s64, 4
    s_add_u32 s64, s64, s44
    s_lshl_b32 s64, s64, 3
    s_add_u32 s64, s64, 49152
    s_waitcnt lgkmcnt(2)
    v_mfma_f32_32x32x16_bf16 v[100:115], a[120:123], v[148:151], v[100:115]
    v_lshlrev_b32 v92, 16, v192
    v_and_b32 v93, 0xffff0000, v192
    v_lshlrev_b32 v94, 16, v193
    v_mfma_f32_32x32x16_bf16 v[116:131], a[120:123], v[152:155], v[116:131]
    v_and_b32 v95, 0xffff0000, v193
    v_lshlrev_b32 v96, 16, v194
    v_and_b32 v97, 0xffff0000, v194
    s_waitcnt lgkmcnt(0)
    s_barrier
    v_mfma_f32_32x32x16_bf16 v[100:115], a[124:127], v[156:159], v[100:115]
    s_add_u32 m0, s56, 49152
    s_mov_b32 s58, 655360
    buffer_load_dwordx4 v20, s[28:31], s58 offen lds
    v_lshlrev_b32 v98, 16, v195
    v_and_b32 v99, 0xffff0000, v195
    v_mfma_f32_32x32x16_bf16 v[116:131], a[124:127], v[160:163], v[116:131]
    buffer_load_dwordx4 v21, s[28:31], s58 offen offset:1024 lds
    s_nop 4
    v_pk_add_f32 v[100:101], v[100:101], v[68:69]
    v_pk_add_f32 v[102:103], v[102:103], v[70:71]
    v_pk_add_f32 v[104:105], v[104:105], v[72:73]
    v_pk_add_f32 v[106:107], v[106:107], v[74:75]
    v_pk_mul_f32 v[100:101], v[100:101], v[212:213]
    v_pk_mul_f32 v[102:103], v[102:103], v[214:215]
    v_pk_mul_f32 v[104:105], v[104:105], v[216:217]
    v_pk_mul_f32 v[106:107], v[106:107], v[218:219]
    v_cvt_pk_bf16_f32 v164, v100, v101
    v_cvt_pk_bf16_f32 v165, v102, v103
    v_cvt_pk_bf16_f32 v166, v104, v105
    v_cvt_pk_bf16_f32 v167, v106, v107
    buffer_store_dwordx4 v[164:167], v48, s[40:43], s59 offen sc1
    v_pk_add_f32 v[108:109], v[108:109], v[76:77]
    v_pk_add_f32 v[110:111], v[110:111], v[78:79]
    v_pk_add_f32 v[112:113], v[112:113], v[80:81]
    v_pk_add_f32 v[114:115], v[114:115], v[82:83]
    v_pk_mul_f32 v[108:109], v[108:109], v[220:221]
    v_pk_mul_f32 v[110:111], v[110:111], v[222:223]
    v_pk_mul_f32 v[112:113], v[112:113], v[224:225]
    v_pk_mul_f32 v[114:115], v[114:115], v[226:227]
    v_cvt_pk_bf16_f32 v168, v108, v109
    v_cvt_pk_bf16_f32 v169, v110, v111
    v_cvt_pk_bf16_f32 v170, v112, v113
    v_cvt_pk_bf16_f32 v171, v114, v115
    buffer_store_dwordx4 v[168:171], v48, s[40:43], s59 offen offset:1024 sc1
    v_pk_add_f32 v[116:117], v[116:117], v[84:85]
    v_pk_add_f32 v[118:119], v[118:119], v[86:87]
    v_pk_add_f32 v[120:121], v[120:121], v[88:89]
    v_pk_add_f32 v[122:123], v[122:123], v[90:91]
    v_pk_mul_f32 v[116:117], v[116:117], v[228:229]
    v_pk_mul_f32 v[118:119], v[118:119], v[230:231]
    v_pk_mul_f32 v[120:121], v[120:121], v[232:233]
    v_pk_mul_f32 v[122:123], v[122:123], v[234:235]
    v_cvt_pk_bf16_f32 v172, v116, v117
    v_cvt_pk_bf16_f32 v173, v118, v119
    v_cvt_pk_bf16_f32 v174, v120, v121
    v_cvt_pk_bf16_f32 v175, v122, v123
    buffer_store_dwordx4 v[172:175], v48, s[40:43], s60 offen sc1
    v_pk_add_f32 v[124:125], v[124:125], v[92:93]
    v_pk_add_f32 v[126:127], v[126:127], v[94:95]
    v_pk_add_f32 v[128:129], v[128:129], v[96:97]
    v_pk_add_f32 v[130:131], v[130:131], v[98:99]
    v_pk_mul_f32 v[124:125], v[124:125], v[236:237]
    v_pk_mul_f32 v[126:127], v[126:127], v[238:239]
    v_pk_mul_f32 v[128:129], v[128:129], v[240:241]
    v_pk_mul_f32 v[130:131], v[130:131], v[242:243]
    v_cvt_pk_bf16_f32 v176, v124, v125
    v_cvt_pk_bf16_f32 v177, v126, v127
    v_cvt_pk_bf16_f32 v178, v128, v129
    v_cvt_pk_bf16_f32 v179, v130, v131
    buffer_store_dwordx4 v[176:179], v48, s[40:43], s60 offen offset:1024 sc1
    s_waitcnt vmcnt(15)
L_chk_1135:
    v_xor_b32 v62, s50, v44
    v_bitop3_b32 v62, v45, s51, v62 bitop3:0xbe
    v_cmp_ne_u32 vcc, 0, v62
    s_nop 0
    s_cbranch_vccnz L_retry_1136
L_cont_1137:
    buffer_load_dword v30, v34, s[40:43], 0 offen sc1
    s_add_u32 s63, s65, 0
    buffer_load_dwordx4 a[128:131], v48, s[40:43], s63 offen sc1
    buffer_load_dwordx4 a[132:135], v48, s[40:43], s63 offen offset:1024 sc1
    buffer_load_dwordx4 a[136:139], v48, s[40:43], s63 offen offset:2048 sc1
    buffer_load_dwordx4 a[140:143], v48, s[40:43], s63 offen offset:3072 sc1
    s_cmp_eq_u32 s44, 0
    s_cselect_b32 s64, s64, 0x1180000
    s_waitcnt vmcnt(5)
    s_barrier
    buffer_store_dwordx2 v[66:67], v49, s[40:43], s64 offen sc1
    s_add_u32 s63, s65, 8192
    buffer_load_dwordx4 a[144:147], v48, s[40:43], s63 offen sc1
    buffer_load_dwordx4 a[148:151], v48, s[40:43], s63 offen offset:1024 sc1
    buffer_load_dwordx4 a[152:155], v48, s[40:43], s63 offen offset:2048 sc1
    buffer_load_dwordx4 a[156:159], v48, s[40:43], s63 offen offset:3072 sc1
    s_add_u32 s63, s65, 16384
    buffer_load_dwordx4 a[160:163], v48, s[40:43], s63 offen sc1
    buffer_load_dwordx4 a[164:167], v48, s[40:43], s63 offen offset:1024 sc1
    buffer_load_dwordx4 a[168:171], v48, s[40:43], s63 offen offset:2048 sc1
    buffer_load_dwordx4 a[172:175], v48, s[40:43], s63 offen offset:3072 sc1
    s_add_u32 s63, s65, 24576
    buffer_load_dwordx4 a[176:179], v48, s[40:43], s63 offen sc1
    buffer_load_dwordx4 a[180:183], v48, s[40:43], s63 offen offset:1024 sc1
    buffer_load_dwordx4 a[184:187], v48, s[40:43], s63 offen offset:2048 sc1
    buffer_load_dwordx4 a[188:191], v48, s[40:43], s63 offen offset:3072 sc1
    ds_read_b64_tr_b16 v[132:133], v26 offset:49152
    ds_read_b64_tr_b16 v[134:135], v26 offset:49664
    ds_read_b64_tr_b16 v[136:137], v27 offset:49152
    ds_read_b64_tr_b16 v[138:139], v27 offset:49664
    ds_read_b64_tr_b16 v[140:141], v26 offset:51200
    ds_read_b64_tr_b16 v[142:143], v26 offset:51712
    ds_read_b64_tr_b16 v[144:145], v27 offset:51200
    ds_read_b64_tr_b16 v[146:147], v27 offset:51712
    s_waitcnt vmcnt(15)
    s_waitcnt lgkmcnt(6)
    v_mfma_f32_32x32x16_bf16 v[68:83], v[132:135], a[128:131], 0
    ds_read_b64_tr_b16 v[148:149], v26 offset:53248
    ds_read_b64_tr_b16 v[150:151], v26 offset:53760
    buffer_load_dwordx4 v22, s[28:31], s58 offen offset:2048 lds
    s_waitcnt lgkmcnt(6)
    v_mfma_f32_32x32x16_bf16 v[84:99], v[136:139], a[128:131], 0
    ds_read_b64_tr_b16 v[152:153], v27 offset:53248
H_M_3:
    s_cbranch_execz L_hopret
    ds_read_b64_tr_b16 v[154:155], v27 offset:53760
    buffer_load_dwordx4 v23, s[28:31], s58 offen offset:3072 lds
    s_waitcnt lgkmcnt(6)
    v_mfma_f32_32x32x16_bf16 v[68:83], v[140:143], a[132:135], v[68:83]
    ds_read_b64_tr_b16 v[156:157], v26 offset:55296
    ds_read_b64_tr_b16 v[158:159], v26 offset:55808
    s_waitcnt lgkmcnt(6)
    v_mfma_f32_32x32x16_bf16 v[84:99], v[144:147], a[132:135], v[84:99]
    ds_read_b64_tr_b16 v[160:161], v27 offset:55296
    ds_read_b64_tr_b16 v[162:163], v27 offset:55808
    s_waitcnt vmcnt(15)
    s_waitcnt lgkmcnt(6)
    v_mfma_f32_32x32x16_bf16 v[68:83], v[148:151], a[136:139], v[68:83]
    s_waitcnt lgkmcnt(4)
    v_mfma_f32_32x32x16_bf16 v[84:99], v[152:155], a[136:139], v[84:99]
    s_waitcnt lgkmcnt(0)
    s_barrier
    v_mfma_f32_32x32x16_bf16 v[68:83], v[156:159], a[140:143], v[68:83]
    ds_read_b64_tr_b16 v[132:133], v28 offset:0
    ds_read_b64_tr_b16 v[134:135], v28 offset:512
    ds_read_b64_tr_b16 v[136:137], v29 offset:0
    ds_read_b64_tr_b16 v[138:139], v29 offset:512
    s_add_u32 m0, s56, 114688
    s_mov_b32 s58, 786432
    buffer_load_dwordx4 v20, s[28:31], s58 offen lds
    v_mfma_f32_32x32x16_bf16 v[84:99], v[160:163], a[140:143], v[84:99]
    ds_read_b64_tr_b16 v[140:141], v28 offset:2048
    ds_read_b64_tr_b16 v[142:143], v28 offset:2560
    ds_read_b64_tr_b16 v[144:145], v29 offset:2048
    ds_read_b64_tr_b16 v[146:147], v29 offset:2560
    buffer_load_dwordx4 v21, s[28:31], s58 offen offset:1024 lds
    s_waitcnt vmcnt(14)
    s_waitcnt lgkmcnt(6)
    v_mfma_f32_32x32x16_bf16 v[68:83], v[132:135], a[144:147], v[68:83]
    ds_read_b64_tr_b16 v[148:149], v28 offset:4096
    ds_read_b64_tr_b16 v[150:151], v28 offset:4608
    buffer_load_dwordx4 v22, s[28:31], s58 offen offset:2048 lds
    s_waitcnt lgkmcnt(6)
    v_mfma_f32_32x32x16_bf16 v[84:99], v[136:139], a[144:147], v[84:99]
    ds_read_b64_tr_b16 v[152:153], v29 offset:4096
    ds_read_b64_tr_b16 v[154:155], v29 offset:4608
    buffer_load_dwordx4 v23, s[28:31], s58 offen offset:3072 lds
    s_waitcnt lgkmcnt(6)
    v_mfma_f32_32x32x16_bf16 v[68:83], v[140:143], a[148:151], v[68:83]
    ds_read_b64_tr_b16 v[156:157], v28 offset:6144
    ds_read_b64_tr_b16 v[158:159], v28 offset:6656
    s_waitcnt lgkmcnt(6)
    v_mfma_f32_32x32x16_bf16 v[84:99], v[144:147], a[148:151], v[84:99]
    ds_read_b64_tr_b16 v[160:161], v29 offset:6144
    ds_read_b64_tr_b16 v[162:163], v29 offset:6656
    s_waitcnt vmcnt(14)
    s_waitcnt lgkmcnt(6)
    v_mfma_f32_32x32x16_bf16 v[68:83], v[148:151], a[152:155], v[68:83]
    ds_read_b64_tr_b16 v[132:133], v26 offset:32768
    ds_read_b64_tr_b16 v[134:135], v26 offset:33280
    s_waitcnt lgkmcnt(6)
    v_mfma_f32_32x32x16_bf16 v[84:99], v[152:155], a[152:155], v[84:99]
    ds_read_b64_tr_b16 v[136:137], v27 offset:32768
    ds_read_b64_tr_b16 v[138:139], v27 offset:33280
    s_waitcnt lgkmcnt(6)
    v_mfma_f32_32x32x16_bf16 v[68:83], v[156:159], a[156:159], v[68:83]
    ds_read_b64_tr_b16 v[140:141], v26 offset:34816
    ds_read_b64_tr_b16 v[142:143], v26 offset:35328
    s_waitcnt lgkmcnt(6)
    v_mfma_f32_32x32x16_bf16 v[84:99], v[160:163], a[156:159], v[84:99]
    ds_read_b64_tr_b16 v[144:145], v27 offset:34816
    ds_read_b64_tr_b16 v[146:147], v27 offset:35328
    s_waitcnt vmcnt(12)
    s_waitcnt lgkmcnt(6)
    v_mfma_f32_32x32x16_bf16 v[68:83], v[132:135], a[160:163], v[68:83]
    ds_read_b64_tr_b16 v[148:149], v26 offset:36864
    ds_read_b64_tr_b16 v[150:151], v26 offset:37376
    s_waitcnt lgkmcnt(6)
    v_mfma_f32_32x32x16_bf16 v[84:99], v[136:139], a[160:163], v[84:99]
    ds_read_b64_tr_b16 v[152:153], v27 offset:36864
    ds_read_b64_tr_b16 v[154:155], v27 offset:37376
    s_waitcnt lgkmcnt(6)
    v_mfma_f32_32x32x16_bf16 v[68:83], v[140:143], a[164:167], v[68:83]
    ds_read_b64_tr_b16 v[156:157], v26 offset:38912
    ds_read_b64_tr_b16 v[158:159], v26 offset:39424
    s_waitcnt lgkmcnt(6)
    v_mfma_f32_32x32x16_bf16 v[84:99], v[144:147], a[164:167], v[84:99]
    ds_read_b64_tr_b16 v[160:161], v27 offset:38912
    ds_read_b64_tr_b16 v[162:163], v27 offset:39424
    s_lshl_b32 s61, s96, 10
    s_add_u32 s61, s61, 49152
    v_and_b32 v254, 0x3ff, v51
    v_add_u32 v254, s61, v254
    buffer_load_dwordx2 v[252:253], v254, s[40:43], 0 offen sc1
    s_waitcnt vmcnt(11)
    s_waitcnt lgkmcnt(6)
    v_mfma_f32_32x32x16_bf16 v[68:83], v[148:151], a[168:171], v[68:83]
    ds_read_b64_tr_b16 v[132:133], v24 offset:0
    ds_read_b64_tr_b16 v[134:135], v24 offset:512
    s_waitcnt lgkmcnt(6)
    v_mfma_f32_32x32x16_bf16 v[84:99], v[152:155], a[168:171], v[84:99]
    ds_read_b64_tr_b16 v[136:137], v25 offset:0
    ds_read_b64_tr_b16 v[138:139], v25 offset:512
    s_waitcnt lgkmcnt(6)
    v_mfma_f32_32x32x16_bf16 v[68:83], v[156:159], a[172:175], v[68:83]
    ds_read_b64_tr_b16 v[140:141], v24 offset:2048
    ds_read_b64_tr_b16 v[142:143], v24 offset:2560
    s_waitcnt lgkmcnt(6)
    v_mfma_f32_32x32x16_bf16 v[84:99], v[160:163], a[172:175], v[84:99]
    ds_read_b64_tr_b16 v[144:145], v25 offset:2048
    ds_read_b64_tr_b16 v[146:147], v25 offset:2560
    s_waitcnt vmcnt(9)
    s_waitcnt lgkmcnt(6)
    v_mfma_f32_32x32x16_bf16 v[68:83], v[132:135], a[176:179], v[68:83]
    ds_read_b64_tr_b16 v[148:149], v24 offset:4096
    ds_read_b64_tr_b16 v[150:151], v24 offset:4608
    s_waitcnt lgkmcnt(6)
    v_mfma_f32_32x32x16_bf16 v[84:99], v[136:139], a[176:179], v[84:99]
    ds_read_b64_tr_b16 v[152:153], v25 offset:4096
    ds_read_b64_tr_b16 v[154:155], v25 offset:4608
    s_waitcnt lgkmcnt(6)
    v_mfma_f32_32x32x16_bf16 v[68:83], v[140:143], a[180:183], v[68:83]
    ds_read_b64_tr_b16 v[156:157], v24 offset:6144
    ds_read_b64_tr_b16 v[158:159], v24 offset:6656
    s_waitcnt lgkmcnt(6)
    v_mfma_f32_32x32x16_bf16 v[84:99], v[144:147], a[180:183], v[84:99]
    ds_read_b64_tr_b16 v[160:161], v25 offset:6144
    ds_read_b64_tr_b16 v[162:163], v25 offset:6656
    s_waitcnt vmcnt(0)
L_chk_1202:
    v_xor_b32 v62, s50, v252
    v_bitop3_b32 v62, v253, s51, v62 bitop3:0xbe
    v_cmp_ne_u32 vcc, 0, v62
    s_nop 0
    s_and_b32 s62, vcc_lo, 0x1111111
    s_cbranch_scc1 L_retry_1203
L_cont_1204:
    s_add_u32 s63, s65, 32768
    buffer_load_dwordx4 a[0:3], v48, s[40:43], s63 offen sc1
    buffer_load_dwordx4 a[4:7], v48, s[40:43], s63 offen offset:1024 sc1
    buffer_load_dwordx4 a[8:11], v48, s[40:43], s63 offen offset:2048 sc1
    buffer_load_dwordx4 a[12:15], v48, s[40:43], s63 offen offset:3072 sc1
    s_add_u32 s63, s65, 40960
    buffer_load_dwordx4 a[16:19], v48, s[40:43], s63 offen sc1
    buffer_load_dwordx4 a[20:23], v48, s[40:43], s63 offen offset:1024 sc1
    buffer_load_dwordx4 a[24:27], v48, s[40:43], s63 offen offset:2048 sc1
    buffer_load_dwordx4 a[28:31], v48, s[40:43], s63 offen offset:3072 sc1
    s_add_u32 s63, s65, 49152
    buffer_load_dwordx4 a[32:35], v48, s[40:43], s63 offen sc1
    buffer_load_dwordx4 a[36:39], v48, s[40:43], s63 offen offset:1024 sc1
    buffer_load_dwordx4 a[40:43], v48, s[40:43], s63 offen offset:2048 sc1
    buffer_load_dwordx4 a[44:47], v48, s[40:43], s63 offen offset:3072 sc1
    s_waitcnt lgkmcnt(6)
    v_mfma_f32_32x32x16_bf16 v[68:83], v[148:151], a[184:187], v[68:83]
    ds_read_b64_tr_b16 v[132:133], v24 offset:32768
    ds_read_b64_tr_b16 v[134:135], v24 offset:33280
    s_waitcnt lgkmcnt(6)
    v_mfma_f32_32x32x16_bf16 v[84:99], v[152:155], a[184:187], v[84:99]
    ds_read_b64_tr_b16 v[136:137], v25 offset:32768
    ds_read_b64_tr_b16 v[138:139], v25 offset:33280
    s_waitcnt lgkmcnt(6)
    v_mfma_f32_32x32x16_bf16 v[68:83], v[156:159], a[188:191], v[68:83]
    ds_read_b64_tr_b16 v[140:141], v24 offset:34816
    ds_read_b64_tr_b16 v[142:143], v24 offset:35328
    s_waitcnt lgkmcnt(6)
    v_mfma_f32_32x32x16_bf16 v[84:99], v[160:163], a[188:191], v[84:99]
    ds_read_b64_tr_b16 v[144:145], v25 offset:34816
    ds_read_b64_tr_b16 v[146:147], v25 offset:35328
    s_waitcnt vmcnt(10)
    s_waitcnt lgkmcnt(6)
    v_mfma_f32_32x32x16_bf16 v[100:115], v[132:135], a[0:3], 0
    ds_read_b64_tr_b16 v[148:149], v24 offset:36864
    ds_read_b64_tr_b16 v[150:151], v24 offset:37376
    s_add_u32 s63, s65, 57344
    buffer_load_dwordx4 a[48:51], v48, s[40:43], s63 offen sc1
    buffer_load_dwordx4 a[52:55], v48, s[40:43], s63 offen offset:1024 sc1
    buffer_load_dwordx4 a[56:59], v48, s[40:43], s63 offen offset:2048 sc1
    buffer_load_dwordx4 a[60:63], v48, s[40:43], s63 offen offset:3072 sc1
    s_waitcnt lgkmcnt(6)
    v_mfma_f32_32x32x16_bf16 v[116:131], v[136:139], a[0:3], 0
    ds_read_b64_tr_b16 v[152:153], v25 offset:36864
    ds_read_b64_tr_b16 v[154:155], v25 offset:37376
    s_waitcnt lgkmcnt(6)
    v_mfma_f32_32x32x16_bf16 v[100:115], v[140:143], a[4:7], v[100:115]
    ds_read_b64_tr_b16 v[156:157], v24 offset:38912
    ds_read_b64_tr_b16 v[158:159], v24 offset:39424
    s_waitcnt lgkmcnt(6)
    v_mfma_f32_32x32x16_bf16 v[116:131], v[144:147], a[4:7], v[116:131]
    ds_read_b64_tr_b16 v[160:161], v25 offset:38912
    ds_read_b64_tr_b16 v[162:163], v25 offset:39424
    s_waitcnt vmcnt(12)
    s_waitcnt lgkmcnt(6)
    v_mfma_f32_32x32x16_bf16 v[100:115], v[148:151], a[8:11], v[100:115]
    ds_read_b64_tr_b16 v[132:133], v28 offset:16384
    ds_read_b64_tr_b16 v[134:135], v28 offset:16896
    s_waitcnt lgkmcnt(6)
    v_mfma_f32_32x32x16_bf16 v[116:131], v[152:155], a[8:11], v[116:131]
    ds_read_b64_tr_b16 v[136:137], v29 offset:16384
    ds_read_b64_tr_b16 v[138:139], v29 offset:16896
    s_waitcnt lgkmcnt(6)
    v_mfma_f32_32x32x16_bf16 v[100:115], v[156:159], a[12:15], v[100:115]
    ds_read_b64_tr_b16 v[140:141], v28 offset:18432
    ds_read_b64_tr_b16 v[142:143], v28 offset:18944
    s_waitcnt lgkmcnt(6)
    v_mfma_f32_32x32x16_bf16 v[116:131], v[160:163], a[12:15], v[116:131]
    ds_read_b64_tr_b16 v[144:145], v29 offset:18432
    ds_read_b64_tr_b16 v[146:147], v29 offset:18944
    s_waitcnt vmcnt(10)
    s_waitcnt lgkmcnt(6)
    v_mfma_f32_32x32x16_bf16 v[100:115], v[132:135], a[16:19], v[100:115]
    ds_read_b64_tr_b16 v[148:149], v28 offset:20480
    ds_read_b64_tr_b16 v[150:151], v28 offset:20992
    s_add_u32 s63, s65, 65536
    buffer_load_dwordx4 a[64:67], v48, s[40:43], s63 offen sc1
    buffer_load_dwordx4 a[68:71], v48, s[40:43], s63 offen offset:1024 sc1
    buffer_load_dwordx4 a[72:75], v48, s[40:43], s63 offen offset:2048 sc1
    buffer_load_dwordx4 a[76:79], v48, s[40:43], s63 offen offset:3072 sc1
    s_waitcnt lgkmcnt(6)
    v_mfma_f32_32x32x16_bf16 v[116:131], v[136:139], a[16:19], v[116:131]
    ds_read_b64_tr_b16 v[152:153], v29 offset:20480
    ds_read_b64_tr_b16 v[154:155], v29 offset:20992
    s_waitcnt lgkmcnt(6)
    v_mfma_f32_32x32x16_bf16 v[100:115], v[140:143], a[20:23], v[100:115]
    ds_read_b64_tr_b16 v[156:157], v28 offset:22528
    ds_read_b64_tr_b16 v[158:159], v28 offset:23040
    s_waitcnt lgkmcnt(6)
    v_mfma_f32_32x32x16_bf16 v[116:131], v[144:147], a[20:23], v[116:131]
    ds_read_b64_tr_b16 v[160:161], v29 offset:22528
    ds_read_b64_tr_b16 v[162:163], v29 offset:23040
    s_waitcnt vmcnt(12)
    s_waitcnt lgkmcnt(6)
    v_mfma_f32_32x32x16_bf16 v[100:115], v[148:151], a[24:27], v[100:115]
    ds_read_b64_tr_b16 v[132:133], v24 offset:16384
    ds_read_b64_tr_b16 v[134:135], v24 offset:16896
    s_waitcnt lgkmcnt(6)
    v_mfma_f32_32x32x16_bf16 v[116:131], v[152:155], a[24:27], v[116:131]
    ds_read_b64_tr_b16 v[136:137], v25 offset:16384
    ds_read_b64_tr_b16 v[138:139], v25 offset:16896
    s_waitcnt lgkmcnt(6)
    v_mfma_f32_32x32x16_bf16 v[100:115], v[156:159], a[28:31], v[100:115]
    ds_read_b64_tr_b16 v[140:141], v24 offset:18432
    ds_read_b64_tr_b16 v[142:143], v24 offset:18944
    s_waitcnt lgkmcnt(6)
    v_mfma_f32_32x32x16_bf16 v[116:131], v[160:163], a[28:31], v[116:131]
    ds_read_b64_tr_b16 v[144:145], v25 offset:18432
    ds_read_b64_tr_b16 v[146:147], v25 offset:18944
    s_waitcnt vmcnt(10)
    s_waitcnt lgkmcnt(6)
    v_mfma_f32_32x32x16_bf16 v[100:115], v[132:135], a[32:35], v[100:115]
    ds_read_b64_tr_b16 v[148:149], v24 offset:20480
    ds_read_b64_tr_b16 v[150:151], v24 offset:20992
    s_add_u32 s63, s65, 73728
    buffer_load_dwordx4 a[80:83], v48, s[40:43], s63 offen sc1
    buffer_load_dwordx4 a[84:87], v48, s[40:43], s63 offen offset:1024 sc1
    buffer_load_dwordx4 a[88:91], v48, s[40:43], s63 offen offset:2048 sc1
    buffer_load_dwordx4 a[92:95], v48, s[40:43], s63 offen offset:3072 sc1
    s_waitcnt lgkmcnt(6)
    v_mfma_f32_32x32x16_bf16 v[116:131], v[136:139], a[32:35], v[116:131]
    ds_read_b64_tr_b16 v[152:153], v25 offset:20480
    ds_read_b64_tr_b16 v[154:155], v25 offset:20992
    s_waitcnt lgkmcnt(6)
    v_mfma_f32_32x32x16_bf16 v[100:115], v[140:143], a[36:39], v[100:115]
    ds_read_b64_tr_b16 v[156:157], v24 offset:22528
    ds_read_b64_tr_b16 v[158:159], v24 offset:23040
    s_waitcnt lgkmcnt(6)
    v_mfma_f32_32x32x16_bf16 v[116:131], v[144:147], a[36:39], v[116:131]
    ds_read_b64_tr_b16 v[160:161], v25 offset:22528
    ds_read_b64_tr_b16 v[162:163], v25 offset:23040
    s_waitcnt vmcnt(12)
    s_waitcnt lgkmcnt(6)
    v_mfma_f32_32x32x16_bf16 v[100:115], v[148:151], a[40:43], v[100:115]
    ds_read_b64_tr_b16 v[132:133], v26 offset:0
    ds_read_b64_tr_b16 v[134:135], v26 offset:512
    s_waitcnt lgkmcnt(6)
    v_mfma_f32_32x32x16_bf16 v[116:131], v[152:155], a[40:43], v[116:131]
    ds_read_b64_tr_b16 v[136:137], v27 offset:0
    ds_read_b64_tr_b16 v[138:139], v27 offset:512
    s_waitcnt lgkmcnt(6)
    v_mfma_f32_32x32x16_bf16 v[100:115], v[156:159], a[44:47], v[100:115]
    ds_read_b64_tr_b16 v[140:141], v26 offset:2048
    ds_read_b64_tr_b16 v[142:143], v26 offset:2560
    s_waitcnt lgkmcnt(6)
    v_mfma_f32_32x32x16_bf16 v[116:131], v[160:163], a[44:47], v[116:131]
    ds_read_b64_tr_b16 v[144:145], v27 offset:2048
    ds_read_b64_tr_b16 v[146:147], v27 offset:2560
    s_waitcnt vmcnt(10)
    s_waitcnt lgkmcnt(6)
    v_mfma_f32_32x32x16_bf16 v[100:115], v[132:135], a[48:51], v[100:115]
    ds_read_b64_tr_b16 v[148:149], v26 offset:4096
    ds_read_b64_tr_b16 v[150:151], v26 offset:4608
    s_add_u32 s63, s65, 81920
    buffer_load_dwordx4 a[96:99], v48, s[40:43], s63 offen sc1
    buffer_load_dwordx4 a[100:103], v48, s[40:43], s63 offen offset:1024 sc1
    buffer_load_dwordx4 a[104:107], v48, s[40:43], s63 offen offset:2048 sc1
    buffer_load_dwordx4 a[108:111], v48, s[40:43], s63 offen offset:3072 sc1
    s_waitcnt lgkmcnt(6)
    v_mfma_f32_32x32x16_bf16 v[116:131], v[136:139], a[48:51], v[116:131]
    ds_read_b64_tr_b16 v[152:153], v27 offset:4096
    ds_read_b64_tr_b16 v[154:155], v27 offset:4608
    s_waitcnt lgkmcnt(6)
    v_mfma_f32_32x32x16_bf16 v[100:115], v[140:143], a[52:55], v[100:115]
    ds_read_b64_tr_b16 v[156:157], v26 offset:6144
    ds_read_b64_tr_b16 v[158:159], v26 offset:6656
    s_waitcnt lgkmcnt(6)
    v_mfma_f32_32x32x16_bf16 v[116:131], v[144:147], a[52:55], v[116:131]
    ds_read_b64_tr_b16 v[160:161], v27 offset:6144
    ds_read_b64_tr_b16 v[162:163], v27 offset:6656
    s_waitcnt vmcnt(12)
    s_waitcnt lgkmcnt(6)
    v_mfma_f32_32x32x16_bf16 v[100:115], v[148:151], a[56:59], v[100:115]
    ds_read_b64_tr_b16 v[132:133], v26 offset:16384
    ds_read_b64_tr_b16 v[134:135], v26 offset:16896
    s_waitcnt lgkmcnt(6)
    v_mfma_f32_32x32x16_bf16 v[116:131], v[152:155], a[56:59], v[116:131]
    ds_read_b64_tr_b16 v[136:137], v27 offset:16384
    ds_read_b64_tr_b16 v[138:139], v27 offset:16896
    v_sub_f32 v32, 1.0, v30
    v_mov_b32 v33, v32
    s_waitcnt lgkmcnt(6)
    v_mfma_f32_32x32x16_bf16 v[100:115], v[156:159], a[60:63], v[100:115]
    ds_read_b64_tr_b16 v[140:141], v26 offset:18432
    ds_read_b64_tr_b16 v[142:143], v26 offset:18944
    s_waitcnt lgkmcnt(6)
    v_mfma_f32_32x32x16_bf16 v[116:131], v[160:163], a[60:63], v[116:131]
    ds_read_b64_tr_b16 v[144:145], v27 offset:18432
    ds_read_b64_tr_b16 v[146:147], v27 offset:18944
    s_waitcnt vmcnt(10)
    s_waitcnt lgkmcnt(6)
    v_mfma_f32_32x32x16_bf16 v[100:115], v[132:135], a[64:67], v[100:115]
    ds_read_b64_tr_b16 v[148:149], v26 offset:20480
    ds_read_b64_tr_b16 v[150:151], v26 offset:20992
    v_mul_f32 v68, v30, v68
    v_mul_f32 v69, v30, v69
    s_waitcnt lgkmcnt(6)
    v_mfma_f32_32x32x16_bf16 v[116:131], v[136:139], a[64:67], v[116:131]
    ds_read_b64_tr_b16 v[152:153], v27 offset:20480
    ds_read_b64_tr_b16 v[154:155], v27 offset:20992
    v_mul_f32 v70, v30, v70
    v_mul_f32 v71, v30, v71
    s_waitcnt lgkmcnt(6)
    v_mfma_f32_32x32x16_bf16 v[100:115], v[140:143], a[68:71], v[100:115]
    ds_read_b64_tr_b16 v[156:157], v26 offset:22528
    ds_read_b64_tr_b16 v[158:159], v26 offset:23040
    v_mul_f32 v72, v30, v72
    v_mul_f32 v73, v30, v73
    s_waitcnt lgkmcnt(6)
    v_mfma_f32_32x32x16_bf16 v[116:131], v[144:147], a[68:71], v[116:131]
    ds_read_b64_tr_b16 v[160:161], v27 offset:22528
    ds_read_b64_tr_b16 v[162:163], v27 offset:23040
    v_mul_f32 v74, v30, v74
    v_mul_f32 v75, v30, v75
    s_waitcnt vmcnt(8)
    s_waitcnt lgkmcnt(6)
    v_mfma_f32_32x32x16_bf16 v[100:115], v[148:151], a[72:75], v[100:115]
    v_mul_f32 v76, v30, v76
    v_mul_f32 v77, v30, v77
    s_waitcnt lgkmcnt(4)
    v_mfma_f32_32x32x16_bf16 v[116:131], v[152:155], a[72:75], v[116:131]
    v_mul_f32 v78, v30, v78
    v_mul_f32 v79, v30, v79
    s_waitcnt lgkmcnt(0)
    s_barrier
    v_mfma_f32_32x32x16_bf16 v[100:115], v[156:159], a[76:79], v[100:115]
    ds_read_b64_tr_b16 v[132:133], v24 offset:49152
    ds_read_b64_tr_b16 v[134:135], v24 offset:49664
    ds_read_b64_tr_b16 v[136:137], v25 offset:49152
    ds_read_b64_tr_b16 v[138:139], v25 offset:49664
    v_mul_f32 v80, v30, v80
    v_mul_f32 v81, v30, v81
    v_mfma_f32_32x32x16_bf16 v[116:131], v[160:163], a[76:79], v[116:131]
    ds_read_b64_tr_b16 v[140:141], v24 offset:51200
    ds_read_b64_tr_b16 v[142:143], v24 offset:51712
    ds_read_b64_tr_b16 v[144:145], v25 offset:51200
    ds_read_b64_tr_b16 v[146:147], v25 offset:51712
    v_mul_f32 v82, v30, v82
    v_mul_f32 v83, v30, v83
    s_waitcnt vmcnt(6)
    s_waitcnt lgkmcnt(6)
    v_mfma_f32_32x32x16_bf16 v[100:115], v[132:135], a[80:83], v[100:115]
    ds_read_b64_tr_b16 v[148:149], v24 offset:53248
    ds_read_b64_tr_b16 v[150:151], v24 offset:53760
    v_mul_f32 v84, v30, v84
    v_mul_f32 v85, v30, v85
    s_waitcnt lgkmcnt(6)
    v_mfma_f32_32x32x16_bf16 v[116:131], v[136:139], a[80:83], v[116:131]
    ds_read_b64_tr_b16 v[152:153], v25 offset:53248
    ds_read_b64_tr_b16 v[154:155], v25 offset:53760
    v_mul_f32 v86, v30, v86
    v_mul_f32 v87, v30, v87
    s_waitcnt lgkmcnt(6)
    v_mfma_f32_32x32x16_bf16 v[100:115], v[140:143], a[84:87], v[100:115]
    ds_read_b64_tr_b16 v[156:157], v24 offset:55296
    ds_read_b64_tr_b16 v[158:159], v24 offset:55808
    v_mul_f32 v88, v30, v88
    v_mul_f32 v89, v30, v89
    s_waitcnt lgkmcnt(6)
    v_mfma_f32_32x32x16_bf16 v[116:131], v[144:147], a[84:87], v[116:131]
    ds_read_b64_tr_b16 v[160:161], v25 offset:55296
    ds_read_b64_tr_b16 v[162:163], v25 offset:55808
    v_mul_f32 v90, v30, v90
    v_mul_f32 v91, v30, v91
    s_waitcnt vmcnt(4)
    s_waitcnt lgkmcnt(6)
    v_mfma_f32_32x32x16_bf16 v[100:115], v[148:151], a[88:91], v[100:115]
    ds_read_b64_tr_b16 v[132:133], v26 offset:49152
    ds_read_b64_tr_b16 v[134:135], v26 offset:49664
    v_mul_f32 v92, v30, v92
    v_mul_f32 v93, v30, v93
    s_waitcnt lgkmcnt(6)
    v_mfma_f32_32x32x16_bf16 v[116:131], v[152:155], a[88:91], v[116:131]
    ds_read_b64_tr_b16 v[136:137], v27 offset:49152
    ds_read_b64_tr_b16 v[138:139], v27 offset:49664
    v_mul_f32 v94, v30, v94
    v_mul_f32 v95, v30, v95
    s_waitcnt lgkmcnt(6)
    v_mfma_f32_32x32x16_bf16 v[100:115], v[156:159], a[92:95], v[100:115]
    ds_read_b64_tr_b16 v[140:141], v26 offset:51200
    ds_read_b64_tr_b16 v[142:143], v26 offset:51712
    v_mul_f32 v96, v30, v96
    v_mul_f32 v97, v30, v97
    s_waitcnt lgkmcnt(6)
    v_mfma_f32_32x32x16_bf16 v[116:131], v[160:163], a[92:95], v[116:131]
    ds_read_b64_tr_b16 v[144:145], v27 offset:51200
    ds_read_b64_tr_b16 v[146:147], v27 offset:51712
    v_mul_f32 v98, v30, v98
    v_mul_f32 v99, v30, v99
    s_waitcnt vmcnt(2)
    s_waitcnt lgkmcnt(6)
    v_mfma_f32_32x32x16_bf16 v[100:115], v[132:135], a[96:99], v[100:115]
    ds_read_b64_tr_b16 v[148:149], v26 offset:53248
    ds_read_b64_tr_b16 v[150:151], v26 offset:53760
    s_waitcnt lgkmcnt(6)
    v_mfma_f32_32x32x16_bf16 v[116:131], v[136:139], a[96:99], v[116:131]
    ds_read_b64_tr_b16 v[152:153], v27 offset:53248
    ds_read_b64_tr_b16 v[154:155], v27 offset:53760
    s_waitcnt lgkmcnt(6)
    v_mfma_f32_32x32x16_bf16 v[100:115], v[140:143], a[100:103], v[100:115]
    ds_read_b64_tr_b16 v[156:157], v26 offset:55296
    ds_read_b64_tr_b16 v[158:159], v26 offset:55808
    s_waitcnt lgkmcnt(6)
    v_mfma_f32_32x32x16_bf16 v[116:131], v[144:147], a[100:103], v[116:131]
    ds_read_b64_tr_b16 v[160:161], v27 offset:55296
    ds_read_b64_tr_b16 v[162:163], v27 offset:55808
    s_waitcnt vmcnt(0)
    s_waitcnt lgkmcnt(6)
    v_mfma_f32_32x32x16_bf16 v[100:115], v[148:151], a[104:107], v[100:115]
    s_waitcnt lgkmcnt(4)
    v_mfma_f32_32x32x16_bf16 v[116:131], v[152:155], a[104:107], v[116:131]
    s_waitcnt lgkmcnt(2)
    v_mfma_f32_32x32x16_bf16 v[100:115], v[156:159], a[108:111], v[100:115]
    s_waitcnt lgkmcnt(0)
    v_mfma_f32_32x32x16_bf16 v[116:131], v[160:163], a[108:111], v[116:131]
    s_barrier
    s_nop 8
    v_pk_fma_f32 v[68:69], v[100:101], v[32:33], v[68:69]
    v_pk_fma_f32 v[70:71], v[102:103], v[32:33], v[70:71]
    ds_write_b128 v35, v[68:71] offset:0
    v_pk_fma_f32 v[72:73], v[104:105], v[32:33], v[72:73]
    v_pk_fma_f32 v[74:75], v[106:107], v[32:33], v[74:75]
    ds_write_b128 v35, v[72:75] offset:32
    v_pk_fma_f32 v[76:77], v[108:109], v[32:33], v[76:77]
    v_pk_fma_f32 v[78:79], v[110:111], v[32:33], v[78:79]
    ds_write_b128 v35, v[76:79] offset:64
    v_pk_fma_f32 v[80:81], v[112:113], v[32:33], v[80:81]
    v_pk_fma_f32 v[82:83], v[114:115], v[32:33], v[82:83]
    ds_write_b128 v35, v[80:83] offset:96
    v_pk_fma_f32 v[84:85], v[116:117], v[32:33], v[84:85]
    v_pk_fma_f32 v[86:87], v[118:119], v[32:33], v[86:87]
    ds_write_b128 v35, v[84:87] offset:128
    v_pk_fma_f32 v[88:89], v[120:121], v[32:33], v[88:89]
    v_pk_fma_f32 v[90:91], v[122:123], v[32:33], v[90:91]
    ds_write_b128 v35, v[88:91] offset:160
    v_pk_fma_f32 v[92:93], v[124:125], v[32:33], v[92:93]
    v_pk_fma_f32 v[94:95], v[126:127], v[32:33], v[94:95]
    ds_write_b128 v35, v[92:95] offset:192
    v_pk_fma_f32 v[96:97], v[128:129], v[32:33], v[96:97]
    v_pk_fma_f32 v[98:99], v[130:131], v[32:33], v[98:99]
    ds_write_b128 v35, v[96:99] offset:224
    s_waitcnt lgkmcnt(0)
    s_barrier
    ds_read_b128 v[164:167], v47 offset:0
    ds_read_b128 v[168:171], v47 offset:16
    ds_read_b128 v[172:175], v47 offset:8704
    ds_read_b128 v[176:179], v47 offset:8720
    ds_read_b128 v[180:183], v47 offset:2176
    ds_read_b128 v[184:187], v47 offset:2192
    ds_read_b128 v[188:191], v47 offset:10880
    ds_read_b128 v[192:195], v47 offset:10896
    s_waitcnt lgkmcnt(4)
    v_pk_add_f32 v[164:165], v[164:165], v[172:173]
    v_pk_add_f32 v[166:167], v[166:167], v[174:175]
    v_pk_add_f32 v[168:169], v[168:169], v[176:177]
    v_pk_add_f32 v[170:171], v[170:171], v[178:179]
    v_cvt_pk_bf16_f32 v172, v164, v165
    v_cvt_pk_bf16_f32 v173, v166, v167
    v_cvt_pk_bf16_f32 v174, v168, v169
    v_cvt_pk_bf16_f32 v175, v170, v171
    buffer_store_dwordx4 v[172:175], v40, s[36:39], 0 offen sc1
    s_waitcnt lgkmcnt(0)
    v_pk_add_f32 v[180:181], v[180:181], v[188:189]
    v_pk_add_f32 v[182:183], v[182:183], v[190:191]
    v_pk_add_f32 v[184:185], v[184:185], v[192:193]
    v_pk_add_f32 v[186:187], v[186:187], v[194:195]
    v_cvt_pk_bf16_f32 v188, v180, v181
    v_cvt_pk_bf16_f32 v189, v182, v183
    v_cvt_pk_bf16_f32 v190, v184, v185
    v_cvt_pk_bf16_f32 v191, v186, v187
    buffer_store_dwordx4 v[188:191], v41, s[36:39], 0 offen sc1
    s_cmp_lg_u32 s2, 0
    s_cbranch_scc1 L_end
    buffer_store_dwordx2 v[66:67], v50, s[40:43], 0 offen sc1
    s_branch L_end
L_roleS0:
H_S0_0:
    s_cbranch_execz H_S0_4
    s_mov_b64 exec, 0
    s_call_b64 s[90:91], L_hopS0
    s_mov_b64 exec, -1
    s_nop 3
    s_add_u32 m0, s56, 32768
    s_xor_b32 s58, s0, 128
    s_add_u32 s58, s58, 0
    s_and_b32 s58, s58, 1023
    s_lshl_b32 s62, s45, 17
    s_add_u32 s58, s58, s62
    buffer_load_dwordx4 v4, s[4:7], s58 offen lds
    buffer_load_dwordx4 v5, s[4:7], s58 offen offset:1024 lds
    buffer_load_dwordx4 v6, s[4:7], s58 offen offset:2048 lds
    buffer_load_dwordx4 v7, s[4:7], s58 offen offset:3072 lds
    s_movk_i32 s60, 3072
    v_mad_u32_u24 v12, v206, s60, v203
    v_add_u32 v13, 11264, v12
    v_add_u32 v14, 47104, v12
    v_add_u32 v15, 58368, v12
    s_mov_b32 s42, 0x1180000
    s_mov_b32 s43, 0x20000
    s_mov_b32 s10, 0x180000
    s_mov_b32 s11, 0x20000
    s_mov_b32 s22, 0x800000
    s_mov_b32 s23, 0x20000
    s_mov_b32 s14, 0x80000
    s_mov_b32 s15, 0x20000
    s_mov_b32 s26, 0x1000
    s_mov_b32 s27, 0x20000
    s_mov_b32 s30, 0xe0000
    s_mov_b32 s31, 0x20000
    s_mov_b32 s34, 0x400
    s_mov_b32 s35, 0x20000
    s_mov_b32 s38, 0x200000
    s_mov_b32 s39, 0x20000
    s_mov_b32 s3, 4000000
    s_lshl_b32 s49, s45, 1
    s_add_u32 s49, s49, s48
    s_and_b32 s61, s47, 1
    s_lshl_b32 s96, s45, 1
    s_add_u32 s96, s96, s61
    s_lshl_b32 s97, s48, 2
    s_lshr_b32 s61, s47, 1
    s_add_u32 s97, s97, s61
    s_lshl_b32 s57, s45, 2
    s_add_u32 s57, s57, s44
    s_mul_i32 s61, s45, 8
    s_mul_i32 s53, s47, 2
    s_add_u32 s53, s53, s61
    s_and_b32 s53, s53, 7
    s_add_u32 s94, s53, 7
    s_and_b32 s94, s94, 7
    s_lshr_b32 s61, s94, 0
    s_lshl_b32 s61, s61, 0
    s_waitcnt lgkmcnt(0)
    s_add_u32 s54, s52, 0
    s_and_b32 s54, s54, 3
    s_mul_i32 s54, s54, 393216
    s_add_u32 s55, s52, 1
    s_and_b32 s55, s55, 3
    s_mul_i32 s55, s55, 393216
    s_add_u32 s93, s52, 2
    s_and_b32 s93, s93, 3
    s_mul_i32 s93, s93, 393216
    s_add_u32 s95, s52, 3
    s_and_b32 s95, s95, 3
    s_mul_i32 s95, s95, 393216
    s_waitcnt vmcnt(8)
    ds_read_b128 a[0:3], v42 offset:0
    ds_read_b128 a[4:7], v42 offset:2048
    ds_read_b128 a[8:11], v43 offset:0
    ds_read_b128 a[12:15], v43 offset:2048
    s_add_u32 m0, s56, 49152
    s_add_u32 s58, s52, 1
    s_and_b32 s58, s58, 3
    s_mul_i32 s58, s58, s1
    s_add_u32 s58, s58, s92
    buffer_load_dwordx4 v8, s[16:19], s58 offen lds
    buffer_load_dwordx4 v9, s[16:19], s58 offen offset:1024 lds
    buffer_load_dwordx4 v10, s[16:19], s58 offen offset:2048 lds
    buffer_load_dwordx4 v11, s[16:19], s58 offen offset:3072 lds
    s_waitcnt vmcnt(8) lgkmcnt(0)
    s_barrier
    ds_read_b64_tr_b16 v[132:133], v24 offset:16384
    ds_read_b64_tr_b16 v[134:135], v24 offset:17408
    ds_read_b64_tr_b16 v[136:137], v25 offset:16384
    ds_read_b64_tr_b16 v[138:139], v25 offset:17408
    ds_read_b64_tr_b16 v[140:141], v26 offset:16384
    ds_read_b64_tr_b16 v[142:143], v26 offset:17408
    ds_read_b64_tr_b16 v[144:145], v27 offset:16384
    ds_read_b64_tr_b16 v[146:147], v27 offset:17408
    s_waitcnt lgkmcnt(6)
    v_mfma_f32_16x16x32_bf16 v[68:71], a[0:3], v[132:135], 0
    ds_read_b64_tr_b16 v[148:149], v24 offset:20480
    s_add_u32 s94, s94, s61
    s_lshl_b32 s94, s94, 8
    s_xor_b32 s61, s48, 1
    v_mfma_f32_16x16x32_bf16 v[84:87], a[4:7], v[132:135], 0
    ds_read_b64_tr_b16 v[150:151], v24 offset:21504
    s_add_u32 m0, s56, 65536
    s_add_u32 s58, s0, 256
    s_and_b32 s58, s58, 1023
    s_lshl_b32 s62, s45, 17
    s_add_u32 s58, s58, s62
    buffer_load_dwordx4 v4, s[4:7], s58 offen lds
    s_lshl_b32 s61, s61, 18
    s_add_u32 s94, s94, s61
    v_mov_b32 v50, 0
    s_waitcnt lgkmcnt(6)
    v_mfma_f32_16x16x32_bf16 v[72:75], a[0:3], v[136:139], 0
H_S0_1:
    s_cbranch_execz H_S0_5
    ds_read_b64_tr_b16 v[152:153], v25 offset:20480
    v_lshlrev_b32 v48, 4, v1
    v_lshlrev_b32 v49, 3, v2
    v_lshrrev_b32 v204, 2, v1
    v_mfma_f32_16x16x32_bf16 v[88:91], a[4:7], v[136:139], 0
    ds_read_b64_tr_b16 v[154:155], v25 offset:21504
    buffer_load_dwordx4 v5, s[4:7], s58 offen offset:1024 lds
    v_and_b32 v205, 3, v1
    v_lshlrev_b32 v205, 3, v205
    v_lshl_add_u32 v51, v204, 7, v205
    s_waitcnt lgkmcnt(6)
    v_mfma_f32_16x16x32_bf16 v[76:79], a[0:3], v[140:143], 0
    ds_read_b64_tr_b16 v[156:157], v26 offset:20480
    s_lshr_b32 s59, s44, 1
    s_lshl_b32 s59, s59, 17
    s_and_b32 s60, s44, 1
    v_mfma_f32_16x16x32_bf16 v[92:95], a[4:7], v[140:143], 0
    ds_read_b64_tr_b16 v[158:159], v26 offset:21504
    buffer_load_dwordx4 v6, s[4:7], s58 offen offset:2048 lds
    s_lshl_b32 s60, s60, 7
    s_add_u32 s59, s59, s60
    s_lshl_b32 s60, s45, 19
    s_waitcnt lgkmcnt(6)
    v_mfma_f32_16x16x32_bf16 v[80:83], a[0:3], v[144:147], 0
    ds_read_b64_tr_b16 v[160:161], v27 offset:20480
    s_add_u32 s59, s59, s60
    s_lshl_b32 s60, s48, 8
    s_add_u32 s59, s59, s60
    v_mfma_f32_16x16x32_bf16 v[96:99], a[4:7], v[144:147], 0
    ds_read_b64_tr_b16 v[162:163], v27 offset:21504
    buffer_load_dwordx4 v7, s[4:7], s58 offen offset:3072 lds
    v_lshrrev_b32 v204, 1, v197
    v_xor_b32 v204, v204, v198
    v_lshlrev_b32 v204, 4, v204
    s_waitcnt lgkmcnt(6)
    v_mfma_f32_16x16x32_bf16 v[68:71], a[8:11], v[148:151], v[68:71]
    ds_read_b64_tr_b16 v[132:133], v24 offset:24576
    v_lshl_add_u32 v204, v199, 12, v204
    v_add_u32 v16, s59, v204
    v_xor_b32 v204, 64, v16
    v_mfma_f32_16x16x32_bf16 v[84:87], a[12:15], v[148:151], v[84:87]
    ds_read_b64_tr_b16 v[134:135], v24 offset:25600
    s_add_u32 m0, s56, 81920
    s_xor_b32 s58, s0, 128
    s_add_u32 s58, s58, 256
    s_and_b32 s58, s58, 1023
    s_lshl_b32 s62, s45, 17
    s_add_u32 s58, s58, s62
    buffer_load_dwordx4 v4, s[4:7], s58 offen lds
    v_add_u32 v17, 64512, v204
    v_add_u32 v18, 14336, v16
    v_add_u32 v19, 78848, v204
    s_waitcnt lgkmcnt(6)
    v_mfma_f32_16x16x32_bf16 v[72:75], a[8:11], v[152:155], v[72:75]
    ds_read_b64_tr_b16 v[136:137], v25 offset:24576
    s_lshl_b32 s59, s44, 15
    s_lshl_b32 s60, s97, 7
    s_add_u32 s59, s59, s60
    v_mfma_f32_16x16x32_bf16 v[88:91], a[12:15], v[152:155], v[88:91]
    ds_read_b64_tr_b16 v[138:139], v25 offset:25600
    buffer_load_dwordx4 v5, s[4:7], s58 offen offset:1024 lds
    v_lshrrev_b32 v204, 2, v197
    v_lshl_add_u32 v204, v204, 3, v199
    v_and_b32 v205, 2, v197
    s_waitcnt lgkmcnt(6)
    v_mfma_f32_16x16x32_bf16 v[76:79], a[8:11], v[156:159], v[76:79]
    ds_read_b64_tr_b16 v[140:141], v26 offset:24576
    v_lshlrev_b32 v205, 1, v205
    v_xor_b32 v205, v205, v198
    v_lshlrev_b32 v205, 4, v205
    s_waitcnt vmcnt(10)
    ds_read_b128 a[16:19], v42 offset:32768
    ds_read_b128 a[20:23], v42 offset:34816
    ds_read_b128 a[24:27], v43 offset:32768
    ds_read_b128 a[28:31], v43 offset:34816
    v_mfma_f32_16x16x32_bf16 v[92:95], a[12:15], v[156:159], v[92:95]
    ds_read_b64_tr_b16 v[142:143], v26 offset:25600
    buffer_load_dwordx4 v6, s[4:7], s58 offen offset:2048 lds
    v_lshl_add_u32 v204, v204, 10, v205
    v_add_u32 v20, s59, v204
    v_add_u32 v21, 3072, v20
    s_waitcnt lgkmcnt(10)
    v_mfma_f32_16x16x32_bf16 v[80:83], a[8:11], v[160:163], v[80:83]
    ds_read_b64_tr_b16 v[144:145], v27 offset:24576
    v_add_u32 v22, 6144, v20
    v_add_u32 v23, 9216, v20
    v_lshlrev_b32 v204, 4, v2
    v_mfma_f32_16x16x32_bf16 v[96:99], a[12:15], v[160:163], v[96:99]
    ds_read_b64_tr_b16 v[146:147], v27 offset:25600
    buffer_load_dwordx4 v7, s[4:7], s58 offen offset:3072 lds
    v_lshl_add_u32 v36, v3, 9, v204
    v_and_b32 v204, 128, v204
    v_add_u32 v37, v36, v204
    s_waitcnt lgkmcnt(3)
    v_mfma_f32_16x16x32_bf16 v[68:71], a[16:19], v[132:135], v[68:71]
    ds_read_b64_tr_b16 v[148:149], v24 offset:28672
    v_mov_b32 v52, 0xc0135761
    v_mov_b32 v53, 0xc0135761
    v_mov_b32 v54, 0xbdd2d3e8
    v_mfma_f32_16x16x32_bf16 v[84:87], a[20:23], v[132:135], v[84:87]
    ds_read_b64_tr_b16 v[150:151], v24 offset:29696
    s_add_u32 m0, s56, 98304
    s_add_u32 s58, s52, 2
    s_and_b32 s58, s58, 3
    s_mul_i32 s58, s58, s1
    s_add_u32 s58, s58, s92
    buffer_load_dwordx4 v8, s[16:19], s58 offen lds
    v_mov_b32 v55, 0xbdd2d3e8
    v_mov_b32 v56, 0x3f800000
    v_mov_b32 v57, 0x3f800000
    v_mfma_f32_16x16x32_bf16 v[72:75], a[16:19], v[136:139], v[72:75]
    ds_read_b64_tr_b16 v[152:153], v25 offset:28672
    v_mov_b32 v58, 0x3fb8aa3b
    v_mov_b32 v59, 0x3fb8aa3b
    v_mov_b32 v60, 0x358637bd
    v_mfma_f32_16x16x32_bf16 v[88:91], a[20:23], v[136:139], v[88:91]
    ds_read_b64_tr_b16 v[154:155], v25 offset:29696
    buffer_load_dwordx4 v9, s[16:19], s58 offen offset:1024 lds
    v_mov_b32 v61, 0x358637bd
    s_waitcnt lgkmcnt(6)
    v_mfma_f32_16x16x32_bf16 v[76:79], a[16:19], v[140:143], v[76:79]
    ds_read_b64_tr_b16 v[156:157], v26 offset:28672
    v_mfma_f32_16x16x32_bf16 v[92:95], a[20:23], v[140:143], v[92:95]
    ds_read_b64_tr_b16 v[158:159], v26 offset:29696
    buffer_load_dwordx4 v10, s[16:19], s58 offen offset:2048 lds
    s_waitcnt lgkmcnt(6)
    v_mfma_f32_16x16x32_bf16 v[80:83], a[16:19], v[144:147], v[80:83]
    ds_read_b64_tr_b16 v[160:161], v27 offset:28672
    v_mfma_f32_16x16x32_bf16 v[96:99], a[20:23], v[144:147], v[96:99]
    ds_read_b64_tr_b16 v[162:163], v27 offset:29696
    buffer_load_dwordx4 v11, s[16:19], s58 offen offset:3072 lds
    s_waitcnt lgkmcnt(6)
    v_mfma_f32_16x16x32_bf16 v[68:71], a[24:27], v[148:151], v[68:71]
    v_mfma_f32_16x16x32_bf16 v[84:87], a[28:31], v[148:151], v[84:87]
    s_add_u32 m0, s56, 114688
    s_add_u32 s58, s0, 512
    s_and_b32 s58, s58, 1023
    s_lshl_b32 s62, s45, 17
    s_add_u32 s58, s58, s62
    buffer_load_dwordx4 v4, s[4:7], s58 offen lds
    s_waitcnt lgkmcnt(4)
    v_mfma_f32_16x16x32_bf16 v[72:75], a[24:27], v[152:155], v[72:75]
    v_mfma_f32_16x16x32_bf16 v[88:91], a[28:31], v[152:155], v[88:91]
    buffer_load_dwordx4 v5, s[4:7], s58 offen offset:1024 lds
    s_waitcnt vmcnt(14) lgkmcnt(0)
    s_barrier
    v_mfma_f32_16x16x32_bf16 v[76:79], a[24:27], v[156:159], v[76:79]
    ds_read_b64_tr_b16 v[132:133], v24 offset:49152
    ds_read_b64_tr_b16 v[134:135], v24 offset:50176
    s_waitcnt vmcnt(10)
    ds_read_b128 a[32:35], v44 offset:0
    ds_read_b128 a[36:39], v44 offset:2048
    ds_read_b128 a[40:43], v45 offset:0
    ds_read_b128 a[44:47], v45 offset:2048
    v_mfma_f32_16x16x32_bf16 v[92:95], a[28:31], v[156:159], v[92:95]
    ds_read_b64_tr_b16 v[136:137], v25 offset:49152
    ds_read_b64_tr_b16 v[138:139], v25 offset:50176
    buffer_load_dwordx4 v6, s[4:7], s58 offen offset:2048 lds
    v_mfma_f32_16x16x32_bf16 v[80:83], a[24:27], v[160:163], v[80:83]
    ds_read_b64_tr_b16 v[140:141], v26 offset:49152
    ds_read_b64_tr_b16 v[142:143], v26 offset:50176
    v_mfma_f32_16x16x32_bf16 v[96:99], a[28:31], v[160:163], v[96:99]
    ds_read_b64_tr_b16 v[144:145], v27 offset:49152
    ds_read_b64_tr_b16 v[146:147], v27 offset:50176
    buffer_load_dwordx4 v7, s[4:7], s58 offen offset:3072 lds
    buffer_load_dwordx2 v[66:67], v50, s[40:43], 0 offen sc1
    s_waitcnt lgkmcnt(6)
    v_mfma_f32_16x16x32_bf16 v[68:71], a[32:35], v[132:135], v[68:71]
    ds_read_b64_tr_b16 v[148:149], v24 offset:53248
    v_mfma_f32_16x16x32_bf16 v[84:87], a[36:39], v[132:135], v[84:87]
    ds_read_b64_tr_b16 v[150:151], v24 offset:54272
    s_add_u32 m0, s56, 0
    s_xor_b32 s58, s0, 128
    s_add_u32 s58, s58, 512
    s_and_b32 s58, s58, 1023
    s_lshl_b32 s62, s45, 17
    s_add_u32 s58, s58, s62
    buffer_load_dwordx4 v4, s[4:7], s58 offen lds
    s_waitcnt lgkmcnt(6)
    v_mfma_f32_16x16x32_bf16 v[72:75], a[32:35], v[136:139], v[72:75]
    ds_read_b64_tr_b16 v[152:153], v25 offset:53248
    v_mfma_f32_16x16x32_bf16 v[88:91], a[36:39], v[136:139], v[88:91]
    ds_read_b64_tr_b16 v[154:155], v25 offset:54272
    buffer_load_dwordx4 v5, s[4:7], s58 offen offset:1024 lds
    s_waitcnt lgkmcnt(6)
    v_mfma_f32_16x16x32_bf16 v[76:79], a[32:35], v[140:143], v[76:79]
    ds_read_b64_tr_b16 v[156:157], v26 offset:53248
    v_mfma_f32_16x16x32_bf16 v[92:95], a[36:39], v[140:143], v[92:95]
    ds_read_b64_tr_b16 v[158:159], v26 offset:54272
    buffer_load_dwordx4 v6, s[4:7], s58 offen offset:2048 lds
    s_waitcnt lgkmcnt(6)
    v_mfma_f32_16x16x32_bf16 v[80:83], a[32:35], v[144:147], v[80:83]
    ds_read_b64_tr_b16 v[160:161], v27 offset:53248
    v_mfma_f32_16x16x32_bf16 v[96:99], a[36:39], v[144:147], v[96:99]
    ds_read_b64_tr_b16 v[162:163], v27 offset:54272
    buffer_load_dwordx4 v7, s[4:7], s58 offen offset:3072 lds
    v_lshlrev_b32 v208, 2, v1
    s_lshl_b32 s59, s49, 2
    s_add_u32 s59, s59, s44
    s_lshl_b32 s60, s59, 4
    s_lshl_b32 s59, s59, 8
    s_add_u32 s59, s59, 720896
    s_add_u32 s60, s60, 589824
    buffer_store_dword v50, v208, s[40:43], s59 offen sc1
    v_and_b32 v209, 12, v208
    buffer_store_dword v50, v209, s[40:43], s60 offen sc1
    s_waitcnt lgkmcnt(6)
    v_mfma_f32_16x16x32_bf16 v[68:71], a[40:43], v[148:151], v[68:71]
    ds_read_b64_tr_b16 v[132:133], v24 offset:57344
    v_mfma_f32_16x16x32_bf16 v[84:87], a[44:47], v[148:151], v[84:87]
    ds_read_b64_tr_b16 v[134:135], v24 offset:58368
    s_add_u32 m0, s56, 32768
    s_add_u32 s58, s52, 3
    s_and_b32 s58, s58, 3
    s_mul_i32 s58, s58, s1
    s_add_u32 s58, s58, s92
    buffer_load_dwordx4 v8, s[16:19], s58 offen lds
    s_waitcnt lgkmcnt(6)
    v_mfma_f32_16x16x32_bf16 v[72:75], a[40:43], v[152:155], v[72:75]
    ds_read_b64_tr_b16 v[136:137], v25 offset:57344
    v_mfma_f32_16x16x32_bf16 v[88:91], a[44:47], v[152:155], v[88:91]
    ds_read_b64_tr_b16 v[138:139], v25 offset:58368
    buffer_load_dwordx4 v9, s[16:19], s58 offen offset:1024 lds
    s_waitcnt lgkmcnt(6)
    v_mfma_f32_16x16x32_bf16 v[76:79], a[40:43], v[156:159], v[76:79]
    ds_read_b64_tr_b16 v[140:141], v26 offset:57344
    s_waitcnt vmcnt(17)
    ds_read_b128 a[48:51], v44 offset:16384
    ds_read_b128 a[52:55], v44 offset:18432
    ds_read_b128 a[56:59], v45 offset:16384
    ds_read_b128 a[60:63], v45 offset:18432
    v_mfma_f32_16x16x32_bf16 v[92:95], a[44:47], v[156:159], v[92:95]
    ds_read_b64_tr_b16 v[142:143], v26 offset:58368
    buffer_load_dwordx4 v10, s[16:19], s58 offen offset:2048 lds
    s_waitcnt lgkmcnt(10)
    v_mfma_f32_16x16x32_bf16 v[80:83], a[40:43], v[160:163], v[80:83]
    ds_read_b64_tr_b16 v[144:145], v27 offset:57344
    v_mfma_f32_16x16x32_bf16 v[96:99], a[44:47], v[160:163], v[96:99]
    ds_read_b64_tr_b16 v[146:147], v27 offset:58368
    buffer_load_dwordx4 v11, s[16:19], s58 offen offset:3072 lds
    s_waitcnt lgkmcnt(3)
    v_mfma_f32_16x16x32_bf16 v[68:71], a[48:51], v[132:135], v[68:71]
    ds_read_b64_tr_b16 v[148:149], v24 offset:61440
    v_mfma_f32_16x16x32_bf16 v[84:87], a[52:55], v[132:135], v[84:87]
    ds_read_b64_tr_b16 v[150:151], v24 offset:62464
    s_add_u32 m0, s56, 16384
    s_add_u32 s58, s0, 768
    s_and_b32 s58, s58, 1023
    s_lshl_b32 s62, s45, 17
    s_add_u32 s58, s58, s62
    buffer_load_dwordx4 v4, s[4:7], s58 offen lds
    v_mfma_f32_16x16x32_bf16 v[72:75], a[48:51], v[136:139], v[72:75]
    ds_read_b64_tr_b16 v[152:153], v25 offset:61440
    v_mfma_f32_16x16x32_bf16 v[88:91], a[52:55], v[136:139], v[88:91]
    ds_read_b64_tr_b16 v[154:155], v25 offset:62464
    buffer_load_dwordx4 v5, s[4:7], s58 offen offset:1024 lds
    s_waitcnt lgkmcnt(6)
    v_mfma_f32_16x16x32_bf16 v[76:79], a[48:51], v[140:143], v[76:79]
    ds_read_b64_tr_b16 v[156:157], v26 offset:61440
    v_mfma_f32_16x16x32_bf16 v[92:95], a[52:55], v[140:143], v[92:95]
    ds_read_b64_tr_b16 v[158:159], v26 offset:62464
    buffer_load_dwordx4 v6, s[4:7], s58 offen offset:2048 lds
    s_waitcnt lgkmcnt(6)
    v_mfma_f32_16x16x32_bf16 v[80:83], a[48:51], v[144:147], v[80:83]
    ds_read_b64_tr_b16 v[160:161], v27 offset:61440
    v_mfma_f32_16x16x32_bf16 v[96:99], a[52:55], v[144:147], v[96:99]
    ds_read_b64_tr_b16 v[162:163], v27 offset:62464
    buffer_load_dwordx4 v7, s[4:7], s58 offen offset:3072 lds
    s_waitcnt lgkmcnt(6)
    v_mfma_f32_16x16x32_bf16 v[68:71], a[56:59], v[148:151], v[68:71]
    v_mfma_f32_16x16x32_bf16 v[84:87], a[60:63], v[148:151], v[84:87]
    s_add_u32 m0, s56, 65536
    s_xor_b32 s58, s0, 128
    s_add_u32 s58, s58, 768
    s_and_b32 s58, s58, 1023
    s_lshl_b32 s62, s45, 17
    s_add_u32 s58, s58, s62
    buffer_load_dwordx4 v4, s[4:7], s58 offen lds
    s_waitcnt lgkmcnt(4)
    v_mfma_f32_16x16x32_bf16 v[72:75], a[56:59], v[152:155], v[72:75]
    v_mfma_f32_16x16x32_bf16 v[88:91], a[60:63], v[152:155], v[88:91]
    buffer_load_dwordx4 v5, s[4:7], s58 offen offset:1024 lds
    s_waitcnt vmcnt(21) lgkmcnt(0)
    s_barrier
    v_mfma_f32_16x16x32_bf16 v[76:79], a[56:59], v[156:159], v[76:79]
    ds_read_b64_tr_b16 v[132:133], v28 offset:32768
    ds_read_b64_tr_b16 v[134:135], v28 offset:33792
    s_waitcnt vmcnt(17)
    ds_read_b128 a[64:67], v44 offset:49152
    ds_read_b128 a[68:71], v44 offset:51200
    ds_read_b128 a[72:75], v45 offset:49152
    ds_read_b128 a[76:79], v45 offset:51200
    v_mfma_f32_16x16x32_bf16 v[92:95], a[60:63], v[156:159], v[92:95]
    ds_read_b64_tr_b16 v[136:137], v29 offset:32768
    ds_read_b64_tr_b16 v[138:139], v29 offset:33792
    buffer_load_dwordx4 v6, s[4:7], s58 offen offset:2048 lds
    v_mfma_f32_16x16x32_bf16 v[80:83], a[56:59], v[160:163], v[80:83]
    ds_read_b64_tr_b16 v[140:141], v30 offset:32768
    ds_read_b64_tr_b16 v[142:143], v30 offset:33792
    v_mfma_f32_16x16x32_bf16 v[96:99], a[60:63], v[160:163], v[96:99]
    ds_read_b64_tr_b16 v[144:145], v31 offset:32768
    ds_read_b64_tr_b16 v[146:147], v31 offset:33792
    buffer_load_dwordx4 v7, s[4:7], s58 offen offset:3072 lds
    s_waitcnt lgkmcnt(6)
    v_mfma_f32_16x16x32_bf16 v[68:71], a[64:67], v[132:135], v[68:71]
    ds_read_b64_tr_b16 v[148:149], v28 offset:36864
    s_add_u32 m0, s56, 81920
    s_add_u32 s58, s54, 2944
    buffer_load_dwordx4 v12, s[8:11], s58 offen lds
    v_mfma_f32_16x16x32_bf16 v[84:87], a[68:71], v[132:135], v[84:87]
    ds_read_b64_tr_b16 v[150:151], v28 offset:37888
    s_waitcnt lgkmcnt(6)
    v_mfma_f32_16x16x32_bf16 v[72:75], a[64:67], v[136:139], v[72:75]
    ds_read_b64_tr_b16 v[152:153], v29 offset:36864
    buffer_load_dwordx4 v13, s[8:11], s58 offen offset:1024 lds
    v_mfma_f32_16x16x32_bf16 v[88:91], a[68:71], v[136:139], v[88:91]
    ds_read_b64_tr_b16 v[154:155], v29 offset:37888
    s_waitcnt lgkmcnt(6)
    v_mfma_f32_16x16x32_bf16 v[76:79], a[64:67], v[140:143], v[76:79]
    ds_read_b64_tr_b16 v[156:157], v30 offset:36864
    v_mfma_f32_16x16x32_bf16 v[92:95], a[68:71], v[140:143], v[92:95]
    ds_read_b64_tr_b16 v[158:159], v30 offset:37888
    s_waitcnt lgkmcnt(6)
    v_mfma_f32_16x16x32_bf16 v[80:83], a[64:67], v[144:147], v[80:83]
    ds_read_b64_tr_b16 v[160:161], v31 offset:36864
    v_mfma_f32_16x16x32_bf16 v[96:99], a[68:71], v[144:147], v[96:99]
    ds_read_b64_tr_b16 v[162:163], v31 offset:37888
    s_waitcnt lgkmcnt(6)
    v_mfma_f32_16x16x32_bf16 v[68:71], a[72:75], v[148:151], v[68:71]
    ds_read_b64_tr_b16 v[132:133], v28 offset:40960
    v_mfma_f32_16x16x32_bf16 v[84:87], a[76:79], v[148:151], v[84:87]
    ds_read_b64_tr_b16 v[134:135], v28 offset:41984
    s_waitcnt lgkmcnt(6)
    v_mfma_f32_16x16x32_bf16 v[72:75], a[72:75], v[152:155], v[72:75]
    ds_read_b64_tr_b16 v[136:137], v29 offset:40960
    v_mfma_f32_16x16x32_bf16 v[88:91], a[76:79], v[152:155], v[88:91]
    ds_read_b64_tr_b16 v[138:139], v29 offset:41984
    s_waitcnt lgkmcnt(6)
    v_mfma_f32_16x16x32_bf16 v[76:79], a[72:75], v[156:159], v[76:79]
    ds_read_b64_tr_b16 v[140:141], v30 offset:40960
    buffer_load_dwordx4 v14, s[8:11], s58 offen offset:2048 lds
    s_waitcnt vmcnt(17)
    ds_read_b128 a[80:83], v42 offset:0
    ds_read_b128 a[84:87], v42 offset:2048
    ds_read_b128 a[88:91], v43 offset:0
    ds_read_b128 a[92:95], v43 offset:2048
    v_mfma_f32_16x16x32_bf16 v[92:95], a[76:79], v[156:159], v[92:95]
    ds_read_b64_tr_b16 v[142:143], v30 offset:41984
    s_waitcnt lgkmcnt(10)
    v_mfma_f32_16x16x32_bf16 v[80:83], a[72:75], v[160:163], v[80:83]
    ds_read_b64_tr_b16 v[144:145], v31 offset:40960
    v_mfma_f32_16x16x32_bf16 v[96:99], a[76:79], v[160:163], v[96:99]
    ds_read_b64_tr_b16 v[146:147], v31 offset:41984
    s_waitcnt lgkmcnt(3)
    v_mfma_f32_16x16x32_bf16 v[68:71], a[80:83], v[132:135], v[68:71]
    ds_read_b64_tr_b16 v[148:149], v28 offset:45056
    v_mfma_f32_16x16x32_bf16 v[84:87], a[84:87], v[132:135], v[84:87]
    ds_read_b64_tr_b16 v[150:151], v28 offset:46080
    v_mfma_f32_16x16x32_bf16 v[72:75], a[80:83], v[136:139], v[72:75]
    ds_read_b64_tr_b16 v[152:153], v29 offset:45056
    v_mfma_f32_16x16x32_bf16 v[88:91], a[84:87], v[136:139], v[88:91]
    ds_read_b64_tr_b16 v[154:155], v29 offset:46080
    s_waitcnt lgkmcnt(6)
    v_mfma_f32_16x16x32_bf16 v[76:79], a[80:83], v[140:143], v[76:79]
    ds_read_b64_tr_b16 v[156:157], v30 offset:45056
    buffer_load_dwordx4 v15, s[8:11], s58 offen offset:3072 lds
    v_mfma_f32_16x16x32_bf16 v[92:95], a[84:87], v[140:143], v[92:95]
    ds_read_b64_tr_b16 v[158:159], v30 offset:46080
    s_waitcnt lgkmcnt(6)
    v_mfma_f32_16x16x32_bf16 v[80:83], a[80:83], v[144:147], v[80:83]
    ds_read_b64_tr_b16 v[160:161], v31 offset:45056
    v_mfma_f32_16x16x32_bf16 v[96:99], a[84:87], v[144:147], v[96:99]
    ds_read_b64_tr_b16 v[162:163], v31 offset:46080
    v_add_u32 v66, 0x9e3779b9, v66
    v_add_u32 v67, 0x7f4a7c15, v67
    v_readfirstlane_b32 s50, v66
    v_readfirstlane_b32 s51, v67
    s_waitcnt lgkmcnt(6)
    v_mfma_f32_16x16x32_bf16 v[68:71], a[88:91], v[148:151], v[68:71]
    v_mfma_f32_16x16x32_bf16 v[84:87], a[92:95], v[148:151], v[84:87]
    s_waitcnt lgkmcnt(4)
    v_mfma_f32_16x16x32_bf16 v[72:75], a[88:91], v[152:155], v[72:75]
    v_mfma_f32_16x16x32_bf16 v[88:91], a[92:95], v[152:155], v[88:91]
    s_waitcnt vmcnt(12) lgkmcnt(0)
    s_barrier
    v_mfma_f32_16x16x32_bf16 v[76:79], a[88:91], v[156:159], v[76:79]
    ds_read_b64_tr_b16 v[132:133], v24 offset:32768
    ds_read_b64_tr_b16 v[134:135], v24 offset:33792
    s_waitcnt vmcnt(8)
    ds_read_b128 a[96:99], v42 offset:16384
    ds_read_b128 a[100:103], v42 offset:18432
    ds_read_b128 a[104:107], v43 offset:16384
    ds_read_b128 a[108:111], v43 offset:18432
    v_mfma_f32_16x16x32_bf16 v[92:95], a[92:95], v[156:159], v[92:95]
    ds_read_b64_tr_b16 v[136:137], v25 offset:32768
    ds_read_b64_tr_b16 v[138:139], v25 offset:33792
    s_add_u32 m0, s56, 49152
    s_add_u32 s58, s55, 2944
    buffer_load_dwordx4 v12, s[8:11], s58 offen lds
    v_mfma_f32_16x16x32_bf16 v[80:83], a[88:91], v[160:163], v[80:83]
    ds_read_b64_tr_b16 v[140:141], v26 offset:32768
    ds_read_b64_tr_b16 v[142:143], v26 offset:33792
    v_mfma_f32_16x16x32_bf16 v[96:99], a[92:95], v[160:163], v[96:99]
    ds_read_b64_tr_b16 v[144:145], v27 offset:32768
    ds_read_b64_tr_b16 v[146:147], v27 offset:33792
    buffer_load_dwordx4 v13, s[8:11], s58 offen offset:1024 lds
    s_lshl_b32 s59, s49, 4
    s_add_u32 s59, s59, s44
    s_lshl_b32 s59, s59, 3
    s_add_u32 s59, s59, 98304
    buffer_store_dwordx2 v[66:67], v50, s[40:43], s59 offen sc1
    s_waitcnt lgkmcnt(6)
    v_mfma_f32_16x16x32_bf16 v[68:71], a[96:99], v[132:135], v[68:71]
    ds_read_b64_tr_b16 v[148:149], v24 offset:36864
    v_mfma_f32_16x16x32_bf16 v[84:87], a[100:103], v[132:135], v[84:87]
    ds_read_b64_tr_b16 v[150:151], v24 offset:37888
    s_waitcnt lgkmcnt(6)
    v_mfma_f32_16x16x32_bf16 v[72:75], a[96:99], v[136:139], v[72:75]
    ds_read_b64_tr_b16 v[152:153], v25 offset:36864
    v_mfma_f32_16x16x32_bf16 v[88:91], a[100:103], v[136:139], v[88:91]
    ds_read_b64_tr_b16 v[154:155], v25 offset:37888
    buffer_load_dwordx4 v14, s[8:11], s58 offen offset:2048 lds
    s_waitcnt lgkmcnt(6)
    v_mfma_f32_16x16x32_bf16 v[76:79], a[96:99], v[140:143], v[76:79]
    ds_read_b64_tr_b16 v[156:157], v26 offset:36864
    v_mfma_f32_16x16x32_bf16 v[92:95], a[100:103], v[140:143], v[92:95]
    ds_read_b64_tr_b16 v[158:159], v26 offset:37888
    s_waitcnt lgkmcnt(6)
    v_mfma_f32_16x16x32_bf16 v[80:83], a[96:99], v[144:147], v[80:83]
    ds_read_b64_tr_b16 v[160:161], v27 offset:36864
    v_mfma_f32_16x16x32_bf16 v[96:99], a[100:103], v[144:147], v[96:99]
    ds_read_b64_tr_b16 v[162:163], v27 offset:37888
    buffer_load_dwordx4 v15, s[8:11], s58 offen offset:3072 lds
    s_waitcnt lgkmcnt(6)
    v_mfma_f32_16x16x32_bf16 v[68:71], a[104:107], v[148:151], v[68:71]
    ds_read_b64_tr_b16 v[132:133], v24 offset:40960
    v_mfma_f32_16x16x32_bf16 v[84:87], a[108:111], v[148:151], v[84:87]
    ds_read_b64_tr_b16 v[134:135], v24 offset:41984
    s_waitcnt lgkmcnt(6)
    v_mfma_f32_16x16x32_bf16 v[72:75], a[104:107], v[152:155], v[72:75]
    ds_read_b64_tr_b16 v[136:137], v25 offset:40960
    v_mfma_f32_16x16x32_bf16 v[88:91], a[108:111], v[152:155], v[88:91]
    ds_read_b64_tr_b16 v[138:139], v25 offset:41984
    s_add_u32 m0, s56, 114688
    s_add_u32 s58, s93, 2944
    buffer_load_dwordx4 v12, s[8:11], s58 offen lds
    s_waitcnt lgkmcnt(6)
    v_mfma_f32_16x16x32_bf16 v[76:79], a[104:107], v[156:159], v[76:79]
    ds_read_b64_tr_b16 v[140:141], v26 offset:40960
    s_waitcnt vmcnt(10)
    ds_read_b128 a[112:115], v44 offset:0
    ds_read_b128 a[116:119], v44 offset:2048
    ds_read_b128 a[120:123], v45 offset:0
    ds_read_b128 a[124:127], v45 offset:2048
    v_mfma_f32_16x16x32_bf16 v[92:95], a[108:111], v[156:159], v[92:95]
    ds_read_b64_tr_b16 v[142:143], v26 offset:41984
    buffer_load_dwordx4 v13, s[8:11], s58 offen offset:1024 lds
    s_waitcnt lgkmcnt(10)
    v_mfma_f32_16x16x32_bf16 v[80:83], a[104:107], v[160:163], v[80:83]
    ds_read_b64_tr_b16 v[144:145], v27 offset:40960
    v_mfma_f32_16x16x32_bf16 v[96:99], a[108:111], v[160:163], v[96:99]
    ds_read_b64_tr_b16 v[146:147], v27 offset:41984
    s_waitcnt lgkmcnt(3)
    v_mfma_f32_16x16x32_bf16 v[68:71], a[112:115], v[132:135], v[68:71]
    ds_read_b64_tr_b16 v[148:149], v24 offset:45056
    buffer_load_dwordx4 v14, s[8:11], s58 offen offset:2048 lds
    v_mfma_f32_16x16x32_bf16 v[84:87], a[116:119], v[132:135], v[84:87]
    ds_read_b64_tr_b16 v[150:151], v24 offset:46080
    v_mfma_f32_16x16x32_bf16 v[72:75], a[112:115], v[136:139], v[72:75]
    ds_read_b64_tr_b16 v[152:153], v25 offset:45056
    v_mfma_f32_16x16x32_bf16 v[88:91], a[116:119], v[136:139], v[88:91]
    ds_read_b64_tr_b16 v[154:155], v25 offset:46080
    buffer_load_dwordx4 v15, s[8:11], s58 offen offset:3072 lds
    s_waitcnt lgkmcnt(6)
    v_mfma_f32_16x16x32_bf16 v[76:79], a[112:115], v[140:143], v[76:79]
    ds_read_b64_tr_b16 v[156:157], v26 offset:45056
    v_mfma_f32_16x16x32_bf16 v[92:95], a[116:119], v[140:143], v[92:95]
    ds_read_b64_tr_b16 v[158:159], v26 offset:46080
    s_waitcnt lgkmcnt(6)
    v_mfma_f32_16x16x32_bf16 v[80:83], a[112:115], v[144:147], v[80:83]
    ds_read_b64_tr_b16 v[160:161], v27 offset:45056
    v_mfma_f32_16x16x32_bf16 v[96:99], a[116:119], v[144:147], v[96:99]
    ds_read_b64_tr_b16 v[162:163], v27 offset:46080
    s_add_u32 m0, s56, 0
    s_add_u32 s58, s95, 2944
    buffer_load_dwordx4 v12, s[8:11], s58 offen lds
    s_waitcnt lgkmcnt(6)
    v_mfma_f32_16x16x32_bf16 v[68:71], a[120:123], v[148:151], v[68:71]
    v_mfma_f32_16x16x32_bf16 v[84:87], a[124:127], v[148:151], v[84:87]
    s_waitcnt lgkmcnt(4)
    v_mfma_f32_16x16x32_bf16 v[72:75], a[120:123], v[152:155], v[72:75]
    buffer_load_dwordx4 v13, s[8:11], s58 offen offset:1024 lds
    v_mfma_f32_16x16x32_bf16 v[88:91], a[124:127], v[152:155], v[88:91]
    buffer_load_dwordx4 v14, s[8:11], s58 offen offset:2048 lds
    s_waitcnt lgkmcnt(0)
    s_barrier
    v_mfma_f32_16x16x32_bf16 v[76:79], a[120:123], v[156:159], v[76:79]
    buffer_load_dwordx4 v15, s[8:11], s58 offen offset:3072 lds
    v_mfma_f32_16x16x32_bf16 v[92:95], a[124:127], v[156:159], v[92:95]
    s_add_u32 m0, s56, 98304
    s_add_u32 s58, s54, 0
    buffer_load_dwordx4 v12, s[8:11], s58 offen lds
    v_mfma_f32_16x16x32_bf16 v[80:83], a[120:123], v[160:163], v[80:83]
    v_mfma_f32_16x16x32_bf16 v[96:99], a[124:127], v[160:163], v[96:99]
    v_pk_mul_f32 v[196:197], v[68:69], v[58:59]
    v_pk_mul_f32 v[198:199], v[70:71], v[58:59]
    v_pk_mul_f32 v[200:201], v[72:73], v[58:59]
    v_pk_mul_f32 v[202:203], v[74:75], v[58:59]
    v_exp_f32_e64 v196, v196 clamp
    v_exp_f32_e64 v197, v197 clamp
    v_exp_f32_e64 v198, v198 clamp
    v_exp_f32_e64 v199, v199 clamp
    v_exp_f32_e64 v200, v200 clamp
    v_exp_f32_e64 v201, v201 clamp
    v_exp_f32_e64 v202, v202 clamp
    v_exp_f32_e64 v203, v203 clamp
    buffer_load_dwordx4 v13, s[8:11], s58 offen offset:1024 lds
    v_max_f32 v68, 0, v68
    v_max_f32 v69, 0, v69
    v_max_f32 v70, 0, v70
    v_max_f32 v71, 0, v71
    v_max_f32 v72, 0, v72
    v_max_f32 v73, 0, v73
    v_max_f32 v74, 0, v74
    v_max_f32 v75, 0, v75
    v_pk_add_f32 v[68:69], v[68:69], v[196:197]
    v_pk_add_f32 v[70:71], v[70:71], v[198:199]
    v_pk_add_f32 v[72:73], v[72:73], v[200:201]
    v_pk_add_f32 v[74:75], v[74:75], v[202:203]
    v_pk_add_f32 v[68:69], v[68:69], v[60:61]
    v_pk_add_f32 v[70:71], v[70:71], v[60:61]
    v_pk_add_f32 v[72:73], v[72:73], v[60:61]
    v_pk_add_f32 v[74:75], v[74:75], v[60:61]
    v_pk_mul_f32 v[196:197], v[76:77], v[58:59]
    v_pk_mul_f32 v[198:199], v[78:79], v[58:59]
    v_pk_mul_f32 v[200:201], v[80:81], v[58:59]
    v_pk_mul_f32 v[202:203], v[82:83], v[58:59]
    v_exp_f32_e64 v196, v196 clamp
    v_exp_f32_e64 v197, v197 clamp
    v_exp_f32_e64 v198, v198 clamp
    v_exp_f32_e64 v199, v199 clamp
    v_exp_f32_e64 v200, v200 clamp
    v_exp_f32_e64 v201, v201 clamp
    v_exp_f32_e64 v202, v202 clamp
    v_exp_f32_e64 v203, v203 clamp
    buffer_load_dwordx4 v14, s[8:11], s58 offen offset:2048 lds
    v_max_f32 v76, 0, v76
    v_max_f32 v77, 0, v77
    v_max_f32 v78, 0, v78
    v_max_f32 v79, 0, v79
    v_max_f32 v80, 0, v80
    v_max_f32 v81, 0, v81
    v_max_f32 v82, 0, v82
    v_max_f32 v83, 0, v83
    v_pk_add_f32 v[76:77], v[76:77], v[196:197]
    v_pk_add_f32 v[78:79], v[78:79], v[198:199]
    v_pk_add_f32 v[80:81], v[80:81], v[200:201]
    v_pk_add_f32 v[82:83], v[82:83], v[202:203]
    v_pk_add_f32 v[76:77], v[76:77], v[60:61]
    v_pk_add_f32 v[78:79], v[78:79], v[60:61]
    v_pk_add_f32 v[80:81], v[80:81], v[60:61]
    v_pk_add_f32 v[82:83], v[82:83], v[60:61]
    v_pk_mul_f32 v[196:197], v[84:85], v[58:59]
    v_pk_mul_f32 v[198:199], v[86:87], v[58:59]
    v_pk_mul_f32 v[200:201], v[88:89], v[58:59]
    v_pk_mul_f32 v[202:203], v[90:91], v[58:59]
    v_exp_f32_e64 v196, v196 clamp
    v_exp_f32_e64 v197, v197 clamp
    v_exp_f32_e64 v198, v198 clamp
    v_exp_f32_e64 v199, v199 clamp
    v_exp_f32_e64 v200, v200 clamp
    v_exp_f32_e64 v201, v201 clamp
    v_exp_f32_e64 v202, v202 clamp
    v_exp_f32_e64 v203, v203 clamp
    v_max_f32 v84, 0, v84
    v_max_f32 v85, 0, v85
    v_max_f32 v86, 0, v86
    v_max_f32 v87, 0, v87
    v_max_f32 v88, 0, v88
    v_max_f32 v89, 0, v89
    v_max_f32 v90, 0, v90
    v_max_f32 v91, 0, v91
    v_pk_add_f32 v[84:85], v[84:85], v[196:197]
    v_pk_add_f32 v[86:87], v[86:87], v[198:199]
    v_pk_add_f32 v[88:89], v[88:89], v[200:201]
    v_pk_add_f32 v[90:91], v[90:91], v[202:203]
    v_pk_add_f32 v[84:85], v[84:85], v[60:61]
    v_pk_add_f32 v[86:87], v[86:87], v[60:61]
H_S0_2:
    s_cbranch_execz H_S0_6
    v_pk_add_f32 v[88:89], v[88:89], v[60:61]
    v_pk_add_f32 v[90:91], v[90:91], v[60:61]
    buffer_load_dwordx4 v15, s[8:11], s58 offen offset:3072 lds
    v_pk_mul_f32 v[196:197], v[92:93], v[58:59]
    v_pk_mul_f32 v[198:199], v[94:95], v[58:59]
    v_pk_mul_f32 v[200:201], v[96:97], v[58:59]
    v_pk_mul_f32 v[202:203], v[98:99], v[58:59]
    v_exp_f32_e64 v196, v196 clamp
    v_exp_f32_e64 v197, v197 clamp
    v_exp_f32_e64 v198, v198 clamp
    v_exp_f32_e64 v199, v199 clamp
    v_exp_f32_e64 v200, v200 clamp
    v_exp_f32_e64 v201, v201 clamp
    v_exp_f32_e64 v202, v202 clamp
    v_exp_f32_e64 v203, v203 clamp
    v_max_f32 v92, 0, v92
    v_max_f32 v93, 0, v93
    v_max_f32 v94, 0, v94
    v_max_f32 v95, 0, v95
    v_max_f32 v96, 0, v96
    v_max_f32 v97, 0, v97
    v_max_f32 v98, 0, v98
    v_max_f32 v99, 0, v99
    v_pk_add_f32 v[92:93], v[92:93], v[196:197]
    v_pk_add_f32 v[94:95], v[94:95], v[198:199]
    v_pk_add_f32 v[96:97], v[96:97], v[200:201]
    v_pk_add_f32 v[98:99], v[98:99], v[202:203]
    v_pk_add_f32 v[92:93], v[92:93], v[60:61]
    v_pk_add_f32 v[94:95], v[94:95], v[60:61]
    v_pk_add_f32 v[96:97], v[96:97], v[60:61]
    v_pk_add_f32 v[98:99], v[98:99], v[60:61]
    s_add_u32 m0, s56, 16384
    s_add_u32 s58, s55, 0
    buffer_load_dwordx4 v12, s[8:11], s58 offen lds
    v_cvt_pk_bf16_f32 v180, v68, v69
    v_cvt_pk_bf16_f32 v181, v70, v71
    v_cvt_pk_bf16_f32 v182, v84, v85
    v_cvt_pk_bf16_f32 v183, v86, v87
    v_cvt_pk_bf16_f32 v184, v72, v73
    v_cvt_pk_bf16_f32 v185, v74, v75
    v_cvt_pk_bf16_f32 v186, v88, v89
    v_cvt_pk_bf16_f32 v187, v90, v91
    v_cvt_pk_bf16_f32 v188, v76, v77
    v_cvt_pk_bf16_f32 v189, v78, v79
    v_cvt_pk_bf16_f32 v190, v92, v93
    v_cvt_pk_bf16_f32 v191, v94, v95
    v_cvt_pk_bf16_f32 v192, v80, v81
    v_cvt_pk_bf16_f32 v193, v82, v83
    v_cvt_pk_bf16_f32 v194, v96, v97
    v_cvt_pk_bf16_f32 v195, v98, v99
    s_waitcnt vmcnt(18)
    s_barrier
    ds_read_b64_tr_b16 v[132:133], v28 offset:16384
    ds_read_b64_tr_b16 v[134:135], v28 offset:17408
    ds_read_b64_tr_b16 v[136:137], v29 offset:16384
    ds_read_b64_tr_b16 v[138:139], v29 offset:17408
    ds_read_b64_tr_b16 v[140:141], v30 offset:16384
    ds_read_b64_tr_b16 v[142:143], v30 offset:17408
    ds_read_b64_tr_b16 v[144:145], v31 offset:16384
    ds_read_b64_tr_b16 v[146:147], v31 offset:17408
    s_waitcnt lgkmcnt(6)
    v_mfma_f32_16x16x32_bf16 v[100:103], a[0:3], v[132:135], 0
    ds_read_b64_tr_b16 v[148:149], v28 offset:20480
    buffer_load_dwordx4 v13, s[8:11], s58 offen offset:1024 lds
    v_mfma_f32_16x16x32_bf16 v[116:119], a[4:7], v[132:135], 0
    ds_read_b64_tr_b16 v[150:151], v28 offset:21504
    buffer_load_dwordx4 v14, s[8:11], s58 offen offset:2048 lds
    s_waitcnt lgkmcnt(6)
    v_mfma_f32_16x16x32_bf16 v[104:107], a[0:3], v[136:139], 0
    ds_read_b64_tr_b16 v[152:153], v29 offset:20480
    v_mfma_f32_16x16x32_bf16 v[120:123], a[4:7], v[136:139], 0
    ds_read_b64_tr_b16 v[154:155], v29 offset:21504
    buffer_load_dwordx4 v15, s[8:11], s58 offen offset:3072 lds
    s_waitcnt lgkmcnt(6)
    v_mfma_f32_16x16x32_bf16 v[108:111], a[0:3], v[140:143], 0
    ds_read_b64_tr_b16 v[156:157], v30 offset:20480
    v_mfma_f32_16x16x32_bf16 v[124:127], a[4:7], v[140:143], 0
    ds_read_b64_tr_b16 v[158:159], v30 offset:21504
    s_waitcnt lgkmcnt(6)
    v_mfma_f32_16x16x32_bf16 v[112:115], a[0:3], v[144:147], 0
    ds_read_b64_tr_b16 v[160:161], v31 offset:20480
    v_mfma_f32_16x16x32_bf16 v[128:131], a[4:7], v[144:147], 0
    ds_read_b64_tr_b16 v[162:163], v31 offset:21504
    s_add_u32 m0, s56, 65536
    s_add_u32 s58, s93, 0
    buffer_load_dwordx4 v12, s[8:11], s58 offen lds
    s_waitcnt lgkmcnt(6)
    v_mfma_f32_16x16x32_bf16 v[100:103], a[8:11], v[148:151], v[100:103]
    ds_read_b64_tr_b16 v[132:133], v28 offset:24576
    v_mfma_f32_16x16x32_bf16 v[116:119], a[12:15], v[148:151], v[116:119]
    ds_read_b64_tr_b16 v[134:135], v28 offset:25600
    s_waitcnt lgkmcnt(6)
    v_mfma_f32_16x16x32_bf16 v[104:107], a[8:11], v[152:155], v[104:107]
    ds_read_b64_tr_b16 v[136:137], v29 offset:24576
    buffer_load_dwordx4 v13, s[8:11], s58 offen offset:1024 lds
    v_mfma_f32_16x16x32_bf16 v[120:123], a[12:15], v[152:155], v[120:123]
    ds_read_b64_tr_b16 v[138:139], v29 offset:25600
    s_waitcnt lgkmcnt(6)
    v_mfma_f32_16x16x32_bf16 v[108:111], a[8:11], v[156:159], v[108:111]
    ds_read_b64_tr_b16 v[140:141], v30 offset:24576
    v_mfma_f32_16x16x32_bf16 v[124:127], a[12:15], v[156:159], v[124:127]
    ds_read_b64_tr_b16 v[142:143], v30 offset:25600
    s_waitcnt lgkmcnt(6)
    v_mfma_f32_16x16x32_bf16 v[112:115], a[8:11], v[160:163], v[112:115]
    ds_read_b64_tr_b16 v[144:145], v31 offset:24576
    buffer_load_dwordx4 v14, s[8:11], s58 offen offset:2048 lds
    v_mfma_f32_16x16x32_bf16 v[128:131], a[12:15], v[160:163], v[128:131]
    ds_read_b64_tr_b16 v[146:147], v31 offset:25600
    s_waitcnt lgkmcnt(6)
    v_mfma_f32_16x16x32_bf16 v[100:103], a[16:19], v[132:135], v[100:103]
    ds_read_b64_tr_b16 v[148:149], v28 offset:28672
    v_mfma_f32_16x16x32_bf16 v[116:119], a[20:23], v[132:135], v[116:119]
    ds_read_b64_tr_b16 v[150:151], v28 offset:29696
    buffer_load_dwordx4 v15, s[8:11], s58 offen offset:3072 lds
    s_waitcnt lgkmcnt(6)
    v_mfma_f32_16x16x32_bf16 v[104:107], a[16:19], v[136:139], v[104:107]
    ds_read_b64_tr_b16 v[152:153], v29 offset:28672
    v_mfma_f32_16x16x32_bf16 v[120:123], a[20:23], v[136:139], v[120:123]
    ds_read_b64_tr_b16 v[154:155], v29 offset:29696
    s_waitcnt lgkmcnt(6)
    v_mfma_f32_16x16x32_bf16 v[108:111], a[16:19], v[140:143], v[108:111]
    ds_read_b64_tr_b16 v[156:157], v30 offset:28672
    s_add_u32 m0, s56, 32768
    s_add_u32 s58, s95, 0
    buffer_load_dwordx4 v12, s[8:11], s58 offen lds
    v_mfma_f32_16x16x32_bf16 v[124:127], a[20:23], v[140:143], v[124:127]
    ds_read_b64_tr_b16 v[158:159], v30 offset:29696
    s_waitcnt lgkmcnt(6)
    v_mfma_f32_16x16x32_bf16 v[112:115], a[16:19], v[144:147], v[112:115]
    ds_read_b64_tr_b16 v[160:161], v31 offset:28672
    v_mfma_f32_16x16x32_bf16 v[128:131], a[20:23], v[144:147], v[128:131]
    ds_read_b64_tr_b16 v[162:163], v31 offset:29696
    s_waitcnt lgkmcnt(6)
    v_mfma_f32_16x16x32_bf16 v[100:103], a[24:27], v[148:151], v[100:103]
    buffer_load_dwordx4 v13, s[8:11], s58 offen offset:1024 lds
    v_mfma_f32_16x16x32_bf16 v[116:119], a[28:31], v[148:151], v[116:119]
    s_waitcnt lgkmcnt(4)
    v_mfma_f32_16x16x32_bf16 v[104:107], a[24:27], v[152:155], v[104:107]
    v_mfma_f32_16x16x32_bf16 v[120:123], a[28:31], v[152:155], v[120:123]
    s_waitcnt vmcnt(22) lgkmcnt(0)
    s_barrier
    v_mfma_f32_16x16x32_bf16 v[108:111], a[24:27], v[156:159], v[108:111]
    ds_read_b64_tr_b16 v[132:133], v24 offset:49152
    ds_read_b64_tr_b16 v[134:135], v24 offset:50176
    buffer_load_dwordx4 v14, s[8:11], s58 offen offset:2048 lds
    v_mfma_f32_16x16x32_bf16 v[124:127], a[28:31], v[156:159], v[124:127]
    ds_read_b64_tr_b16 v[136:137], v25 offset:49152
    ds_read_b64_tr_b16 v[138:139], v25 offset:50176
    buffer_load_dwordx4 v15, s[8:11], s58 offen offset:3072 lds
    v_mfma_f32_16x16x32_bf16 v[112:115], a[24:27], v[160:163], v[112:115]
    ds_read_b64_tr_b16 v[140:141], v26 offset:49152
    ds_read_b64_tr_b16 v[142:143], v26 offset:50176
    s_add_u32 m0, s56, 81920
    s_add_u32 s58, s54, 128
    buffer_load_dwordx4 v12, s[8:11], s58 offen lds
    v_mfma_f32_16x16x32_bf16 v[128:131], a[28:31], v[160:163], v[128:131]
    ds_read_b64_tr_b16 v[144:145], v27 offset:49152
    ds_read_b64_tr_b16 v[146:147], v27 offset:50176
    s_waitcnt lgkmcnt(6)
    v_mfma_f32_16x16x32_bf16 v[100:103], a[32:35], v[132:135], v[100:103]
    ds_read_b64_tr_b16 v[148:149], v24 offset:53248
    v_mfma_f32_16x16x32_bf16 v[116:119], a[36:39], v[132:135], v[116:119]
    ds_read_b64_tr_b16 v[150:151], v24 offset:54272
    s_waitcnt lgkmcnt(6)
    v_mfma_f32_16x16x32_bf16 v[104:107], a[32:35], v[136:139], v[104:107]
    ds_read_b64_tr_b16 v[152:153], v25 offset:53248
    v_mfma_f32_16x16x32_bf16 v[120:123], a[36:39], v[136:139], v[120:123]
    ds_read_b64_tr_b16 v[154:155], v25 offset:54272
    buffer_load_dwordx4 v13, s[8:11], s58 offen offset:1024 lds
    s_waitcnt lgkmcnt(6)
    v_mfma_f32_16x16x32_bf16 v[108:111], a[32:35], v[140:143], v[108:111]
    ds_read_b64_tr_b16 v[156:157], v26 offset:53248
    v_mfma_f32_16x16x32_bf16 v[124:127], a[36:39], v[140:143], v[124:127]
    ds_read_b64_tr_b16 v[158:159], v26 offset:54272
    s_waitcnt lgkmcnt(6)
    v_mfma_f32_16x16x32_bf16 v[112:115], a[32:35], v[144:147], v[112:115]
    ds_read_b64_tr_b16 v[160:161], v27 offset:53248
    v_mfma_f32_16x16x32_bf16 v[128:131], a[36:39], v[144:147], v[128:131]
    ds_read_b64_tr_b16 v[162:163], v27 offset:54272
    s_waitcnt lgkmcnt(6)
    v_mfma_f32_16x16x32_bf16 v[100:103], a[40:43], v[148:151], v[100:103]
    ds_read_b64_tr_b16 v[132:133], v24 offset:57344
    v_mfma_f32_16x16x32_bf16 v[116:119], a[44:47], v[148:151], v[116:119]
    ds_read_b64_tr_b16 v[134:135], v24 offset:58368
    s_waitcnt lgkmcnt(6)
    v_mfma_f32_16x16x32_bf16 v[104:107], a[40:43], v[152:155], v[104:107]
    ds_read_b64_tr_b16 v[136:137], v25 offset:57344
    v_mfma_f32_16x16x32_bf16 v[120:123], a[44:47], v[152:155], v[120:123]
    ds_read_b64_tr_b16 v[138:139], v25 offset:58368
    s_waitcnt lgkmcnt(6)
    v_mfma_f32_16x16x32_bf16 v[108:111], a[40:43], v[156:159], v[108:111]
    ds_read_b64_tr_b16 v[140:141], v26 offset:57344
    buffer_load_dwordx4 v14, s[8:11], s58 offen offset:2048 lds
    v_mfma_f32_16x16x32_bf16 v[124:127], a[44:47], v[156:159], v[124:127]
    ds_read_b64_tr_b16 v[142:143], v26 offset:58368
    s_waitcnt lgkmcnt(6)
    v_mfma_f32_16x16x32_bf16 v[112:115], a[40:43], v[160:163], v[112:115]
    ds_read_b64_tr_b16 v[144:145], v27 offset:57344
    v_mfma_f32_16x16x32_bf16 v[128:131], a[44:47], v[160:163], v[128:131]
    ds_read_b64_tr_b16 v[146:147], v27 offset:58368
    s_waitcnt lgkmcnt(6)
    v_mfma_f32_16x16x32_bf16 v[100:103], a[48:51], v[132:135], v[100:103]
    ds_read_b64_tr_b16 v[148:149], v24 offset:61440
    v_mfma_f32_16x16x32_bf16 v[116:119], a[52:55], v[132:135], v[116:119]
    ds_read_b64_tr_b16 v[150:151], v24 offset:62464
    s_waitcnt lgkmcnt(6)
    v_mfma_f32_16x16x32_bf16 v[104:107], a[48:51], v[136:139], v[104:107]
    ds_read_b64_tr_b16 v[152:153], v25 offset:61440
    v_mfma_f32_16x16x32_bf16 v[120:123], a[52:55], v[136:139], v[120:123]
    ds_read_b64_tr_b16 v[154:155], v25 offset:62464
    s_waitcnt lgkmcnt(6)
    v_mfma_f32_16x16x32_bf16 v[108:111], a[48:51], v[140:143], v[108:111]
    ds_read_b64_tr_b16 v[156:157], v26 offset:61440
    v_mfma_f32_16x16x32_bf16 v[124:127], a[52:55], v[140:143], v[124:127]
    ds_read_b64_tr_b16 v[158:159], v26 offset:62464
    s_waitcnt lgkmcnt(6)
    v_mfma_f32_16x16x32_bf16 v[112:115], a[48:51], v[144:147], v[112:115]
    ds_read_b64_tr_b16 v[160:161], v27 offset:61440
    buffer_load_dwordx4 v15, s[8:11], s58 offen offset:3072 lds
    v_mfma_f32_16x16x32_bf16 v[128:131], a[52:55], v[144:147], v[128:131]
    ds_read_b64_tr_b16 v[162:163], v27 offset:62464
    s_waitcnt lgkmcnt(6)
    v_mfma_f32_16x16x32_bf16 v[100:103], a[56:59], v[148:151], v[100:103]
    v_mfma_f32_16x16x32_bf16 v[116:119], a[60:63], v[148:151], v[116:119]
    s_waitcnt lgkmcnt(4)
    v_mfma_f32_16x16x32_bf16 v[104:107], a[56:59], v[152:155], v[104:107]
    v_mfma_f32_16x16x32_bf16 v[120:123], a[60:63], v[152:155], v[120:123]
    s_waitcnt vmcnt(24) lgkmcnt(0)
    s_barrier
    v_mfma_f32_16x16x32_bf16 v[108:111], a[56:59], v[156:159], v[108:111]
    ds_read_b64_tr_b16 v[132:133], v28 offset:49152
    ds_read_b64_tr_b16 v[134:135], v28 offset:50176
    v_mfma_f32_16x16x32_bf16 v[124:127], a[60:63], v[156:159], v[124:127]
    ds_read_b64_tr_b16 v[136:137], v29 offset:49152
    ds_read_b64_tr_b16 v[138:139], v29 offset:50176
    v_mfma_f32_16x16x32_bf16 v[112:115], a[56:59], v[160:163], v[112:115]
    ds_read_b64_tr_b16 v[140:141], v30 offset:49152
    ds_read_b64_tr_b16 v[142:143], v30 offset:50176
    v_mfma_f32_16x16x32_bf16 v[128:131], a[60:63], v[160:163], v[128:131]
    ds_read_b64_tr_b16 v[144:145], v31 offset:49152
    ds_read_b64_tr_b16 v[146:147], v31 offset:50176
    s_add_u32 m0, s56, 49152
    s_add_u32 s58, s55, 128
    buffer_load_dwordx4 v12, s[8:11], s58 offen lds
    s_waitcnt lgkmcnt(6)
    v_mfma_f32_16x16x32_bf16 v[100:103], a[64:67], v[132:135], v[100:103]
    ds_read_b64_tr_b16 v[148:149], v28 offset:53248
    v_mfma_f32_16x16x32_bf16 v[116:119], a[68:71], v[132:135], v[116:119]
    ds_read_b64_tr_b16 v[150:151], v28 offset:54272
    s_waitcnt lgkmcnt(6)
    v_mfma_f32_16x16x32_bf16 v[104:107], a[64:67], v[136:139], v[104:107]
    ds_read_b64_tr_b16 v[152:153], v29 offset:53248
    v_mfma_f32_16x16x32_bf16 v[120:123], a[68:71], v[136:139], v[120:123]
    ds_read_b64_tr_b16 v[154:155], v29 offset:54272
    buffer_load_dwordx4 v13, s[8:11], s58 offen offset:1024 lds
    s_waitcnt lgkmcnt(6)
    v_mfma_f32_16x16x32_bf16 v[108:111], a[64:67], v[140:143], v[108:111]
    ds_read_b64_tr_b16 v[156:157], v30 offset:53248
    v_mfma_f32_16x16x32_bf16 v[124:127], a[68:71], v[140:143], v[124:127]
    ds_read_b64_tr_b16 v[158:159], v30 offset:54272
    s_waitcnt lgkmcnt(6)
    v_mfma_f32_16x16x32_bf16 v[112:115], a[64:67], v[144:147], v[112:115]
    ds_read_b64_tr_b16 v[160:161], v31 offset:53248
    v_mfma_f32_16x16x32_bf16 v[128:131], a[68:71], v[144:147], v[128:131]
    ds_read_b64_tr_b16 v[162:163], v31 offset:54272
    buffer_load_dwordx4 v14, s[8:11], s58 offen offset:2048 lds
    s_waitcnt lgkmcnt(6)
    v_mfma_f32_16x16x32_bf16 v[100:103], a[72:75], v[148:151], v[100:103]
    ds_read_b64_tr_b16 v[132:133], v28 offset:57344
    v_mfma_f32_16x16x32_bf16 v[116:119], a[76:79], v[148:151], v[116:119]
    ds_read_b64_tr_b16 v[134:135], v28 offset:58368
    s_waitcnt lgkmcnt(6)
    v_mfma_f32_16x16x32_bf16 v[104:107], a[72:75], v[152:155], v[104:107]
    ds_read_b64_tr_b16 v[136:137], v29 offset:57344
    v_mfma_f32_16x16x32_bf16 v[120:123], a[76:79], v[152:155], v[120:123]
    ds_read_b64_tr_b16 v[138:139], v29 offset:58368
    s_waitcnt lgkmcnt(6)
    v_mfma_f32_16x16x32_bf16 v[108:111], a[72:75], v[156:159], v[108:111]
    ds_read_b64_tr_b16 v[140:141], v30 offset:57344
    buffer_load_dwordx4 v15, s[8:11], s58 offen offset:3072 lds
    v_mfma_f32_16x16x32_bf16 v[124:127], a[76:79], v[156:159], v[124:127]
    ds_read_b64_tr_b16 v[142:143], v30 offset:58368
    s_waitcnt lgkmcnt(6)
    v_mfma_f32_16x16x32_bf16 v[112:115], a[72:75], v[160:163], v[112:115]
    ds_read_b64_tr_b16 v[144:145], v31 offset:57344
    v_mfma_f32_16x16x32_bf16 v[128:131], a[76:79], v[160:163], v[128:131]
    ds_read_b64_tr_b16 v[146:147], v31 offset:58368
    s_waitcnt lgkmcnt(6)
    v_mfma_f32_16x16x32_bf16 v[100:103], a[80:83], v[132:135], v[100:103]
    ds_read_b64_tr_b16 v[148:149], v28 offset:61440
    v_mfma_f32_16x16x32_bf16 v[116:119], a[84:87], v[132:135], v[116:119]
    ds_read_b64_tr_b16 v[150:151], v28 offset:62464
    s_waitcnt lgkmcnt(6)
    v_mfma_f32_16x16x32_bf16 v[104:107], a[80:83], v[136:139], v[104:107]
    ds_read_b64_tr_b16 v[152:153], v29 offset:61440
    v_mfma_f32_16x16x32_bf16 v[120:123], a[84:87], v[136:139], v[120:123]
    ds_read_b64_tr_b16 v[154:155], v29 offset:62464
    s_waitcnt lgkmcnt(6)
    v_mfma_f32_16x16x32_bf16 v[108:111], a[80:83], v[140:143], v[108:111]
    ds_read_b64_tr_b16 v[156:157], v30 offset:61440
    v_mfma_f32_16x16x32_bf16 v[124:127], a[84:87], v[140:143], v[124:127]
    ds_read_b64_tr_b16 v[158:159], v30 offset:62464
    s_waitcnt lgkmcnt(6)
    v_mfma_f32_16x16x32_bf16 v[112:115], a[80:83], v[144:147], v[112:115]
    ds_read_b64_tr_b16 v[160:161], v31 offset:61440
    v_mfma_f32_16x16x32_bf16 v[128:131], a[84:87], v[144:147], v[128:131]
    ds_read_b64_tr_b16 v[162:163], v31 offset:62464
    s_waitcnt lgkmcnt(6)
    v_mfma_f32_16x16x32_bf16 v[100:103], a[88:91], v[148:151], v[100:103]
    v_mfma_f32_16x16x32_bf16 v[116:119], a[92:95], v[148:151], v[116:119]
    s_waitcnt lgkmcnt(4)
    v_mfma_f32_16x16x32_bf16 v[104:107], a[88:91], v[152:155], v[104:107]
    v_mfma_f32_16x16x32_bf16 v[120:123], a[92:95], v[152:155], v[120:123]
    s_waitcnt vmcnt(24) lgkmcnt(0)
    s_barrier
    v_mfma_f32_16x16x32_bf16 v[108:111], a[88:91], v[156:159], v[108:111]
    ds_read_b64_tr_b16 v[132:133], v24 offset:0
    ds_read_b64_tr_b16 v[134:135], v24 offset:1024
    s_add_u32 m0, s56, 114688
    s_add_u32 s58, s93, 128
    buffer_load_dwordx4 v12, s[8:11], s58 offen lds
    v_mfma_f32_16x16x32_bf16 v[124:127], a[92:95], v[156:159], v[124:127]
    ds_read_b64_tr_b16 v[136:137], v25 offset:0
    ds_read_b64_tr_b16 v[138:139], v25 offset:1024
    buffer_load_dwordx4 v13, s[8:11], s58 offen offset:1024 lds
    v_mfma_f32_16x16x32_bf16 v[112:115], a[88:91], v[160:163], v[112:115]
    ds_read_b64_tr_b16 v[140:141], v26 offset:0
    ds_read_b64_tr_b16 v[142:143], v26 offset:1024
    buffer_load_dwordx4 v14, s[8:11], s58 offen offset:2048 lds
    v_mfma_f32_16x16x32_bf16 v[128:131], a[92:95], v[160:163], v[128:131]
    ds_read_b64_tr_b16 v[144:145], v27 offset:0
    ds_read_b64_tr_b16 v[146:147], v27 offset:1024
    buffer_load_dwordx4 v15, s[8:11], s58 offen offset:3072 lds
    s_waitcnt lgkmcnt(6)
    v_mfma_f32_16x16x32_bf16 v[100:103], a[96:99], v[132:135], v[100:103]
    ds_read_b64_tr_b16 v[148:149], v24 offset:4096
    v_mfma_f32_16x16x32_bf16 v[116:119], a[100:103], v[132:135], v[116:119]
    ds_read_b64_tr_b16 v[150:151], v24 offset:5120
    s_waitcnt lgkmcnt(6)
    v_mfma_f32_16x16x32_bf16 v[104:107], a[96:99], v[136:139], v[104:107]
    ds_read_b64_tr_b16 v[152:153], v25 offset:4096
    v_mfma_f32_16x16x32_bf16 v[120:123], a[100:103], v[136:139], v[120:123]
    ds_read_b64_tr_b16 v[154:155], v25 offset:5120
    s_waitcnt lgkmcnt(6)
    v_mfma_f32_16x16x32_bf16 v[108:111], a[96:99], v[140:143], v[108:111]
    ds_read_b64_tr_b16 v[156:157], v26 offset:4096
    v_mfma_f32_16x16x32_bf16 v[124:127], a[100:103], v[140:143], v[124:127]
    ds_read_b64_tr_b16 v[158:159], v26 offset:5120
    s_waitcnt lgkmcnt(6)
    v_mfma_f32_16x16x32_bf16 v[112:115], a[96:99], v[144:147], v[112:115]
    ds_read_b64_tr_b16 v[160:161], v27 offset:4096
    v_mfma_f32_16x16x32_bf16 v[128:131], a[100:103], v[144:147], v[128:131]
    ds_read_b64_tr_b16 v[162:163], v27 offset:5120
    s_lshl_b32 s59, s47, 9
    s_add_u32 s59, s59, 98304
    v_and_b32 v46, 0x1ff, v51
    v_add_u32 v46, s59, v46
    buffer_load_dwordx2 v[44:45], v46, s[40:43], 0 offen sc1
    s_waitcnt lgkmcnt(6)
    v_mfma_f32_16x16x32_bf16 v[100:103], a[104:107], v[148:151], v[100:103]
    ds_read_b64_tr_b16 v[132:133], v24 offset:8192
    v_mfma_f32_16x16x32_bf16 v[116:119], a[108:111], v[148:151], v[116:119]
    ds_read_b64_tr_b16 v[134:135], v24 offset:9216
    s_waitcnt lgkmcnt(6)
    v_mfma_f32_16x16x32_bf16 v[104:107], a[104:107], v[152:155], v[104:107]
    ds_read_b64_tr_b16 v[136:137], v25 offset:8192
    v_mfma_f32_16x16x32_bf16 v[120:123], a[108:111], v[152:155], v[120:123]
    ds_read_b64_tr_b16 v[138:139], v25 offset:9216
    s_waitcnt lgkmcnt(6)
    v_mfma_f32_16x16x32_bf16 v[108:111], a[104:107], v[156:159], v[108:111]
    ds_read_b64_tr_b16 v[140:141], v26 offset:8192
    v_mfma_f32_16x16x32_bf16 v[124:127], a[108:111], v[156:159], v[124:127]
    ds_read_b64_tr_b16 v[142:143], v26 offset:9216
    s_waitcnt lgkmcnt(6)
    v_mfma_f32_16x16x32_bf16 v[112:115], a[104:107], v[160:163], v[112:115]
    ds_read_b64_tr_b16 v[144:145], v27 offset:8192
    v_mfma_f32_16x16x32_bf16 v[128:131], a[108:111], v[160:163], v[128:131]
    ds_read_b64_tr_b16 v[146:147], v27 offset:9216
    s_waitcnt lgkmcnt(6)
    v_mfma_f32_16x16x32_bf16 v[100:103], a[112:115], v[132:135], v[100:103]
    ds_read_b64_tr_b16 v[148:149], v24 offset:12288
    v_mfma_f32_16x16x32_bf16 v[116:119], a[116:119], v[132:135], v[116:119]
    ds_read_b64_tr_b16 v[150:151], v24 offset:13312
    s_waitcnt lgkmcnt(6)
    v_mfma_f32_16x16x32_bf16 v[104:107], a[112:115], v[136:139], v[104:107]
    ds_read_b64_tr_b16 v[152:153], v25 offset:12288
    v_mfma_f32_16x16x32_bf16 v[120:123], a[116:119], v[136:139], v[120:123]
    ds_read_b64_tr_b16 v[154:155], v25 offset:13312
    s_waitcnt lgkmcnt(6)
    v_mfma_f32_16x16x32_bf16 v[108:111], a[112:115], v[140:143], v[108:111]
    ds_read_b64_tr_b16 v[156:157], v26 offset:12288
    v_mfma_f32_16x16x32_bf16 v[124:127], a[116:119], v[140:143], v[124:127]
    ds_read_b64_tr_b16 v[158:159], v26 offset:13312
    s_waitcnt lgkmcnt(6)
    v_mfma_f32_16x16x32_bf16 v[112:115], a[112:115], v[144:147], v[112:115]
    ds_read_b64_tr_b16 v[160:161], v27 offset:12288
    v_mfma_f32_16x16x32_bf16 v[128:131], a[116:119], v[144:147], v[128:131]
    ds_read_b64_tr_b16 v[162:163], v27 offset:13312
    s_waitcnt lgkmcnt(6)
    v_mfma_f32_16x16x32_bf16 v[100:103], a[120:123], v[148:151], v[100:103]
    v_mfma_f32_16x16x32_bf16 v[116:119], a[124:127], v[148:151], v[116:119]
    s_waitcnt lgkmcnt(4)
    v_mfma_f32_16x16x32_bf16 v[104:107], a[120:123], v[152:155], v[104:107]
    v_mfma_f32_16x16x32_bf16 v[120:123], a[124:127], v[152:155], v[120:123]
    s_waitcnt lgkmcnt(0)
    s_barrier
    v_mfma_f32_16x16x32_bf16 v[108:111], a[120:123], v[156:159], v[108:111]
    s_add_u32 m0, s56, 0
    s_add_u32 s58, s95, 128
    buffer_load_dwordx4 v12, s[8:11], s58 offen lds
    v_mfma_f32_16x16x32_bf16 v[124:127], a[124:127], v[156:159], v[124:127]
    buffer_load_dwordx4 v13, s[8:11], s58 offen offset:1024 lds
    v_mfma_f32_16x16x32_bf16 v[112:115], a[120:123], v[160:163], v[112:115]
    buffer_load_dwordx4 v14, s[8:11], s58 offen offset:2048 lds
    v_mfma_f32_16x16x32_bf16 v[128:131], a[124:127], v[160:163], v[128:131]
    buffer_load_dwordx4 v15, s[8:11], s58 offen offset:3072 lds
    v_cvt_pk_bf16_f32 v220, v100, v101
    v_cvt_pk_bf16_f32 v221, v102, v103
    v_cvt_pk_bf16_f32 v222, v116, v117
    v_cvt_pk_bf16_f32 v223, v118, v119
    v_cvt_pk_bf16_f32 v224, v104, v105
    v_cvt_pk_bf16_f32 v225, v106, v107
    v_cvt_pk_bf16_f32 v226, v120, v121
    v_cvt_pk_bf16_f32 v227, v122, v123
    v_cvt_pk_bf16_f32 v228, v108, v109
    v_cvt_pk_bf16_f32 v229, v110, v111
    v_cvt_pk_bf16_f32 v230, v124, v125
    v_cvt_pk_bf16_f32 v231, v126, v127
    v_cvt_pk_bf16_f32 v232, v112, v113
    v_cvt_pk_bf16_f32 v233, v114, v115
    v_cvt_pk_bf16_f32 v234, v128, v129
    v_cvt_pk_bf16_f32 v235, v130, v131
    v_mov_b32 v240, 0x3f803f80
    v_and_b32 v241, 3, v2
    v_cmp_eq_u32 vcc, 0, v241
    s_nop 1
    v_cndmask_b32 v236, v50, v240, vcc
    v_cndmask_b32 v237, v50, v240, vcc
    v_cndmask_b32 v238, v50, v240, vcc
    v_cndmask_b32 v239, v50, v240, vcc
    v_mfma_f32_16x16x32_bf16 v[68:71], v[180:183], v[220:223], 0
    s_nop 0
    v_mfma_f32_16x16x32_bf16 v[84:87], v[180:183], v[236:239], 0
    v_cmp_eq_u32 vcc, 1, v241
    s_nop 1
    v_cndmask_b32 v244, v50, v240, vcc
    v_cndmask_b32 v245, v50, v240, vcc
    v_cndmask_b32 v246, v50, v240, vcc
    v_cndmask_b32 v247, v50, v240, vcc
    v_mfma_f32_16x16x32_bf16 v[72:75], v[184:187], v[224:227], 0
    s_nop 0
    v_mfma_f32_16x16x32_bf16 v[84:87], v[184:187], v[244:247], v[84:87]
    v_cmp_eq_u32 vcc, 2, v241
    s_nop 1
    v_cndmask_b32 v236, v50, v240, vcc
    v_cndmask_b32 v237, v50, v240, vcc
    v_cndmask_b32 v238, v50, v240, vcc
    v_cndmask_b32 v239, v50, v240, vcc
    v_mfma_f32_16x16x32_bf16 v[76:79], v[188:191], v[228:231], 0
    s_nop 0
    v_mfma_f32_16x16x32_bf16 v[84:87], v[188:191], v[236:239], v[84:87]
    v_cmp_eq_u32 vcc, 3, v241
    s_nop 1
    v_cndmask_b32 v244, v50, v240, vcc
    v_cndmask_b32 v245, v50, v240, vcc
    v_cndmask_b32 v246, v50, v240, vcc
    v_cndmask_b32 v247, v50, v240, vcc
    v_mfma_f32_16x16x32_bf16 v[80:83], v[192:195], v[232:235], 0
    s_nop 0
    v_mfma_f32_16x16x32_bf16 v[84:87], v[192:195], v[244:247], v[84:87]
    s_lshl_b32 s59, s44, 10
    s_add_u32 s59, s59, 147456
    v_add_u32 v243, s59, v48
    s_add_u32 s59, s56, 147456
    v_lshlrev_b32 v249, 2, v1
    v_add_u32 v248, s59, v249
    ds_write_b128 v243, v[68:71] offset:0
    ds_write_b128 v243, v[72:75] offset:4096
    ds_write_b128 v243, v[76:79] offset:8192
    ds_write_b128 v243, v[80:83] offset:12288
    v_lshrrev_b32 v240, 2, v2
    v_lshl_add_u32 v242, v3, 2, v240
    v_lshl_add_u32 v242, v241, 4, v242
    v_lshlrev_b32 v242, 2, v242
    v_cmp_eq_u32 vcc, 1, v240
    s_nop 1
    v_cndmask_b32 v84, v84, v85, vcc
    v_cmp_eq_u32 vcc, 2, v240
    s_nop 1
    v_cndmask_b32 v84, v84, v86, vcc
    v_cmp_eq_u32 vcc, 3, v240
    s_nop 1
    v_cndmask_b32 v84, v84, v87, vcc
    s_lshl_b32 s59, s44, 8
    s_add_u32 s59, s59, 131072
    v_add_u32 v243, s59, v249
    ds_write_b32 v243, v84
    v_add_u32 v243, 131072, v249
    s_waitcnt vmcnt(4)
L_chk_1626:
    v_xor_b32 v62, s50, v44
    v_bitop3_b32 v62, v45, s51, v62 bitop3:0xbe
    v_cmp_ne_u32 vcc, 0, v62
    s_nop 0
    s_cbranch_vccnz L_retry_1627
L_cont_1628:
    s_waitcnt lgkmcnt(0)
    s_barrier
    ds_read2st64_b32 v[84:85], v243 offset0:0 offset1:1
    ds_read2st64_b32 v[86:87], v243 offset0:2 offset1:3
    ds_read2st64_b32 v[68:69], v248 offset0:0 offset1:1
    ds_read2st64_b32 v[70:71], v248 offset0:2 offset1:3
    ds_read2st64_b32 v[72:73], v248 offset0:4 offset1:5
    ds_read2st64_b32 v[74:75], v248 offset0:6 offset1:7
    ds_read2st64_b32 v[76:77], v248 offset0:8 offset1:9
    ds_read2st64_b32 v[78:79], v248 offset0:10 offset1:11
    ds_read2st64_b32 v[80:81], v248 offset0:12 offset1:13
    ds_read2st64_b32 v[82:83], v248 offset0:14 offset1:15
    s_lshl_b32 s59, s47, 2
    s_add_u32 s59, s59, s44
    s_lshl_b32 s59, s59, 10
    s_add_u32 s59, s59, 720896
    s_waitcnt lgkmcnt(0)
    v_pk_add_f32 v[68:69], v[68:69], v[72:73]
    v_pk_add_f32 v[70:71], v[70:71], v[74:75]
    v_pk_add_f32 v[76:77], v[76:77], v[80:81]
    v_pk_add_f32 v[78:79], v[78:79], v[82:83]
    v_pk_add_f32 v[68:69], v[68:69], v[76:77]
    v_pk_add_f32 v[70:71], v[70:71], v[78:79]
    buffer_atomic_add_f32 v68, v249, s[40:43], s59 offen sc1
    buffer_atomic_add_f32 v69, v249, s[40:43], s59 offen offset:256 sc1
    buffer_atomic_add_f32 v70, v249, s[40:43], s59 offen offset:512 sc1
    buffer_atomic_add_f32 v71, v249, s[40:43], s59 offen offset:768 sc1
    v_pk_add_f32 v[84:85], v[84:85], v[86:87]
    v_add_f32 v84, v84, v85
    s_lshl_b32 s59, s47, 8
    s_add_u32 s59, s59, 589824
    s_lshl_b32 s64, s47, 2
    s_lshr_b32 s60, s45, 2
    s_add_u32 s64, s64, s60
    s_lshl_b32 s64, s64, 4
    s_and_b32 s60, s45, 3
    s_add_u32 s64, s64, s60
    s_lshl_b32 s64, s64, 3
    s_add_u32 s64, s64, 32768
    s_cmp_eq_u32 s44, 0
    s_cselect_b32 s64, s64, 0x1180000
    s_cselect_b32 s59, s59, 0x1180000
    buffer_atomic_add_f32 v84, v242, s[40:43], s59 offen sc1
    s_barrier
    ds_read_b64_tr_b16 v[132:133], v28 offset:32768
    ds_read_b64_tr_b16 v[134:135], v28 offset:33792
    ds_read_b64_tr_b16 v[136:137], v29 offset:32768
    ds_read_b64_tr_b16 v[138:139], v29 offset:33792
    ds_read_b64_tr_b16 v[140:141], v30 offset:32768
    ds_read_b64_tr_b16 v[142:143], v30 offset:33792
    ds_read_b64_tr_b16 v[144:145], v31 offset:32768
    ds_read_b64_tr_b16 v[146:147], v31 offset:33792
    s_waitcnt lgkmcnt(6)
    v_mfma_f32_16x16x32_bf16 v[68:71], v[132:135], a[0:3], 0
    ds_read_b64_tr_b16 v[148:149], v28 offset:36864
    v_mfma_f32_16x16x32_bf16 v[84:87], v[132:135], a[4:7], 0
    ds_read_b64_tr_b16 v[150:151], v28 offset:37888
    s_waitcnt lgkmcnt(6)
    v_mfma_f32_16x16x32_bf16 v[72:75], v[136:139], a[0:3], 0
    ds_read_b64_tr_b16 v[152:153], v29 offset:36864
    v_mfma_f32_16x16x32_bf16 v[88:91], v[136:139], a[4:7], 0
    ds_read_b64_tr_b16 v[154:155], v29 offset:37888
    s_waitcnt lgkmcnt(6)
    v_mfma_f32_16x16x32_bf16 v[76:79], v[140:143], a[0:3], 0
    ds_read_b64_tr_b16 v[156:157], v30 offset:36864
    v_mfma_f32_16x16x32_bf16 v[92:95], v[140:143], a[4:7], 0
    ds_read_b64_tr_b16 v[158:159], v30 offset:37888
    s_waitcnt lgkmcnt(6)
    v_mfma_f32_16x16x32_bf16 v[80:83], v[144:147], a[0:3], 0
    ds_read_b64_tr_b16 v[160:161], v31 offset:36864
    v_mfma_f32_16x16x32_bf16 v[96:99], v[144:147], a[4:7], 0
    ds_read_b64_tr_b16 v[162:163], v31 offset:37888
    s_waitcnt lgkmcnt(6)
    v_mfma_f32_16x16x32_bf16 v[68:71], v[148:151], a[8:11], v[68:71]
    ds_read_b64_tr_b16 v[132:133], v28 offset:40960
    v_mfma_f32_16x16x32_bf16 v[84:87], v[148:151], a[12:15], v[84:87]
    ds_read_b64_tr_b16 v[134:135], v28 offset:41984
    s_waitcnt lgkmcnt(6)
    v_mfma_f32_16x16x32_bf16 v[72:75], v[152:155], a[8:11], v[72:75]
    ds_read_b64_tr_b16 v[136:137], v29 offset:40960
    v_mfma_f32_16x16x32_bf16 v[88:91], v[152:155], a[12:15], v[88:91]
    ds_read_b64_tr_b16 v[138:139], v29 offset:41984
    s_waitcnt lgkmcnt(6)
    v_mfma_f32_16x16x32_bf16 v[76:79], v[156:159], a[8:11], v[76:79]
    ds_read_b64_tr_b16 v[140:141], v30 offset:40960
H_S0_3:
    s_cbranch_execz L_hopret
    v_mfma_f32_16x16x32_bf16 v[92:95], v[156:159], a[12:15], v[92:95]
    ds_read_b64_tr_b16 v[142:143], v30 offset:41984
    s_waitcnt lgkmcnt(6)
    v_mfma_f32_16x16x32_bf16 v[80:83], v[160:163], a[8:11], v[80:83]
    ds_read_b64_tr_b16 v[144:145], v31 offset:40960
    v_mfma_f32_16x16x32_bf16 v[96:99], v[160:163], a[12:15], v[96:99]
    ds_read_b64_tr_b16 v[146:147], v31 offset:41984
    s_waitcnt lgkmcnt(6)
    v_mfma_f32_16x16x32_bf16 v[68:71], v[132:135], a[16:19], v[68:71]
    ds_read_b64_tr_b16 v[148:149], v28 offset:45056
    v_mfma_f32_16x16x32_bf16 v[84:87], v[132:135], a[20:23], v[84:87]
    ds_read_b64_tr_b16 v[150:151], v28 offset:46080
    s_waitcnt lgkmcnt(6)
    v_mfma_f32_16x16x32_bf16 v[72:75], v[136:139], a[16:19], v[72:75]
    ds_read_b64_tr_b16 v[152:153], v29 offset:45056
    v_mfma_f32_16x16x32_bf16 v[88:91], v[136:139], a[20:23], v[88:91]
    ds_read_b64_tr_b16 v[154:155], v29 offset:46080
    s_waitcnt lgkmcnt(6)
    v_mfma_f32_16x16x32_bf16 v[76:79], v[140:143], a[16:19], v[76:79]
    ds_read_b64_tr_b16 v[156:157], v30 offset:45056
    v_mfma_f32_16x16x32_bf16 v[92:95], v[140:143], a[20:23], v[92:95]
    ds_read_b64_tr_b16 v[158:159], v30 offset:46080
    s_waitcnt lgkmcnt(6)
    v_mfma_f32_16x16x32_bf16 v[80:83], v[144:147], a[16:19], v[80:83]
    ds_read_b64_tr_b16 v[160:161], v31 offset:45056
    v_mfma_f32_16x16x32_bf16 v[96:99], v[144:147], a[20:23], v[96:99]
    ds_read_b64_tr_b16 v[162:163], v31 offset:46080
    s_waitcnt lgkmcnt(6)
    v_mfma_f32_16x16x32_bf16 v[68:71], v[148:151], a[24:27], v[68:71]
    v_mfma_f32_16x16x32_bf16 v[84:87], v[148:151], a[28:31], v[84:87]
    s_waitcnt lgkmcnt(4)
    v_mfma_f32_16x16x32_bf16 v[72:75], v[152:155], a[24:27], v[72:75]
    v_mfma_f32_16x16x32_bf16 v[88:91], v[152:155], a[28:31], v[88:91]
    s_waitcnt lgkmcnt(0)
    s_barrier
    v_mfma_f32_16x16x32_bf16 v[76:79], v[156:159], a[24:27], v[76:79]
    ds_read_b64_tr_b16 v[132:133], v24 offset:16384
    ds_read_b64_tr_b16 v[134:135], v24 offset:17408
    s_add_u32 m0, s56, 98304
    s_add_u32 s58, s54, 256
    buffer_load_dwordx4 v12, s[8:11], s58 offen lds
    v_mfma_f32_16x16x32_bf16 v[92:95], v[156:159], a[28:31], v[92:95]
    ds_read_b64_tr_b16 v[136:137], v25 offset:16384
    ds_read_b64_tr_b16 v[138:139], v25 offset:17408
    buffer_load_dwordx4 v13, s[8:11], s58 offen offset:1024 lds
    v_mfma_f32_16x16x32_bf16 v[80:83], v[160:163], a[24:27], v[80:83]
    ds_read_b64_tr_b16 v[140:141], v26 offset:16384
    ds_read_b64_tr_b16 v[142:143], v26 offset:17408
    buffer_load_dwordx4 v14, s[8:11], s58 offen offset:2048 lds
    v_mfma_f32_16x16x32_bf16 v[96:99], v[160:163], a[28:31], v[96:99]
    ds_read_b64_tr_b16 v[144:145], v27 offset:16384
    ds_read_b64_tr_b16 v[146:147], v27 offset:17408
    s_waitcnt lgkmcnt(6)
    v_mfma_f32_16x16x32_bf16 v[68:71], v[132:135], a[32:35], v[68:71]
    ds_read_b64_tr_b16 v[148:149], v24 offset:20480
    v_mfma_f32_16x16x32_bf16 v[84:87], v[132:135], a[36:39], v[84:87]
    ds_read_b64_tr_b16 v[150:151], v24 offset:21504
    s_waitcnt lgkmcnt(6)
    v_mfma_f32_16x16x32_bf16 v[72:75], v[136:139], a[32:35], v[72:75]
    ds_read_b64_tr_b16 v[152:153], v25 offset:20480
    v_mfma_f32_16x16x32_bf16 v[88:91], v[136:139], a[36:39], v[88:91]
    ds_read_b64_tr_b16 v[154:155], v25 offset:21504
    buffer_load_dwordx4 v15, s[8:11], s58 offen offset:3072 lds
    s_waitcnt lgkmcnt(6)
    v_mfma_f32_16x16x32_bf16 v[76:79], v[140:143], a[32:35], v[76:79]
    ds_read_b64_tr_b16 v[156:157], v26 offset:20480
    v_mfma_f32_16x16x32_bf16 v[92:95], v[140:143], a[36:39], v[92:95]
    ds_read_b64_tr_b16 v[158:159], v26 offset:21504
    s_waitcnt lgkmcnt(6)
    v_mfma_f32_16x16x32_bf16 v[80:83], v[144:147], a[32:35], v[80:83]
    ds_read_b64_tr_b16 v[160:161], v27 offset:20480
    v_mfma_f32_16x16x32_bf16 v[96:99], v[144:147], a[36:39], v[96:99]
    ds_read_b64_tr_b16 v[162:163], v27 offset:21504
    s_waitcnt lgkmcnt(6)
    v_mfma_f32_16x16x32_bf16 v[68:71], v[148:151], a[40:43], v[68:71]
    ds_read_b64_tr_b16 v[132:133], v24 offset:24576
    v_mfma_f32_16x16x32_bf16 v[84:87], v[148:151], a[44:47], v[84:87]
    ds_read_b64_tr_b16 v[134:135], v24 offset:25600
    s_waitcnt lgkmcnt(6)
    v_mfma_f32_16x16x32_bf16 v[72:75], v[152:155], a[40:43], v[72:75]
    ds_read_b64_tr_b16 v[136:137], v25 offset:24576
    v_mfma_f32_16x16x32_bf16 v[88:91], v[152:155], a[44:47], v[88:91]
    ds_read_b64_tr_b16 v[138:139], v25 offset:25600
    s_waitcnt lgkmcnt(6)
    v_mfma_f32_16x16x32_bf16 v[76:79], v[156:159], a[40:43], v[76:79]
    ds_read_b64_tr_b16 v[140:141], v26 offset:24576
    v_mfma_f32_16x16x32_bf16 v[92:95], v[156:159], a[44:47], v[92:95]
    ds_read_b64_tr_b16 v[142:143], v26 offset:25600
    s_waitcnt lgkmcnt(6)
    v_mfma_f32_16x16x32_bf16 v[80:83], v[160:163], a[40:43], v[80:83]
    ds_read_b64_tr_b16 v[144:145], v27 offset:24576
    v_mfma_f32_16x16x32_bf16 v[96:99], v[160:163], a[44:47], v[96:99]
    ds_read_b64_tr_b16 v[146:147], v27 offset:25600
    s_waitcnt vmcnt(4)
    s_waitcnt lgkmcnt(6)
    v_mfma_f32_16x16x32_bf16 v[68:71], v[132:135], a[48:51], v[68:71]
    ds_read_b64_tr_b16 v[148:149], v24 offset:28672
    v_mfma_f32_16x16x32_bf16 v[84:87], v[132:135], a[52:55], v[84:87]
    ds_read_b64_tr_b16 v[150:151], v24 offset:29696
    s_waitcnt lgkmcnt(6)
    v_mfma_f32_16x16x32_bf16 v[72:75], v[136:139], a[48:51], v[72:75]
    ds_read_b64_tr_b16 v[152:153], v25 offset:28672
    v_mfma_f32_16x16x32_bf16 v[88:91], v[136:139], a[52:55], v[88:91]
    ds_read_b64_tr_b16 v[154:155], v25 offset:29696
    s_waitcnt lgkmcnt(6)
    v_mfma_f32_16x16x32_bf16 v[76:79], v[140:143], a[48:51], v[76:79]
    ds_read_b64_tr_b16 v[156:157], v26 offset:28672
    v_mfma_f32_16x16x32_bf16 v[92:95], v[140:143], a[52:55], v[92:95]
    ds_read_b64_tr_b16 v[158:159], v26 offset:29696
    s_waitcnt lgkmcnt(6)
    v_mfma_f32_16x16x32_bf16 v[80:83], v[144:147], a[48:51], v[80:83]
    ds_read_b64_tr_b16 v[160:161], v27 offset:28672
    v_mfma_f32_16x16x32_bf16 v[96:99], v[144:147], a[52:55], v[96:99]
    ds_read_b64_tr_b16 v[162:163], v27 offset:29696
    s_waitcnt lgkmcnt(6)
    v_mfma_f32_16x16x32_bf16 v[68:71], v[148:151], a[56:59], v[68:71]
    v_mfma_f32_16x16x32_bf16 v[84:87], v[148:151], a[60:63], v[84:87]
    s_waitcnt lgkmcnt(4)
    v_mfma_f32_16x16x32_bf16 v[72:75], v[152:155], a[56:59], v[72:75]
    v_mfma_f32_16x16x32_bf16 v[88:91], v[152:155], a[60:63], v[88:91]
    s_waitcnt lgkmcnt(0)
    s_barrier
    v_mfma_f32_16x16x32_bf16 v[76:79], v[156:159], a[56:59], v[76:79]
    ds_read_b64_tr_b16 v[132:133], v28 offset:0
    ds_read_b64_tr_b16 v[134:135], v28 offset:1024
    s_add_u32 m0, s56, 16384
    s_add_u32 s58, s55, 256
    buffer_load_dwordx4 v12, s[8:11], s58 offen lds
    v_mfma_f32_16x16x32_bf16 v[92:95], v[156:159], a[60:63], v[92:95]
    ds_read_b64_tr_b16 v[136:137], v29 offset:0
    ds_read_b64_tr_b16 v[138:139], v29 offset:1024
    buffer_load_dwordx4 v13, s[8:11], s58 offen offset:1024 lds
    v_mfma_f32_16x16x32_bf16 v[80:83], v[160:163], a[56:59], v[80:83]
    ds_read_b64_tr_b16 v[140:141], v30 offset:0
    ds_read_b64_tr_b16 v[142:143], v30 offset:1024
    buffer_load_dwordx4 v14, s[8:11], s58 offen offset:2048 lds
    v_mfma_f32_16x16x32_bf16 v[96:99], v[160:163], a[60:63], v[96:99]
    ds_read_b64_tr_b16 v[144:145], v31 offset:0
    ds_read_b64_tr_b16 v[146:147], v31 offset:1024
    buffer_load_dwordx4 v15, s[8:11], s58 offen offset:3072 lds
    buffer_store_dwordx2 v[66:67], v50, s[40:43], s64 offen sc1
    s_waitcnt lgkmcnt(6)
    v_mfma_f32_16x16x32_bf16 v[68:71], v[132:135], a[64:67], v[68:71]
    ds_read_b64_tr_b16 v[148:149], v28 offset:4096
    v_mfma_f32_16x16x32_bf16 v[84:87], v[132:135], a[68:71], v[84:87]
    ds_read_b64_tr_b16 v[150:151], v28 offset:5120
    s_waitcnt lgkmcnt(6)
    v_mfma_f32_16x16x32_bf16 v[72:75], v[136:139], a[64:67], v[72:75]
    ds_read_b64_tr_b16 v[152:153], v29 offset:4096
    v_mfma_f32_16x16x32_bf16 v[88:91], v[136:139], a[68:71], v[88:91]
    ds_read_b64_tr_b16 v[154:155], v29 offset:5120
    s_waitcnt lgkmcnt(6)
    v_mfma_f32_16x16x32_bf16 v[76:79], v[140:143], a[64:67], v[76:79]
    ds_read_b64_tr_b16 v[156:157], v30 offset:4096
    v_mfma_f32_16x16x32_bf16 v[92:95], v[140:143], a[68:71], v[92:95]
    ds_read_b64_tr_b16 v[158:159], v30 offset:5120
    s_waitcnt lgkmcnt(6)
    v_mfma_f32_16x16x32_bf16 v[80:83], v[144:147], a[64:67], v[80:83]
    ds_read_b64_tr_b16 v[160:161], v31 offset:4096
    v_mfma_f32_16x16x32_bf16 v[96:99], v[144:147], a[68:71], v[96:99]
    ds_read_b64_tr_b16 v[162:163], v31 offset:5120
    s_waitcnt lgkmcnt(6)
    v_mfma_f32_16x16x32_bf16 v[68:71], v[148:151], a[72:75], v[68:71]
    ds_read_b64_tr_b16 v[132:133], v28 offset:8192
    v_mfma_f32_16x16x32_bf16 v[84:87], v[148:151], a[76:79], v[84:87]
    ds_read_b64_tr_b16 v[134:135], v28 offset:9216
    s_waitcnt lgkmcnt(6)
    v_mfma_f32_16x16x32_bf16 v[72:75], v[152:155], a[72:75], v[72:75]
    ds_read_b64_tr_b16 v[136:137], v29 offset:8192
    v_mfma_f32_16x16x32_bf16 v[88:91], v[152:155], a[76:79], v[88:91]
    ds_read_b64_tr_b16 v[138:139], v29 offset:9216
    s_waitcnt lgkmcnt(6)
    v_mfma_f32_16x16x32_bf16 v[76:79], v[156:159], a[72:75], v[76:79]
    ds_read_b64_tr_b16 v[140:141], v30 offset:8192
    v_mfma_f32_16x16x32_bf16 v[92:95], v[156:159], a[76:79], v[92:95]
    ds_read_b64_tr_b16 v[142:143], v30 offset:9216
    s_waitcnt lgkmcnt(6)
    v_mfma_f32_16x16x32_bf16 v[80:83], v[160:163], a[72:75], v[80:83]
    ds_read_b64_tr_b16 v[144:145], v31 offset:8192
    v_mfma_f32_16x16x32_bf16 v[96:99], v[160:163], a[76:79], v[96:99]
    ds_read_b64_tr_b16 v[146:147], v31 offset:9216
    s_waitcnt lgkmcnt(6)
    v_mfma_f32_16x16x32_bf16 v[68:71], v[132:135], a[80:83], v[68:71]
    ds_read_b64_tr_b16 v[148:149], v28 offset:12288
    v_mfma_f32_16x16x32_bf16 v[84:87], v[132:135], a[84:87], v[84:87]
    ds_read_b64_tr_b16 v[150:151], v28 offset:13312
    s_waitcnt lgkmcnt(6)
    v_mfma_f32_16x16x32_bf16 v[72:75], v[136:139], a[80:83], v[72:75]
    ds_read_b64_tr_b16 v[152:153], v29 offset:12288
    v_mfma_f32_16x16x32_bf16 v[88:91], v[136:139], a[84:87], v[88:91]
    ds_read_b64_tr_b16 v[154:155], v29 offset:13312
    s_waitcnt lgkmcnt(6)
    v_mfma_f32_16x16x32_bf16 v[76:79], v[140:143], a[80:83], v[76:79]
    ds_read_b64_tr_b16 v[156:157], v30 offset:12288
    v_mfma_f32_16x16x32_bf16 v[92:95], v[140:143], a[84:87], v[92:95]
    ds_read_b64_tr_b16 v[158:159], v30 offset:13312
    s_waitcnt lgkmcnt(6)
    v_mfma_f32_16x16x32_bf16 v[80:83], v[144:147], a[80:83], v[80:83]
    ds_read_b64_tr_b16 v[160:161], v31 offset:12288
    v_mfma_f32_16x16x32_bf16 v[96:99], v[144:147], a[84:87], v[96:99]
    ds_read_b64_tr_b16 v[162:163], v31 offset:13312
    s_waitcnt lgkmcnt(6)
    v_mfma_f32_16x16x32_bf16 v[68:71], v[148:151], a[88:91], v[68:71]
    v_mfma_f32_16x16x32_bf16 v[84:87], v[148:151], a[92:95], v[84:87]
    s_waitcnt lgkmcnt(4)
    v_mfma_f32_16x16x32_bf16 v[72:75], v[152:155], a[88:91], v[72:75]
    v_mfma_f32_16x16x32_bf16 v[88:91], v[152:155], a[92:95], v[88:91]
    s_waitcnt lgkmcnt(0)
    s_barrier
    v_mfma_f32_16x16x32_bf16 v[76:79], v[156:159], a[88:91], v[76:79]
    ds_read_b64_tr_b16 v[132:133], v24 offset:32768
    ds_read_b64_tr_b16 v[134:135], v24 offset:33792
    s_add_u32 m0, s56, 65536
    s_add_u32 s58, s93, 256
    buffer_load_dwordx4 v12, s[8:11], s58 offen lds
    v_mfma_f32_16x16x32_bf16 v[92:95], v[156:159], a[92:95], v[92:95]
    ds_read_b64_tr_b16 v[136:137], v25 offset:32768
    ds_read_b64_tr_b16 v[138:139], v25 offset:33792
    buffer_load_dwordx4 v13, s[8:11], s58 offen offset:1024 lds
    v_mfma_f32_16x16x32_bf16 v[80:83], v[160:163], a[88:91], v[80:83]
    ds_read_b64_tr_b16 v[140:141], v26 offset:32768
    ds_read_b64_tr_b16 v[142:143], v26 offset:33792
    buffer_load_dwordx4 v14, s[8:11], s58 offen offset:2048 lds
    v_mfma_f32_16x16x32_bf16 v[96:99], v[160:163], a[92:95], v[96:99]
    ds_read_b64_tr_b16 v[144:145], v27 offset:32768
    ds_read_b64_tr_b16 v[146:147], v27 offset:33792
    buffer_load_dwordx4 v15, s[8:11], s58 offen offset:3072 lds
    s_waitcnt lgkmcnt(6)
    v_mfma_f32_16x16x32_bf16 v[68:71], v[132:135], a[96:99], v[68:71]
    ds_read_b64_tr_b16 v[148:149], v24 offset:36864
    v_mfma_f32_16x16x32_bf16 v[84:87], v[132:135], a[100:103], v[84:87]
    ds_read_b64_tr_b16 v[150:151], v24 offset:37888
    s_waitcnt lgkmcnt(6)
    v_mfma_f32_16x16x32_bf16 v[72:75], v[136:139], a[96:99], v[72:75]
    ds_read_b64_tr_b16 v[152:153], v25 offset:36864
    v_mfma_f32_16x16x32_bf16 v[88:91], v[136:139], a[100:103], v[88:91]
    ds_read_b64_tr_b16 v[154:155], v25 offset:37888
    s_waitcnt lgkmcnt(6)
    v_mfma_f32_16x16x32_bf16 v[76:79], v[140:143], a[96:99], v[76:79]
    ds_read_b64_tr_b16 v[156:157], v26 offset:36864
    v_mfma_f32_16x16x32_bf16 v[92:95], v[140:143], a[100:103], v[92:95]
    ds_read_b64_tr_b16 v[158:159], v26 offset:37888
    s_waitcnt lgkmcnt(6)
    v_mfma_f32_16x16x32_bf16 v[80:83], v[144:147], a[96:99], v[80:83]
    ds_read_b64_tr_b16 v[160:161], v27 offset:36864
    v_mfma_f32_16x16x32_bf16 v[96:99], v[144:147], a[100:103], v[96:99]
    ds_read_b64_tr_b16 v[162:163], v27 offset:37888
    s_waitcnt lgkmcnt(6)
    v_mfma_f32_16x16x32_bf16 v[68:71], v[148:151], a[104:107], v[68:71]
    ds_read_b64_tr_b16 v[132:133], v24 offset:40960
    v_mfma_f32_16x16x32_bf16 v[84:87], v[148:151], a[108:111], v[84:87]
    ds_read_b64_tr_b16 v[134:135], v24 offset:41984
    s_waitcnt lgkmcnt(6)
    v_mfma_f32_16x16x32_bf16 v[72:75], v[152:155], a[104:107], v[72:75]
    ds_read_b64_tr_b16 v[136:137], v25 offset:40960
    v_mfma_f32_16x16x32_bf16 v[88:91], v[152:155], a[108:111], v[88:91]
    ds_read_b64_tr_b16 v[138:139], v25 offset:41984
    s_waitcnt lgkmcnt(6)
    v_mfma_f32_16x16x32_bf16 v[76:79], v[156:159], a[104:107], v[76:79]
    ds_read_b64_tr_b16 v[140:141], v26 offset:40960
    v_mfma_f32_16x16x32_bf16 v[92:95], v[156:159], a[108:111], v[92:95]
    ds_read_b64_tr_b16 v[142:143], v26 offset:41984
    s_waitcnt lgkmcnt(6)
    v_mfma_f32_16x16x32_bf16 v[80:83], v[160:163], a[104:107], v[80:83]
    ds_read_b64_tr_b16 v[144:145], v27 offset:40960
    v_mfma_f32_16x16x32_bf16 v[96:99], v[160:163], a[108:111], v[96:99]
    ds_read_b64_tr_b16 v[146:147], v27 offset:41984
    s_waitcnt lgkmcnt(6)
    v_mfma_f32_16x16x32_bf16 v[68:71], v[132:135], a[112:115], v[68:71]
    ds_read_b64_tr_b16 v[148:149], v24 offset:45056
    v_mfma_f32_16x16x32_bf16 v[84:87], v[132:135], a[116:119], v[84:87]
    ds_read_b64_tr_b16 v[150:151], v24 offset:46080
    s_waitcnt lgkmcnt(6)
    v_mfma_f32_16x16x32_bf16 v[72:75], v[136:139], a[112:115], v[72:75]
    ds_read_b64_tr_b16 v[152:153], v25 offset:45056
    v_mfma_f32_16x16x32_bf16 v[88:91], v[136:139], a[116:119], v[88:91]
    ds_read_b64_tr_b16 v[154:155], v25 offset:46080
    s_waitcnt lgkmcnt(6)
    v_mfma_f32_16x16x32_bf16 v[76:79], v[140:143], a[112:115], v[76:79]
    ds_read_b64_tr_b16 v[156:157], v26 offset:45056
    v_mfma_f32_16x16x32_bf16 v[92:95], v[140:143], a[116:119], v[92:95]
    ds_read_b64_tr_b16 v[158:159], v26 offset:46080
    s_waitcnt lgkmcnt(6)
    v_mfma_f32_16x16x32_bf16 v[80:83], v[144:147], a[112:115], v[80:83]
    ds_read_b64_tr_b16 v[160:161], v27 offset:45056
    v_mfma_f32_16x16x32_bf16 v[96:99], v[144:147], a[116:119], v[96:99]
    ds_read_b64_tr_b16 v[162:163], v27 offset:46080
    s_waitcnt lgkmcnt(6)
    v_mfma_f32_16x16x32_bf16 v[68:71], v[148:151], a[120:123], v[68:71]
    v_mfma_f32_16x16x32_bf16 v[84:87], v[148:151], a[124:127], v[84:87]
    s_waitcnt lgkmcnt(4)
    v_mfma_f32_16x16x32_bf16 v[72:75], v[152:155], a[120:123], v[72:75]
    v_mfma_f32_16x16x32_bf16 v[88:91], v[152:155], a[124:127], v[88:91]
    s_waitcnt lgkmcnt(0)
    s_barrier
    v_mfma_f32_16x16x32_bf16 v[76:79], v[156:159], a[120:123], v[76:79]
    s_add_u32 m0, s56, 32768
    s_add_u32 s58, s95, 256
    buffer_load_dwordx4 v12, s[8:11], s58 offen lds
    v_mfma_f32_16x16x32_bf16 v[92:95], v[156:159], a[124:127], v[92:95]
    buffer_load_dwordx4 v13, s[8:11], s58 offen offset:1024 lds
    v_mfma_f32_16x16x32_bf16 v[80:83], v[160:163], a[120:123], v[80:83]
    buffer_load_dwordx4 v14, s[8:11], s58 offen offset:2048 lds
    v_mfma_f32_16x16x32_bf16 v[96:99], v[160:163], a[124:127], v[96:99]
    buffer_load_dwordx4 v15, s[8:11], s58 offen offset:3072 lds
    v_pk_mul_f32 v[196:197], v[68:69], v[58:59]
    v_pk_mul_f32 v[198:199], v[70:71], v[58:59]
    v_pk_mul_f32 v[200:201], v[72:73], v[58:59]
    v_pk_mul_f32 v[202:203], v[74:75], v[58:59]
    v_exp_f32_e64 v196, v196 clamp
    v_exp_f32_e64 v197, v197 clamp
    v_exp_f32_e64 v198, v198 clamp
    v_exp_f32_e64 v199, v199 clamp
    v_exp_f32_e64 v200, v200 clamp
    v_exp_f32_e64 v201, v201 clamp
    v_exp_f32_e64 v202, v202 clamp
    v_exp_f32_e64 v203, v203 clamp
    v_lshrrev_b32 v39, 2, v1
    v_and_b32 v40, 3, v1
    v_lshlrev_b32 v40, 7, v40
    v_lshl_add_u32 v39, v39, 10, v40
    s_and_b32 s59, s57, 15
    s_lshl_b32 s59, s59, 14
    s_add_u32 s59, s59, 0
    v_add_u32 v39, s59, v39
    s_lshr_b32 s59, s45, 2
    s_add_u32 s59, s59, 0
    s_and_b32 s59, s59, 3
    s_lshl_b32 s59, s59, 18
    buffer_load_dword v38, v39, s[28:31], s59 offen
    v_max_f32 v68, 0, v68
    v_max_f32 v69, 0, v69
    v_max_f32 v70, 0, v70
    v_max_f32 v71, 0, v71
    v_max_f32 v72, 0, v72
    v_max_f32 v73, 0, v73
    v_max_f32 v74, 0, v74
    v_max_f32 v75, 0, v75
    v_pk_add_f32 v[68:69], v[68:69], v[196:197]
    v_pk_add_f32 v[70:71], v[70:71], v[198:199]
    v_pk_add_f32 v[72:73], v[72:73], v[200:201]
    v_pk_add_f32 v[74:75], v[74:75], v[202:203]
    v_pk_add_f32 v[68:69], v[68:69], v[60:61]
    v_pk_add_f32 v[70:71], v[70:71], v[60:61]
    v_pk_add_f32 v[72:73], v[72:73], v[60:61]
    v_pk_add_f32 v[74:75], v[74:75], v[60:61]
    v_pk_mul_f32 v[196:197], v[76:77], v[58:59]
    v_pk_mul_f32 v[198:199], v[78:79], v[58:59]
    v_pk_mul_f32 v[200:201], v[80:81], v[58:59]
    v_pk_mul_f32 v[202:203], v[82:83], v[58:59]
    v_exp_f32_e64 v196, v196 clamp
    v_exp_f32_e64 v197, v197 clamp
    v_exp_f32_e64 v198, v198 clamp
    v_exp_f32_e64 v199, v199 clamp
    v_exp_f32_e64 v200, v200 clamp
    v_exp_f32_e64 v201, v201 clamp
    v_exp_f32_e64 v202, v202 clamp
    v_exp_f32_e64 v203, v203 clamp
    v_max_f32 v76, 0, v76
    v_max_f32 v77, 0, v77
    v_max_f32 v78, 0, v78
    v_max_f32 v79, 0, v79
    v_max_f32 v80, 0, v80
    v_max_f32 v81, 0, v81
    v_max_f32 v82, 0, v82
    v_max_f32 v83, 0, v83
    v_pk_add_f32 v[76:77], v[76:77], v[196:197]
    v_pk_add_f32 v[78:79], v[78:79], v[198:199]
    v_pk_add_f32 v[80:81], v[80:81], v[200:201]
    v_pk_add_f32 v[82:83], v[82:83], v[202:203]
    v_pk_add_f32 v[76:77], v[76:77], v[60:61]
    v_pk_add_f32 v[78:79], v[78:79], v[60:61]
    v_pk_add_f32 v[80:81], v[80:81], v[60:61]
    v_pk_add_f32 v[82:83], v[82:83], v[60:61]
    v_pk_mul_f32 v[196:197], v[84:85], v[58:59]
    v_pk_mul_f32 v[198:199], v[86:87], v[58:59]
    v_pk_mul_f32 v[200:201], v[88:89], v[58:59]
    v_pk_mul_f32 v[202:203], v[90:91], v[58:59]
    v_exp_f32_e64 v196, v196 clamp
    v_exp_f32_e64 v197, v197 clamp
    v_exp_f32_e64 v198, v198 clamp
    v_exp_f32_e64 v199, v199 clamp
    v_exp_f32_e64 v200, v200 clamp
    v_exp_f32_e64 v201, v201 clamp
    v_exp_f32_e64 v202, v202 clamp
    v_exp_f32_e64 v203, v203 clamp
    v_max_f32 v84, 0, v84
    v_max_f32 v85, 0, v85
    v_max_f32 v86, 0, v86
    v_max_f32 v87, 0, v87
    v_max_f32 v88, 0, v88
    v_max_f32 v89, 0, v89
    v_max_f32 v90, 0, v90
    v_max_f32 v91, 0, v91
    v_pk_add_f32 v[84:85], v[84:85], v[196:197]
    v_pk_add_f32 v[86:87], v[86:87], v[198:199]
    v_pk_add_f32 v[88:89], v[88:89], v[200:201]
    v_pk_add_f32 v[90:91], v[90:91], v[202:203]
    v_pk_add_f32 v[84:85], v[84:85], v[60:61]
    v_pk_add_f32 v[86:87], v[86:87], v[60:61]
    v_pk_add_f32 v[88:89], v[88:89], v[60:61]
    v_pk_add_f32 v[90:91], v[90:91], v[60:61]
    v_pk_mul_f32 v[196:197], v[92:93], v[58:59]
    v_pk_mul_f32 v[198:199], v[94:95], v[58:59]
    v_pk_mul_f32 v[200:201], v[96:97], v[58:59]
    v_pk_mul_f32 v[202:203], v[98:99], v[58:59]
    v_exp_f32_e64 v196, v196 clamp
    v_exp_f32_e64 v197, v197 clamp
    v_exp_f32_e64 v198, v198 clamp
    v_exp_f32_e64 v199, v199 clamp
    v_exp_f32_e64 v200, v200 clamp
    v_exp_f32_e64 v201, v201 clamp
    v_exp_f32_e64 v202, v202 clamp
    v_exp_f32_e64 v203, v203 clamp
    v_max_f32 v92, 0, v92
    v_max_f32 v93, 0, v93
    v_max_f32 v94, 0, v94
    v_max_f32 v95, 0, v95
    v_max_f32 v96, 0, v96
    v_max_f32 v97, 0, v97
    v_max_f32 v98, 0, v98
    v_max_f32 v99, 0, v99
    v_pk_add_f32 v[92:93], v[92:93], v[196:197]
    v_pk_add_f32 v[94:95], v[94:95], v[198:199]
    v_pk_add_f32 v[96:97], v[96:97], v[200:201]
    v_pk_add_f32 v[98:99], v[98:99], v[202:203]
    v_pk_add_f32 v[92:93], v[92:93], v[60:61]
    v_pk_add_f32 v[94:95], v[94:95], v[60:61]
    v_pk_add_f32 v[96:97], v[96:97], v[60:61]
    v_pk_add_f32 v[98:99], v[98:99], v[60:61]
    s_lshr_b32 s59, s45, 2
    s_add_u32 s59, s59, 1
    s_and_b32 s59, s59, 3
    s_lshl_b32 s59, s59, 18
    buffer_load_dword v38, v39, s[28:31], s59 offen
    v_cvt_pk_bf16_f32 v204, v68, v69
    v_cvt_pk_bf16_f32 v205, v70, v71
    v_cvt_pk_bf16_f32 v206, v72, v73
    v_cvt_pk_bf16_f32 v207, v74, v75
    v_cvt_pk_bf16_f32 v208, v76, v77
    v_cvt_pk_bf16_f32 v209, v78, v79
    v_cvt_pk_bf16_f32 v210, v80, v81
    v_cvt_pk_bf16_f32 v211, v82, v83
    v_cvt_pk_bf16_f32 v212, v84, v85
    v_cvt_pk_bf16_f32 v213, v86, v87
    v_cvt_pk_bf16_f32 v214, v88, v89
    v_cvt_pk_bf16_f32 v215, v90, v91
    v_cvt_pk_bf16_f32 v216, v92, v93
    v_cvt_pk_bf16_f32 v217, v94, v95
    v_cvt_pk_bf16_f32 v218, v96, v97
    v_cvt_pk_bf16_f32 v219, v98, v99
    v_accvgpr_write_b32 a128, v204
    v_accvgpr_write_b32 a129, v205
    v_accvgpr_write_b32 a130, v206
    v_accvgpr_write_b32 a131, v207
    v_accvgpr_write_b32 a132, v208
    v_accvgpr_write_b32 a133, v209
    v_accvgpr_write_b32 a134, v210
    v_accvgpr_write_b32 a135, v211
    v_accvgpr_write_b32 a136, v212
    v_accvgpr_write_b32 a137, v213
    v_accvgpr_write_b32 a138, v214
    v_accvgpr_write_b32 a139, v215
    v_accvgpr_write_b32 a140, v216
    v_accvgpr_write_b32 a141, v217
    v_accvgpr_write_b32 a142, v218
    v_accvgpr_write_b32 a143, v219
    ds_read_b64_tr_b16 v[132:133], v28 offset:16384
    ds_read_b64_tr_b16 v[134:135], v28 offset:17408
    ds_read_b64_tr_b16 v[136:137], v29 offset:16384
    ds_read_b64_tr_b16 v[138:139], v29 offset:17408
    ds_read_b64_tr_b16 v[140:141], v30 offset:16384
    ds_read_b64_tr_b16 v[142:143], v30 offset:17408
    ds_read_b64_tr_b16 v[144:145], v31 offset:16384
    ds_read_b64_tr_b16 v[146:147], v31 offset:17408
    s_waitcnt lgkmcnt(6)
    v_mfma_f32_16x16x32_bf16 v[68:71], v[132:135], a[0:3], 0
    ds_read_b64_tr_b16 v[148:149], v28 offset:20480
    v_mfma_f32_16x16x32_bf16 v[84:87], v[132:135], a[4:7], 0
    ds_read_b64_tr_b16 v[150:151], v28 offset:21504
    s_waitcnt lgkmcnt(6)
    v_mfma_f32_16x16x32_bf16 v[72:75], v[136:139], a[0:3], 0
    ds_read_b64_tr_b16 v[152:153], v29 offset:20480
    v_mfma_f32_16x16x32_bf16 v[88:91], v[136:139], a[4:7], 0
    ds_read_b64_tr_b16 v[154:155], v29 offset:21504
    s_waitcnt lgkmcnt(6)
    v_mfma_f32_16x16x32_bf16 v[76:79], v[140:143], a[0:3], 0
    ds_read_b64_tr_b16 v[156:157], v30 offset:20480
    v_mfma_f32_16x16x32_bf16 v[92:95], v[140:143], a[4:7], 0
    ds_read_b64_tr_b16 v[158:159], v30 offset:21504
    s_waitcnt lgkmcnt(6)
    v_mfma_f32_16x16x32_bf16 v[80:83], v[144:147], a[0:3], 0
    ds_read_b64_tr_b16 v[160:161], v31 offset:20480
    v_mfma_f32_16x16x32_bf16 v[96:99], v[144:147], a[4:7], 0
    ds_read_b64_tr_b16 v[162:163], v31 offset:21504
    s_waitcnt lgkmcnt(6)
    v_mfma_f32_16x16x32_bf16 v[68:71], v[148:151], a[8:11], v[68:71]
    ds_read_b64_tr_b16 v[132:133], v28 offset:24576
    v_mfma_f32_16x16x32_bf16 v[84:87], v[148:151], a[12:15], v[84:87]
    ds_read_b64_tr_b16 v[134:135], v28 offset:25600
    s_waitcnt lgkmcnt(6)
    v_mfma_f32_16x16x32_bf16 v[72:75], v[152:155], a[8:11], v[72:75]
    ds_read_b64_tr_b16 v[136:137], v29 offset:24576
    v_mfma_f32_16x16x32_bf16 v[88:91], v[152:155], a[12:15], v[88:91]
    ds_read_b64_tr_b16 v[138:139], v29 offset:25600
    s_waitcnt lgkmcnt(6)
    v_mfma_f32_16x16x32_bf16 v[76:79], v[156:159], a[8:11], v[76:79]
    ds_read_b64_tr_b16 v[140:141], v30 offset:24576
    v_mfma_f32_16x16x32_bf16 v[92:95], v[156:159], a[12:15], v[92:95]
    ds_read_b64_tr_b16 v[142:143], v30 offset:25600
    s_waitcnt lgkmcnt(6)
    v_mfma_f32_16x16x32_bf16 v[80:83], v[160:163], a[8:11], v[80:83]
    ds_read_b64_tr_b16 v[144:145], v31 offset:24576
    v_mfma_f32_16x16x32_bf16 v[96:99], v[160:163], a[12:15], v[96:99]
    ds_read_b64_tr_b16 v[146:147], v31 offset:25600
    s_waitcnt lgkmcnt(6)
    v_mfma_f32_16x16x32_bf16 v[68:71], v[132:135], a[16:19], v[68:71]
    ds_read_b64_tr_b16 v[148:149], v28 offset:28672
    v_mfma_f32_16x16x32_bf16 v[84:87], v[132:135], a[20:23], v[84:87]
    ds_read_b64_tr_b16 v[150:151], v28 offset:29696
    s_waitcnt lgkmcnt(6)
    v_mfma_f32_16x16x32_bf16 v[72:75], v[136:139], a[16:19], v[72:75]
    ds_read_b64_tr_b16 v[152:153], v29 offset:28672
    v_mfma_f32_16x16x32_bf16 v[88:91], v[136:139], a[20:23], v[88:91]
    ds_read_b64_tr_b16 v[154:155], v29 offset:29696
    s_waitcnt lgkmcnt(6)
    v_mfma_f32_16x16x32_bf16 v[76:79], v[140:143], a[16:19], v[76:79]
    ds_read_b64_tr_b16 v[156:157], v30 offset:28672
    v_mfma_f32_16x16x32_bf16 v[92:95], v[140:143], a[20:23], v[92:95]
    ds_read_b64_tr_b16 v[158:159], v30 offset:29696
    s_waitcnt lgkmcnt(6)
    v_mfma_f32_16x16x32_bf16 v[80:83], v[144:147], a[16:19], v[80:83]
    ds_read_b64_tr_b16 v[160:161], v31 offset:28672
    v_mfma_f32_16x16x32_bf16 v[96:99], v[144:147], a[20:23], v[96:99]
    ds_read_b64_tr_b16 v[162:163], v31 offset:29696
    s_waitcnt lgkmcnt(6)
    v_mfma_f32_16x16x32_bf16 v[68:71], v[148:151], a[24:27], v[68:71]
    ds_read_b64_tr_b16 v[132:133], v24 offset:49152
    v_mfma_f32_16x16x32_bf16 v[84:87], v[148:151], a[28:31], v[84:87]
    ds_read_b64_tr_b16 v[134:135], v24 offset:50176
    s_waitcnt lgkmcnt(6)
    v_mfma_f32_16x16x32_bf16 v[72:75], v[152:155], a[24:27], v[72:75]
    ds_read_b64_tr_b16 v[136:137], v25 offset:49152
    v_mfma_f32_16x16x32_bf16 v[88:91], v[152:155], a[28:31], v[88:91]
    ds_read_b64_tr_b16 v[138:139], v25 offset:50176
    s_waitcnt lgkmcnt(6)
    v_mfma_f32_16x16x32_bf16 v[76:79], v[156:159], a[24:27], v[76:79]
    ds_read_b64_tr_b16 v[140:141], v26 offset:49152
    v_mfma_f32_16x16x32_bf16 v[92:95], v[156:159], a[28:31], v[92:95]
    ds_read_b64_tr_b16 v[142:143], v26 offset:50176
    s_waitcnt lgkmcnt(6)
    v_mfma_f32_16x16x32_bf16 v[80:83], v[160:163], a[24:27], v[80:83]
    ds_read_b64_tr_b16 v[144:145], v27 offset:49152
    v_mfma_f32_16x16x32_bf16 v[96:99], v[160:163], a[28:31], v[96:99]
    ds_read_b64_tr_b16 v[146:147], v27 offset:50176
    s_waitcnt lgkmcnt(6)
    v_mfma_f32_16x16x32_bf16 v[68:71], v[132:135], a[32:35], v[68:71]
    ds_read_b64_tr_b16 v[148:149], v24 offset:53248
    s_lshr_b32 s59, s45, 2
    s_add_u32 s59, s59, 2
    s_and_b32 s59, s59, 3
    s_lshl_b32 s59, s59, 18
    buffer_load_dword v38, v39, s[28:31], s59 offen
    v_mfma_f32_16x16x32_bf16 v[84:87], v[132:135], a[36:39], v[84:87]
    ds_read_b64_tr_b16 v[150:151], v24 offset:54272
    s_waitcnt lgkmcnt(6)
    v_mfma_f32_16x16x32_bf16 v[72:75], v[136:139], a[32:35], v[72:75]
    ds_read_b64_tr_b16 v[152:153], v25 offset:53248
    v_mfma_f32_16x16x32_bf16 v[88:91], v[136:139], a[36:39], v[88:91]
    ds_read_b64_tr_b16 v[154:155], v25 offset:54272
    s_waitcnt lgkmcnt(6)
    v_mfma_f32_16x16x32_bf16 v[76:79], v[140:143], a[32:35], v[76:79]
    ds_read_b64_tr_b16 v[156:157], v26 offset:53248
    v_mfma_f32_16x16x32_bf16 v[92:95], v[140:143], a[36:39], v[92:95]
    ds_read_b64_tr_b16 v[158:159], v26 offset:54272
    s_waitcnt lgkmcnt(6)
H_S0_4:
    s_cbranch_execz H_S_0
    v_mfma_f32_16x16x32_bf16 v[80:83], v[144:147], a[32:35], v[80:83]
    ds_read_b64_tr_b16 v[160:161], v27 offset:53248
    v_mfma_f32_16x16x32_bf16 v[96:99], v[144:147], a[36:39], v[96:99]
    ds_read_b64_tr_b16 v[162:163], v27 offset:54272
    s_waitcnt lgkmcnt(6)
    v_mfma_f32_16x16x32_bf16 v[68:71], v[148:151], a[40:43], v[68:71]
    ds_read_b64_tr_b16 v[132:133], v24 offset:57344
    v_mfma_f32_16x16x32_bf16 v[84:87], v[148:151], a[44:47], v[84:87]
    ds_read_b64_tr_b16 v[134:135], v24 offset:58368
    s_waitcnt lgkmcnt(6)
    v_mfma_f32_16x16x32_bf16 v[72:75], v[152:155], a[40:43], v[72:75]
    ds_read_b64_tr_b16 v[136:137], v25 offset:57344
    v_mfma_f32_16x16x32_bf16 v[88:91], v[152:155], a[44:47], v[88:91]
    ds_read_b64_tr_b16 v[138:139], v25 offset:58368
    s_waitcnt lgkmcnt(6)
    v_mfma_f32_16x16x32_bf16 v[76:79], v[156:159], a[40:43], v[76:79]
    ds_read_b64_tr_b16 v[140:141], v26 offset:57344
    v_mfma_f32_16x16x32_bf16 v[92:95], v[156:159], a[44:47], v[92:95]
    ds_read_b64_tr_b16 v[142:143], v26 offset:58368
    s_waitcnt lgkmcnt(6)
    v_mfma_f32_16x16x32_bf16 v[80:83], v[160:163], a[40:43], v[80:83]
    ds_read_b64_tr_b16 v[144:145], v27 offset:57344
    v_mfma_f32_16x16x32_bf16 v[96:99], v[160:163], a[44:47], v[96:99]
    ds_read_b64_tr_b16 v[146:147], v27 offset:58368
    s_waitcnt lgkmcnt(6)
    v_mfma_f32_16x16x32_bf16 v[68:71], v[132:135], a[48:51], v[68:71]
    ds_read_b64_tr_b16 v[148:149], v24 offset:61440
    v_mfma_f32_16x16x32_bf16 v[84:87], v[132:135], a[52:55], v[84:87]
    ds_read_b64_tr_b16 v[150:151], v24 offset:62464
    s_waitcnt lgkmcnt(6)
    v_mfma_f32_16x16x32_bf16 v[72:75], v[136:139], a[48:51], v[72:75]
    ds_read_b64_tr_b16 v[152:153], v25 offset:61440
    v_mfma_f32_16x16x32_bf16 v[88:91], v[136:139], a[52:55], v[88:91]
    ds_read_b64_tr_b16 v[154:155], v25 offset:62464
    s_waitcnt lgkmcnt(6)
    v_mfma_f32_16x16x32_bf16 v[76:79], v[140:143], a[48:51], v[76:79]
    ds_read_b64_tr_b16 v[156:157], v26 offset:61440
    v_mfma_f32_16x16x32_bf16 v[92:95], v[140:143], a[52:55], v[92:95]
    ds_read_b64_tr_b16 v[158:159], v26 offset:62464
    s_waitcnt lgkmcnt(6)
    v_mfma_f32_16x16x32_bf16 v[80:83], v[144:147], a[48:51], v[80:83]
    ds_read_b64_tr_b16 v[160:161], v27 offset:61440
    v_mfma_f32_16x16x32_bf16 v[96:99], v[144:147], a[52:55], v[96:99]
    ds_read_b64_tr_b16 v[162:163], v27 offset:62464
    s_waitcnt lgkmcnt(6)
    v_mfma_f32_16x16x32_bf16 v[68:71], v[148:151], a[56:59], v[68:71]
    v_mfma_f32_16x16x32_bf16 v[84:87], v[148:151], a[60:63], v[84:87]
    s_waitcnt lgkmcnt(4)
    v_mfma_f32_16x16x32_bf16 v[72:75], v[152:155], a[56:59], v[72:75]
    v_mfma_f32_16x16x32_bf16 v[88:91], v[152:155], a[60:63], v[88:91]
    s_waitcnt lgkmcnt(0)
    s_barrier
    v_mfma_f32_16x16x32_bf16 v[76:79], v[156:159], a[56:59], v[76:79]
    ds_read_b64_tr_b16 v[132:133], v28 offset:49152
    ds_read_b64_tr_b16 v[134:135], v28 offset:50176
    v_mfma_f32_16x16x32_bf16 v[92:95], v[156:159], a[60:63], v[92:95]
    ds_read_b64_tr_b16 v[136:137], v29 offset:49152
    ds_read_b64_tr_b16 v[138:139], v29 offset:50176
    v_mfma_f32_16x16x32_bf16 v[80:83], v[160:163], a[56:59], v[80:83]
    ds_read_b64_tr_b16 v[140:141], v30 offset:49152
    ds_read_b64_tr_b16 v[142:143], v30 offset:50176
    v_mfma_f32_16x16x32_bf16 v[96:99], v[160:163], a[60:63], v[96:99]
    ds_read_b64_tr_b16 v[144:145], v31 offset:49152
    ds_read_b64_tr_b16 v[146:147], v31 offset:50176
    s_waitcnt lgkmcnt(6)
    v_mfma_f32_16x16x32_bf16 v[68:71], v[132:135], a[64:67], v[68:71]
    ds_read_b64_tr_b16 v[148:149], v28 offset:53248
    v_mfma_f32_16x16x32_bf16 v[84:87], v[132:135], a[68:71], v[84:87]
    ds_read_b64_tr_b16 v[150:151], v28 offset:54272
    s_waitcnt lgkmcnt(6)
    v_mfma_f32_16x16x32_bf16 v[72:75], v[136:139], a[64:67], v[72:75]
    ds_read_b64_tr_b16 v[152:153], v29 offset:53248
    v_mfma_f32_16x16x32_bf16 v[88:91], v[136:139], a[68:71], v[88:91]
    ds_read_b64_tr_b16 v[154:155], v29 offset:54272
    s_waitcnt lgkmcnt(6)
    v_mfma_f32_16x16x32_bf16 v[76:79], v[140:143], a[64:67], v[76:79]
    ds_read_b64_tr_b16 v[156:157], v30 offset:53248
    v_mfma_f32_16x16x32_bf16 v[92:95], v[140:143], a[68:71], v[92:95]
    ds_read_b64_tr_b16 v[158:159], v30 offset:54272
    s_waitcnt lgkmcnt(6)
    v_mfma_f32_16x16x32_bf16 v[80:83], v[144:147], a[64:67], v[80:83]
    ds_read_b64_tr_b16 v[160:161], v31 offset:53248
    v_mfma_f32_16x16x32_bf16 v[96:99], v[144:147], a[68:71], v[96:99]
    ds_read_b64_tr_b16 v[162:163], v31 offset:54272
    s_waitcnt lgkmcnt(6)
    v_mfma_f32_16x16x32_bf16 v[68:71], v[148:151], a[72:75], v[68:71]
    ds_read_b64_tr_b16 v[132:133], v28 offset:57344
    v_mfma_f32_16x16x32_bf16 v[84:87], v[148:151], a[76:79], v[84:87]
    ds_read_b64_tr_b16 v[134:135], v28 offset:58368
    s_waitcnt lgkmcnt(6)
    v_mfma_f32_16x16x32_bf16 v[72:75], v[152:155], a[72:75], v[72:75]
    ds_read_b64_tr_b16 v[136:137], v29 offset:57344
    v_mfma_f32_16x16x32_bf16 v[88:91], v[152:155], a[76:79], v[88:91]
    ds_read_b64_tr_b16 v[138:139], v29 offset:58368
    s_waitcnt lgkmcnt(6)
    v_mfma_f32_16x16x32_bf16 v[76:79], v[156:159], a[72:75], v[76:79]
    ds_read_b64_tr_b16 v[140:141], v30 offset:57344
    s_lshr_b32 s59, s45, 2
    s_add_u32 s59, s59, 3
    s_and_b32 s59, s59, 3
    s_lshl_b32 s59, s59, 18
    buffer_load_dword v38, v39, s[28:31], s59 offen
    v_mfma_f32_16x16x32_bf16 v[92:95], v[156:159], a[76:79], v[92:95]
    ds_read_b64_tr_b16 v[142:143], v30 offset:58368
    s_waitcnt lgkmcnt(6)
    v_mfma_f32_16x16x32_bf16 v[80:83], v[160:163], a[72:75], v[80:83]
    ds_read_b64_tr_b16 v[144:145], v31 offset:57344
    v_mfma_f32_16x16x32_bf16 v[96:99], v[160:163], a[76:79], v[96:99]
    ds_read_b64_tr_b16 v[146:147], v31 offset:58368
    s_waitcnt lgkmcnt(6)
    v_mfma_f32_16x16x32_bf16 v[68:71], v[132:135], a[80:83], v[68:71]
    ds_read_b64_tr_b16 v[148:149], v28 offset:61440
    v_mfma_f32_16x16x32_bf16 v[84:87], v[132:135], a[84:87], v[84:87]
    ds_read_b64_tr_b16 v[150:151], v28 offset:62464
    s_waitcnt lgkmcnt(6)
    v_mfma_f32_16x16x32_bf16 v[72:75], v[136:139], a[80:83], v[72:75]
    ds_read_b64_tr_b16 v[152:153], v29 offset:61440
    v_mfma_f32_16x16x32_bf16 v[88:91], v[136:139], a[84:87], v[88:91]
    ds_read_b64_tr_b16 v[154:155], v29 offset:62464
    s_waitcnt lgkmcnt(6)
    v_mfma_f32_16x16x32_bf16 v[76:79], v[140:143], a[80:83], v[76:79]
    ds_read_b64_tr_b16 v[156:157], v30 offset:61440
    v_mfma_f32_16x16x32_bf16 v[92:95], v[140:143], a[84:87], v[92:95]
    ds_read_b64_tr_b16 v[158:159], v30 offset:62464
    s_waitcnt lgkmcnt(6)
    v_mfma_f32_16x16x32_bf16 v[80:83], v[144:147], a[80:83], v[80:83]
    ds_read_b64_tr_b16 v[160:161], v31 offset:61440
    v_mfma_f32_16x16x32_bf16 v[96:99], v[144:147], a[84:87], v[96:99]
    ds_read_b64_tr_b16 v[162:163], v31 offset:62464
    s_waitcnt lgkmcnt(6)
    v_mfma_f32_16x16x32_bf16 v[68:71], v[148:151], a[88:91], v[68:71]
    ds_read_b64_tr_b16 v[132:133], v24 offset:0
    v_mfma_f32_16x16x32_bf16 v[84:87], v[148:151], a[92:95], v[84:87]
    ds_read_b64_tr_b16 v[134:135], v24 offset:1024
    s_waitcnt lgkmcnt(6)
    v_mfma_f32_16x16x32_bf16 v[72:75], v[152:155], a[88:91], v[72:75]
    ds_read_b64_tr_b16 v[136:137], v25 offset:0
    v_mfma_f32_16x16x32_bf16 v[88:91], v[152:155], a[92:95], v[88:91]
    ds_read_b64_tr_b16 v[138:139], v25 offset:1024
    s_waitcnt lgkmcnt(6)
    v_mfma_f32_16x16x32_bf16 v[76:79], v[156:159], a[88:91], v[76:79]
    ds_read_b64_tr_b16 v[140:141], v26 offset:0
    v_mfma_f32_16x16x32_bf16 v[92:95], v[156:159], a[92:95], v[92:95]
    ds_read_b64_tr_b16 v[142:143], v26 offset:1024
    s_waitcnt lgkmcnt(6)
    v_mfma_f32_16x16x32_bf16 v[80:83], v[160:163], a[88:91], v[80:83]
    ds_read_b64_tr_b16 v[144:145], v27 offset:0
    v_mfma_f32_16x16x32_bf16 v[96:99], v[160:163], a[92:95], v[96:99]
    ds_read_b64_tr_b16 v[146:147], v27 offset:1024
    s_waitcnt lgkmcnt(6)
    v_mfma_f32_16x16x32_bf16 v[68:71], v[132:135], a[96:99], v[68:71]
    ds_read_b64_tr_b16 v[148:149], v24 offset:4096
    v_mfma_f32_16x16x32_bf16 v[84:87], v[132:135], a[100:103], v[84:87]
    ds_read_b64_tr_b16 v[150:151], v24 offset:5120
    s_waitcnt lgkmcnt(6)
    v_mfma_f32_16x16x32_bf16 v[72:75], v[136:139], a[96:99], v[72:75]
    ds_read_b64_tr_b16 v[152:153], v25 offset:4096
    v_mfma_f32_16x16x32_bf16 v[88:91], v[136:139], a[100:103], v[88:91]
    ds_read_b64_tr_b16 v[154:155], v25 offset:5120
    s_waitcnt lgkmcnt(6)
    v_mfma_f32_16x16x32_bf16 v[76:79], v[140:143], a[96:99], v[76:79]
    ds_read_b64_tr_b16 v[156:157], v26 offset:4096
    v_mfma_f32_16x16x32_bf16 v[92:95], v[140:143], a[100:103], v[92:95]
    ds_read_b64_tr_b16 v[158:159], v26 offset:5120
    s_waitcnt lgkmcnt(6)
    v_mfma_f32_16x16x32_bf16 v[80:83], v[144:147], a[96:99], v[80:83]
    ds_read_b64_tr_b16 v[160:161], v27 offset:4096
    v_mfma_f32_16x16x32_bf16 v[96:99], v[144:147], a[100:103], v[96:99]
    ds_read_b64_tr_b16 v[162:163], v27 offset:5120
    s_waitcnt lgkmcnt(6)
    v_mfma_f32_16x16x32_bf16 v[68:71], v[148:151], a[104:107], v[68:71]
    ds_read_b64_tr_b16 v[132:133], v24 offset:8192
    v_mfma_f32_16x16x32_bf16 v[84:87], v[148:151], a[108:111], v[84:87]
    ds_read_b64_tr_b16 v[134:135], v24 offset:9216
    s_waitcnt lgkmcnt(6)
    v_mfma_f32_16x16x32_bf16 v[72:75], v[152:155], a[104:107], v[72:75]
    ds_read_b64_tr_b16 v[136:137], v25 offset:8192
    v_mfma_f32_16x16x32_bf16 v[88:91], v[152:155], a[108:111], v[88:91]
    ds_read_b64_tr_b16 v[138:139], v25 offset:9216
    s_waitcnt lgkmcnt(6)
    v_mfma_f32_16x16x32_bf16 v[76:79], v[156:159], a[104:107], v[76:79]
    ds_read_b64_tr_b16 v[140:141], v26 offset:8192
    v_mfma_f32_16x16x32_bf16 v[92:95], v[156:159], a[108:111], v[92:95]
    ds_read_b64_tr_b16 v[142:143], v26 offset:9216
    s_waitcnt lgkmcnt(6)
    v_mfma_f32_16x16x32_bf16 v[80:83], v[160:163], a[104:107], v[80:83]
    ds_read_b64_tr_b16 v[144:145], v27 offset:8192
    v_mfma_f32_16x16x32_bf16 v[96:99], v[160:163], a[108:111], v[96:99]
    ds_read_b64_tr_b16 v[146:147], v27 offset:9216
    s_waitcnt lgkmcnt(6)
    v_mfma_f32_16x16x32_bf16 v[68:71], v[132:135], a[112:115], v[68:71]
    ds_read_b64_tr_b16 v[148:149], v24 offset:12288
    v_mfma_f32_16x16x32_bf16 v[84:87], v[132:135], a[116:119], v[84:87]
    ds_read_b64_tr_b16 v[150:151], v24 offset:13312
    s_waitcnt lgkmcnt(6)
    v_mfma_f32_16x16x32_bf16 v[72:75], v[136:139], a[112:115], v[72:75]
    ds_read_b64_tr_b16 v[152:153], v25 offset:12288
    v_mfma_f32_16x16x32_bf16 v[88:91], v[136:139], a[116:119], v[88:91]
    ds_read_b64_tr_b16 v[154:155], v25 offset:13312
    s_waitcnt lgkmcnt(6)
    v_mfma_f32_16x16x32_bf16 v[76:79], v[140:143], a[112:115], v[76:79]
    ds_read_b64_tr_b16 v[156:157], v26 offset:12288
    v_mfma_f32_16x16x32_bf16 v[92:95], v[140:143], a[116:119], v[92:95]
    ds_read_b64_tr_b16 v[158:159], v26 offset:13312
    s_waitcnt lgkmcnt(6)
    v_mfma_f32_16x16x32_bf16 v[80:83], v[144:147], a[112:115], v[80:83]
    ds_read_b64_tr_b16 v[160:161], v27 offset:12288
    v_mfma_f32_16x16x32_bf16 v[96:99], v[144:147], a[116:119], v[96:99]
    ds_read_b64_tr_b16 v[162:163], v27 offset:13312
    s_waitcnt lgkmcnt(6)
    v_mfma_f32_16x16x32_bf16 v[68:71], v[148:151], a[120:123], v[68:71]
    v_mfma_f32_16x16x32_bf16 v[84:87], v[148:151], a[124:127], v[84:87]
    s_lshr_b32 s59, s45, 2
    s_add_u32 s59, s59, 0
    s_and_b32 s59, s59, 1
    s_lshl_b32 s59, s59, 18
    buffer_load_dword v38, v39, s[12:15], s59 offen
    s_waitcnt lgkmcnt(4)
    v_mfma_f32_16x16x32_bf16 v[72:75], v[152:155], a[120:123], v[72:75]
    v_mfma_f32_16x16x32_bf16 v[88:91], v[152:155], a[124:127], v[88:91]
    s_waitcnt lgkmcnt(0)
    s_barrier
    v_mfma_f32_16x16x32_bf16 v[76:79], v[156:159], a[120:123], v[76:79]
    v_mfma_f32_16x16x32_bf16 v[92:95], v[156:159], a[124:127], v[92:95]
    v_mfma_f32_16x16x32_bf16 v[80:83], v[160:163], a[120:123], v[80:83]
    v_mfma_f32_16x16x32_bf16 v[96:99], v[160:163], a[124:127], v[96:99]
    v_pk_mul_f32 v[196:197], v[68:69], v[58:59]
    v_pk_mul_f32 v[198:199], v[70:71], v[58:59]
    v_pk_mul_f32 v[200:201], v[72:73], v[58:59]
    v_pk_mul_f32 v[202:203], v[74:75], v[58:59]
    v_exp_f32_e64 v196, v196 clamp
    v_exp_f32_e64 v197, v197 clamp
    v_exp_f32_e64 v198, v198 clamp
    v_exp_f32_e64 v199, v199 clamp
    v_exp_f32_e64 v200, v200 clamp
    v_exp_f32_e64 v201, v201 clamp
    v_exp_f32_e64 v202, v202 clamp
    v_exp_f32_e64 v203, v203 clamp
    v_max_f32 v68, 0, v68
    v_max_f32 v69, 0, v69
    v_max_f32 v70, 0, v70
    v_max_f32 v71, 0, v71
    v_max_f32 v72, 0, v72
    v_max_f32 v73, 0, v73
    v_max_f32 v74, 0, v74
    v_max_f32 v75, 0, v75
    v_pk_add_f32 v[68:69], v[68:69], v[196:197]
    v_pk_add_f32 v[70:71], v[70:71], v[198:199]
    v_pk_add_f32 v[72:73], v[72:73], v[200:201]
    v_pk_add_f32 v[74:75], v[74:75], v[202:203]
    v_pk_add_f32 v[68:69], v[68:69], v[60:61]
    v_pk_add_f32 v[70:71], v[70:71], v[60:61]
    v_pk_add_f32 v[72:73], v[72:73], v[60:61]
    v_pk_add_f32 v[74:75], v[74:75], v[60:61]
    v_pk_mul_f32 v[196:197], v[76:77], v[58:59]
    v_pk_mul_f32 v[198:199], v[78:79], v[58:59]
    v_pk_mul_f32 v[200:201], v[80:81], v[58:59]
    v_pk_mul_f32 v[202:203], v[82:83], v[58:59]
    v_exp_f32_e64 v196, v196 clamp
    v_exp_f32_e64 v197, v197 clamp
    v_exp_f32_e64 v198, v198 clamp
    v_exp_f32_e64 v199, v199 clamp
    v_exp_f32_e64 v200, v200 clamp
    v_exp_f32_e64 v201, v201 clamp
    v_exp_f32_e64 v202, v202 clamp
    v_exp_f32_e64 v203, v203 clamp
    v_max_f32 v76, 0, v76
    v_max_f32 v77, 0, v77
    v_max_f32 v78, 0, v78
    v_max_f32 v79, 0, v79
    v_max_f32 v80, 0, v80
    v_max_f32 v81, 0, v81
    v_max_f32 v82, 0, v82
    v_max_f32 v83, 0, v83
    v_pk_add_f32 v[76:77], v[76:77], v[196:197]
    v_pk_add_f32 v[78:79], v[78:79], v[198:199]
    v_pk_add_f32 v[80:81], v[80:81], v[200:201]
    v_pk_add_f32 v[82:83], v[82:83], v[202:203]
    v_pk_add_f32 v[76:77], v[76:77], v[60:61]
    v_pk_add_f32 v[78:79], v[78:79], v[60:61]
    v_pk_add_f32 v[80:81], v[80:81], v[60:61]
    v_pk_add_f32 v[82:83], v[82:83], v[60:61]
    v_pk_mul_f32 v[196:197], v[84:85], v[58:59]
    v_pk_mul_f32 v[198:199], v[86:87], v[58:59]
    v_pk_mul_f32 v[200:201], v[88:89], v[58:59]
    v_pk_mul_f32 v[202:203], v[90:91], v[58:59]
    v_exp_f32_e64 v196, v196 clamp
    v_exp_f32_e64 v197, v197 clamp
    v_exp_f32_e64 v198, v198 clamp
    v_exp_f32_e64 v199, v199 clamp
    v_exp_f32_e64 v200, v200 clamp
    v_exp_f32_e64 v201, v201 clamp
    v_exp_f32_e64 v202, v202 clamp
    v_exp_f32_e64 v203, v203 clamp
    v_max_f32 v84, 0, v84
    v_max_f32 v85, 0, v85
    v_max_f32 v86, 0, v86
    v_max_f32 v87, 0, v87
    v_max_f32 v88, 0, v88
    v_max_f32 v89, 0, v89
    v_max_f32 v90, 0, v90
    v_max_f32 v91, 0, v91
    v_pk_add_f32 v[84:85], v[84:85], v[196:197]
    v_pk_add_f32 v[86:87], v[86:87], v[198:199]
    v_pk_add_f32 v[88:89], v[88:89], v[200:201]
    v_pk_add_f32 v[90:91], v[90:91], v[202:203]
    v_pk_add_f32 v[84:85], v[84:85], v[60:61]
    v_pk_add_f32 v[86:87], v[86:87], v[60:61]
    v_pk_add_f32 v[88:89], v[88:89], v[60:61]
    v_pk_add_f32 v[90:91], v[90:91], v[60:61]
    v_pk_mul_f32 v[196:197], v[92:93], v[58:59]
    v_pk_mul_f32 v[198:199], v[94:95], v[58:59]
    v_pk_mul_f32 v[200:201], v[96:97], v[58:59]
    v_pk_mul_f32 v[202:203], v[98:99], v[58:59]
    v_exp_f32_e64 v196, v196 clamp
    v_exp_f32_e64 v197, v197 clamp
    v_exp_f32_e64 v198, v198 clamp
    v_exp_f32_e64 v199, v199 clamp
    v_exp_f32_e64 v200, v200 clamp
    v_exp_f32_e64 v201, v201 clamp
    v_exp_f32_e64 v202, v202 clamp
    v_exp_f32_e64 v203, v203 clamp
    v_max_f32 v92, 0, v92
    v_max_f32 v93, 0, v93
    v_max_f32 v94, 0, v94
    v_max_f32 v95, 0, v95
    v_max_f32 v96, 0, v96
    v_max_f32 v97, 0, v97
    v_max_f32 v98, 0, v98
    v_max_f32 v99, 0, v99
    v_pk_add_f32 v[92:93], v[92:93], v[196:197]
    v_pk_add_f32 v[94:95], v[94:95], v[198:199]
    v_pk_add_f32 v[96:97], v[96:97], v[200:201]
    v_pk_add_f32 v[98:99], v[98:99], v[202:203]
    v_pk_add_f32 v[92:93], v[92:93], v[60:61]
    v_pk_add_f32 v[94:95], v[94:95], v[60:61]
    v_pk_add_f32 v[96:97], v[96:97], v[60:61]
    v_pk_add_f32 v[98:99], v[98:99], v[60:61]
    v_cvt_pk_bf16_f32 v204, v68, v69
    v_cvt_pk_bf16_f32 v205, v70, v71
    v_cvt_pk_bf16_f32 v206, v72, v73
    v_cvt_pk_bf16_f32 v207, v74, v75
    v_cvt_pk_bf16_f32 v208, v76, v77
    v_cvt_pk_bf16_f32 v209, v78, v79
    v_cvt_pk_bf16_f32 v210, v80, v81
    v_cvt_pk_bf16_f32 v211, v82, v83
    v_cvt_pk_bf16_f32 v212, v84, v85
    v_cvt_pk_bf16_f32 v213, v86, v87
    v_cvt_pk_bf16_f32 v214, v88, v89
    v_cvt_pk_bf16_f32 v215, v90, v91
    v_cvt_pk_bf16_f32 v216, v92, v93
    v_cvt_pk_bf16_f32 v217, v94, v95
    v_cvt_pk_bf16_f32 v218, v96, v97
    v_cvt_pk_bf16_f32 v219, v98, v99
    v_accvgpr_write_b32 a144, v204
    v_accvgpr_write_b32 a145, v205
    v_accvgpr_write_b32 a146, v206
    v_accvgpr_write_b32 a147, v207
    v_accvgpr_write_b32 a148, v208
    v_accvgpr_write_b32 a149, v209
    v_accvgpr_write_b32 a150, v210
    v_accvgpr_write_b32 a151, v211
    v_accvgpr_write_b32 a152, v212
    v_accvgpr_write_b32 a153, v213
    v_accvgpr_write_b32 a154, v214
    v_accvgpr_write_b32 a155, v215
    v_accvgpr_write_b32 a156, v216
    v_accvgpr_write_b32 a157, v217
    v_accvgpr_write_b32 a158, v218
    v_accvgpr_write_b32 a159, v219
    s_waitcnt vmcnt(18)
    s_barrier
    ds_read_b64_tr_b16 v[132:133], v28 offset:32768
    ds_read_b64_tr_b16 v[134:135], v28 offset:33792
    ds_read_b64_tr_b16 v[136:137], v29 offset:32768
    ds_read_b64_tr_b16 v[138:139], v29 offset:33792
    ds_read_b64_tr_b16 v[140:141], v30 offset:32768
    ds_read_b64_tr_b16 v[142:143], v30 offset:33792
    ds_read_b64_tr_b16 v[144:145], v31 offset:32768
    ds_read_b64_tr_b16 v[146:147], v31 offset:33792
    s_waitcnt lgkmcnt(6)
    v_mfma_f32_16x16x32_bf16 v[68:71], v[132:135], a[0:3], 0
    ds_read_b64_tr_b16 v[148:149], v28 offset:36864
    s_lshr_b32 s59, s45, 2
    s_add_u32 s59, s59, 1
    s_and_b32 s59, s59, 1
    s_lshl_b32 s59, s59, 18
    buffer_load_dword v38, v39, s[12:15], s59 offen
    v_mfma_f32_16x16x32_bf16 v[84:87], v[132:135], a[4:7], 0
    ds_read_b64_tr_b16 v[150:151], v28 offset:37888
    s_waitcnt lgkmcnt(6)
    v_mfma_f32_16x16x32_bf16 v[72:75], v[136:139], a[0:3], 0
    ds_read_b64_tr_b16 v[152:153], v29 offset:36864
    v_mfma_f32_16x16x32_bf16 v[88:91], v[136:139], a[4:7], 0
    ds_read_b64_tr_b16 v[154:155], v29 offset:37888
    s_waitcnt lgkmcnt(6)
    v_mfma_f32_16x16x32_bf16 v[76:79], v[140:143], a[0:3], 0
    ds_read_b64_tr_b16 v[156:157], v30 offset:36864
    v_mfma_f32_16x16x32_bf16 v[92:95], v[140:143], a[4:7], 0
    ds_read_b64_tr_b16 v[158:159], v30 offset:37888
    s_waitcnt lgkmcnt(6)
    v_mfma_f32_16x16x32_bf16 v[80:83], v[144:147], a[0:3], 0
    ds_read_b64_tr_b16 v[160:161], v31 offset:36864
    v_mfma_f32_16x16x32_bf16 v[96:99], v[144:147], a[4:7], 0
    ds_read_b64_tr_b16 v[162:163], v31 offset:37888
    s_waitcnt lgkmcnt(6)
    v_mfma_f32_16x16x32_bf16 v[68:71], v[148:151], a[8:11], v[68:71]
    ds_read_b64_tr_b16 v[132:133], v28 offset:40960
    v_mfma_f32_16x16x32_bf16 v[84:87], v[148:151], a[12:15], v[84:87]
    ds_read_b64_tr_b16 v[134:135], v28 offset:41984
    s_waitcnt lgkmcnt(6)
    v_mfma_f32_16x16x32_bf16 v[72:75], v[152:155], a[8:11], v[72:75]
    ds_read_b64_tr_b16 v[136:137], v29 offset:40960
    v_mfma_f32_16x16x32_bf16 v[88:91], v[152:155], a[12:15], v[88:91]
    ds_read_b64_tr_b16 v[138:139], v29 offset:41984
    s_waitcnt lgkmcnt(6)
    v_mfma_f32_16x16x32_bf16 v[76:79], v[156:159], a[8:11], v[76:79]
    ds_read_b64_tr_b16 v[140:141], v30 offset:40960
    v_mfma_f32_16x16x32_bf16 v[92:95], v[156:159], a[12:15], v[92:95]
    ds_read_b64_tr_b16 v[142:143], v30 offset:41984
    s_waitcnt lgkmcnt(6)
    v_mfma_f32_16x16x32_bf16 v[80:83], v[160:163], a[8:11], v[80:83]
    ds_read_b64_tr_b16 v[144:145], v31 offset:40960
    v_mfma_f32_16x16x32_bf16 v[96:99], v[160:163], a[12:15], v[96:99]
    ds_read_b64_tr_b16 v[146:147], v31 offset:41984
    s_lshr_b32 s59, s0, 6
    s_and_b32 s60, s59, 2
    s_and_b32 s59, s59, 12
    v_xor_b32 v240, s60, v2
    v_add_u32 v240, s59, v240
    v_and_b32 v240, 15, v240
    v_lshl_add_u32 v240, v240, 2, v3
    v_lshlrev_b32 v240, 4, v240
    buffer_load_dwordx4 v[228:231], v240, s[32:35], 0 offen
    s_waitcnt lgkmcnt(6)
    v_mfma_f32_16x16x32_bf16 v[68:71], v[132:135], a[16:19], v[68:71]
    ds_read_b64_tr_b16 v[148:149], v28 offset:45056
    v_mfma_f32_16x16x32_bf16 v[84:87], v[132:135], a[20:23], v[84:87]
    ds_read_b64_tr_b16 v[150:151], v28 offset:46080
    s_waitcnt lgkmcnt(6)
    v_mfma_f32_16x16x32_bf16 v[72:75], v[136:139], a[16:19], v[72:75]
    ds_read_b64_tr_b16 v[152:153], v29 offset:45056
    v_mfma_f32_16x16x32_bf16 v[88:91], v[136:139], a[20:23], v[88:91]
    ds_read_b64_tr_b16 v[154:155], v29 offset:46080
    s_waitcnt lgkmcnt(6)
    v_mfma_f32_16x16x32_bf16 v[76:79], v[140:143], a[16:19], v[76:79]
    ds_read_b64_tr_b16 v[156:157], v30 offset:45056
    v_mfma_f32_16x16x32_bf16 v[92:95], v[140:143], a[20:23], v[92:95]
    ds_read_b64_tr_b16 v[158:159], v30 offset:46080
    s_waitcnt lgkmcnt(6)
    v_mfma_f32_16x16x32_bf16 v[80:83], v[144:147], a[16:19], v[80:83]
    ds_read_b64_tr_b16 v[160:161], v31 offset:45056
    v_mfma_f32_16x16x32_bf16 v[96:99], v[144:147], a[20:23], v[96:99]
    ds_read_b64_tr_b16 v[162:163], v31 offset:46080
    s_waitcnt lgkmcnt(6)
    v_mfma_f32_16x16x32_bf16 v[68:71], v[148:151], a[24:27], v[68:71]
    v_mfma_f32_16x16x32_bf16 v[84:87], v[148:151], a[28:31], v[84:87]
    s_waitcnt lgkmcnt(4)
    v_mfma_f32_16x16x32_bf16 v[72:75], v[152:155], a[24:27], v[72:75]
    v_mfma_f32_16x16x32_bf16 v[88:91], v[152:155], a[28:31], v[88:91]
    s_waitcnt vmcnt(16) lgkmcnt(0)
    s_barrier
    v_mfma_f32_16x16x32_bf16 v[76:79], v[156:159], a[24:27], v[76:79]
    ds_read_b64_tr_b16 v[132:133], v24 offset:16384
    ds_read_b64_tr_b16 v[134:135], v24 offset:17408
    v_mfma_f32_16x16x32_bf16 v[92:95], v[156:159], a[28:31], v[92:95]
    ds_read_b64_tr_b16 v[136:137], v25 offset:16384
    ds_read_b64_tr_b16 v[138:139], v25 offset:17408
    v_mfma_f32_16x16x32_bf16 v[80:83], v[160:163], a[24:27], v[80:83]
    ds_read_b64_tr_b16 v[140:141], v26 offset:16384
    ds_read_b64_tr_b16 v[142:143], v26 offset:17408
    v_mfma_f32_16x16x32_bf16 v[96:99], v[160:163], a[28:31], v[96:99]
    ds_read_b64_tr_b16 v[144:145], v27 offset:16384
    ds_read_b64_tr_b16 v[146:147], v27 offset:17408
    s_waitcnt lgkmcnt(6)
    v_mfma_f32_16x16x32_bf16 v[68:71], v[132:135], a[32:35], v[68:71]
    ds_read_b64_tr_b16 v[148:149], v24 offset:20480
    v_mfma_f32_16x16x32_bf16 v[84:87], v[132:135], a[36:39], v[84:87]
    ds_read_b64_tr_b16 v[150:151], v24 offset:21504
    s_waitcnt lgkmcnt(6)
    v_mfma_f32_16x16x32_bf16 v[72:75], v[136:139], a[32:35], v[72:75]
    ds_read_b64_tr_b16 v[152:153], v25 offset:20480
    v_mfma_f32_16x16x32_bf16 v[88:91], v[136:139], a[36:39], v[88:91]
    ds_read_b64_tr_b16 v[154:155], v25 offset:21504
    s_waitcnt lgkmcnt(6)
    v_mfma_f32_16x16x32_bf16 v[76:79], v[140:143], a[32:35], v[76:79]
    ds_read_b64_tr_b16 v[156:157], v26 offset:20480
    v_mfma_f32_16x16x32_bf16 v[92:95], v[140:143], a[36:39], v[92:95]
    ds_read_b64_tr_b16 v[158:159], v26 offset:21504
    s_waitcnt lgkmcnt(6)
    v_mfma_f32_16x16x32_bf16 v[80:83], v[144:147], a[32:35], v[80:83]
    ds_read_b64_tr_b16 v[160:161], v27 offset:20480
    v_mfma_f32_16x16x32_bf16 v[96:99], v[144:147], a[36:39], v[96:99]
    ds_read_b64_tr_b16 v[162:163], v27 offset:21504
    s_waitcnt lgkmcnt(6)
    v_mfma_f32_16x16x32_bf16 v[68:71], v[148:151], a[40:43], v[68:71]
    ds_read_b64_tr_b16 v[132:133], v24 offset:24576
    v_mfma_f32_16x16x32_bf16 v[84:87], v[148:151], a[44:47], v[84:87]
    ds_read_b64_tr_b16 v[134:135], v24 offset:25600
    s_waitcnt lgkmcnt(6)
    v_mfma_f32_16x16x32_bf16 v[72:75], v[152:155], a[40:43], v[72:75]
    ds_read_b64_tr_b16 v[136:137], v25 offset:24576
    v_mfma_f32_16x16x32_bf16 v[88:91], v[152:155], a[44:47], v[88:91]
    ds_read_b64_tr_b16 v[138:139], v25 offset:25600
    s_waitcnt lgkmcnt(6)
    v_mfma_f32_16x16x32_bf16 v[76:79], v[156:159], a[40:43], v[76:79]
    ds_read_b64_tr_b16 v[140:141], v26 offset:24576
    v_mfma_f32_16x16x32_bf16 v[92:95], v[156:159], a[44:47], v[92:95]
    ds_read_b64_tr_b16 v[142:143], v26 offset:25600
    s_waitcnt lgkmcnt(6)
    v_mfma_f32_16x16x32_bf16 v[80:83], v[160:163], a[40:43], v[80:83]
    ds_read_b64_tr_b16 v[144:145], v27 offset:24576
    v_mfma_f32_16x16x32_bf16 v[96:99], v[160:163], a[44:47], v[96:99]
    ds_read_b64_tr_b16 v[146:147], v27 offset:25600
    s_waitcnt lgkmcnt(6)
    v_mfma_f32_16x16x32_bf16 v[68:71], v[132:135], a[48:51], v[68:71]
    ds_read_b64_tr_b16 v[148:149], v24 offset:28672
    v_mfma_f32_16x16x32_bf16 v[84:87], v[132:135], a[52:55], v[84:87]
    ds_read_b64_tr_b16 v[150:151], v24 offset:29696
    s_waitcnt lgkmcnt(6)
    v_mfma_f32_16x16x32_bf16 v[72:75], v[136:139], a[48:51], v[72:75]
    ds_read_b64_tr_b16 v[152:153], v25 offset:28672
    v_mfma_f32_16x16x32_bf16 v[88:91], v[136:139], a[52:55], v[88:91]
    ds_read_b64_tr_b16 v[154:155], v25 offset:29696
    s_waitcnt lgkmcnt(6)
    v_mfma_f32_16x16x32_bf16 v[76:79], v[140:143], a[48:51], v[76:79]
    ds_read_b64_tr_b16 v[156:157], v26 offset:28672
    v_mfma_f32_16x16x32_bf16 v[92:95], v[140:143], a[52:55], v[92:95]
    ds_read_b64_tr_b16 v[158:159], v26 offset:29696
    s_waitcnt lgkmcnt(6)
    v_mfma_f32_16x16x32_bf16 v[80:83], v[144:147], a[48:51], v[80:83]
    ds_read_b64_tr_b16 v[160:161], v27 offset:28672
    v_mfma_f32_16x16x32_bf16 v[96:99], v[144:147], a[52:55], v[96:99]
    ds_read_b64_tr_b16 v[162:163], v27 offset:29696
    s_waitcnt lgkmcnt(6)
    v_mfma_f32_16x16x32_bf16 v[68:71], v[148:151], a[56:59], v[68:71]
    v_mfma_f32_16x16x32_bf16 v[84:87], v[148:151], a[60:63], v[84:87]
    s_waitcnt lgkmcnt(4)
    v_mfma_f32_16x16x32_bf16 v[72:75], v[152:155], a[56:59], v[72:75]
    v_mfma_f32_16x16x32_bf16 v[88:91], v[152:155], a[60:63], v[88:91]
    s_waitcnt vmcnt(11) lgkmcnt(0)
    s_barrier
    v_mfma_f32_16x16x32_bf16 v[76:79], v[156:159], a[56:59], v[76:79]
    ds_read_b64_tr_b16 v[132:133], v28 offset:0
    ds_read_b64_tr_b16 v[134:135], v28 offset:1024
    v_mfma_f32_16x16x32_bf16 v[92:95], v[156:159], a[60:63], v[92:95]
    ds_read_b64_tr_b16 v[136:137], v29 offset:0
    ds_read_b64_tr_b16 v[138:139], v29 offset:1024
    v_mfma_f32_16x16x32_bf16 v[80:83], v[160:163], a[56:59], v[80:83]
    ds_read_b64_tr_b16 v[140:141], v30 offset:0
    ds_read_b64_tr_b16 v[142:143], v30 offset:1024
    v_mfma_f32_16x16x32_bf16 v[96:99], v[160:163], a[60:63], v[96:99]
    ds_read_b64_tr_b16 v[144:145], v31 offset:0
    ds_read_b64_tr_b16 v[146:147], v31 offset:1024
    s_waitcnt lgkmcnt(6)
    v_mfma_f32_16x16x32_bf16 v[68:71], v[132:135], a[64:67], v[68:71]
    ds_read_b64_tr_b16 v[148:149], v28 offset:4096
    v_mfma_f32_16x16x32_bf16 v[84:87], v[132:135], a[68:71], v[84:87]
    ds_read_b64_tr_b16 v[150:151], v28 offset:5120
    s_waitcnt lgkmcnt(6)
    v_mfma_f32_16x16x32_bf16 v[72:75], v[136:139], a[64:67], v[72:75]
    ds_read_b64_tr_b16 v[152:153], v29 offset:4096
    v_mfma_f32_16x16x32_bf16 v[88:91], v[136:139], a[68:71], v[88:91]
    ds_read_b64_tr_b16 v[154:155], v29 offset:5120
    s_waitcnt lgkmcnt(6)
    v_mfma_f32_16x16x32_bf16 v[76:79], v[140:143], a[64:67], v[76:79]
    ds_read_b64_tr_b16 v[156:157], v30 offset:4096
    v_mfma_f32_16x16x32_bf16 v[92:95], v[140:143], a[68:71], v[92:95]
    ds_read_b64_tr_b16 v[158:159], v30 offset:5120
    s_waitcnt lgkmcnt(6)
    v_mfma_f32_16x16x32_bf16 v[80:83], v[144:147], a[64:67], v[80:83]
    ds_read_b64_tr_b16 v[160:161], v31 offset:4096
    v_mfma_f32_16x16x32_bf16 v[96:99], v[144:147], a[68:71], v[96:99]
    ds_read_b64_tr_b16 v[162:163], v31 offset:5120
    s_waitcnt lgkmcnt(6)
    v_mfma_f32_16x16x32_bf16 v[68:71], v[148:151], a[72:75], v[68:71]
    ds_read_b64_tr_b16 v[132:133], v28 offset:8192
    v_mfma_f32_16x16x32_bf16 v[84:87], v[148:151], a[76:79], v[84:87]
    ds_read_b64_tr_b16 v[134:135], v28 offset:9216
H_S0_5:
    s_cbranch_execz H_S_1
    s_waitcnt lgkmcnt(6)
    v_mfma_f32_16x16x32_bf16 v[72:75], v[152:155], a[72:75], v[72:75]
    ds_read_b64_tr_b16 v[136:137], v29 offset:8192
    v_mfma_f32_16x16x32_bf16 v[88:91], v[152:155], a[76:79], v[88:91]
    ds_read_b64_tr_b16 v[138:139], v29 offset:9216
    s_waitcnt lgkmcnt(6)
    v_mfma_f32_16x16x32_bf16 v[76:79], v[156:159], a[72:75], v[76:79]
    ds_read_b64_tr_b16 v[140:141], v30 offset:8192
    v_mfma_f32_16x16x32_bf16 v[92:95], v[156:159], a[76:79], v[92:95]
    ds_read_b64_tr_b16 v[142:143], v30 offset:9216
    s_waitcnt lgkmcnt(6)
    v_mfma_f32_16x16x32_bf16 v[80:83], v[160:163], a[72:75], v[80:83]
    ds_read_b64_tr_b16 v[144:145], v31 offset:8192
    v_mfma_f32_16x16x32_bf16 v[96:99], v[160:163], a[76:79], v[96:99]
    ds_read_b64_tr_b16 v[146:147], v31 offset:9216
    s_waitcnt lgkmcnt(6)
    v_mfma_f32_16x16x32_bf16 v[68:71], v[132:135], a[80:83], v[68:71]
    ds_read_b64_tr_b16 v[148:149], v28 offset:12288
    v_mfma_f32_16x16x32_bf16 v[84:87], v[132:135], a[84:87], v[84:87]
    ds_read_b64_tr_b16 v[150:151], v28 offset:13312
    s_waitcnt lgkmcnt(6)
    v_mfma_f32_16x16x32_bf16 v[72:75], v[136:139], a[80:83], v[72:75]
    ds_read_b64_tr_b16 v[152:153], v29 offset:12288
    v_mfma_f32_16x16x32_bf16 v[88:91], v[136:139], a[84:87], v[88:91]
    ds_read_b64_tr_b16 v[154:155], v29 offset:13312
    s_waitcnt lgkmcnt(6)
    v_mfma_f32_16x16x32_bf16 v[76:79], v[140:143], a[80:83], v[76:79]
    ds_read_b64_tr_b16 v[156:157], v30 offset:12288
    v_mfma_f32_16x16x32_bf16 v[92:95], v[140:143], a[84:87], v[92:95]
    ds_read_b64_tr_b16 v[158:159], v30 offset:13312
    s_waitcnt lgkmcnt(6)
    v_mfma_f32_16x16x32_bf16 v[80:83], v[144:147], a[80:83], v[80:83]
    ds_read_b64_tr_b16 v[160:161], v31 offset:12288
    v_mfma_f32_16x16x32_bf16 v[96:99], v[144:147], a[84:87], v[96:99]
    ds_read_b64_tr_b16 v[162:163], v31 offset:13312
    s_waitcnt lgkmcnt(6)
    v_mfma_f32_16x16x32_bf16 v[68:71], v[148:151], a[88:91], v[68:71]
    v_mfma_f32_16x16x32_bf16 v[84:87], v[148:151], a[92:95], v[84:87]
    s_waitcnt lgkmcnt(4)
    v_mfma_f32_16x16x32_bf16 v[72:75], v[152:155], a[88:91], v[72:75]
    v_mfma_f32_16x16x32_bf16 v[88:91], v[152:155], a[92:95], v[88:91]
    s_waitcnt vmcnt(7) lgkmcnt(0)
    s_barrier
    v_mfma_f32_16x16x32_bf16 v[76:79], v[156:159], a[88:91], v[76:79]
    ds_read_b64_tr_b16 v[132:133], v24 offset:32768
    ds_read_b64_tr_b16 v[134:135], v24 offset:33792
    v_mfma_f32_16x16x32_bf16 v[92:95], v[156:159], a[92:95], v[92:95]
    ds_read_b64_tr_b16 v[136:137], v25 offset:32768
    ds_read_b64_tr_b16 v[138:139], v25 offset:33792
    v_mfma_f32_16x16x32_bf16 v[80:83], v[160:163], a[88:91], v[80:83]
    ds_read_b64_tr_b16 v[140:141], v26 offset:32768
    ds_read_b64_tr_b16 v[142:143], v26 offset:33792
    v_mfma_f32_16x16x32_bf16 v[96:99], v[160:163], a[92:95], v[96:99]
    ds_read_b64_tr_b16 v[144:145], v27 offset:32768
    ds_read_b64_tr_b16 v[146:147], v27 offset:33792
    s_waitcnt lgkmcnt(6)
    v_mfma_f32_16x16x32_bf16 v[68:71], v[132:135], a[96:99], v[68:71]
    ds_read_b64_tr_b16 v[148:149], v24 offset:36864
    v_mfma_f32_16x16x32_bf16 v[84:87], v[132:135], a[100:103], v[84:87]
    ds_read_b64_tr_b16 v[150:151], v24 offset:37888
    s_waitcnt lgkmcnt(6)
    v_mfma_f32_16x16x32_bf16 v[72:75], v[136:139], a[96:99], v[72:75]
    ds_read_b64_tr_b16 v[152:153], v25 offset:36864
    v_mfma_f32_16x16x32_bf16 v[88:91], v[136:139], a[100:103], v[88:91]
    ds_read_b64_tr_b16 v[154:155], v25 offset:37888
    s_waitcnt lgkmcnt(6)
    v_mfma_f32_16x16x32_bf16 v[76:79], v[140:143], a[96:99], v[76:79]
    ds_read_b64_tr_b16 v[156:157], v26 offset:36864
    v_mfma_f32_16x16x32_bf16 v[92:95], v[140:143], a[100:103], v[92:95]
    ds_read_b64_tr_b16 v[158:159], v26 offset:37888
    s_waitcnt lgkmcnt(6)
    v_mfma_f32_16x16x32_bf16 v[80:83], v[144:147], a[96:99], v[80:83]
    ds_read_b64_tr_b16 v[160:161], v27 offset:36864
    v_mfma_f32_16x16x32_bf16 v[96:99], v[144:147], a[100:103], v[96:99]
    ds_read_b64_tr_b16 v[162:163], v27 offset:37888
    s_waitcnt lgkmcnt(6)
    v_mfma_f32_16x16x32_bf16 v[68:71], v[148:151], a[104:107], v[68:71]
    ds_read_b64_tr_b16 v[132:133], v24 offset:40960
    v_mfma_f32_16x16x32_bf16 v[84:87], v[148:151], a[108:111], v[84:87]
    ds_read_b64_tr_b16 v[134:135], v24 offset:41984
    s_waitcnt lgkmcnt(6)
    v_mfma_f32_16x16x32_bf16 v[72:75], v[152:155], a[104:107], v[72:75]
    ds_read_b64_tr_b16 v[136:137], v25 offset:40960
    v_mfma_f32_16x16x32_bf16 v[88:91], v[152:155], a[108:111], v[88:91]
    ds_read_b64_tr_b16 v[138:139], v25 offset:41984
    s_waitcnt lgkmcnt(6)
    v_mfma_f32_16x16x32_bf16 v[76:79], v[156:159], a[104:107], v[76:79]
    ds_read_b64_tr_b16 v[140:141], v26 offset:40960
    v_mfma_f32_16x16x32_bf16 v[92:95], v[156:159], a[108:111], v[92:95]
    ds_read_b64_tr_b16 v[142:143], v26 offset:41984
    s_waitcnt lgkmcnt(6)
    v_mfma_f32_16x16x32_bf16 v[80:83], v[160:163], a[104:107], v[80:83]
    ds_read_b64_tr_b16 v[144:145], v27 offset:40960
    v_mfma_f32_16x16x32_bf16 v[96:99], v[160:163], a[108:111], v[96:99]
    ds_read_b64_tr_b16 v[146:147], v27 offset:41984
    s_waitcnt lgkmcnt(6)
    v_mfma_f32_16x16x32_bf16 v[68:71], v[132:135], a[112:115], v[68:71]
    ds_read_b64_tr_b16 v[148:149], v24 offset:45056
    v_mfma_f32_16x16x32_bf16 v[84:87], v[132:135], a[116:119], v[84:87]
    ds_read_b64_tr_b16 v[150:151], v24 offset:46080
    s_waitcnt lgkmcnt(6)
    v_mfma_f32_16x16x32_bf16 v[72:75], v[136:139], a[112:115], v[72:75]
    ds_read_b64_tr_b16 v[152:153], v25 offset:45056
    v_mfma_f32_16x16x32_bf16 v[88:91], v[136:139], a[116:119], v[88:91]
    ds_read_b64_tr_b16 v[154:155], v25 offset:46080
    s_waitcnt lgkmcnt(6)
    v_mfma_f32_16x16x32_bf16 v[76:79], v[140:143], a[112:115], v[76:79]
    ds_read_b64_tr_b16 v[156:157], v26 offset:45056
    v_mfma_f32_16x16x32_bf16 v[92:95], v[140:143], a[116:119], v[92:95]
    ds_read_b64_tr_b16 v[158:159], v26 offset:46080
    s_waitcnt lgkmcnt(6)
    v_mfma_f32_16x16x32_bf16 v[80:83], v[144:147], a[112:115], v[80:83]
    ds_read_b64_tr_b16 v[160:161], v27 offset:45056
    v_mfma_f32_16x16x32_bf16 v[96:99], v[144:147], a[116:119], v[96:99]
    ds_read_b64_tr_b16 v[162:163], v27 offset:46080
    s_waitcnt lgkmcnt(6)
    v_mfma_f32_16x16x32_bf16 v[68:71], v[148:151], a[120:123], v[68:71]
    v_mfma_f32_16x16x32_bf16 v[84:87], v[148:151], a[124:127], v[84:87]
    s_waitcnt lgkmcnt(4)
    v_mfma_f32_16x16x32_bf16 v[72:75], v[152:155], a[120:123], v[72:75]
    v_mfma_f32_16x16x32_bf16 v[88:91], v[152:155], a[124:127], v[88:91]
    s_waitcnt lgkmcnt(0)
    s_barrier
    v_mfma_f32_16x16x32_bf16 v[76:79], v[156:159], a[120:123], v[76:79]
    v_mfma_f32_16x16x32_bf16 v[92:95], v[156:159], a[124:127], v[92:95]
    v_mfma_f32_16x16x32_bf16 v[80:83], v[160:163], a[120:123], v[80:83]
    v_mfma_f32_16x16x32_bf16 v[96:99], v[160:163], a[124:127], v[96:99]
    v_mov_b32 v248, v51
    v_add_u32 v249, 2048, v51
    v_min_u32 v248, 1432, v248
    v_add_u32 v248, 32768, v248
    buffer_load_dwordx2 v[244:245], v248, s[40:43], 0 offen sc1
    v_min_u32 v249, 1432, v249
    v_add_u32 v249, 32768, v249
    buffer_load_dwordx2 v[246:247], v249, s[40:43], 0 offen sc1
    v_pk_mul_f32 v[196:197], v[68:69], v[58:59]
    v_pk_mul_f32 v[198:199], v[70:71], v[58:59]
    v_pk_mul_f32 v[200:201], v[72:73], v[58:59]
    v_pk_mul_f32 v[202:203], v[74:75], v[58:59]
    v_exp_f32_e64 v196, v196 clamp
    v_exp_f32_e64 v197, v197 clamp
    v_exp_f32_e64 v198, v198 clamp
    v_exp_f32_e64 v199, v199 clamp
    v_exp_f32_e64 v200, v200 clamp
    v_exp_f32_e64 v201, v201 clamp
    v_exp_f32_e64 v202, v202 clamp
    v_exp_f32_e64 v203, v203 clamp
    v_max_f32 v68, 0, v68
    v_max_f32 v69, 0, v69
    v_max_f32 v70, 0, v70
    v_max_f32 v71, 0, v71
    v_max_f32 v72, 0, v72
    v_max_f32 v73, 0, v73
    v_max_f32 v74, 0, v74
    v_max_f32 v75, 0, v75
    v_pk_add_f32 v[68:69], v[68:69], v[196:197]
    v_pk_add_f32 v[70:71], v[70:71], v[198:199]
    v_pk_add_f32 v[72:73], v[72:73], v[200:201]
    v_pk_add_f32 v[74:75], v[74:75], v[202:203]
    v_pk_add_f32 v[68:69], v[68:69], v[60:61]
    v_pk_add_f32 v[70:71], v[70:71], v[60:61]
    v_pk_add_f32 v[72:73], v[72:73], v[60:61]
    v_pk_add_f32 v[74:75], v[74:75], v[60:61]
    v_pk_mul_f32 v[196:197], v[76:77], v[58:59]
    v_pk_mul_f32 v[198:199], v[78:79], v[58:59]
    v_pk_mul_f32 v[200:201], v[80:81], v[58:59]
    v_pk_mul_f32 v[202:203], v[82:83], v[58:59]
    v_exp_f32_e64 v196, v196 clamp
    v_exp_f32_e64 v197, v197 clamp
    v_exp_f32_e64 v198, v198 clamp
    v_exp_f32_e64 v199, v199 clamp
    v_exp_f32_e64 v200, v200 clamp
    v_exp_f32_e64 v201, v201 clamp
    v_exp_f32_e64 v202, v202 clamp
    v_exp_f32_e64 v203, v203 clamp
    v_max_f32 v76, 0, v76
    v_max_f32 v77, 0, v77
    v_max_f32 v78, 0, v78
    v_max_f32 v79, 0, v79
    v_max_f32 v80, 0, v80
    v_max_f32 v81, 0, v81
    v_max_f32 v82, 0, v82
    v_max_f32 v83, 0, v83
    v_pk_add_f32 v[76:77], v[76:77], v[196:197]
    v_pk_add_f32 v[78:79], v[78:79], v[198:199]
    v_pk_add_f32 v[80:81], v[80:81], v[200:201]
    v_pk_add_f32 v[82:83], v[82:83], v[202:203]
    v_pk_add_f32 v[76:77], v[76:77], v[60:61]
    v_pk_add_f32 v[78:79], v[78:79], v[60:61]
    v_pk_add_f32 v[80:81], v[80:81], v[60:61]
    v_pk_add_f32 v[82:83], v[82:83], v[60:61]
    v_pk_mul_f32 v[196:197], v[84:85], v[58:59]
    v_pk_mul_f32 v[198:199], v[86:87], v[58:59]
    v_pk_mul_f32 v[200:201], v[88:89], v[58:59]
    v_pk_mul_f32 v[202:203], v[90:91], v[58:59]
    v_exp_f32_e64 v196, v196 clamp
    v_exp_f32_e64 v197, v197 clamp
    v_exp_f32_e64 v198, v198 clamp
    v_exp_f32_e64 v199, v199 clamp
    v_exp_f32_e64 v200, v200 clamp
    v_exp_f32_e64 v201, v201 clamp
    v_exp_f32_e64 v202, v202 clamp
    v_exp_f32_e64 v203, v203 clamp
    v_max_f32 v84, 0, v84
    v_max_f32 v85, 0, v85
    v_max_f32 v86, 0, v86
    v_max_f32 v87, 0, v87
    v_max_f32 v88, 0, v88
    v_max_f32 v89, 0, v89
    v_max_f32 v90, 0, v90
    v_max_f32 v91, 0, v91
    v_pk_add_f32 v[84:85], v[84:85], v[196:197]
    v_pk_add_f32 v[86:87], v[86:87], v[198:199]
    v_pk_add_f32 v[88:89], v[88:89], v[200:201]
    v_pk_add_f32 v[90:91], v[90:91], v[202:203]
    v_pk_add_f32 v[84:85], v[84:85], v[60:61]
    v_pk_add_f32 v[86:87], v[86:87], v[60:61]
    v_pk_add_f32 v[88:89], v[88:89], v[60:61]
    v_pk_add_f32 v[90:91], v[90:91], v[60:61]
    v_pk_mul_f32 v[196:197], v[92:93], v[58:59]
    v_pk_mul_f32 v[198:199], v[94:95], v[58:59]
    v_pk_mul_f32 v[200:201], v[96:97], v[58:59]
    v_pk_mul_f32 v[202:203], v[98:99], v[58:59]
    v_exp_f32_e64 v196, v196 clamp
    v_exp_f32_e64 v197, v197 clamp
    v_exp_f32_e64 v198, v198 clamp
    v_exp_f32_e64 v199, v199 clamp
    v_exp_f32_e64 v200, v200 clamp
    v_exp_f32_e64 v201, v201 clamp
    v_exp_f32_e64 v202, v202 clamp
    v_exp_f32_e64 v203, v203 clamp
    v_max_f32 v92, 0, v92
    v_max_f32 v93, 0, v93
    v_max_f32 v94, 0, v94
    v_max_f32 v95, 0, v95
    v_max_f32 v96, 0, v96
    v_max_f32 v97, 0, v97
    v_max_f32 v98, 0, v98
    v_max_f32 v99, 0, v99
    v_pk_add_f32 v[92:93], v[92:93], v[196:197]
    v_pk_add_f32 v[94:95], v[94:95], v[198:199]
    v_pk_add_f32 v[96:97], v[96:97], v[200:201]
    v_pk_add_f32 v[98:99], v[98:99], v[202:203]
    v_pk_add_f32 v[92:93], v[92:93], v[60:61]
    v_pk_add_f32 v[94:95], v[94:95], v[60:61]
    v_pk_add_f32 v[96:97], v[96:97], v[60:61]
    v_pk_add_f32 v[98:99], v[98:99], v[60:61]
    v_cvt_pk_bf16_f32 v204, v68, v69
    v_cvt_pk_bf16_f32 v205, v70, v71
    v_cvt_pk_bf16_f32 v206, v72, v73
    v_cvt_pk_bf16_f32 v207, v74, v75
    v_cvt_pk_bf16_f32 v208, v76, v77
    v_cvt_pk_bf16_f32 v209, v78, v79
    v_cvt_pk_bf16_f32 v210, v80, v81
    v_cvt_pk_bf16_f32 v211, v82, v83
    v_cvt_pk_bf16_f32 v212, v84, v85
    v_cvt_pk_bf16_f32 v213, v86, v87
    v_cvt_pk_bf16_f32 v214, v88, v89
    v_cvt_pk_bf16_f32 v215, v90, v91
    v_cvt_pk_bf16_f32 v216, v92, v93
    v_cvt_pk_bf16_f32 v217, v94, v95
    v_cvt_pk_bf16_f32 v218, v96, v97
    v_cvt_pk_bf16_f32 v219, v98, v99
    v_accvgpr_write_b32 a160, v204
    v_accvgpr_write_b32 a161, v205
    v_accvgpr_write_b32 a162, v206
    v_accvgpr_write_b32 a163, v207
    v_accvgpr_write_b32 a164, v208
    v_accvgpr_write_b32 a165, v209
    v_accvgpr_write_b32 a166, v210
    v_accvgpr_write_b32 a167, v211
    v_accvgpr_write_b32 a168, v212
    v_accvgpr_write_b32 a169, v213
    v_accvgpr_write_b32 a170, v214
    v_accvgpr_write_b32 a171, v215
    v_accvgpr_write_b32 a172, v216
    v_accvgpr_write_b32 a173, v217
    v_accvgpr_write_b32 a174, v218
    v_accvgpr_write_b32 a175, v219
    s_waitcnt vmcnt(0)
L_chk_2023:
    v_xor_b32 v62, s50, v244
    v_bitop3_b32 v62, v245, s51, v62 bitop3:0xbe
    v_bitop3_b32 v62, v246, s50, v62 bitop3:0xbe
    v_bitop3_b32 v62, v247, s51, v62 bitop3:0xbe
    v_cmp_ne_u32 vcc, 0, v62
    s_nop 0
    s_cbranch_vccnz L_retry_2024
L_cont_2025:
    v_lshlrev_b32 v248, 4, v3
    v_lshl_add_u32 v248, v2, 6, v248
    s_mov_b32 s59, 589824
    buffer_load_dwordx4 v[220:223], v248, s[40:43], s59 offen sc1
    s_mov_b32 s59, 720896
    buffer_load_dwordx4 v[100:103], v48, s[40:43], s59 offen sc1
    buffer_load_dwordx4 v[104:107], v48, s[40:43], s59 offen offset:1024 sc1
    buffer_load_dwordx4 v[108:111], v48, s[40:43], s59 offen offset:2048 sc1
    buffer_load_dwordx4 v[112:115], v48, s[40:43], s59 offen offset:3072 sc1
    s_mov_b32 s59, 724992
    buffer_load_dwordx4 v[116:119], v48, s[40:43], s59 offen sc1
    buffer_load_dwordx4 v[120:123], v48, s[40:43], s59 offen offset:1024 sc1
    buffer_load_dwordx4 v[124:127], v48, s[40:43], s59 offen offset:2048 sc1
    buffer_load_dwordx4 v[128:131], v48, s[40:43], s59 offen offset:3072 sc1
    s_mov_b32 s59, 729088
    buffer_load_dwordx4 v[164:167], v48, s[40:43], s59 offen sc1
    buffer_load_dwordx4 v[168:171], v48, s[40:43], s59 offen offset:1024 sc1
    buffer_load_dwordx4 v[172:175], v48, s[40:43], s59 offen offset:2048 sc1
    buffer_load_dwordx4 v[176:179], v48, s[40:43], s59 offen offset:3072 sc1
    s_mul_i32 s65, s57, 90112
    s_add_u32 s65, s65, 12582912
    s_waitcnt vmcnt(12)
    v_cvt_pk_bf16_f32 v220, v220, v221
    v_cvt_pk_bf16_f32 v221, v222, v223
    s_nop 0
    v_mov_b32_dpp v212, v220 row_newbcast:0 row_mask:0xf bank_mask:0xf
    v_mov_b32_dpp v213, v221 row_newbcast:0 row_mask:0xf bank_mask:0xf
    v_mov_b32_dpp v214, v220 row_newbcast:1 row_mask:0xf bank_mask:0xf
    v_mov_b32_dpp v215, v221 row_newbcast:1 row_mask:0xf bank_mask:0xf
    v_mov_b32_dpp v216, v220 row_newbcast:2 row_mask:0xf bank_mask:0xf
    v_mov_b32_dpp v217, v221 row_newbcast:2 row_mask:0xf bank_mask:0xf
    v_mov_b32_dpp v218, v220 row_newbcast:3 row_mask:0xf bank_mask:0xf
    v_mov_b32_dpp v219, v221 row_newbcast:3 row_mask:0xf bank_mask:0xf
    v_mfma_f32_16x16x16_bf16 v[132:135], v[212:213], a[128:129], 0
    v_mfma_f32_16x16x16_bf16 v[136:139], v[214:215], a[130:131], 0
    v_mfma_f32_16x16x16_bf16 v[140:143], v[216:217], a[132:133], 0
    v_mfma_f32_16x16x16_bf16 v[144:147], v[218:219], a[134:135], 0
    v_mfma_f32_16x16x16_bf16 v[148:151], v[212:213], a[136:137], 0
    v_mfma_f32_16x16x16_bf16 v[152:155], v[214:215], a[138:139], 0
    v_mfma_f32_16x16x16_bf16 v[156:159], v[216:217], a[140:141], 0
    v_mfma_f32_16x16x16_bf16 v[160:163], v[218:219], a[142:143], 0
    s_waitcnt vmcnt(8)
    v_cvt_pk_bf16_f32 v100, v100, v101
    v_cvt_pk_bf16_f32 v101, v102, v103
    v_cvt_pk_bf16_f32 v104, v104, v105
    v_cvt_pk_bf16_f32 v105, v106, v107
    v_cvt_pk_bf16_f32 v108, v108, v109
    v_cvt_pk_bf16_f32 v109, v110, v111
    v_cvt_pk_bf16_f32 v112, v112, v113
    v_cvt_pk_bf16_f32 v113, v114, v115
    v_mfma_f32_16x16x16_bf16 v[68:71], v[100:101], a[128:129], 0
    v_add_f32 v196, v60, v132
    v_mfma_f32_16x16x16_bf16 v[72:75], v[104:105], a[130:131], 0
    v_add_f32 v198, v60, v136
    v_mfma_f32_16x16x16_bf16 v[76:79], v[108:109], a[132:133], 0
    v_add_f32 v200, v60, v140
    v_mfma_f32_16x16x16_bf16 v[80:83], v[112:113], a[134:135], 0
    v_add_f32 v202, v60, v144
    v_mfma_f32_16x16x16_bf16 v[84:87], v[100:101], a[136:137], 0
    v_add_f32 v204, v60, v148
    v_mfma_f32_16x16x16_bf16 v[88:91], v[104:105], a[138:139], 0
    v_add_f32 v206, v60, v152
    v_mfma_f32_16x16x16_bf16 v[92:95], v[108:109], a[140:141], 0
    v_add_f32 v208, v60, v156
    v_mfma_f32_16x16x16_bf16 v[96:99], v[112:113], a[142:143], 0
    v_add_f32 v210, v60, v160
    v_rcp_f32 v196, v196
    v_rcp_f32 v198, v198
    v_rcp_f32 v200, v200
    v_rcp_f32 v202, v202
    v_rcp_f32 v204, v204
    v_rcp_f32 v206, v206
    v_rcp_f32 v208, v208
    v_rcp_f32 v210, v210
    v_pk_mul_f32 v[68:69], v[68:69], v[196:197] op_sel_hi:[1,0]
    v_pk_mul_f32 v[70:71], v[70:71], v[196:197] op_sel_hi:[1,0]
    v_pk_mul_f32 v[72:73], v[72:73], v[198:199] op_sel_hi:[1,0]
    v_pk_mul_f32 v[74:75], v[74:75], v[198:199] op_sel_hi:[1,0]
    v_pk_mul_f32 v[76:77], v[76:77], v[200:201] op_sel_hi:[1,0]
    v_pk_mul_f32 v[78:79], v[78:79], v[200:201] op_sel_hi:[1,0]
    v_pk_mul_f32 v[80:81], v[80:81], v[202:203] op_sel_hi:[1,0]
    v_pk_mul_f32 v[82:83], v[82:83], v[202:203] op_sel_hi:[1,0]
    v_pk_mul_f32 v[84:85], v[84:85], v[204:205] op_sel_hi:[1,0]
    v_pk_mul_f32 v[86:87], v[86:87], v[204:205] op_sel_hi:[1,0]
    v_pk_mul_f32 v[88:89], v[88:89], v[206:207] op_sel_hi:[1,0]
    v_pk_mul_f32 v[90:91], v[90:91], v[206:207] op_sel_hi:[1,0]
    v_pk_mul_f32 v[92:93], v[92:93], v[208:209] op_sel_hi:[1,0]
    v_pk_mul_f32 v[94:95], v[94:95], v[208:209] op_sel_hi:[1,0]
    v_pk_mul_f32 v[96:97], v[96:97], v[210:211] op_sel_hi:[1,0]
    v_pk_mul_f32 v[98:99], v[98:99], v[210:211] op_sel_hi:[1,0]
    v_cvt_pk_bf16_f32 v100, v68, v69
    v_cvt_pk_bf16_f32 v101, v70, v71
    v_cvt_pk_bf16_f32 v102, v72, v73
    v_cvt_pk_bf16_f32 v103, v74, v75
    v_cvt_pk_bf16_f32 v104, v76, v77
    v_cvt_pk_bf16_f32 v105, v78, v79
    v_cvt_pk_bf16_f32 v106, v80, v81
    v_cvt_pk_bf16_f32 v107, v82, v83
    v_cvt_pk_bf16_f32 v108, v84, v85
    v_cvt_pk_bf16_f32 v109, v86, v87
    v_cvt_pk_bf16_f32 v110, v88, v89
    v_cvt_pk_bf16_f32 v111, v90, v91
    v_cvt_pk_bf16_f32 v112, v92, v93
    v_cvt_pk_bf16_f32 v113, v94, v95
    v_cvt_pk_bf16_f32 v114, v96, v97
    v_cvt_pk_bf16_f32 v115, v98, v99
    s_add_u32 s59, s65, 0
    buffer_store_dwordx4 v[100:103], v36, s[40:43], s59 offen sc1
    buffer_store_dwordx4 v[104:107], v36, s[40:43], s59 offen offset:2048 sc1
    buffer_store_dwordx4 v[108:111], v36, s[40:43], s59 offen offset:256 sc1
    buffer_store_dwordx4 v[112:115], v36, s[40:43], s59 offen offset:2304 sc1
    v_mov_b32_dpp v212, v220 row_newbcast:4 row_mask:0xf bank_mask:0xf
    v_mov_b32_dpp v213, v221 row_newbcast:4 row_mask:0xf bank_mask:0xf
    v_mov_b32_dpp v214, v220 row_newbcast:5 row_mask:0xf bank_mask:0xf
    v_mov_b32_dpp v215, v221 row_newbcast:5 row_mask:0xf bank_mask:0xf
    v_mov_b32_dpp v216, v220 row_newbcast:6 row_mask:0xf bank_mask:0xf
    v_mov_b32_dpp v217, v221 row_newbcast:6 row_mask:0xf bank_mask:0xf
    v_mov_b32_dpp v218, v220 row_newbcast:7 row_mask:0xf bank_mask:0xf
    v_mov_b32_dpp v219, v221 row_newbcast:7 row_mask:0xf bank_mask:0xf
    v_mfma_f32_16x16x16_bf16 v[132:135], v[212:213], a[144:145], 0
    v_mfma_f32_16x16x16_bf16 v[136:139], v[214:215], a[146:147], 0
    v_mfma_f32_16x16x16_bf16 v[140:143], v[216:217], a[148:149], 0
    v_mfma_f32_16x16x16_bf16 v[144:147], v[218:219], a[150:151], 0
    v_mfma_f32_16x16x16_bf16 v[148:151], v[212:213], a[152:153], 0
    v_mfma_f32_16x16x16_bf16 v[152:155], v[214:215], a[154:155], 0
    v_mfma_f32_16x16x16_bf16 v[156:159], v[216:217], a[156:157], 0
    v_mfma_f32_16x16x16_bf16 v[160:163], v[218:219], a[158:159], 0
    s_waitcnt vmcnt(8)
    v_cvt_pk_bf16_f32 v116, v116, v117
    v_cvt_pk_bf16_f32 v117, v118, v119
    v_cvt_pk_bf16_f32 v120, v120, v121
    v_cvt_pk_bf16_f32 v121, v122, v123
    v_cvt_pk_bf16_f32 v124, v124, v125
    v_cvt_pk_bf16_f32 v125, v126, v127
    v_cvt_pk_bf16_f32 v128, v128, v129
    v_cvt_pk_bf16_f32 v129, v130, v131
    v_mfma_f32_16x16x16_bf16 v[68:71], v[116:117], a[144:145], 0
    v_add_f32 v196, v60, v132
    v_mfma_f32_16x16x16_bf16 v[72:75], v[120:121], a[146:147], 0
    v_add_f32 v198, v60, v136
    v_mfma_f32_16x16x16_bf16 v[76:79], v[124:125], a[148:149], 0
    v_add_f32 v200, v60, v140
    v_mfma_f32_16x16x16_bf16 v[80:83], v[128:129], a[150:151], 0
    v_add_f32 v202, v60, v144
    v_mfma_f32_16x16x16_bf16 v[84:87], v[116:117], a[152:153], 0
    v_add_f32 v204, v60, v148
    v_mfma_f32_16x16x16_bf16 v[88:91], v[120:121], a[154:155], 0
    v_add_f32 v206, v60, v152
    v_mfma_f32_16x16x16_bf16 v[92:95], v[124:125], a[156:157], 0
    v_add_f32 v208, v60, v156
    v_mfma_f32_16x16x16_bf16 v[96:99], v[128:129], a[158:159], 0
    v_add_f32 v210, v60, v160
    v_rcp_f32 v196, v196
    v_rcp_f32 v198, v198
    v_rcp_f32 v200, v200
    v_rcp_f32 v202, v202
    v_rcp_f32 v204, v204
    v_rcp_f32 v206, v206
    v_rcp_f32 v208, v208
    v_rcp_f32 v210, v210
    v_pk_mul_f32 v[68:69], v[68:69], v[196:197] op_sel_hi:[1,0]
    v_pk_mul_f32 v[70:71], v[70:71], v[196:197] op_sel_hi:[1,0]
    v_pk_mul_f32 v[72:73], v[72:73], v[198:199] op_sel_hi:[1,0]
    v_pk_mul_f32 v[74:75], v[74:75], v[198:199] op_sel_hi:[1,0]
    v_pk_mul_f32 v[76:77], v[76:77], v[200:201] op_sel_hi:[1,0]
    v_pk_mul_f32 v[78:79], v[78:79], v[200:201] op_sel_hi:[1,0]
    v_pk_mul_f32 v[80:81], v[80:81], v[202:203] op_sel_hi:[1,0]
    v_pk_mul_f32 v[82:83], v[82:83], v[202:203] op_sel_hi:[1,0]
    v_pk_mul_f32 v[84:85], v[84:85], v[204:205] op_sel_hi:[1,0]
    v_pk_mul_f32 v[86:87], v[86:87], v[204:205] op_sel_hi:[1,0]
    v_pk_mul_f32 v[88:89], v[88:89], v[206:207] op_sel_hi:[1,0]
    v_pk_mul_f32 v[90:91], v[90:91], v[206:207] op_sel_hi:[1,0]
    v_pk_mul_f32 v[92:93], v[92:93], v[208:209] op_sel_hi:[1,0]
    v_pk_mul_f32 v[94:95], v[94:95], v[208:209] op_sel_hi:[1,0]
    v_pk_mul_f32 v[96:97], v[96:97], v[210:211] op_sel_hi:[1,0]
    v_pk_mul_f32 v[98:99], v[98:99], v[210:211] op_sel_hi:[1,0]
    v_cvt_pk_bf16_f32 v116, v68, v69
    v_cvt_pk_bf16_f32 v117, v70, v71
    v_cvt_pk_bf16_f32 v118, v72, v73
    v_cvt_pk_bf16_f32 v119, v74, v75
    v_cvt_pk_bf16_f32 v120, v76, v77
    v_cvt_pk_bf16_f32 v121, v78, v79
    v_cvt_pk_bf16_f32 v122, v80, v81
    v_cvt_pk_bf16_f32 v123, v82, v83
    v_cvt_pk_bf16_f32 v124, v84, v85
    v_cvt_pk_bf16_f32 v125, v86, v87
    v_cvt_pk_bf16_f32 v126, v88, v89
    v_cvt_pk_bf16_f32 v127, v90, v91
    v_cvt_pk_bf16_f32 v128, v92, v93
    v_cvt_pk_bf16_f32 v129, v94, v95
    v_cvt_pk_bf16_f32 v130, v96, v97
    v_cvt_pk_bf16_f32 v131, v98, v99
    s_add_u32 s59, s65, 4096
    buffer_store_dwordx4 v[116:119], v36, s[40:43], s59 offen sc1
    buffer_store_dwordx4 v[120:123], v36, s[40:43], s59 offen offset:2048 sc1
    buffer_store_dwordx4 v[124:127], v36, s[40:43], s59 offen offset:256 sc1
    buffer_store_dwordx4 v[128:131], v36, s[40:43], s59 offen offset:2304 sc1
    v_mov_b32_dpp v212, v220 row_newbcast:8 row_mask:0xf bank_mask:0xf
    v_mov_b32_dpp v213, v221 row_newbcast:8 row_mask:0xf bank_mask:0xf
    v_mov_b32_dpp v214, v220 row_newbcast:9 row_mask:0xf bank_mask:0xf
    v_mov_b32_dpp v215, v221 row_newbcast:9 row_mask:0xf bank_mask:0xf
    v_mov_b32_dpp v216, v220 row_newbcast:10 row_mask:0xf bank_mask:0xf
    v_mov_b32_dpp v217, v221 row_newbcast:10 row_mask:0xf bank_mask:0xf
    v_mov_b32_dpp v218, v220 row_newbcast:11 row_mask:0xf bank_mask:0xf
    v_mov_b32_dpp v219, v221 row_newbcast:11 row_mask:0xf bank_mask:0xf
    v_mfma_f32_16x16x16_bf16 v[132:135], v[212:213], a[160:161], 0
    v_mfma_f32_16x16x16_bf16 v[136:139], v[214:215], a[162:163], 0
    v_mfma_f32_16x16x16_bf16 v[140:143], v[216:217], a[164:165], 0
    v_mfma_f32_16x16x16_bf16 v[144:147], v[218:219], a[166:167], 0
    v_mfma_f32_16x16x16_bf16 v[148:151], v[212:213], a[168:169], 0
    v_mfma_f32_16x16x16_bf16 v[152:155], v[214:215], a[170:171], 0
    v_mfma_f32_16x16x16_bf16 v[156:159], v[216:217], a[172:173], 0
    v_mfma_f32_16x16x16_bf16 v[160:163], v[218:219], a[174:175], 0
    s_waitcnt vmcnt(8)
    v_cvt_pk_bf16_f32 v164, v164, v165
    v_cvt_pk_bf16_f32 v165, v166, v167
    v_cvt_pk_bf16_f32 v168, v168, v169
    v_cvt_pk_bf16_f32 v169, v170, v171
    v_cvt_pk_bf16_f32 v172, v172, v173
    v_cvt_pk_bf16_f32 v173, v174, v175
    v_cvt_pk_bf16_f32 v176, v176, v177
    v_cvt_pk_bf16_f32 v177, v178, v179
    v_mfma_f32_16x16x16_bf16 v[68:71], v[164:165], a[160:161], 0
    v_add_f32 v196, v60, v132
    v_mfma_f32_16x16x16_bf16 v[72:75], v[168:169], a[162:163], 0
    v_add_f32 v198, v60, v136
    v_mfma_f32_16x16x16_bf16 v[76:79], v[172:173], a[164:165], 0
    v_add_f32 v200, v60, v140
    v_mfma_f32_16x16x16_bf16 v[80:83], v[176:177], a[166:167], 0
    v_add_f32 v202, v60, v144
    v_mfma_f32_16x16x16_bf16 v[84:87], v[164:165], a[168:169], 0
    v_add_f32 v204, v60, v148
    v_mfma_f32_16x16x16_bf16 v[88:91], v[168:169], a[170:171], 0
    v_add_f32 v206, v60, v152
    v_mfma_f32_16x16x16_bf16 v[92:95], v[172:173], a[172:173], 0
    v_add_f32 v208, v60, v156
    v_mfma_f32_16x16x16_bf16 v[96:99], v[176:177], a[174:175], 0
    v_add_f32 v210, v60, v160
    v_rcp_f32 v196, v196
    v_rcp_f32 v198, v198
    v_rcp_f32 v200, v200
    v_rcp_f32 v202, v202
    v_rcp_f32 v204, v204
    v_rcp_f32 v206, v206
    v_rcp_f32 v208, v208
    v_rcp_f32 v210, v210
    v_pk_mul_f32 v[68:69], v[68:69], v[196:197] op_sel_hi:[1,0]
    v_pk_mul_f32 v[70:71], v[70:71], v[196:197] op_sel_hi:[1,0]
    v_pk_mul_f32 v[72:73], v[72:73], v[198:199] op_sel_hi:[1,0]
    v_pk_mul_f32 v[74:75], v[74:75], v[198:199] op_sel_hi:[1,0]
    v_pk_mul_f32 v[76:77], v[76:77], v[200:201] op_sel_hi:[1,0]
    v_pk_mul_f32 v[78:79], v[78:79], v[200:201] op_sel_hi:[1,0]
    v_pk_mul_f32 v[80:81], v[80:81], v[202:203] op_sel_hi:[1,0]
    v_pk_mul_f32 v[82:83], v[82:83], v[202:203] op_sel_hi:[1,0]
    v_pk_mul_f32 v[84:85], v[84:85], v[204:205] op_sel_hi:[1,0]
    v_pk_mul_f32 v[86:87], v[86:87], v[204:205] op_sel_hi:[1,0]
    v_pk_mul_f32 v[88:89], v[88:89], v[206:207] op_sel_hi:[1,0]
    v_pk_mul_f32 v[90:91], v[90:91], v[206:207] op_sel_hi:[1,0]
    v_pk_mul_f32 v[92:93], v[92:93], v[208:209] op_sel_hi:[1,0]
    v_pk_mul_f32 v[94:95], v[94:95], v[208:209] op_sel_hi:[1,0]
    v_pk_mul_f32 v[96:97], v[96:97], v[210:211] op_sel_hi:[1,0]
    v_pk_mul_f32 v[98:99], v[98:99], v[210:211] op_sel_hi:[1,0]
    v_cvt_pk_bf16_f32 v164, v68, v69
    v_cvt_pk_bf16_f32 v165, v70, v71
    v_cvt_pk_bf16_f32 v166, v72, v73
    v_cvt_pk_bf16_f32 v167, v74, v75
    v_cvt_pk_bf16_f32 v168, v76, v77
    v_cvt_pk_bf16_f32 v169, v78, v79
    v_cvt_pk_bf16_f32 v170, v80, v81
    v_cvt_pk_bf16_f32 v171, v82, v83
    v_cvt_pk_bf16_f32 v172, v84, v85
    v_cvt_pk_bf16_f32 v173, v86, v87
    v_cvt_pk_bf16_f32 v174, v88, v89
    v_cvt_pk_bf16_f32 v175, v90, v91
    v_cvt_pk_bf16_f32 v176, v92, v93
    v_cvt_pk_bf16_f32 v177, v94, v95
    v_cvt_pk_bf16_f32 v178, v96, v97
    v_cvt_pk_bf16_f32 v179, v98, v99
    s_add_u32 s59, s65, 8192
    buffer_store_dwordx4 v[164:167], v36, s[40:43], s59 offen sc1
    buffer_store_dwordx4 v[168:171], v36, s[40:43], s59 offen offset:2048 sc1
    buffer_store_dwordx4 v[172:175], v36, s[40:43], s59 offen offset:256 sc1
    buffer_store_dwordx4 v[176:179], v36, s[40:43], s59 offen offset:2304 sc1
    v_mov_b32_dpp v232, v228 row_newbcast:0 row_mask:0xf bank_mask:0xf
H_S0_6:
    s_cbranch_execz L_hopret
    v_mov_b32_dpp v233, v229 row_newbcast:0 row_mask:0xf bank_mask:0xf
    v_mov_b32_dpp v234, v230 row_newbcast:0 row_mask:0xf bank_mask:0xf
    v_mov_b32_dpp v235, v231 row_newbcast:0 row_mask:0xf bank_mask:0xf
    s_nop 1
    v_mfma_f32_16x16x32_bf16 v[220:223], v[232:235], a[0:3], 0
    v_mfma_f32_16x16x32_bf16 v[224:227], v[232:235], a[4:7], 0
    v_mov_b32_dpp v236, v228 row_newbcast:1 row_mask:0xf bank_mask:0xf
    v_mov_b32_dpp v237, v229 row_newbcast:1 row_mask:0xf bank_mask:0xf
    v_mov_b32_dpp v238, v230 row_newbcast:1 row_mask:0xf bank_mask:0xf
    v_mov_b32_dpp v239, v231 row_newbcast:1 row_mask:0xf bank_mask:0xf
    s_nop 1
    v_mfma_f32_16x16x32_bf16 v[220:223], v[236:239], a[8:11], v[220:223]
    v_mfma_f32_16x16x32_bf16 v[224:227], v[236:239], a[12:15], v[224:227]
    v_mov_b32_dpp v232, v228 row_newbcast:2 row_mask:0xf bank_mask:0xf
    v_mov_b32_dpp v233, v229 row_newbcast:2 row_mask:0xf bank_mask:0xf
    v_mov_b32_dpp v234, v230 row_newbcast:2 row_mask:0xf bank_mask:0xf
    v_mov_b32_dpp v235, v231 row_newbcast:2 row_mask:0xf bank_mask:0xf
    s_nop 1
    v_mfma_f32_16x16x32_bf16 v[220:223], v[232:235], a[16:19], v[220:223]
    v_mfma_f32_16x16x32_bf16 v[224:227], v[232:235], a[20:23], v[224:227]
    v_mov_b32_dpp v236, v228 row_newbcast:3 row_mask:0xf bank_mask:0xf
    v_mov_b32_dpp v237, v229 row_newbcast:3 row_mask:0xf bank_mask:0xf
    v_mov_b32_dpp v238, v230 row_newbcast:3 row_mask:0xf bank_mask:0xf
    v_mov_b32_dpp v239, v231 row_newbcast:3 row_mask:0xf bank_mask:0xf
    s_nop 1
    v_mfma_f32_16x16x32_bf16 v[220:223], v[236:239], a[24:27], v[220:223]
    v_mfma_f32_16x16x32_bf16 v[224:227], v[236:239], a[28:31], v[224:227]
    v_mov_b32_dpp v232, v228 row_newbcast:4 row_mask:0xf bank_mask:0xf
    v_mov_b32_dpp v233, v229 row_newbcast:4 row_mask:0xf bank_mask:0xf
    v_mov_b32_dpp v234, v230 row_newbcast:4 row_mask:0xf bank_mask:0xf
    v_mov_b32_dpp v235, v231 row_newbcast:4 row_mask:0xf bank_mask:0xf
    s_nop 1
    v_mfma_f32_16x16x32_bf16 v[220:223], v[232:235], a[32:35], v[220:223]
    v_mfma_f32_16x16x32_bf16 v[224:227], v[232:235], a[36:39], v[224:227]
    v_mov_b32_dpp v236, v228 row_newbcast:5 row_mask:0xf bank_mask:0xf
    v_mov_b32_dpp v237, v229 row_newbcast:5 row_mask:0xf bank_mask:0xf
    v_mov_b32_dpp v238, v230 row_newbcast:5 row_mask:0xf bank_mask:0xf
    v_mov_b32_dpp v239, v231 row_newbcast:5 row_mask:0xf bank_mask:0xf
    s_nop 1
    v_mfma_f32_16x16x32_bf16 v[220:223], v[236:239], a[40:43], v[220:223]
    v_mfma_f32_16x16x32_bf16 v[224:227], v[236:239], a[44:47], v[224:227]
    v_mov_b32_dpp v232, v228 row_newbcast:6 row_mask:0xf bank_mask:0xf
    v_mov_b32_dpp v233, v229 row_newbcast:6 row_mask:0xf bank_mask:0xf
    v_mov_b32_dpp v234, v230 row_newbcast:6 row_mask:0xf bank_mask:0xf
    v_mov_b32_dpp v235, v231 row_newbcast:6 row_mask:0xf bank_mask:0xf
    s_nop 1
    v_mfma_f32_16x16x32_bf16 v[220:223], v[232:235], a[48:51], v[220:223]
    v_mfma_f32_16x16x32_bf16 v[224:227], v[232:235], a[52:55], v[224:227]
    v_mov_b32_dpp v236, v228 row_newbcast:7 row_mask:0xf bank_mask:0xf
    v_mov_b32_dpp v237, v229 row_newbcast:7 row_mask:0xf bank_mask:0xf
    v_mov_b32_dpp v238, v230 row_newbcast:7 row_mask:0xf bank_mask:0xf
    v_mov_b32_dpp v239, v231 row_newbcast:7 row_mask:0xf bank_mask:0xf
    s_nop 1
    v_mfma_f32_16x16x32_bf16 v[220:223], v[236:239], a[56:59], v[220:223]
    v_mfma_f32_16x16x32_bf16 v[224:227], v[236:239], a[60:63], v[224:227]
    v_mov_b32_dpp v232, v228 row_newbcast:8 row_mask:0xf bank_mask:0xf
    v_mov_b32_dpp v233, v229 row_newbcast:8 row_mask:0xf bank_mask:0xf
    v_mov_b32_dpp v234, v230 row_newbcast:8 row_mask:0xf bank_mask:0xf
    v_mov_b32_dpp v235, v231 row_newbcast:8 row_mask:0xf bank_mask:0xf
    s_nop 1
    v_mfma_f32_16x16x32_bf16 v[220:223], v[232:235], a[64:67], v[220:223]
    v_mfma_f32_16x16x32_bf16 v[224:227], v[232:235], a[68:71], v[224:227]
    v_mov_b32_dpp v236, v228 row_newbcast:9 row_mask:0xf bank_mask:0xf
    v_mov_b32_dpp v237, v229 row_newbcast:9 row_mask:0xf bank_mask:0xf
    v_mov_b32_dpp v238, v230 row_newbcast:9 row_mask:0xf bank_mask:0xf
    v_mov_b32_dpp v239, v231 row_newbcast:9 row_mask:0xf bank_mask:0xf
    s_nop 1
    v_mfma_f32_16x16x32_bf16 v[220:223], v[236:239], a[72:75], v[220:223]
    v_mfma_f32_16x16x32_bf16 v[224:227], v[236:239], a[76:79], v[224:227]
    v_mov_b32_dpp v232, v228 row_newbcast:10 row_mask:0xf bank_mask:0xf
    v_mov_b32_dpp v233, v229 row_newbcast:10 row_mask:0xf bank_mask:0xf
    v_mov_b32_dpp v234, v230 row_newbcast:10 row_mask:0xf bank_mask:0xf
    v_mov_b32_dpp v235, v231 row_newbcast:10 row_mask:0xf bank_mask:0xf
    s_nop 1
    v_mfma_f32_16x16x32_bf16 v[220:223], v[232:235], a[80:83], v[220:223]
    v_mfma_f32_16x16x32_bf16 v[224:227], v[232:235], a[84:87], v[224:227]
    v_mov_b32_dpp v236, v228 row_newbcast:11 row_mask:0xf bank_mask:0xf
    v_mov_b32_dpp v237, v229 row_newbcast:11 row_mask:0xf bank_mask:0xf
    v_mov_b32_dpp v238, v230 row_newbcast:11 row_mask:0xf bank_mask:0xf
    v_mov_b32_dpp v239, v231 row_newbcast:11 row_mask:0xf bank_mask:0xf
    s_nop 1
    v_mfma_f32_16x16x32_bf16 v[220:223], v[236:239], a[88:91], v[220:223]
    v_mfma_f32_16x16x32_bf16 v[224:227], v[236:239], a[92:95], v[224:227]
    v_mov_b32_dpp v232, v228 row_newbcast:12 row_mask:0xf bank_mask:0xf
    v_mov_b32_dpp v233, v229 row_newbcast:12 row_mask:0xf bank_mask:0xf
    v_mov_b32_dpp v234, v230 row_newbcast:12 row_mask:0xf bank_mask:0xf
    v_mov_b32_dpp v235, v231 row_newbcast:12 row_mask:0xf bank_mask:0xf
    s_nop 1
    v_mfma_f32_16x16x32_bf16 v[220:223], v[232:235], a[96:99], v[220:223]
    v_mfma_f32_16x16x32_bf16 v[224:227], v[232:235], a[100:103], v[224:227]
    v_mov_b32_dpp v236, v228 row_newbcast:13 row_mask:0xf bank_mask:0xf
    v_mov_b32_dpp v237, v229 row_newbcast:13 row_mask:0xf bank_mask:0xf
    v_mov_b32_dpp v238, v230 row_newbcast:13 row_mask:0xf bank_mask:0xf
    v_mov_b32_dpp v239, v231 row_newbcast:13 row_mask:0xf bank_mask:0xf
    s_nop 1
    v_mfma_f32_16x16x32_bf16 v[220:223], v[236:239], a[104:107], v[220:223]
    v_mfma_f32_16x16x32_bf16 v[224:227], v[236:239], a[108:111], v[224:227]
    v_mov_b32_dpp v232, v228 row_newbcast:14 row_mask:0xf bank_mask:0xf
    v_mov_b32_dpp v233, v229 row_newbcast:14 row_mask:0xf bank_mask:0xf
    v_mov_b32_dpp v234, v230 row_newbcast:14 row_mask:0xf bank_mask:0xf
    v_mov_b32_dpp v235, v231 row_newbcast:14 row_mask:0xf bank_mask:0xf
    s_nop 1
    v_mfma_f32_16x16x32_bf16 v[220:223], v[232:235], a[112:115], v[220:223]
    v_mfma_f32_16x16x32_bf16 v[224:227], v[232:235], a[116:119], v[224:227]
    v_mov_b32_dpp v236, v228 row_newbcast:15 row_mask:0xf bank_mask:0xf
    v_mov_b32_dpp v237, v229 row_newbcast:15 row_mask:0xf bank_mask:0xf
    v_mov_b32_dpp v238, v230 row_newbcast:15 row_mask:0xf bank_mask:0xf
    v_mov_b32_dpp v239, v231 row_newbcast:15 row_mask:0xf bank_mask:0xf
    s_nop 1
    v_mfma_f32_16x16x32_bf16 v[220:223], v[236:239], a[120:123], v[220:223]
    v_mfma_f32_16x16x32_bf16 v[224:227], v[236:239], a[124:127], v[224:227]
    s_nop 6
    v_mul_f32_e64 v220, -v220, v58
    v_mul_f32_e64 v224, -v224, v58
    v_exp_f32 v220, v220
    v_exp_f32 v224, v224
    v_add_f32 v220, 1.0, v220
    v_add_f32 v224, 1.0, v224
    v_rcp_f32 v220, v220
    v_rcp_f32 v224, v224
    v_lshlrev_b32 v228, 2, v2
    s_lshl_b32 s59, s57, 7
    s_add_u32 s59, s59, 102400
    buffer_store_dword v220, v228, s[40:43], s59 offen sc1
    buffer_store_dword v224, v228, s[40:43], s59 offen offset:64 sc1
    s_lshr_b32 s64, s57, 1
    s_lshl_b32 s64, s64, 10
    s_and_b32 s60, s44, 1
    s_lshl_b32 s60, s60, 3
    s_add_u32 s64, s64, s60
    s_add_u32 s64, s64, 50048
    s_nop 7
    s_branch L_P3s
L_roleS1:
H_S1_0:
    s_cbranch_execz H_S1_4
    s_mov_b64 exec, 0
    s_call_b64 s[90:91], L_hopS1
    s_mov_b64 exec, -1
    s_nop 3
    s_add_u32 m0, s56, 32768
    s_xor_b32 s58, s0, 128
    s_add_u32 s58, s58, 0
    s_and_b32 s58, s58, 1023
    s_lshl_b32 s62, s45, 17
    s_add_u32 s58, s58, s62
    buffer_load_dwordx4 v4, s[4:7], s58 offen lds
    buffer_load_dwordx4 v5, s[4:7], s58 offen offset:1024 lds
    buffer_load_dwordx4 v6, s[4:7], s58 offen offset:2048 lds
    buffer_load_dwordx4 v7, s[4:7], s58 offen offset:3072 lds
    s_movk_i32 s60, 3072
    v_mad_u32_u24 v12, v206, s60, v203
    v_add_u32 v13, 11264, v12
    v_add_u32 v14, 47104, v12
    v_add_u32 v15, 58368, v12
    s_mov_b32 s42, 0x1180000
    s_mov_b32 s43, 0x20000
    s_mov_b32 s10, 0x180000
    s_mov_b32 s11, 0x20000
    s_mov_b32 s22, 0x800000
    s_mov_b32 s23, 0x20000
    s_mov_b32 s14, 0x80000
    s_mov_b32 s15, 0x20000
    s_mov_b32 s26, 0x1000
    s_mov_b32 s27, 0x20000
    s_mov_b32 s30, 0xe0000
    s_mov_b32 s31, 0x20000
    s_mov_b32 s34, 0x400
    s_mov_b32 s35, 0x20000
    s_mov_b32 s38, 0x200000
    s_mov_b32 s39, 0x20000
    s_mov_b32 s3, 4000000
    s_lshl_b32 s49, s45, 1
    s_add_u32 s49, s49, s48
    s_and_b32 s61, s47, 1
    s_lshl_b32 s96, s45, 1
    s_add_u32 s96, s96, s61
    s_lshl_b32 s97, s48, 2
    s_lshr_b32 s61, s47, 1
    s_add_u32 s97, s97, s61
    s_lshl_b32 s57, s45, 2
    s_add_u32 s57, s57, s44
    s_mul_i32 s61, s45, 8
    s_mul_i32 s53, s47, 2
    s_add_u32 s53, s53, s61
    s_and_b32 s53, s53, 7
    s_add_u32 s94, s53, 7
    s_and_b32 s94, s94, 7
    s_lshr_b32 s61, s94, 0
    s_lshl_b32 s61, s61, 0
    s_waitcnt lgkmcnt(0)
    s_add_u32 s54, s52, 0
    s_and_b32 s54, s54, 3
    s_mul_i32 s54, s54, 393216
    s_add_u32 s55, s52, 1
    s_and_b32 s55, s55, 3
    s_mul_i32 s55, s55, 393216
    s_add_u32 s93, s52, 2
    s_and_b32 s93, s93, 3
    s_mul_i32 s93, s93, 393216
    s_add_u32 s95, s52, 3
    s_and_b32 s95, s95, 3
    s_mul_i32 s95, s95, 393216
    s_waitcnt vmcnt(8)
    ds_read_b128 a[0:3], v42 offset:0
    ds_read_b128 a[4:7], v42 offset:2048
    ds_read_b128 a[8:11], v43 offset:0
    ds_read_b128 a[12:15], v43 offset:2048
    s_add_u32 m0, s56, 49152
    s_add_u32 s58, s52, 1
    s_and_b32 s58, s58, 3
    s_mul_i32 s58, s58, s1
    s_add_u32 s58, s58, s92
    buffer_load_dwordx4 v8, s[16:19], s58 offen lds
    buffer_load_dwordx4 v9, s[16:19], s58 offen offset:1024 lds
    buffer_load_dwordx4 v10, s[16:19], s58 offen offset:2048 lds
    buffer_load_dwordx4 v11, s[16:19], s58 offen offset:3072 lds
    s_waitcnt vmcnt(8) lgkmcnt(0)
    s_barrier
    ds_read_b64_tr_b16 v[132:133], v24 offset:16384
    ds_read_b64_tr_b16 v[134:135], v24 offset:17408
    ds_read_b64_tr_b16 v[136:137], v25 offset:16384
    ds_read_b64_tr_b16 v[138:139], v25 offset:17408
    ds_read_b64_tr_b16 v[140:141], v26 offset:16384
    ds_read_b64_tr_b16 v[142:143], v26 offset:17408
    ds_read_b64_tr_b16 v[144:145], v27 offset:16384
    ds_read_b64_tr_b16 v[146:147], v27 offset:17408
    s_waitcnt lgkmcnt(6)
    v_mfma_f32_16x16x32_bf16 v[68:71], v[132:135], a[0:3], 0
    ds_read_b64_tr_b16 v[148:149], v24 offset:20480
    s_add_u32 s94, s94, s61
    s_lshl_b32 s94, s94, 8
    s_xor_b32 s61, s48, 1
    v_mfma_f32_16x16x32_bf16 v[84:87], v[132:135], a[4:7], 0
    ds_read_b64_tr_b16 v[150:151], v24 offset:21504
    s_add_u32 m0, s56, 65536
    s_add_u32 s58, s0, 256
    s_and_b32 s58, s58, 1023
    s_lshl_b32 s62, s45, 17
    s_add_u32 s58, s58, s62
    buffer_load_dwordx4 v4, s[4:7], s58 offen lds
    s_lshl_b32 s61, s61, 18
    s_add_u32 s94, s94, s61
    v_mov_b32 v50, 0
    s_waitcnt lgkmcnt(6)
    v_mfma_f32_16x16x32_bf16 v[72:75], v[136:139], a[0:3], 0
    ds_read_b64_tr_b16 v[152:153], v25 offset:20480
    v_lshlrev_b32 v48, 4, v1
    v_lshlrev_b32 v49, 3, v2
    v_lshrrev_b32 v204, 2, v1
    v_mfma_f32_16x16x32_bf16 v[88:91], v[136:139], a[4:7], 0
    ds_read_b64_tr_b16 v[154:155], v25 offset:21504
    buffer_load_dwordx4 v5, s[4:7], s58 offen offset:1024 lds
    v_and_b32 v205, 3, v1
    v_lshlrev_b32 v205, 3, v205
    v_lshl_add_u32 v51, v204, 7, v205
    s_waitcnt lgkmcnt(6)
    v_mfma_f32_16x16x32_bf16 v[76:79], v[140:143], a[0:3], 0
    ds_read_b64_tr_b16 v[156:157], v26 offset:20480
    s_lshr_b32 s59, s44, 1
    s_lshl_b32 s59, s59, 17
    s_and_b32 s60, s44, 1
    v_mfma_f32_16x16x32_bf16 v[92:95], v[140:143], a[4:7], 0
    ds_read_b64_tr_b16 v[158:159], v26 offset:21504
    buffer_load_dwordx4 v6, s[4:7], s58 offen offset:2048 lds
    s_lshl_b32 s60, s60, 7
    s_add_u32 s59, s59, s60
    s_lshl_b32 s60, s45, 19
    s_waitcnt lgkmcnt(6)
    v_mfma_f32_16x16x32_bf16 v[80:83], v[144:147], a[0:3], 0
    ds_read_b64_tr_b16 v[160:161], v27 offset:20480
    s_add_u32 s59, s59, s60
    s_lshl_b32 s60, s48, 8
    s_add_u32 s59, s59, s60
    v_mfma_f32_16x16x32_bf16 v[96:99], v[144:147], a[4:7], 0
    ds_read_b64_tr_b16 v[162:163], v27 offset:21504
    buffer_load_dwordx4 v7, s[4:7], s58 offen offset:3072 lds
    v_lshrrev_b32 v204, 1, v197
    v_xor_b32 v204, v204, v198
    v_lshlrev_b32 v204, 4, v204
    s_waitcnt lgkmcnt(6)
    v_mfma_f32_16x16x32_bf16 v[68:71], v[148:151], a[8:11], v[68:71]
    ds_read_b64_tr_b16 v[132:133], v24 offset:24576
    v_lshl_add_u32 v204, v199, 12, v204
    v_add_u32 v16, s59, v204
    v_xor_b32 v204, 64, v16
    v_mfma_f32_16x16x32_bf16 v[84:87], v[148:151], a[12:15], v[84:87]
    ds_read_b64_tr_b16 v[134:135], v24 offset:25600
    s_add_u32 m0, s56, 81920
    s_xor_b32 s58, s0, 128
    s_add_u32 s58, s58, 256
    s_and_b32 s58, s58, 1023
    s_lshl_b32 s62, s45, 17
    s_add_u32 s58, s58, s62
    buffer_load_dwordx4 v4, s[4:7], s58 offen lds
    v_add_u32 v17, 64512, v204
    v_add_u32 v18, 14336, v16
    v_add_u32 v19, 78848, v204
    s_waitcnt lgkmcnt(6)
    v_mfma_f32_16x16x32_bf16 v[72:75], v[152:155], a[8:11], v[72:75]
    ds_read_b64_tr_b16 v[136:137], v25 offset:24576
    s_lshl_b32 s59, s44, 15
    s_lshl_b32 s60, s97, 7
    s_add_u32 s59, s59, s60
    v_mfma_f32_16x16x32_bf16 v[88:91], v[152:155], a[12:15], v[88:91]
    ds_read_b64_tr_b16 v[138:139], v25 offset:25600
    buffer_load_dwordx4 v5, s[4:7], s58 offen offset:1024 lds
    v_lshrrev_b32 v204, 2, v197
    v_lshl_add_u32 v204, v204, 3, v199
    v_and_b32 v205, 2, v197
    s_waitcnt lgkmcnt(6)
    v_mfma_f32_16x16x32_bf16 v[76:79], v[156:159], a[8:11], v[76:79]
    ds_read_b64_tr_b16 v[140:141], v26 offset:24576
    v_lshlrev_b32 v205, 1, v205
    v_xor_b32 v205, v205, v198
    v_lshlrev_b32 v205, 4, v205
    s_waitcnt vmcnt(10)
    ds_read_b128 a[16:19], v42 offset:32768
    ds_read_b128 a[20:23], v42 offset:34816
    ds_read_b128 a[24:27], v43 offset:32768
    ds_read_b128 a[28:31], v43 offset:34816
    v_mfma_f32_16x16x32_bf16 v[92:95], v[156:159], a[12:15], v[92:95]
    ds_read_b64_tr_b16 v[142:143], v26 offset:25600
    buffer_load_dwordx4 v6, s[4:7], s58 offen offset:2048 lds
    v_lshl_add_u32 v204, v204, 10, v205
    v_add_u32 v20, s59, v204
    v_add_u32 v21, 3072, v20
    s_waitcnt lgkmcnt(10)
    v_mfma_f32_16x16x32_bf16 v[80:83], v[160:163], a[8:11], v[80:83]
    ds_read_b64_tr_b16 v[144:145], v27 offset:24576
    v_add_u32 v22, 6144, v20
    v_add_u32 v23, 9216, v20
    v_lshlrev_b32 v204, 4, v2
    v_mfma_f32_16x16x32_bf16 v[96:99], v[160:163], a[12:15], v[96:99]
    ds_read_b64_tr_b16 v[146:147], v27 offset:25600
    buffer_load_dwordx4 v7, s[4:7], s58 offen offset:3072 lds
    v_lshl_add_u32 v36, v3, 9, v204
    v_and_b32 v204, 128, v204
    v_add_u32 v37, v36, v204
    s_waitcnt lgkmcnt(3)
    v_mfma_f32_16x16x32_bf16 v[68:71], v[132:135], a[16:19], v[68:71]
    ds_read_b64_tr_b16 v[148:149], v24 offset:28672
    v_mov_b32 v52, 0xc0135761
    v_mov_b32 v53, 0xc0135761
    v_mov_b32 v54, 0xbdd2d3e8
    v_mfma_f32_16x16x32_bf16 v[84:87], v[132:135], a[20:23], v[84:87]
    ds_read_b64_tr_b16 v[150:151], v24 offset:29696
    s_add_u32 m0, s56, 98304
    s_add_u32 s58, s52, 2
    s_and_b32 s58, s58, 3
    s_mul_i32 s58, s58, s1
    s_add_u32 s58, s58, s92
    buffer_load_dwordx4 v8, s[16:19], s58 offen lds
    v_mov_b32 v55, 0xbdd2d3e8
    v_mov_b32 v56, 0x3f800000
    v_mov_b32 v57, 0x3f800000
    v_mfma_f32_16x16x32_bf16 v[72:75], v[136:139], a[16:19], v[72:75]
    ds_read_b64_tr_b16 v[152:153], v25 offset:28672
    v_mov_b32 v58, 0x3fb8aa3b
    v_mov_b32 v59, 0x3fb8aa3b
    v_mov_b32 v60, 0x358637bd
    v_mfma_f32_16x16x32_bf16 v[88:91], v[136:139], a[20:23], v[88:91]
    ds_read_b64_tr_b16 v[154:155], v25 offset:29696
    buffer_load_dwordx4 v9, s[16:19], s58 offen offset:1024 lds
    v_mov_b32 v61, 0x358637bd
    s_waitcnt lgkmcnt(6)
    v_mfma_f32_16x16x32_bf16 v[76:79], v[140:143], a[16:19], v[76:79]
    ds_read_b64_tr_b16 v[156:157], v26 offset:28672
    v_mfma_f32_16x16x32_bf16 v[92:95], v[140:143], a[20:23], v[92:95]
    ds_read_b64_tr_b16 v[158:159], v26 offset:29696
    buffer_load_dwordx4 v10, s[16:19], s58 offen offset:2048 lds
    s_waitcnt lgkmcnt(6)
    v_mfma_f32_16x16x32_bf16 v[80:83], v[144:147], a[16:19], v[80:83]
    ds_read_b64_tr_b16 v[160:161], v27 offset:28672
    v_mfma_f32_16x16x32_bf16 v[96:99], v[144:147], a[20:23], v[96:99]
    ds_read_b64_tr_b16 v[162:163], v27 offset:29696
    buffer_load_dwordx4 v11, s[16:19], s58 offen offset:3072 lds
    s_waitcnt lgkmcnt(6)
    v_mfma_f32_16x16x32_bf16 v[68:71], v[148:151], a[24:27], v[68:71]
    v_mfma_f32_16x16x32_bf16 v[84:87], v[148:151], a[28:31], v[84:87]
    s_add_u32 m0, s56, 114688
    s_add_u32 s58, s0, 512
    s_and_b32 s58, s58, 1023
    s_lshl_b32 s62, s45, 17
    s_add_u32 s58, s58, s62
    buffer_load_dwordx4 v4, s[4:7], s58 offen lds
    s_waitcnt lgkmcnt(4)
    v_mfma_f32_16x16x32_bf16 v[72:75], v[152:155], a[24:27], v[72:75]
    v_mfma_f32_16x16x32_bf16 v[88:91], v[152:155], a[28:31], v[88:91]
    buffer_load_dwordx4 v5, s[4:7], s58 offen offset:1024 lds
    s_waitcnt vmcnt(14) lgkmcnt(0)
    s_barrier
    v_mfma_f32_16x16x32_bf16 v[76:79], v[156:159], a[24:27], v[76:79]
    ds_read_b64_tr_b16 v[132:133], v24 offset:49152
    ds_read_b64_tr_b16 v[134:135], v24 offset:50176
    s_waitcnt vmcnt(10)
    ds_read_b128 a[32:35], v44 offset:0
    ds_read_b128 a[36:39], v44 offset:2048
    ds_read_b128 a[40:43], v45 offset:0
    ds_read_b128 a[44:47], v45 offset:2048
    v_mfma_f32_16x16x32_bf16 v[92:95], v[156:159], a[28:31], v[92:95]
    ds_read_b64_tr_b16 v[136:137], v25 offset:49152
    ds_read_b64_tr_b16 v[138:139], v25 offset:50176
    buffer_load_dwordx4 v6, s[4:7], s58 offen offset:2048 lds
    v_mfma_f32_16x16x32_bf16 v[80:83], v[160:163], a[24:27], v[80:83]
    ds_read_b64_tr_b16 v[140:141], v26 offset:49152
    ds_read_b64_tr_b16 v[142:143], v26 offset:50176
    v_mfma_f32_16x16x32_bf16 v[96:99], v[160:163], a[28:31], v[96:99]
    ds_read_b64_tr_b16 v[144:145], v27 offset:49152
    ds_read_b64_tr_b16 v[146:147], v27 offset:50176
    buffer_load_dwordx4 v7, s[4:7], s58 offen offset:3072 lds
    buffer_load_dwordx2 v[66:67], v50, s[40:43], 0 offen sc1
    s_waitcnt lgkmcnt(6)
    v_mfma_f32_16x16x32_bf16 v[68:71], v[132:135], a[32:35], v[68:71]
    ds_read_b64_tr_b16 v[148:149], v24 offset:53248
    v_mfma_f32_16x16x32_bf16 v[84:87], v[132:135], a[36:39], v[84:87]
    ds_read_b64_tr_b16 v[150:151], v24 offset:54272
    s_add_u32 m0, s56, 0
    s_xor_b32 s58, s0, 128
    s_add_u32 s58, s58, 512
    s_and_b32 s58, s58, 1023
    s_lshl_b32 s62, s45, 17
    s_add_u32 s58, s58, s62
    buffer_load_dwordx4 v4, s[4:7], s58 offen lds
    s_waitcnt lgkmcnt(6)
    v_mfma_f32_16x16x32_bf16 v[72:75], v[136:139], a[32:35], v[72:75]
    ds_read_b64_tr_b16 v[152:153], v25 offset:53248
    v_mfma_f32_16x16x32_bf16 v[88:91], v[136:139], a[36:39], v[88:91]
    ds_read_b64_tr_b16 v[154:155], v25 offset:54272
    buffer_load_dwordx4 v5, s[4:7], s58 offen offset:1024 lds
    s_waitcnt lgkmcnt(6)
    v_mfma_f32_16x16x32_bf16 v[76:79], v[140:143], a[32:35], v[76:79]
    ds_read_b64_tr_b16 v[156:157], v26 offset:53248
    v_mfma_f32_16x16x32_bf16 v[92:95], v[140:143], a[36:39], v[92:95]
    ds_read_b64_tr_b16 v[158:159], v26 offset:54272
    buffer_load_dwordx4 v6, s[4:7], s58 offen offset:2048 lds
    s_waitcnt lgkmcnt(6)
    v_mfma_f32_16x16x32_bf16 v[80:83], v[144:147], a[32:35], v[80:83]
    ds_read_b64_tr_b16 v[160:161], v27 offset:53248
    v_mfma_f32_16x16x32_bf16 v[96:99], v[144:147], a[36:39], v[96:99]
    ds_read_b64_tr_b16 v[162:163], v27 offset:54272
    buffer_load_dwordx4 v7, s[4:7], s58 offen offset:3072 lds
    v_lshlrev_b32 v208, 2, v1
    s_lshl_b32 s59, s49, 2
    s_add_u32 s59, s59, s44
    s_lshl_b32 s60, s59, 4
    s_lshl_b32 s59, s59, 8
    s_add_u32 s59, s59, 720896
    s_add_u32 s60, s60, 589824
    buffer_store_dword v50, v208, s[40:43], s59 offen sc1
    v_and_b32 v209, 12, v208
    buffer_store_dword v50, v209, s[40:43], s60 offen sc1
    s_waitcnt lgkmcnt(6)
    v_mfma_f32_16x16x32_bf16 v[68:71], v[148:151], a[40:43], v[68:71]
    ds_read_b64_tr_b16 v[132:133], v24 offset:57344
    v_mfma_f32_16x16x32_bf16 v[84:87], v[148:151], a[44:47], v[84:87]
    ds_read_b64_tr_b16 v[134:135], v24 offset:58368
    s_add_u32 m0, s56, 32768
    s_add_u32 s58, s52, 3
    s_and_b32 s58, s58, 3
    s_mul_i32 s58, s58, s1
    s_add_u32 s58, s58, s92
    buffer_load_dwordx4 v8, s[16:19], s58 offen lds
    s_waitcnt lgkmcnt(6)
    v_mfma_f32_16x16x32_bf16 v[72:75], v[152:155], a[40:43], v[72:75]
    ds_read_b64_tr_b16 v[136:137], v25 offset:57344
    v_mfma_f32_16x16x32_bf16 v[88:91], v[152:155], a[44:47], v[88:91]
    ds_read_b64_tr_b16 v[138:139], v25 offset:58368
    buffer_load_dwordx4 v9, s[16:19], s58 offen offset:1024 lds
    s_waitcnt lgkmcnt(6)
    v_mfma_f32_16x16x32_bf16 v[76:79], v[156:159], a[40:43], v[76:79]
    ds_read_b64_tr_b16 v[140:141], v26 offset:57344
    s_waitcnt vmcnt(17)
    ds_read_b128 a[48:51], v44 offset:16384
    ds_read_b128 a[52:55], v44 offset:18432
    ds_read_b128 a[56:59], v45 offset:16384
    ds_read_b128 a[60:63], v45 offset:18432
    v_mfma_f32_16x16x32_bf16 v[92:95], v[156:159], a[44:47], v[92:95]
    ds_read_b64_tr_b16 v[142:143], v26 offset:58368
    buffer_load_dwordx4 v10, s[16:19], s58 offen offset:2048 lds
    s_waitcnt lgkmcnt(10)
    v_mfma_f32_16x16x32_bf16 v[80:83], v[160:163], a[40:43], v[80:83]
    ds_read_b64_tr_b16 v[144:145], v27 offset:57344
    v_mfma_f32_16x16x32_bf16 v[96:99], v[160:163], a[44:47], v[96:99]
    ds_read_b64_tr_b16 v[146:147], v27 offset:58368
    buffer_load_dwordx4 v11, s[16:19], s58 offen offset:3072 lds
    s_waitcnt lgkmcnt(3)
    v_mfma_f32_16x16x32_bf16 v[68:71], v[132:135], a[48:51], v[68:71]
    ds_read_b64_tr_b16 v[148:149], v24 offset:61440
    v_mfma_f32_16x16x32_bf16 v[84:87], v[132:135], a[52:55], v[84:87]
    ds_read_b64_tr_b16 v[150:151], v24 offset:62464
    s_add_u32 m0, s56, 16384
    s_add_u32 s58, s0, 768
    s_and_b32 s58, s58, 1023
    s_lshl_b32 s62, s45, 17
    s_add_u32 s58, s58, s62
    buffer_load_dwordx4 v4, s[4:7], s58 offen lds
    v_mfma_f32_16x16x32_bf16 v[72:75], v[136:139], a[48:51], v[72:75]
    ds_read_b64_tr_b16 v[152:153], v25 offset:61440
    v_mfma_f32_16x16x32_bf16 v[88:91], v[136:139], a[52:55], v[88:91]
    ds_read_b64_tr_b16 v[154:155], v25 offset:62464
    buffer_load_dwordx4 v5, s[4:7], s58 offen offset:1024 lds
    s_waitcnt lgkmcnt(6)
    v_mfma_f32_16x16x32_bf16 v[76:79], v[140:143], a[48:51], v[76:79]
    ds_read_b64_tr_b16 v[156:157], v26 offset:61440
    v_mfma_f32_16x16x32_bf16 v[92:95], v[140:143], a[52:55], v[92:95]
    ds_read_b64_tr_b16 v[158:159], v26 offset:62464
    buffer_load_dwordx4 v6, s[4:7], s58 offen offset:2048 lds
    s_waitcnt lgkmcnt(6)
    v_mfma_f32_16x16x32_bf16 v[80:83], v[144:147], a[48:51], v[80:83]
    ds_read_b64_tr_b16 v[160:161], v27 offset:61440
    v_mfma_f32_16x16x32_bf16 v[96:99], v[144:147], a[52:55], v[96:99]
    ds_read_b64_tr_b16 v[162:163], v27 offset:62464
    buffer_load_dwordx4 v7, s[4:7], s58 offen offset:3072 lds
    s_waitcnt lgkmcnt(6)
    v_mfma_f32_16x16x32_bf16 v[68:71], v[148:151], a[56:59], v[68:71]
    v_mfma_f32_16x16x32_bf16 v[84:87], v[148:151], a[60:63], v[84:87]
    s_add_u32 m0, s56, 65536
    s_xor_b32 s58, s0, 128
    s_add_u32 s58, s58, 768
    s_and_b32 s58, s58, 1023
    s_lshl_b32 s62, s45, 17
    s_add_u32 s58, s58, s62
    buffer_load_dwordx4 v4, s[4:7], s58 offen lds
    s_waitcnt lgkmcnt(4)
    v_mfma_f32_16x16x32_bf16 v[72:75], v[152:155], a[56:59], v[72:75]
    v_mfma_f32_16x16x32_bf16 v[88:91], v[152:155], a[60:63], v[88:91]
    buffer_load_dwordx4 v5, s[4:7], s58 offen offset:1024 lds
    s_waitcnt vmcnt(21) lgkmcnt(0)
    s_barrier
    v_mfma_f32_16x16x32_bf16 v[76:79], v[156:159], a[56:59], v[76:79]
    ds_read_b64_tr_b16 v[132:133], v28 offset:32768
    ds_read_b64_tr_b16 v[134:135], v28 offset:33792
    s_waitcnt vmcnt(17)
    ds_read_b128 a[64:67], v44 offset:49152
    ds_read_b128 a[68:71], v44 offset:51200
    ds_read_b128 a[72:75], v45 offset:49152
    ds_read_b128 a[76:79], v45 offset:51200
    v_mfma_f32_16x16x32_bf16 v[92:95], v[156:159], a[60:63], v[92:95]
    ds_read_b64_tr_b16 v[136:137], v29 offset:32768
    ds_read_b64_tr_b16 v[138:139], v29 offset:33792
    buffer_load_dwordx4 v6, s[4:7], s58 offen offset:2048 lds
    v_mfma_f32_16x16x32_bf16 v[80:83], v[160:163], a[56:59], v[80:83]
    ds_read_b64_tr_b16 v[140:141], v30 offset:32768
    ds_read_b64_tr_b16 v[142:143], v30 offset:33792
    v_mfma_f32_16x16x32_bf16 v[96:99], v[160:163], a[60:63], v[96:99]
    ds_read_b64_tr_b16 v[144:145], v31 offset:32768
    ds_read_b64_tr_b16 v[146:147], v31 offset:33792
    buffer_load_dwordx4 v7, s[4:7], s58 offen offset:3072 lds
    s_waitcnt lgkmcnt(6)
    v_mfma_f32_16x16x32_bf16 v[68:71], v[132:135], a[64:67], v[68:71]
    ds_read_b64_tr_b16 v[148:149], v28 offset:36864
    s_add_u32 m0, s56, 81920
    s_add_u32 s58, s54, 512
    buffer_load_dwordx4 v12, s[8:11], s58 offen lds
    v_mfma_f32_16x16x32_bf16 v[84:87], v[132:135], a[68:71], v[84:87]
    ds_read_b64_tr_b16 v[150:151], v28 offset:37888
    s_waitcnt lgkmcnt(6)
    v_mfma_f32_16x16x32_bf16 v[72:75], v[136:139], a[64:67], v[72:75]
    ds_read_b64_tr_b16 v[152:153], v29 offset:36864
    buffer_load_dwordx4 v13, s[8:11], s58 offen offset:1024 lds
    v_mfma_f32_16x16x32_bf16 v[88:91], v[136:139], a[68:71], v[88:91]
    ds_read_b64_tr_b16 v[154:155], v29 offset:37888
    s_waitcnt lgkmcnt(6)
    v_mfma_f32_16x16x32_bf16 v[76:79], v[140:143], a[64:67], v[76:79]
    ds_read_b64_tr_b16 v[156:157], v30 offset:36864
    v_mfma_f32_16x16x32_bf16 v[92:95], v[140:143], a[68:71], v[92:95]
    ds_read_b64_tr_b16 v[158:159], v30 offset:37888
    s_waitcnt lgkmcnt(6)
    v_mfma_f32_16x16x32_bf16 v[80:83], v[144:147], a[64:67], v[80:83]
    ds_read_b64_tr_b16 v[160:161], v31 offset:36864
    v_mfma_f32_16x16x32_bf16 v[96:99], v[144:147], a[68:71], v[96:99]
    ds_read_b64_tr_b16 v[162:163], v31 offset:37888
    s_waitcnt lgkmcnt(6)
    v_mfma_f32_16x16x32_bf16 v[68:71], v[148:151], a[72:75], v[68:71]
    ds_read_b64_tr_b16 v[132:133], v28 offset:40960
    v_mfma_f32_16x16x32_bf16 v[84:87], v[148:151], a[76:79], v[84:87]
    ds_read_b64_tr_b16 v[134:135], v28 offset:41984
    s_waitcnt lgkmcnt(6)
    v_mfma_f32_16x16x32_bf16 v[72:75], v[152:155], a[72:75], v[72:75]
    ds_read_b64_tr_b16 v[136:137], v29 offset:40960
    v_mfma_f32_16x16x32_bf16 v[88:91], v[152:155], a[76:79], v[88:91]
    ds_read_b64_tr_b16 v[138:139], v29 offset:41984
    s_waitcnt lgkmcnt(6)
    v_mfma_f32_16x16x32_bf16 v[76:79], v[156:159], a[72:75], v[76:79]
    ds_read_b64_tr_b16 v[140:141], v30 offset:40960
    buffer_load_dwordx4 v14, s[8:11], s58 offen offset:2048 lds
    s_waitcnt vmcnt(17)
    ds_read_b128 a[80:83], v42 offset:0
    ds_read_b128 a[84:87], v42 offset:2048
    ds_read_b128 a[88:91], v43 offset:0
    ds_read_b128 a[92:95], v43 offset:2048
    v_mfma_f32_16x16x32_bf16 v[92:95], v[156:159], a[76:79], v[92:95]
    ds_read_b64_tr_b16 v[142:143], v30 offset:41984
    s_waitcnt lgkmcnt(10)
    v_mfma_f32_16x16x32_bf16 v[80:83], v[160:163], a[72:75], v[80:83]
    ds_read_b64_tr_b16 v[144:145], v31 offset:40960
    v_mfma_f32_16x16x32_bf16 v[96:99], v[160:163], a[76:79], v[96:99]
    ds_read_b64_tr_b16 v[146:147], v31 offset:41984
    s_waitcnt lgkmcnt(3)
    v_mfma_f32_16x16x32_bf16 v[68:71], v[132:135], a[80:83], v[68:71]
    ds_read_b64_tr_b16 v[148:149], v28 offset:45056
    v_mfma_f32_16x16x32_bf16 v[84:87], v[132:135], a[84:87], v[84:87]
    ds_read_b64_tr_b16 v[150:151], v28 offset:46080
    v_mfma_f32_16x16x32_bf16 v[72:75], v[136:139], a[80:83], v[72:75]
    ds_read_b64_tr_b16 v[152:153], v29 offset:45056
H_S1_1:
    s_cbranch_execz H_S1_5
    v_mfma_f32_16x16x32_bf16 v[88:91], v[136:139], a[84:87], v[88:91]
    ds_read_b64_tr_b16 v[154:155], v29 offset:46080
    s_waitcnt lgkmcnt(6)
    v_mfma_f32_16x16x32_bf16 v[76:79], v[140:143], a[80:83], v[76:79]
    ds_read_b64_tr_b16 v[156:157], v30 offset:45056
    buffer_load_dwordx4 v15, s[8:11], s58 offen offset:3072 lds
    v_mfma_f32_16x16x32_bf16 v[92:95], v[140:143], a[84:87], v[92:95]
    ds_read_b64_tr_b16 v[158:159], v30 offset:46080
    s_waitcnt lgkmcnt(6)
    v_mfma_f32_16x16x32_bf16 v[80:83], v[144:147], a[80:83], v[80:83]
    ds_read_b64_tr_b16 v[160:161], v31 offset:45056
    v_mfma_f32_16x16x32_bf16 v[96:99], v[144:147], a[84:87], v[96:99]
    ds_read_b64_tr_b16 v[162:163], v31 offset:46080
    v_add_u32 v66, 0x9e3779b9, v66
    v_add_u32 v67, 0x7f4a7c15, v67
    v_readfirstlane_b32 s50, v66
    v_readfirstlane_b32 s51, v67
    s_waitcnt lgkmcnt(6)
    v_mfma_f32_16x16x32_bf16 v[68:71], v[148:151], a[88:91], v[68:71]
    v_mfma_f32_16x16x32_bf16 v[84:87], v[148:151], a[92:95], v[84:87]
    s_waitcnt lgkmcnt(4)
    v_mfma_f32_16x16x32_bf16 v[72:75], v[152:155], a[88:91], v[72:75]
    v_mfma_f32_16x16x32_bf16 v[88:91], v[152:155], a[92:95], v[88:91]
    s_waitcnt vmcnt(12) lgkmcnt(0)
    s_barrier
    v_mfma_f32_16x16x32_bf16 v[76:79], v[156:159], a[88:91], v[76:79]
    ds_read_b64_tr_b16 v[132:133], v24 offset:32768
    ds_read_b64_tr_b16 v[134:135], v24 offset:33792
    s_waitcnt vmcnt(8)
    ds_read_b128 a[96:99], v42 offset:16384
    ds_read_b128 a[100:103], v42 offset:18432
    ds_read_b128 a[104:107], v43 offset:16384
    ds_read_b128 a[108:111], v43 offset:18432
    v_mfma_f32_16x16x32_bf16 v[92:95], v[156:159], a[92:95], v[92:95]
    ds_read_b64_tr_b16 v[136:137], v25 offset:32768
    ds_read_b64_tr_b16 v[138:139], v25 offset:33792
    s_add_u32 m0, s56, 49152
    s_add_u32 s58, s55, 512
    buffer_load_dwordx4 v12, s[8:11], s58 offen lds
    v_mfma_f32_16x16x32_bf16 v[80:83], v[160:163], a[88:91], v[80:83]
    ds_read_b64_tr_b16 v[140:141], v26 offset:32768
    ds_read_b64_tr_b16 v[142:143], v26 offset:33792
    v_mfma_f32_16x16x32_bf16 v[96:99], v[160:163], a[92:95], v[96:99]
    ds_read_b64_tr_b16 v[144:145], v27 offset:32768
    ds_read_b64_tr_b16 v[146:147], v27 offset:33792
    buffer_load_dwordx4 v13, s[8:11], s58 offen offset:1024 lds
    s_lshl_b32 s59, s49, 4
    s_add_u32 s59, s59, s44
    s_lshl_b32 s59, s59, 3
    s_add_u32 s59, s59, 98304
    buffer_store_dwordx2 v[66:67], v50, s[40:43], s59 offen sc1
    s_waitcnt lgkmcnt(6)
    v_mfma_f32_16x16x32_bf16 v[68:71], v[132:135], a[96:99], v[68:71]
    ds_read_b64_tr_b16 v[148:149], v24 offset:36864
    v_mfma_f32_16x16x32_bf16 v[84:87], v[132:135], a[100:103], v[84:87]
    ds_read_b64_tr_b16 v[150:151], v24 offset:37888
    s_waitcnt lgkmcnt(6)
    v_mfma_f32_16x16x32_bf16 v[72:75], v[136:139], a[96:99], v[72:75]
    ds_read_b64_tr_b16 v[152:153], v25 offset:36864
    v_mfma_f32_16x16x32_bf16 v[88:91], v[136:139], a[100:103], v[88:91]
    ds_read_b64_tr_b16 v[154:155], v25 offset:37888
    buffer_load_dwordx4 v14, s[8:11], s58 offen offset:2048 lds
    s_waitcnt lgkmcnt(6)
    v_mfma_f32_16x16x32_bf16 v[76:79], v[140:143], a[96:99], v[76:79]
    ds_read_b64_tr_b16 v[156:157], v26 offset:36864
    v_mfma_f32_16x16x32_bf16 v[92:95], v[140:143], a[100:103], v[92:95]
    ds_read_b64_tr_b16 v[158:159], v26 offset:37888
    s_waitcnt lgkmcnt(6)
    v_mfma_f32_16x16x32_bf16 v[80:83], v[144:147], a[96:99], v[80:83]
    ds_read_b64_tr_b16 v[160:161], v27 offset:36864
    v_mfma_f32_16x16x32_bf16 v[96:99], v[144:147], a[100:103], v[96:99]
    ds_read_b64_tr_b16 v[162:163], v27 offset:37888
    buffer_load_dwordx4 v15, s[8:11], s58 offen offset:3072 lds
    s_waitcnt lgkmcnt(6)
    v_mfma_f32_16x16x32_bf16 v[68:71], v[148:151], a[104:107], v[68:71]
    ds_read_b64_tr_b16 v[132:133], v24 offset:40960
    v_mfma_f32_16x16x32_bf16 v[84:87], v[148:151], a[108:111], v[84:87]
    ds_read_b64_tr_b16 v[134:135], v24 offset:41984
    s_waitcnt lgkmcnt(6)
    v_mfma_f32_16x16x32_bf16 v[72:75], v[152:155], a[104:107], v[72:75]
    ds_read_b64_tr_b16 v[136:137], v25 offset:40960
    v_mfma_f32_16x16x32_bf16 v[88:91], v[152:155], a[108:111], v[88:91]
    ds_read_b64_tr_b16 v[138:139], v25 offset:41984
    s_add_u32 m0, s56, 114688
    s_add_u32 s58, s93, 512
    buffer_load_dwordx4 v12, s[8:11], s58 offen lds
    s_waitcnt lgkmcnt(6)
    v_mfma_f32_16x16x32_bf16 v[76:79], v[156:159], a[104:107], v[76:79]
    ds_read_b64_tr_b16 v[140:141], v26 offset:40960
    s_waitcnt vmcnt(10)
    ds_read_b128 a[112:115], v44 offset:0
    ds_read_b128 a[116:119], v44 offset:2048
    ds_read_b128 a[120:123], v45 offset:0
    ds_read_b128 a[124:127], v45 offset:2048
    v_mfma_f32_16x16x32_bf16 v[92:95], v[156:159], a[108:111], v[92:95]
    ds_read_b64_tr_b16 v[142:143], v26 offset:41984
    buffer_load_dwordx4 v13, s[8:11], s58 offen offset:1024 lds
    s_waitcnt lgkmcnt(10)
    v_mfma_f32_16x16x32_bf16 v[80:83], v[160:163], a[104:107], v[80:83]
    ds_read_b64_tr_b16 v[144:145], v27 offset:40960
    v_mfma_f32_16x16x32_bf16 v[96:99], v[160:163], a[108:111], v[96:99]
    ds_read_b64_tr_b16 v[146:147], v27 offset:41984
    s_waitcnt lgkmcnt(3)
    v_mfma_f32_16x16x32_bf16 v[68:71], v[132:135], a[112:115], v[68:71]
    ds_read_b64_tr_b16 v[148:149], v24 offset:45056
    buffer_load_dwordx4 v14, s[8:11], s58 offen offset:2048 lds
    v_mfma_f32_16x16x32_bf16 v[84:87], v[132:135], a[116:119], v[84:87]
    ds_read_b64_tr_b16 v[150:151], v24 offset:46080
    v_mfma_f32_16x16x32_bf16 v[72:75], v[136:139], a[112:115], v[72:75]
    ds_read_b64_tr_b16 v[152:153], v25 offset:45056
    v_mfma_f32_16x16x32_bf16 v[88:91], v[136:139], a[116:119], v[88:91]
    ds_read_b64_tr_b16 v[154:155], v25 offset:46080
    buffer_load_dwordx4 v15, s[8:11], s58 offen offset:3072 lds
    s_waitcnt lgkmcnt(6)
    v_mfma_f32_16x16x32_bf16 v[76:79], v[140:143], a[112:115], v[76:79]
    ds_read_b64_tr_b16 v[156:157], v26 offset:45056
    v_mfma_f32_16x16x32_bf16 v[92:95], v[140:143], a[116:119], v[92:95]
    ds_read_b64_tr_b16 v[158:159], v26 offset:46080
    s_waitcnt lgkmcnt(6)
    v_mfma_f32_16x16x32_bf16 v[80:83], v[144:147], a[112:115], v[80:83]
    ds_read_b64_tr_b16 v[160:161], v27 offset:45056
    v_mfma_f32_16x16x32_bf16 v[96:99], v[144:147], a[116:119], v[96:99]
    ds_read_b64_tr_b16 v[162:163], v27 offset:46080
    s_add_u32 m0, s56, 0
    s_add_u32 s58, s95, 512
    buffer_load_dwordx4 v12, s[8:11], s58 offen lds
    s_waitcnt lgkmcnt(6)
    v_mfma_f32_16x16x32_bf16 v[68:71], v[148:151], a[120:123], v[68:71]
    v_mfma_f32_16x16x32_bf16 v[84:87], v[148:151], a[124:127], v[84:87]
    s_waitcnt lgkmcnt(4)
    v_mfma_f32_16x16x32_bf16 v[72:75], v[152:155], a[120:123], v[72:75]
    buffer_load_dwordx4 v13, s[8:11], s58 offen offset:1024 lds
    v_mfma_f32_16x16x32_bf16 v[88:91], v[152:155], a[124:127], v[88:91]
    buffer_load_dwordx4 v14, s[8:11], s58 offen offset:2048 lds
    s_waitcnt lgkmcnt(0)
    s_barrier
    v_mfma_f32_16x16x32_bf16 v[76:79], v[156:159], a[120:123], v[76:79]
    buffer_load_dwordx4 v15, s[8:11], s58 offen offset:3072 lds
    v_mfma_f32_16x16x32_bf16 v[92:95], v[156:159], a[124:127], v[92:95]
    s_add_u32 m0, s56, 98304
    s_add_u32 s58, s54, 640
    buffer_load_dwordx4 v12, s[8:11], s58 offen lds
    v_mfma_f32_16x16x32_bf16 v[80:83], v[160:163], a[120:123], v[80:83]
    v_mfma_f32_16x16x32_bf16 v[96:99], v[160:163], a[124:127], v[96:99]
    v_pk_mul_f32 v[196:197], v[68:69], v[58:59]
    v_pk_mul_f32 v[198:199], v[70:71], v[58:59]
    v_pk_mul_f32 v[200:201], v[72:73], v[58:59]
    v_pk_mul_f32 v[202:203], v[74:75], v[58:59]
    v_exp_f32_e64 v196, v196 clamp
    v_exp_f32_e64 v197, v197 clamp
    v_exp_f32_e64 v198, v198 clamp
    v_exp_f32_e64 v199, v199 clamp
    v_exp_f32_e64 v200, v200 clamp
    v_exp_f32_e64 v201, v201 clamp
    v_exp_f32_e64 v202, v202 clamp
    v_exp_f32_e64 v203, v203 clamp
    buffer_load_dwordx4 v13, s[8:11], s58 offen offset:1024 lds
    v_max_f32 v68, 0, v68
    v_max_f32 v69, 0, v69
    v_max_f32 v70, 0, v70
    v_max_f32 v71, 0, v71
    v_max_f32 v72, 0, v72
    v_max_f32 v73, 0, v73
    v_max_f32 v74, 0, v74
    v_max_f32 v75, 0, v75
    v_pk_add_f32 v[68:69], v[68:69], v[196:197]
    v_pk_add_f32 v[70:71], v[70:71], v[198:199]
    v_pk_add_f32 v[72:73], v[72:73], v[200:201]
    v_pk_add_f32 v[74:75], v[74:75], v[202:203]
    v_pk_add_f32 v[68:69], v[68:69], v[60:61]
    v_pk_add_f32 v[70:71], v[70:71], v[60:61]
    v_pk_add_f32 v[72:73], v[72:73], v[60:61]
    v_pk_add_f32 v[74:75], v[74:75], v[60:61]
    v_pk_mul_f32 v[196:197], v[76:77], v[58:59]
    v_pk_mul_f32 v[198:199], v[78:79], v[58:59]
    v_pk_mul_f32 v[200:201], v[80:81], v[58:59]
    v_pk_mul_f32 v[202:203], v[82:83], v[58:59]
    v_exp_f32_e64 v196, v196 clamp
    v_exp_f32_e64 v197, v197 clamp
    v_exp_f32_e64 v198, v198 clamp
    v_exp_f32_e64 v199, v199 clamp
    v_exp_f32_e64 v200, v200 clamp
    v_exp_f32_e64 v201, v201 clamp
    v_exp_f32_e64 v202, v202 clamp
    v_exp_f32_e64 v203, v203 clamp
    buffer_load_dwordx4 v14, s[8:11], s58 offen offset:2048 lds
    v_max_f32 v76, 0, v76
    v_max_f32 v77, 0, v77
    v_max_f32 v78, 0, v78
    v_max_f32 v79, 0, v79
    v_max_f32 v80, 0, v80
    v_max_f32 v81, 0, v81
    v_max_f32 v82, 0, v82
    v_max_f32 v83, 0, v83
    v_pk_add_f32 v[76:77], v[76:77], v[196:197]
    v_pk_add_f32 v[78:79], v[78:79], v[198:199]
    v_pk_add_f32 v[80:81], v[80:81], v[200:201]
    v_pk_add_f32 v[82:83], v[82:83], v[202:203]
    v_pk_add_f32 v[76:77], v[76:77], v[60:61]
    v_pk_add_f32 v[78:79], v[78:79], v[60:61]
    v_pk_add_f32 v[80:81], v[80:81], v[60:61]
    v_pk_add_f32 v[82:83], v[82:83], v[60:61]
    v_pk_mul_f32 v[196:197], v[84:85], v[58:59]
    v_pk_mul_f32 v[198:199], v[86:87], v[58:59]
    v_pk_mul_f32 v[200:201], v[88:89], v[58:59]
    v_pk_mul_f32 v[202:203], v[90:91], v[58:59]
    v_exp_f32_e64 v196, v196 clamp
    v_exp_f32_e64 v197, v197 clamp
    v_exp_f32_e64 v198, v198 clamp
    v_exp_f32_e64 v199, v199 clamp
    v_exp_f32_e64 v200, v200 clamp
    v_exp_f32_e64 v201, v201 clamp
    v_exp_f32_e64 v202, v202 clamp
    v_exp_f32_e64 v203, v203 clamp
    v_max_f32 v84, 0, v84
    v_max_f32 v85, 0, v85
    v_max_f32 v86, 0, v86
    v_max_f32 v87, 0, v87
    v_max_f32 v88, 0, v88
    v_max_f32 v89, 0, v89
    v_max_f32 v90, 0, v90
    v_max_f32 v91, 0, v91
    v_pk_add_f32 v[84:85], v[84:85], v[196:197]
    v_pk_add_f32 v[86:87], v[86:87], v[198:199]
    v_pk_add_f32 v[88:89], v[88:89], v[200:201]
    v_pk_add_f32 v[90:91], v[90:91], v[202:203]
    v_pk_add_f32 v[84:85], v[84:85], v[60:61]
    v_pk_add_f32 v[86:87], v[86:87], v[60:61]
    v_pk_add_f32 v[88:89], v[88:89], v[60:61]
    v_pk_add_f32 v[90:91], v[90:91], v[60:61]
    buffer_load_dwordx4 v15, s[8:11], s58 offen offset:3072 lds
    v_pk_mul_f32 v[196:197], v[92:93], v[58:59]
    v_pk_mul_f32 v[198:199], v[94:95], v[58:59]
    v_pk_mul_f32 v[200:201], v[96:97], v[58:59]
    v_pk_mul_f32 v[202:203], v[98:99], v[58:59]
    v_exp_f32_e64 v196, v196 clamp
    v_exp_f32_e64 v197, v197 clamp
    v_exp_f32_e64 v198, v198 clamp
    v_exp_f32_e64 v199, v199 clamp
    v_exp_f32_e64 v200, v200 clamp
    v_exp_f32_e64 v201, v201 clamp
    v_exp_f32_e64 v202, v202 clamp
    v_exp_f32_e64 v203, v203 clamp
    v_max_f32 v92, 0, v92
    v_max_f32 v93, 0, v93
    v_max_f32 v94, 0, v94
    v_max_f32 v95, 0, v95
    v_max_f32 v96, 0, v96
    v_max_f32 v97, 0, v97
    v_max_f32 v98, 0, v98
    v_max_f32 v99, 0, v99
    v_pk_add_f32 v[92:93], v[92:93], v[196:197]
    v_pk_add_f32 v[94:95], v[94:95], v[198:199]
    v_pk_add_f32 v[96:97], v[96:97], v[200:201]
    v_pk_add_f32 v[98:99], v[98:99], v[202:203]
    v_pk_add_f32 v[92:93], v[92:93], v[60:61]
    v_pk_add_f32 v[94:95], v[94:95], v[60:61]
    v_pk_add_f32 v[96:97], v[96:97], v[60:61]
    v_pk_add_f32 v[98:99], v[98:99], v[60:61]
    s_add_u32 m0, s56, 16384
    s_add_u32 s58, s55, 640
    buffer_load_dwordx4 v12, s[8:11], s58 offen lds
    v_cvt_pk_bf16_f32 v204, v68, v69
    v_cvt_pk_bf16_f32 v205, v70, v71
    v_cvt_pk_bf16_f32 v206, v72, v73
    v_cvt_pk_bf16_f32 v207, v74, v75
    v_cvt_pk_bf16_f32 v208, v76, v77
    v_cvt_pk_bf16_f32 v209, v78, v79
    v_cvt_pk_bf16_f32 v210, v80, v81
    v_cvt_pk_bf16_f32 v211, v82, v83
    v_cvt_pk_bf16_f32 v212, v84, v85
    v_cvt_pk_bf16_f32 v213, v86, v87
    v_cvt_pk_bf16_f32 v214, v88, v89
    v_cvt_pk_bf16_f32 v215, v90, v91
    v_cvt_pk_bf16_f32 v216, v92, v93
    v_cvt_pk_bf16_f32 v217, v94, v95
    v_cvt_pk_bf16_f32 v218, v96, v97
    v_cvt_pk_bf16_f32 v219, v98, v99
    v_accvgpr_write_b32 a128, v204
    v_accvgpr_write_b32 a129, v205
    v_accvgpr_write_b32 a130, v206
    v_accvgpr_write_b32 a131, v207
    v_accvgpr_write_b32 a132, v208
    v_accvgpr_write_b32 a133, v209
    v_accvgpr_write_b32 a134, v210
    v_accvgpr_write_b32 a135, v211
    v_accvgpr_write_b32 a136, v212
    v_accvgpr_write_b32 a137, v213
    v_accvgpr_write_b32 a138, v214
    v_accvgpr_write_b32 a139, v215
    v_accvgpr_write_b32 a140, v216
    v_accvgpr_write_b32 a141, v217
    v_accvgpr_write_b32 a142, v218
    v_accvgpr_write_b32 a143, v219
    s_waitcnt vmcnt(18)
    s_barrier
    ds_read_b64_tr_b16 v[132:133], v28 offset:16384
    ds_read_b64_tr_b16 v[134:135], v28 offset:17408
    ds_read_b64_tr_b16 v[136:137], v29 offset:16384
    ds_read_b64_tr_b16 v[138:139], v29 offset:17408
    ds_read_b64_tr_b16 v[140:141], v30 offset:16384
    ds_read_b64_tr_b16 v[142:143], v30 offset:17408
    ds_read_b64_tr_b16 v[144:145], v31 offset:16384
    ds_read_b64_tr_b16 v[146:147], v31 offset:17408
    s_waitcnt lgkmcnt(6)
    v_mfma_f32_16x16x32_bf16 v[100:103], v[132:135], a[0:3], 0
    ds_read_b64_tr_b16 v[148:149], v28 offset:20480
    buffer_load_dwordx4 v13, s[8:11], s58 offen offset:1024 lds
    v_mfma_f32_16x16x32_bf16 v[116:119], v[132:135], a[4:7], 0
    ds_read_b64_tr_b16 v[150:151], v28 offset:21504
    buffer_load_dwordx4 v14, s[8:11], s58 offen offset:2048 lds
    s_waitcnt lgkmcnt(6)
    v_mfma_f32_16x16x32_bf16 v[104:107], v[136:139], a[0:3], 0
    ds_read_b64_tr_b16 v[152:153], v29 offset:20480
    buffer_load_dwordx4 v15, s[8:11], s58 offen offset:3072 lds
    v_mfma_f32_16x16x32_bf16 v[120:123], v[136:139], a[4:7], 0
    ds_read_b64_tr_b16 v[154:155], v29 offset:21504
    s_waitcnt lgkmcnt(6)
    v_mfma_f32_16x16x32_bf16 v[108:111], v[140:143], a[0:3], 0
    ds_read_b64_tr_b16 v[156:157], v30 offset:20480
    s_add_u32 m0, s56, 65536
    s_add_u32 s58, s93, 640
    buffer_load_dwordx4 v12, s[8:11], s58 offen lds
    v_mfma_f32_16x16x32_bf16 v[124:127], v[140:143], a[4:7], 0
    ds_read_b64_tr_b16 v[158:159], v30 offset:21504
    s_waitcnt lgkmcnt(6)
    v_mfma_f32_16x16x32_bf16 v[112:115], v[144:147], a[0:3], 0
    ds_read_b64_tr_b16 v[160:161], v31 offset:20480
    v_mfma_f32_16x16x32_bf16 v[128:131], v[144:147], a[4:7], 0
    ds_read_b64_tr_b16 v[162:163], v31 offset:21504
    buffer_load_dwordx4 v13, s[8:11], s58 offen offset:1024 lds
    s_waitcnt lgkmcnt(6)
    v_mfma_f32_16x16x32_bf16 v[100:103], v[148:151], a[8:11], v[100:103]
    ds_read_b64_tr_b16 v[132:133], v28 offset:24576
    v_mfma_f32_16x16x32_bf16 v[116:119], v[148:151], a[12:15], v[116:119]
    ds_read_b64_tr_b16 v[134:135], v28 offset:25600
    s_waitcnt lgkmcnt(6)
    v_mfma_f32_16x16x32_bf16 v[104:107], v[152:155], a[8:11], v[104:107]
    ds_read_b64_tr_b16 v[136:137], v29 offset:24576
    buffer_load_dwordx4 v14, s[8:11], s58 offen offset:2048 lds
    v_mfma_f32_16x16x32_bf16 v[120:123], v[152:155], a[12:15], v[120:123]
    ds_read_b64_tr_b16 v[138:139], v29 offset:25600
    s_waitcnt lgkmcnt(6)
    v_mfma_f32_16x16x32_bf16 v[108:111], v[156:159], a[8:11], v[108:111]
    ds_read_b64_tr_b16 v[140:141], v30 offset:24576
    v_mfma_f32_16x16x32_bf16 v[124:127], v[156:159], a[12:15], v[124:127]
    ds_read_b64_tr_b16 v[142:143], v30 offset:25600
    s_waitcnt lgkmcnt(6)
    v_mfma_f32_16x16x32_bf16 v[112:115], v[160:163], a[8:11], v[112:115]
    ds_read_b64_tr_b16 v[144:145], v31 offset:24576
    buffer_load_dwordx4 v15, s[8:11], s58 offen offset:3072 lds
    v_mfma_f32_16x16x32_bf16 v[128:131], v[160:163], a[12:15], v[128:131]
    ds_read_b64_tr_b16 v[146:147], v31 offset:25600
    s_waitcnt lgkmcnt(6)
    v_mfma_f32_16x16x32_bf16 v[100:103], v[132:135], a[16:19], v[100:103]
    ds_read_b64_tr_b16 v[148:149], v28 offset:28672
    v_mfma_f32_16x16x32_bf16 v[116:119], v[132:135], a[20:23], v[116:119]
    ds_read_b64_tr_b16 v[150:151], v28 offset:29696
    s_add_u32 m0, s56, 32768
    s_add_u32 s58, s95, 640
    buffer_load_dwordx4 v12, s[8:11], s58 offen lds
    s_waitcnt lgkmcnt(6)
    v_mfma_f32_16x16x32_bf16 v[104:107], v[136:139], a[16:19], v[104:107]
    ds_read_b64_tr_b16 v[152:153], v29 offset:28672
    v_mfma_f32_16x16x32_bf16 v[120:123], v[136:139], a[20:23], v[120:123]
    ds_read_b64_tr_b16 v[154:155], v29 offset:29696
    s_waitcnt lgkmcnt(6)
    v_mfma_f32_16x16x32_bf16 v[108:111], v[140:143], a[16:19], v[108:111]
    ds_read_b64_tr_b16 v[156:157], v30 offset:28672
    buffer_load_dwordx4 v13, s[8:11], s58 offen offset:1024 lds
    v_mfma_f32_16x16x32_bf16 v[124:127], v[140:143], a[20:23], v[124:127]
    ds_read_b64_tr_b16 v[158:159], v30 offset:29696
    s_waitcnt lgkmcnt(6)
    v_mfma_f32_16x16x32_bf16 v[112:115], v[144:147], a[16:19], v[112:115]
    ds_read_b64_tr_b16 v[160:161], v31 offset:28672
    v_mfma_f32_16x16x32_bf16 v[128:131], v[144:147], a[20:23], v[128:131]
    ds_read_b64_tr_b16 v[162:163], v31 offset:29696
    buffer_load_dwordx4 v14, s[8:11], s58 offen offset:2048 lds
    s_waitcnt lgkmcnt(6)
    v_mfma_f32_16x16x32_bf16 v[100:103], v[148:151], a[24:27], v[100:103]
    buffer_load_dwordx4 v15, s[8:11], s58 offen offset:3072 lds
    v_mfma_f32_16x16x32_bf16 v[116:119], v[148:151], a[28:31], v[116:119]
    s_waitcnt lgkmcnt(4)
    v_mfma_f32_16x16x32_bf16 v[104:107], v[152:155], a[24:27], v[104:107]
    v_mfma_f32_16x16x32_bf16 v[120:123], v[152:155], a[28:31], v[120:123]
    s_waitcnt vmcnt(24) lgkmcnt(0)
    s_barrier
    v_mfma_f32_16x16x32_bf16 v[108:111], v[156:159], a[24:27], v[108:111]
    ds_read_b64_tr_b16 v[132:133], v24 offset:49152
    ds_read_b64_tr_b16 v[134:135], v24 offset:50176
    s_add_u32 m0, s56, 81920
    s_add_u32 s58, s54, 768
    buffer_load_dwordx4 v12, s[8:11], s58 offen lds
    v_mfma_f32_16x16x32_bf16 v[124:127], v[156:159], a[28:31], v[124:127]
    ds_read_b64_tr_b16 v[136:137], v25 offset:49152
    ds_read_b64_tr_b16 v[138:139], v25 offset:50176
    v_mfma_f32_16x16x32_bf16 v[112:115], v[160:163], a[24:27], v[112:115]
    ds_read_b64_tr_b16 v[140:141], v26 offset:49152
    ds_read_b64_tr_b16 v[142:143], v26 offset:50176
    v_mfma_f32_16x16x32_bf16 v[128:131], v[160:163], a[28:31], v[128:131]
    ds_read_b64_tr_b16 v[144:145], v27 offset:49152
    ds_read_b64_tr_b16 v[146:147], v27 offset:50176
    s_waitcnt lgkmcnt(6)
    v_mfma_f32_16x16x32_bf16 v[100:103], v[132:135], a[32:35], v[100:103]
    ds_read_b64_tr_b16 v[148:149], v24 offset:53248
    buffer_load_dwordx4 v13, s[8:11], s58 offen offset:1024 lds
    v_mfma_f32_16x16x32_bf16 v[116:119], v[132:135], a[36:39], v[116:119]
    ds_read_b64_tr_b16 v[150:151], v24 offset:54272
    s_waitcnt lgkmcnt(6)
    v_mfma_f32_16x16x32_bf16 v[104:107], v[136:139], a[32:35], v[104:107]
    ds_read_b64_tr_b16 v[152:153], v25 offset:53248
    v_mfma_f32_16x16x32_bf16 v[120:123], v[136:139], a[36:39], v[120:123]
    ds_read_b64_tr_b16 v[154:155], v25 offset:54272
    s_waitcnt lgkmcnt(6)
    v_mfma_f32_16x16x32_bf16 v[108:111], v[140:143], a[32:35], v[108:111]
    ds_read_b64_tr_b16 v[156:157], v26 offset:53248
    v_mfma_f32_16x16x32_bf16 v[124:127], v[140:143], a[36:39], v[124:127]
    ds_read_b64_tr_b16 v[158:159], v26 offset:54272
    s_waitcnt lgkmcnt(6)
    v_mfma_f32_16x16x32_bf16 v[112:115], v[144:147], a[32:35], v[112:115]
    ds_read_b64_tr_b16 v[160:161], v27 offset:53248
    v_mfma_f32_16x16x32_bf16 v[128:131], v[144:147], a[36:39], v[128:131]
    ds_read_b64_tr_b16 v[162:163], v27 offset:54272
    s_waitcnt lgkmcnt(6)
    v_mfma_f32_16x16x32_bf16 v[100:103], v[148:151], a[40:43], v[100:103]
    ds_read_b64_tr_b16 v[132:133], v24 offset:57344
    v_mfma_f32_16x16x32_bf16 v[116:119], v[148:151], a[44:47], v[116:119]
    ds_read_b64_tr_b16 v[134:135], v24 offset:58368
    s_waitcnt lgkmcnt(6)
    v_mfma_f32_16x16x32_bf16 v[104:107], v[152:155], a[40:43], v[104:107]
    ds_read_b64_tr_b16 v[136:137], v25 offset:57344
    buffer_load_dwordx4 v14, s[8:11], s58 offen offset:2048 lds
    v_mfma_f32_16x16x32_bf16 v[120:123], v[152:155], a[44:47], v[120:123]
    ds_read_b64_tr_b16 v[138:139], v25 offset:58368
    s_waitcnt lgkmcnt(6)
    v_mfma_f32_16x16x32_bf16 v[108:111], v[156:159], a[40:43], v[108:111]
    ds_read_b64_tr_b16 v[140:141], v26 offset:57344
    v_mfma_f32_16x16x32_bf16 v[124:127], v[156:159], a[44:47], v[124:127]
    ds_read_b64_tr_b16 v[142:143], v26 offset:58368
    s_waitcnt lgkmcnt(6)
    v_mfma_f32_16x16x32_bf16 v[112:115], v[160:163], a[40:43], v[112:115]
    ds_read_b64_tr_b16 v[144:145], v27 offset:57344
    v_mfma_f32_16x16x32_bf16 v[128:131], v[160:163], a[44:47], v[128:131]
    ds_read_b64_tr_b16 v[146:147], v27 offset:58368
    s_waitcnt lgkmcnt(6)
    v_mfma_f32_16x16x32_bf16 v[100:103], v[132:135], a[48:51], v[100:103]
    ds_read_b64_tr_b16 v[148:149], v24 offset:61440
    v_mfma_f32_16x16x32_bf16 v[116:119], v[132:135], a[52:55], v[116:119]
    ds_read_b64_tr_b16 v[150:151], v24 offset:62464
    s_waitcnt lgkmcnt(6)
    v_mfma_f32_16x16x32_bf16 v[104:107], v[136:139], a[48:51], v[104:107]
    ds_read_b64_tr_b16 v[152:153], v25 offset:61440
    v_mfma_f32_16x16x32_bf16 v[120:123], v[136:139], a[52:55], v[120:123]
    ds_read_b64_tr_b16 v[154:155], v25 offset:62464
    s_waitcnt lgkmcnt(6)
    v_mfma_f32_16x16x32_bf16 v[108:111], v[140:143], a[48:51], v[108:111]
    ds_read_b64_tr_b16 v[156:157], v26 offset:61440
    buffer_load_dwordx4 v15, s[8:11], s58 offen offset:3072 lds
    v_mfma_f32_16x16x32_bf16 v[124:127], v[140:143], a[52:55], v[124:127]
    ds_read_b64_tr_b16 v[158:159], v26 offset:62464
    s_waitcnt lgkmcnt(6)
    v_mfma_f32_16x16x32_bf16 v[112:115], v[144:147], a[48:51], v[112:115]
    ds_read_b64_tr_b16 v[160:161], v27 offset:61440
    v_mfma_f32_16x16x32_bf16 v[128:131], v[144:147], a[52:55], v[128:131]
    ds_read_b64_tr_b16 v[162:163], v27 offset:62464
    s_waitcnt lgkmcnt(6)
    v_mfma_f32_16x16x32_bf16 v[100:103], v[148:151], a[56:59], v[100:103]
    v_mfma_f32_16x16x32_bf16 v[116:119], v[148:151], a[60:63], v[116:119]
    s_waitcnt lgkmcnt(4)
    v_mfma_f32_16x16x32_bf16 v[104:107], v[152:155], a[56:59], v[104:107]
    v_mfma_f32_16x16x32_bf16 v[120:123], v[152:155], a[60:63], v[120:123]
    s_waitcnt vmcnt(24) lgkmcnt(0)
    s_barrier
    v_mfma_f32_16x16x32_bf16 v[108:111], v[156:159], a[56:59], v[108:111]
    ds_read_b64_tr_b16 v[132:133], v28 offset:49152
    ds_read_b64_tr_b16 v[134:135], v28 offset:50176
    v_mfma_f32_16x16x32_bf16 v[124:127], v[156:159], a[60:63], v[124:127]
    ds_read_b64_tr_b16 v[136:137], v29 offset:49152
    ds_read_b64_tr_b16 v[138:139], v29 offset:50176
    s_add_u32 m0, s56, 49152
    s_add_u32 s58, s55, 768
    buffer_load_dwordx4 v12, s[8:11], s58 offen lds
    v_mfma_f32_16x16x32_bf16 v[112:115], v[160:163], a[56:59], v[112:115]
    ds_read_b64_tr_b16 v[140:141], v30 offset:49152
    ds_read_b64_tr_b16 v[142:143], v30 offset:50176
    v_mfma_f32_16x16x32_bf16 v[128:131], v[160:163], a[60:63], v[128:131]
    ds_read_b64_tr_b16 v[144:145], v31 offset:49152
    ds_read_b64_tr_b16 v[146:147], v31 offset:50176
    s_waitcnt lgkmcnt(6)
    v_mfma_f32_16x16x32_bf16 v[100:103], v[132:135], a[64:67], v[100:103]
    ds_read_b64_tr_b16 v[148:149], v28 offset:53248
    v_mfma_f32_16x16x32_bf16 v[116:119], v[132:135], a[68:71], v[116:119]
    ds_read_b64_tr_b16 v[150:151], v28 offset:54272
    buffer_load_dwordx4 v13, s[8:11], s58 offen offset:1024 lds
    s_waitcnt lgkmcnt(6)
    v_mfma_f32_16x16x32_bf16 v[104:107], v[136:139], a[64:67], v[104:107]
    ds_read_b64_tr_b16 v[152:153], v29 offset:53248
    v_mfma_f32_16x16x32_bf16 v[120:123], v[136:139], a[68:71], v[120:123]
    ds_read_b64_tr_b16 v[154:155], v29 offset:54272
    s_waitcnt lgkmcnt(6)
    v_mfma_f32_16x16x32_bf16 v[108:111], v[140:143], a[64:67], v[108:111]
    ds_read_b64_tr_b16 v[156:157], v30 offset:53248
    v_mfma_f32_16x16x32_bf16 v[124:127], v[140:143], a[68:71], v[124:127]
    ds_read_b64_tr_b16 v[158:159], v30 offset:54272
    buffer_load_dwordx4 v14, s[8:11], s58 offen offset:2048 lds
    s_waitcnt lgkmcnt(6)
    v_mfma_f32_16x16x32_bf16 v[112:115], v[144:147], a[64:67], v[112:115]
    ds_read_b64_tr_b16 v[160:161], v31 offset:53248
    v_mfma_f32_16x16x32_bf16 v[128:131], v[144:147], a[68:71], v[128:131]
    ds_read_b64_tr_b16 v[162:163], v31 offset:54272
    s_waitcnt lgkmcnt(6)
    v_mfma_f32_16x16x32_bf16 v[100:103], v[148:151], a[72:75], v[100:103]
    ds_read_b64_tr_b16 v[132:133], v28 offset:57344
    v_mfma_f32_16x16x32_bf16 v[116:119], v[148:151], a[76:79], v[116:119]
    ds_read_b64_tr_b16 v[134:135], v28 offset:58368
    buffer_load_dwordx4 v15, s[8:11], s58 offen offset:3072 lds
    s_waitcnt lgkmcnt(6)
    v_mfma_f32_16x16x32_bf16 v[104:107], v[152:155], a[72:75], v[104:107]
    ds_read_b64_tr_b16 v[136:137], v29 offset:57344
    v_mfma_f32_16x16x32_bf16 v[120:123], v[152:155], a[76:79], v[120:123]
    ds_read_b64_tr_b16 v[138:139], v29 offset:58368
    s_waitcnt lgkmcnt(6)
    v_mfma_f32_16x16x32_bf16 v[108:111], v[156:159], a[72:75], v[108:111]
    ds_read_b64_tr_b16 v[140:141], v30 offset:57344
    v_mfma_f32_16x16x32_bf16 v[124:127], v[156:159], a[76:79], v[124:127]
    ds_read_b64_tr_b16 v[142:143], v30 offset:58368
    s_waitcnt lgkmcnt(6)
    v_mfma_f32_16x16x32_bf16 v[112:115], v[160:163], a[72:75], v[112:115]
    ds_read_b64_tr_b16 v[144:145], v31 offset:57344
    v_mfma_f32_16x16x32_bf16 v[128:131], v[160:163], a[76:79], v[128:131]
    ds_read_b64_tr_b16 v[146:147], v31 offset:58368
    s_waitcnt lgkmcnt(6)
    v_mfma_f32_16x16x32_bf16 v[100:103], v[132:135], a[80:83], v[100:103]
    ds_read_b64_tr_b16 v[148:149], v28 offset:61440
    v_mfma_f32_16x16x32_bf16 v[116:119], v[132:135], a[84:87], v[116:119]
    ds_read_b64_tr_b16 v[150:151], v28 offset:62464
    s_waitcnt lgkmcnt(6)
    v_mfma_f32_16x16x32_bf16 v[104:107], v[136:139], a[80:83], v[104:107]
    ds_read_b64_tr_b16 v[152:153], v29 offset:61440
    v_mfma_f32_16x16x32_bf16 v[120:123], v[136:139], a[84:87], v[120:123]
    ds_read_b64_tr_b16 v[154:155], v29 offset:62464
    s_waitcnt lgkmcnt(6)
    v_mfma_f32_16x16x32_bf16 v[108:111], v[140:143], a[80:83], v[108:111]
    ds_read_b64_tr_b16 v[156:157], v30 offset:61440
    v_mfma_f32_16x16x32_bf16 v[124:127], v[140:143], a[84:87], v[124:127]
    ds_read_b64_tr_b16 v[158:159], v30 offset:62464
    s_waitcnt lgkmcnt(6)
    v_mfma_f32_16x16x32_bf16 v[112:115], v[144:147], a[80:83], v[112:115]
    ds_read_b64_tr_b16 v[160:161], v31 offset:61440
    v_mfma_f32_16x16x32_bf16 v[128:131], v[144:147], a[84:87], v[128:131]
    ds_read_b64_tr_b16 v[162:163], v31 offset:62464
    s_waitcnt lgkmcnt(6)
    v_mfma_f32_16x16x32_bf16 v[100:103], v[148:151], a[88:91], v[100:103]
    v_mfma_f32_16x16x32_bf16 v[116:119], v[148:151], a[92:95], v[116:119]
    s_waitcnt lgkmcnt(4)
    v_mfma_f32_16x16x32_bf16 v[104:107], v[152:155], a[88:91], v[104:107]
    v_mfma_f32_16x16x32_bf16 v[120:123], v[152:155], a[92:95], v[120:123]
    s_waitcnt vmcnt(24) lgkmcnt(0)
    s_barrier
    v_mfma_f32_16x16x32_bf16 v[108:111], v[156:159], a[88:91], v[108:111]
    ds_read_b64_tr_b16 v[132:133], v24 offset:0
    ds_read_b64_tr_b16 v[134:135], v24 offset:1024
    s_add_u32 m0, s56, 114688
    s_add_u32 s58, s93, 768
    buffer_load_dwordx4 v12, s[8:11], s58 offen lds
    v_mfma_f32_16x16x32_bf16 v[124:127], v[156:159], a[92:95], v[124:127]
    ds_read_b64_tr_b16 v[136:137], v25 offset:0
H_S1_2:
    s_cbranch_execz L_hopret
    ds_read_b64_tr_b16 v[138:139], v25 offset:1024
    buffer_load_dwordx4 v13, s[8:11], s58 offen offset:1024 lds
    v_mfma_f32_16x16x32_bf16 v[112:115], v[160:163], a[88:91], v[112:115]
    ds_read_b64_tr_b16 v[140:141], v26 offset:0
    ds_read_b64_tr_b16 v[142:143], v26 offset:1024
    buffer_load_dwordx4 v14, s[8:11], s58 offen offset:2048 lds
    v_mfma_f32_16x16x32_bf16 v[128:131], v[160:163], a[92:95], v[128:131]
    ds_read_b64_tr_b16 v[144:145], v27 offset:0
    ds_read_b64_tr_b16 v[146:147], v27 offset:1024
    buffer_load_dwordx4 v15, s[8:11], s58 offen offset:3072 lds
    s_waitcnt lgkmcnt(6)
    v_mfma_f32_16x16x32_bf16 v[100:103], v[132:135], a[96:99], v[100:103]
    ds_read_b64_tr_b16 v[148:149], v24 offset:4096
    v_mfma_f32_16x16x32_bf16 v[116:119], v[132:135], a[100:103], v[116:119]
    ds_read_b64_tr_b16 v[150:151], v24 offset:5120
    s_waitcnt lgkmcnt(6)
    v_mfma_f32_16x16x32_bf16 v[104:107], v[136:139], a[96:99], v[104:107]
    ds_read_b64_tr_b16 v[152:153], v25 offset:4096
    v_mfma_f32_16x16x32_bf16 v[120:123], v[136:139], a[100:103], v[120:123]
    ds_read_b64_tr_b16 v[154:155], v25 offset:5120
    s_waitcnt lgkmcnt(6)
    v_mfma_f32_16x16x32_bf16 v[108:111], v[140:143], a[96:99], v[108:111]
    ds_read_b64_tr_b16 v[156:157], v26 offset:4096
    v_mfma_f32_16x16x32_bf16 v[124:127], v[140:143], a[100:103], v[124:127]
    ds_read_b64_tr_b16 v[158:159], v26 offset:5120
    s_waitcnt lgkmcnt(6)
    v_mfma_f32_16x16x32_bf16 v[112:115], v[144:147], a[96:99], v[112:115]
    ds_read_b64_tr_b16 v[160:161], v27 offset:4096
    v_mfma_f32_16x16x32_bf16 v[128:131], v[144:147], a[100:103], v[128:131]
    ds_read_b64_tr_b16 v[162:163], v27 offset:5120
    s_waitcnt lgkmcnt(6)
    v_mfma_f32_16x16x32_bf16 v[100:103], v[148:151], a[104:107], v[100:103]
    ds_read_b64_tr_b16 v[132:133], v24 offset:8192
    v_mfma_f32_16x16x32_bf16 v[116:119], v[148:151], a[108:111], v[116:119]
    ds_read_b64_tr_b16 v[134:135], v24 offset:9216
    s_waitcnt lgkmcnt(6)
    v_mfma_f32_16x16x32_bf16 v[104:107], v[152:155], a[104:107], v[104:107]
    ds_read_b64_tr_b16 v[136:137], v25 offset:8192
    v_mfma_f32_16x16x32_bf16 v[120:123], v[152:155], a[108:111], v[120:123]
    ds_read_b64_tr_b16 v[138:139], v25 offset:9216
    s_waitcnt lgkmcnt(6)
    v_mfma_f32_16x16x32_bf16 v[108:111], v[156:159], a[104:107], v[108:111]
    ds_read_b64_tr_b16 v[140:141], v26 offset:8192
    v_mfma_f32_16x16x32_bf16 v[124:127], v[156:159], a[108:111], v[124:127]
    ds_read_b64_tr_b16 v[142:143], v26 offset:9216
    s_waitcnt lgkmcnt(6)
    v_mfma_f32_16x16x32_bf16 v[112:115], v[160:163], a[104:107], v[112:115]
    ds_read_b64_tr_b16 v[144:145], v27 offset:8192
    v_mfma_f32_16x16x32_bf16 v[128:131], v[160:163], a[108:111], v[128:131]
    ds_read_b64_tr_b16 v[146:147], v27 offset:9216
    s_waitcnt lgkmcnt(6)
    v_mfma_f32_16x16x32_bf16 v[100:103], v[132:135], a[112:115], v[100:103]
    ds_read_b64_tr_b16 v[148:149], v24 offset:12288
    v_mfma_f32_16x16x32_bf16 v[116:119], v[132:135], a[116:119], v[116:119]
    ds_read_b64_tr_b16 v[150:151], v24 offset:13312
    s_waitcnt lgkmcnt(6)
    v_mfma_f32_16x16x32_bf16 v[104:107], v[136:139], a[112:115], v[104:107]
    ds_read_b64_tr_b16 v[152:153], v25 offset:12288
    v_mfma_f32_16x16x32_bf16 v[120:123], v[136:139], a[116:119], v[120:123]
    ds_read_b64_tr_b16 v[154:155], v25 offset:13312
    s_waitcnt lgkmcnt(6)
    v_mfma_f32_16x16x32_bf16 v[108:111], v[140:143], a[112:115], v[108:111]
    ds_read_b64_tr_b16 v[156:157], v26 offset:12288
    v_mfma_f32_16x16x32_bf16 v[124:127], v[140:143], a[116:119], v[124:127]
    ds_read_b64_tr_b16 v[158:159], v26 offset:13312
    s_waitcnt lgkmcnt(6)
    v_mfma_f32_16x16x32_bf16 v[112:115], v[144:147], a[112:115], v[112:115]
    ds_read_b64_tr_b16 v[160:161], v27 offset:12288
    v_mfma_f32_16x16x32_bf16 v[128:131], v[144:147], a[116:119], v[128:131]
    ds_read_b64_tr_b16 v[162:163], v27 offset:13312
    s_waitcnt lgkmcnt(6)
    v_mfma_f32_16x16x32_bf16 v[100:103], v[148:151], a[120:123], v[100:103]
    v_mfma_f32_16x16x32_bf16 v[116:119], v[148:151], a[124:127], v[116:119]
    s_waitcnt lgkmcnt(4)
    v_mfma_f32_16x16x32_bf16 v[104:107], v[152:155], a[120:123], v[104:107]
    v_mfma_f32_16x16x32_bf16 v[120:123], v[152:155], a[124:127], v[120:123]
    s_waitcnt lgkmcnt(0)
    s_barrier
    v_mfma_f32_16x16x32_bf16 v[108:111], v[156:159], a[120:123], v[108:111]
    s_add_u32 m0, s56, 0
    s_add_u32 s58, s95, 768
    buffer_load_dwordx4 v12, s[8:11], s58 offen lds
    v_mfma_f32_16x16x32_bf16 v[124:127], v[156:159], a[124:127], v[124:127]
    buffer_load_dwordx4 v13, s[8:11], s58 offen offset:1024 lds
    v_mfma_f32_16x16x32_bf16 v[112:115], v[160:163], a[120:123], v[112:115]
    buffer_load_dwordx4 v14, s[8:11], s58 offen offset:2048 lds
    v_mfma_f32_16x16x32_bf16 v[128:131], v[160:163], a[124:127], v[128:131]
    buffer_load_dwordx4 v15, s[8:11], s58 offen offset:3072 lds
    v_pk_mul_f32 v[196:197], v[100:101], v[58:59]
    v_pk_mul_f32 v[198:199], v[102:103], v[58:59]
    v_pk_mul_f32 v[200:201], v[104:105], v[58:59]
    v_pk_mul_f32 v[202:203], v[106:107], v[58:59]
    v_exp_f32_e64 v196, v196 clamp
    v_exp_f32_e64 v197, v197 clamp
    v_exp_f32_e64 v198, v198 clamp
    v_exp_f32_e64 v199, v199 clamp
    v_exp_f32_e64 v200, v200 clamp
    v_exp_f32_e64 v201, v201 clamp
    v_exp_f32_e64 v202, v202 clamp
    v_exp_f32_e64 v203, v203 clamp
    v_max_f32 v100, 0, v100
    v_max_f32 v101, 0, v101
    v_max_f32 v102, 0, v102
    v_max_f32 v103, 0, v103
    v_max_f32 v104, 0, v104
    v_max_f32 v105, 0, v105
    v_max_f32 v106, 0, v106
    v_max_f32 v107, 0, v107
    v_pk_add_f32 v[100:101], v[100:101], v[196:197]
    v_pk_add_f32 v[102:103], v[102:103], v[198:199]
    v_pk_add_f32 v[104:105], v[104:105], v[200:201]
    v_pk_add_f32 v[106:107], v[106:107], v[202:203]
    v_pk_add_f32 v[100:101], v[100:101], v[60:61]
    v_pk_add_f32 v[102:103], v[102:103], v[60:61]
    v_pk_add_f32 v[104:105], v[104:105], v[60:61]
    v_pk_add_f32 v[106:107], v[106:107], v[60:61]
    v_pk_mul_f32 v[196:197], v[108:109], v[58:59]
    v_pk_mul_f32 v[198:199], v[110:111], v[58:59]
    v_pk_mul_f32 v[200:201], v[112:113], v[58:59]
    v_pk_mul_f32 v[202:203], v[114:115], v[58:59]
    v_exp_f32_e64 v196, v196 clamp
    v_exp_f32_e64 v197, v197 clamp
    v_exp_f32_e64 v198, v198 clamp
    v_exp_f32_e64 v199, v199 clamp
    v_exp_f32_e64 v200, v200 clamp
    v_exp_f32_e64 v201, v201 clamp
    v_exp_f32_e64 v202, v202 clamp
    v_exp_f32_e64 v203, v203 clamp
    v_max_f32 v108, 0, v108
    v_max_f32 v109, 0, v109
    v_max_f32 v110, 0, v110
    v_max_f32 v111, 0, v111
    v_max_f32 v112, 0, v112
    v_max_f32 v113, 0, v113
    v_max_f32 v114, 0, v114
    v_max_f32 v115, 0, v115
    v_pk_add_f32 v[108:109], v[108:109], v[196:197]
    v_pk_add_f32 v[110:111], v[110:111], v[198:199]
    v_pk_add_f32 v[112:113], v[112:113], v[200:201]
    v_pk_add_f32 v[114:115], v[114:115], v[202:203]
    v_pk_add_f32 v[108:109], v[108:109], v[60:61]
    v_pk_add_f32 v[110:111], v[110:111], v[60:61]
    v_pk_add_f32 v[112:113], v[112:113], v[60:61]
    v_pk_add_f32 v[114:115], v[114:115], v[60:61]
    v_pk_mul_f32 v[196:197], v[116:117], v[58:59]
    v_pk_mul_f32 v[198:199], v[118:119], v[58:59]
    v_pk_mul_f32 v[200:201], v[120:121], v[58:59]
    v_pk_mul_f32 v[202:203], v[122:123], v[58:59]
    v_exp_f32_e64 v196, v196 clamp
    v_exp_f32_e64 v197, v197 clamp
    v_exp_f32_e64 v198, v198 clamp
    v_exp_f32_e64 v199, v199 clamp
    v_exp_f32_e64 v200, v200 clamp
    v_exp_f32_e64 v201, v201 clamp
    v_exp_f32_e64 v202, v202 clamp
    v_exp_f32_e64 v203, v203 clamp
    v_max_f32 v116, 0, v116
    v_max_f32 v117, 0, v117
    v_max_f32 v118, 0, v118
    v_max_f32 v119, 0, v119
    v_max_f32 v120, 0, v120
    v_max_f32 v121, 0, v121
    v_max_f32 v122, 0, v122
    v_max_f32 v123, 0, v123
    v_pk_add_f32 v[116:117], v[116:117], v[196:197]
    v_pk_add_f32 v[118:119], v[118:119], v[198:199]
    v_pk_add_f32 v[120:121], v[120:121], v[200:201]
    v_pk_add_f32 v[122:123], v[122:123], v[202:203]
    v_pk_add_f32 v[116:117], v[116:117], v[60:61]
    v_pk_add_f32 v[118:119], v[118:119], v[60:61]
    v_pk_add_f32 v[120:121], v[120:121], v[60:61]
    v_pk_add_f32 v[122:123], v[122:123], v[60:61]
    v_pk_mul_f32 v[196:197], v[124:125], v[58:59]
    v_pk_mul_f32 v[198:199], v[126:127], v[58:59]
    v_pk_mul_f32 v[200:201], v[128:129], v[58:59]
    v_pk_mul_f32 v[202:203], v[130:131], v[58:59]
    v_exp_f32_e64 v196, v196 clamp
    v_exp_f32_e64 v197, v197 clamp
    v_exp_f32_e64 v198, v198 clamp
    v_exp_f32_e64 v199, v199 clamp
    v_exp_f32_e64 v200, v200 clamp
    v_exp_f32_e64 v201, v201 clamp
    v_exp_f32_e64 v202, v202 clamp
    v_exp_f32_e64 v203, v203 clamp
    v_max_f32 v124, 0, v124
    v_max_f32 v125, 0, v125
    v_max_f32 v126, 0, v126
    v_max_f32 v127, 0, v127
    v_max_f32 v128, 0, v128
    v_max_f32 v129, 0, v129
    v_max_f32 v130, 0, v130
    v_max_f32 v131, 0, v131
    v_pk_add_f32 v[124:125], v[124:125], v[196:197]
    v_pk_add_f32 v[126:127], v[126:127], v[198:199]
    v_pk_add_f32 v[128:129], v[128:129], v[200:201]
    v_pk_add_f32 v[130:131], v[130:131], v[202:203]
    v_pk_add_f32 v[124:125], v[124:125], v[60:61]
    v_pk_add_f32 v[126:127], v[126:127], v[60:61]
    v_pk_add_f32 v[128:129], v[128:129], v[60:61]
    v_pk_add_f32 v[130:131], v[130:131], v[60:61]
    v_cvt_pk_bf16_f32 v204, v100, v101
    v_cvt_pk_bf16_f32 v205, v102, v103
    v_cvt_pk_bf16_f32 v206, v104, v105
    v_cvt_pk_bf16_f32 v207, v106, v107
    v_cvt_pk_bf16_f32 v208, v108, v109
    v_cvt_pk_bf16_f32 v209, v110, v111
    v_cvt_pk_bf16_f32 v210, v112, v113
    v_cvt_pk_bf16_f32 v211, v114, v115
    v_cvt_pk_bf16_f32 v212, v116, v117
    v_cvt_pk_bf16_f32 v213, v118, v119
    v_cvt_pk_bf16_f32 v214, v120, v121
    v_cvt_pk_bf16_f32 v215, v122, v123
    v_cvt_pk_bf16_f32 v216, v124, v125
    v_cvt_pk_bf16_f32 v217, v126, v127
    v_cvt_pk_bf16_f32 v218, v128, v129
    v_cvt_pk_bf16_f32 v219, v130, v131
    v_accvgpr_write_b32 a144, v204
    v_accvgpr_write_b32 a145, v205
    v_accvgpr_write_b32 a146, v206
    v_accvgpr_write_b32 a147, v207
    v_accvgpr_write_b32 a148, v208
    v_accvgpr_write_b32 a149, v209
    v_accvgpr_write_b32 a150, v210
    v_accvgpr_write_b32 a151, v211
    v_accvgpr_write_b32 a152, v212
    v_accvgpr_write_b32 a153, v213
    v_accvgpr_write_b32 a154, v214
    v_accvgpr_write_b32 a155, v215
    v_accvgpr_write_b32 a156, v216
    v_accvgpr_write_b32 a157, v217
    v_accvgpr_write_b32 a158, v218
    v_accvgpr_write_b32 a159, v219
    s_waitcnt vmcnt(28)
    s_barrier
    ds_read_b64_tr_b16 v[132:133], v28 offset:32768
    ds_read_b64_tr_b16 v[134:135], v28 offset:33792
    ds_read_b64_tr_b16 v[136:137], v29 offset:32768
    ds_read_b64_tr_b16 v[138:139], v29 offset:33792
    ds_read_b64_tr_b16 v[140:141], v30 offset:32768
    ds_read_b64_tr_b16 v[142:143], v30 offset:33792
    ds_read_b64_tr_b16 v[144:145], v31 offset:32768
    ds_read_b64_tr_b16 v[146:147], v31 offset:33792
    s_waitcnt lgkmcnt(6)
    v_mfma_f32_16x16x32_bf16 v[68:71], v[132:135], a[0:3], 0
    ds_read_b64_tr_b16 v[148:149], v28 offset:36864
    v_mfma_f32_16x16x32_bf16 v[84:87], v[132:135], a[4:7], 0
    ds_read_b64_tr_b16 v[150:151], v28 offset:37888
    s_waitcnt lgkmcnt(6)
    v_mfma_f32_16x16x32_bf16 v[72:75], v[136:139], a[0:3], 0
    ds_read_b64_tr_b16 v[152:153], v29 offset:36864
    v_mfma_f32_16x16x32_bf16 v[88:91], v[136:139], a[4:7], 0
    ds_read_b64_tr_b16 v[154:155], v29 offset:37888
    s_waitcnt lgkmcnt(6)
    v_mfma_f32_16x16x32_bf16 v[76:79], v[140:143], a[0:3], 0
    ds_read_b64_tr_b16 v[156:157], v30 offset:36864
    v_mfma_f32_16x16x32_bf16 v[92:95], v[140:143], a[4:7], 0
    ds_read_b64_tr_b16 v[158:159], v30 offset:37888
    s_waitcnt lgkmcnt(6)
    v_mfma_f32_16x16x32_bf16 v[80:83], v[144:147], a[0:3], 0
    ds_read_b64_tr_b16 v[160:161], v31 offset:36864
    v_mfma_f32_16x16x32_bf16 v[96:99], v[144:147], a[4:7], 0
    ds_read_b64_tr_b16 v[162:163], v31 offset:37888
    s_waitcnt lgkmcnt(6)
    v_mfma_f32_16x16x32_bf16 v[68:71], v[148:151], a[8:11], v[68:71]
    ds_read_b64_tr_b16 v[132:133], v28 offset:40960
    v_mfma_f32_16x16x32_bf16 v[84:87], v[148:151], a[12:15], v[84:87]
    ds_read_b64_tr_b16 v[134:135], v28 offset:41984
    s_waitcnt lgkmcnt(6)
    v_mfma_f32_16x16x32_bf16 v[72:75], v[152:155], a[8:11], v[72:75]
    ds_read_b64_tr_b16 v[136:137], v29 offset:40960
    v_mfma_f32_16x16x32_bf16 v[88:91], v[152:155], a[12:15], v[88:91]
    ds_read_b64_tr_b16 v[138:139], v29 offset:41984
    s_waitcnt lgkmcnt(6)
    v_mfma_f32_16x16x32_bf16 v[76:79], v[156:159], a[8:11], v[76:79]
    ds_read_b64_tr_b16 v[140:141], v30 offset:40960
    v_mfma_f32_16x16x32_bf16 v[92:95], v[156:159], a[12:15], v[92:95]
    ds_read_b64_tr_b16 v[142:143], v30 offset:41984
    s_waitcnt lgkmcnt(6)
    v_mfma_f32_16x16x32_bf16 v[80:83], v[160:163], a[8:11], v[80:83]
    ds_read_b64_tr_b16 v[144:145], v31 offset:40960
    v_mfma_f32_16x16x32_bf16 v[96:99], v[160:163], a[12:15], v[96:99]
    ds_read_b64_tr_b16 v[146:147], v31 offset:41984
    s_waitcnt lgkmcnt(6)
    v_mfma_f32_16x16x32_bf16 v[68:71], v[132:135], a[16:19], v[68:71]
    ds_read_b64_tr_b16 v[148:149], v28 offset:45056
    v_mfma_f32_16x16x32_bf16 v[84:87], v[132:135], a[20:23], v[84:87]
    ds_read_b64_tr_b16 v[150:151], v28 offset:46080
    s_waitcnt lgkmcnt(6)
    v_mfma_f32_16x16x32_bf16 v[72:75], v[136:139], a[16:19], v[72:75]
    ds_read_b64_tr_b16 v[152:153], v29 offset:45056
    v_mfma_f32_16x16x32_bf16 v[88:91], v[136:139], a[20:23], v[88:91]
    ds_read_b64_tr_b16 v[154:155], v29 offset:46080
    s_waitcnt lgkmcnt(6)
    v_mfma_f32_16x16x32_bf16 v[76:79], v[140:143], a[16:19], v[76:79]
    ds_read_b64_tr_b16 v[156:157], v30 offset:45056
    v_mfma_f32_16x16x32_bf16 v[92:95], v[140:143], a[20:23], v[92:95]
    ds_read_b64_tr_b16 v[158:159], v30 offset:46080
    s_waitcnt lgkmcnt(6)
    v_mfma_f32_16x16x32_bf16 v[80:83], v[144:147], a[16:19], v[80:83]
    ds_read_b64_tr_b16 v[160:161], v31 offset:45056
    v_mfma_f32_16x16x32_bf16 v[96:99], v[144:147], a[20:23], v[96:99]
    ds_read_b64_tr_b16 v[162:163], v31 offset:46080
    s_waitcnt lgkmcnt(6)
    v_mfma_f32_16x16x32_bf16 v[68:71], v[148:151], a[24:27], v[68:71]
    v_mfma_f32_16x16x32_bf16 v[84:87], v[148:151], a[28:31], v[84:87]
    s_waitcnt lgkmcnt(4)
    v_mfma_f32_16x16x32_bf16 v[72:75], v[152:155], a[24:27], v[72:75]
    v_mfma_f32_16x16x32_bf16 v[88:91], v[152:155], a[28:31], v[88:91]
    s_waitcnt vmcnt(24) lgkmcnt(0)
    s_barrier
    v_mfma_f32_16x16x32_bf16 v[76:79], v[156:159], a[24:27], v[76:79]
    ds_read_b64_tr_b16 v[132:133], v24 offset:16384
    ds_read_b64_tr_b16 v[134:135], v24 offset:17408
    s_add_u32 m0, s56, 98304
    s_add_u32 s58, s54, 896
    buffer_load_dwordx4 v12, s[8:11], s58 offen lds
    v_mfma_f32_16x16x32_bf16 v[92:95], v[156:159], a[28:31], v[92:95]
    ds_read_b64_tr_b16 v[136:137], v25 offset:16384
    ds_read_b64_tr_b16 v[138:139], v25 offset:17408
    buffer_load_dwordx4 v13, s[8:11], s58 offen offset:1024 lds
    v_mfma_f32_16x16x32_bf16 v[80:83], v[160:163], a[24:27], v[80:83]
    ds_read_b64_tr_b16 v[140:141], v26 offset:16384
    ds_read_b64_tr_b16 v[142:143], v26 offset:17408
    buffer_load_dwordx4 v14, s[8:11], s58 offen offset:2048 lds
    v_mfma_f32_16x16x32_bf16 v[96:99], v[160:163], a[28:31], v[96:99]
    ds_read_b64_tr_b16 v[144:145], v27 offset:16384
    ds_read_b64_tr_b16 v[146:147], v27 offset:17408
    s_waitcnt lgkmcnt(6)
    v_mfma_f32_16x16x32_bf16 v[68:71], v[132:135], a[32:35], v[68:71]
    ds_read_b64_tr_b16 v[148:149], v24 offset:20480
    v_mfma_f32_16x16x32_bf16 v[84:87], v[132:135], a[36:39], v[84:87]
    ds_read_b64_tr_b16 v[150:151], v24 offset:21504
    s_waitcnt lgkmcnt(6)
    v_mfma_f32_16x16x32_bf16 v[72:75], v[136:139], a[32:35], v[72:75]
    ds_read_b64_tr_b16 v[152:153], v25 offset:20480
    v_mfma_f32_16x16x32_bf16 v[88:91], v[136:139], a[36:39], v[88:91]
    ds_read_b64_tr_b16 v[154:155], v25 offset:21504
    buffer_load_dwordx4 v15, s[8:11], s58 offen offset:3072 lds
    s_waitcnt lgkmcnt(6)
    v_mfma_f32_16x16x32_bf16 v[76:79], v[140:143], a[32:35], v[76:79]
    ds_read_b64_tr_b16 v[156:157], v26 offset:20480
    v_mfma_f32_16x16x32_bf16 v[92:95], v[140:143], a[36:39], v[92:95]
    ds_read_b64_tr_b16 v[158:159], v26 offset:21504
    s_waitcnt lgkmcnt(6)
    v_mfma_f32_16x16x32_bf16 v[80:83], v[144:147], a[32:35], v[80:83]
    ds_read_b64_tr_b16 v[160:161], v27 offset:20480
    v_mfma_f32_16x16x32_bf16 v[96:99], v[144:147], a[36:39], v[96:99]
    ds_read_b64_tr_b16 v[162:163], v27 offset:21504
    s_waitcnt lgkmcnt(6)
    v_mfma_f32_16x16x32_bf16 v[68:71], v[148:151], a[40:43], v[68:71]
    ds_read_b64_tr_b16 v[132:133], v24 offset:24576
    v_mfma_f32_16x16x32_bf16 v[84:87], v[148:151], a[44:47], v[84:87]
    ds_read_b64_tr_b16 v[134:135], v24 offset:25600
    s_waitcnt lgkmcnt(6)
    v_mfma_f32_16x16x32_bf16 v[72:75], v[152:155], a[40:43], v[72:75]
    ds_read_b64_tr_b16 v[136:137], v25 offset:24576
    v_mfma_f32_16x16x32_bf16 v[88:91], v[152:155], a[44:47], v[88:91]
    ds_read_b64_tr_b16 v[138:139], v25 offset:25600
    s_waitcnt lgkmcnt(6)
    v_mfma_f32_16x16x32_bf16 v[76:79], v[156:159], a[40:43], v[76:79]
    ds_read_b64_tr_b16 v[140:141], v26 offset:24576
    v_mfma_f32_16x16x32_bf16 v[92:95], v[156:159], a[44:47], v[92:95]
    ds_read_b64_tr_b16 v[142:143], v26 offset:25600
    s_waitcnt lgkmcnt(6)
    v_mfma_f32_16x16x32_bf16 v[80:83], v[160:163], a[40:43], v[80:83]
    ds_read_b64_tr_b16 v[144:145], v27 offset:24576
    v_mfma_f32_16x16x32_bf16 v[96:99], v[160:163], a[44:47], v[96:99]
    ds_read_b64_tr_b16 v[146:147], v27 offset:25600
    s_waitcnt lgkmcnt(6)
    v_mfma_f32_16x16x32_bf16 v[68:71], v[132:135], a[48:51], v[68:71]
    ds_read_b64_tr_b16 v[148:149], v24 offset:28672
    v_mfma_f32_16x16x32_bf16 v[84:87], v[132:135], a[52:55], v[84:87]
    ds_read_b64_tr_b16 v[150:151], v24 offset:29696
    s_waitcnt lgkmcnt(6)
    v_mfma_f32_16x16x32_bf16 v[72:75], v[136:139], a[48:51], v[72:75]
    ds_read_b64_tr_b16 v[152:153], v25 offset:28672
    v_mfma_f32_16x16x32_bf16 v[88:91], v[136:139], a[52:55], v[88:91]
    ds_read_b64_tr_b16 v[154:155], v25 offset:29696
    s_waitcnt lgkmcnt(6)
    v_mfma_f32_16x16x32_bf16 v[76:79], v[140:143], a[48:51], v[76:79]
    ds_read_b64_tr_b16 v[156:157], v26 offset:28672
    v_mfma_f32_16x16x32_bf16 v[92:95], v[140:143], a[52:55], v[92:95]
    ds_read_b64_tr_b16 v[158:159], v26 offset:29696
    s_waitcnt lgkmcnt(6)
    v_mfma_f32_16x16x32_bf16 v[80:83], v[144:147], a[48:51], v[80:83]
    ds_read_b64_tr_b16 v[160:161], v27 offset:28672
    v_mfma_f32_16x16x32_bf16 v[96:99], v[144:147], a[52:55], v[96:99]
    ds_read_b64_tr_b16 v[162:163], v27 offset:29696
    s_waitcnt lgkmcnt(6)
    v_mfma_f32_16x16x32_bf16 v[68:71], v[148:151], a[56:59], v[68:71]
    v_mfma_f32_16x16x32_bf16 v[84:87], v[148:151], a[60:63], v[84:87]
    s_waitcnt lgkmcnt(4)
    v_mfma_f32_16x16x32_bf16 v[72:75], v[152:155], a[56:59], v[72:75]
    v_mfma_f32_16x16x32_bf16 v[88:91], v[152:155], a[60:63], v[88:91]
    s_waitcnt vmcnt(24) lgkmcnt(0)
    s_barrier
    v_mfma_f32_16x16x32_bf16 v[76:79], v[156:159], a[56:59], v[76:79]
    ds_read_b64_tr_b16 v[132:133], v28 offset:0
    ds_read_b64_tr_b16 v[134:135], v28 offset:1024
    s_add_u32 m0, s56, 16384
    s_add_u32 s58, s55, 896
    buffer_load_dwordx4 v12, s[8:11], s58 offen lds
    v_mfma_f32_16x16x32_bf16 v[92:95], v[156:159], a[60:63], v[92:95]
    ds_read_b64_tr_b16 v[136:137], v29 offset:0
    ds_read_b64_tr_b16 v[138:139], v29 offset:1024
    buffer_load_dwordx4 v13, s[8:11], s58 offen offset:1024 lds
    v_mfma_f32_16x16x32_bf16 v[80:83], v[160:163], a[56:59], v[80:83]
    ds_read_b64_tr_b16 v[140:141], v30 offset:0
    ds_read_b64_tr_b16 v[142:143], v30 offset:1024
    buffer_load_dwordx4 v14, s[8:11], s58 offen offset:2048 lds
    v_mfma_f32_16x16x32_bf16 v[96:99], v[160:163], a[60:63], v[96:99]
    ds_read_b64_tr_b16 v[144:145], v31 offset:0
    ds_read_b64_tr_b16 v[146:147], v31 offset:1024
    buffer_load_dwordx4 v15, s[8:11], s58 offen offset:3072 lds
    s_waitcnt lgkmcnt(6)
    v_mfma_f32_16x16x32_bf16 v[68:71], v[132:135], a[64:67], v[68:71]
    ds_read_b64_tr_b16 v[148:149], v28 offset:4096
    v_mfma_f32_16x16x32_bf16 v[84:87], v[132:135], a[68:71], v[84:87]
    ds_read_b64_tr_b16 v[150:151], v28 offset:5120
    s_waitcnt lgkmcnt(6)
    v_mfma_f32_16x16x32_bf16 v[72:75], v[136:139], a[64:67], v[72:75]
    ds_read_b64_tr_b16 v[152:153], v29 offset:4096
    v_mfma_f32_16x16x32_bf16 v[88:91], v[136:139], a[68:71], v[88:91]
    ds_read_b64_tr_b16 v[154:155], v29 offset:5120
    s_waitcnt lgkmcnt(6)
    v_mfma_f32_16x16x32_bf16 v[76:79], v[140:143], a[64:67], v[76:79]
    ds_read_b64_tr_b16 v[156:157], v30 offset:4096
    v_mfma_f32_16x16x32_bf16 v[92:95], v[140:143], a[68:71], v[92:95]
    ds_read_b64_tr_b16 v[158:159], v30 offset:5120
    s_waitcnt lgkmcnt(6)
    v_mfma_f32_16x16x32_bf16 v[80:83], v[144:147], a[64:67], v[80:83]
    ds_read_b64_tr_b16 v[160:161], v31 offset:4096
    v_mfma_f32_16x16x32_bf16 v[96:99], v[144:147], a[68:71], v[96:99]
    ds_read_b64_tr_b16 v[162:163], v31 offset:5120
    s_waitcnt lgkmcnt(6)
    v_mfma_f32_16x16x32_bf16 v[68:71], v[148:151], a[72:75], v[68:71]
    ds_read_b64_tr_b16 v[132:133], v28 offset:8192
    v_mfma_f32_16x16x32_bf16 v[84:87], v[148:151], a[76:79], v[84:87]
    ds_read_b64_tr_b16 v[134:135], v28 offset:9216
    s_waitcnt lgkmcnt(6)
    v_mfma_f32_16x16x32_bf16 v[72:75], v[152:155], a[72:75], v[72:75]
    ds_read_b64_tr_b16 v[136:137], v29 offset:8192
    v_mfma_f32_16x16x32_bf16 v[88:91], v[152:155], a[76:79], v[88:91]
    ds_read_b64_tr_b16 v[138:139], v29 offset:9216
    s_waitcnt lgkmcnt(6)
    v_mfma_f32_16x16x32_bf16 v[76:79], v[156:159], a[72:75], v[76:79]
    ds_read_b64_tr_b16 v[140:141], v30 offset:8192
    v_mfma_f32_16x16x32_bf16 v[92:95], v[156:159], a[76:79], v[92:95]
    ds_read_b64_tr_b16 v[142:143], v30 offset:9216
    s_waitcnt lgkmcnt(6)
    v_mfma_f32_16x16x32_bf16 v[80:83], v[160:163], a[72:75], v[80:83]
    ds_read_b64_tr_b16 v[144:145], v31 offset:8192
    v_mfma_f32_16x16x32_bf16 v[96:99], v[160:163], a[76:79], v[96:99]
    ds_read_b64_tr_b16 v[146:147], v31 offset:9216
    s_waitcnt lgkmcnt(6)
    v_mfma_f32_16x16x32_bf16 v[68:71], v[132:135], a[80:83], v[68:71]
    ds_read_b64_tr_b16 v[148:149], v28 offset:12288
    v_mfma_f32_16x16x32_bf16 v[84:87], v[132:135], a[84:87], v[84:87]
    ds_read_b64_tr_b16 v[150:151], v28 offset:13312
    s_waitcnt lgkmcnt(6)
    v_mfma_f32_16x16x32_bf16 v[72:75], v[136:139], a[80:83], v[72:75]
    ds_read_b64_tr_b16 v[152:153], v29 offset:12288
    v_mfma_f32_16x16x32_bf16 v[88:91], v[136:139], a[84:87], v[88:91]
    ds_read_b64_tr_b16 v[154:155], v29 offset:13312
    s_waitcnt lgkmcnt(6)
    v_mfma_f32_16x16x32_bf16 v[76:79], v[140:143], a[80:83], v[76:79]
    ds_read_b64_tr_b16 v[156:157], v30 offset:12288
    v_mfma_f32_16x16x32_bf16 v[92:95], v[140:143], a[84:87], v[92:95]
    ds_read_b64_tr_b16 v[158:159], v30 offset:13312
    s_waitcnt lgkmcnt(6)
    v_mfma_f32_16x16x32_bf16 v[80:83], v[144:147], a[80:83], v[80:83]
    ds_read_b64_tr_b16 v[160:161], v31 offset:12288
    v_mfma_f32_16x16x32_bf16 v[96:99], v[144:147], a[84:87], v[96:99]
    ds_read_b64_tr_b16 v[162:163], v31 offset:13312
    s_waitcnt lgkmcnt(6)
    v_mfma_f32_16x16x32_bf16 v[68:71], v[148:151], a[88:91], v[68:71]
    v_mfma_f32_16x16x32_bf16 v[84:87], v[148:151], a[92:95], v[84:87]
    s_waitcnt lgkmcnt(4)
    v_mfma_f32_16x16x32_bf16 v[72:75], v[152:155], a[88:91], v[72:75]
    v_mfma_f32_16x16x32_bf16 v[88:91], v[152:155], a[92:95], v[88:91]
    s_waitcnt vmcnt(24) lgkmcnt(0)
    s_barrier
    v_mfma_f32_16x16x32_bf16 v[76:79], v[156:159], a[88:91], v[76:79]
    ds_read_b64_tr_b16 v[132:133], v24 offset:32768
    ds_read_b64_tr_b16 v[134:135], v24 offset:33792
    s_add_u32 m0, s56, 65536
    s_add_u32 s58, s93, 896
    buffer_load_dwordx4 v12, s[8:11], s58 offen lds
    v_mfma_f32_16x16x32_bf16 v[92:95], v[156:159], a[92:95], v[92:95]
    ds_read_b64_tr_b16 v[136:137], v25 offset:32768
    ds_read_b64_tr_b16 v[138:139], v25 offset:33792
    buffer_load_dwordx4 v13, s[8:11], s58 offen offset:1024 lds
    v_mfma_f32_16x16x32_bf16 v[80:83], v[160:163], a[88:91], v[80:83]
    ds_read_b64_tr_b16 v[140:141], v26 offset:32768
    ds_read_b64_tr_b16 v[142:143], v26 offset:33792
    buffer_load_dwordx4 v14, s[8:11], s58 offen offset:2048 lds
    v_mfma_f32_16x16x32_bf16 v[96:99], v[160:163], a[92:95], v[96:99]
    ds_read_b64_tr_b16 v[144:145], v27 offset:32768
    ds_read_b64_tr_b16 v[146:147], v27 offset:33792
    buffer_load_dwordx4 v15, s[8:11], s58 offen offset:3072 lds
    s_waitcnt lgkmcnt(6)
    v_mfma_f32_16x16x32_bf16 v[68:71], v[132:135], a[96:99], v[68:71]
    ds_read_b64_tr_b16 v[148:149], v24 offset:36864
    v_mfma_f32_16x16x32_bf16 v[84:87], v[132:135], a[100:103], v[84:87]
    ds_read_b64_tr_b16 v[150:151], v24 offset:37888
    s_waitcnt lgkmcnt(6)
    v_mfma_f32_16x16x32_bf16 v[72:75], v[136:139], a[96:99], v[72:75]
    ds_read_b64_tr_b16 v[152:153], v25 offset:36864
    v_mfma_f32_16x16x32_bf16 v[88:91], v[136:139], a[100:103], v[88:91]
    ds_read_b64_tr_b16 v[154:155], v25 offset:37888
    s_waitcnt lgkmcnt(6)
    v_mfma_f32_16x16x32_bf16 v[76:79], v[140:143], a[96:99], v[76:79]
    ds_read_b64_tr_b16 v[156:157], v26 offset:36864
    v_mfma_f32_16x16x32_bf16 v[92:95], v[140:143], a[100:103], v[92:95]
    ds_read_b64_tr_b16 v[158:159], v26 offset:37888
    s_waitcnt lgkmcnt(6)
    v_mfma_f32_16x16x32_bf16 v[80:83], v[144:147], a[96:99], v[80:83]
    ds_read_b64_tr_b16 v[160:161], v27 offset:36864
    v_mfma_f32_16x16x32_bf16 v[96:99], v[144:147], a[100:103], v[96:99]
    ds_read_b64_tr_b16 v[162:163], v27 offset:37888
    s_waitcnt lgkmcnt(6)
    v_mfma_f32_16x16x32_bf16 v[68:71], v[148:151], a[104:107], v[68:71]
    ds_read_b64_tr_b16 v[132:133], v24 offset:40960
    v_mfma_f32_16x16x32_bf16 v[84:87], v[148:151], a[108:111], v[84:87]
    ds_read_b64_tr_b16 v[134:135], v24 offset:41984
    s_waitcnt lgkmcnt(6)
    v_mfma_f32_16x16x32_bf16 v[72:75], v[152:155], a[104:107], v[72:75]
    ds_read_b64_tr_b16 v[136:137], v25 offset:40960
    v_mfma_f32_16x16x32_bf16 v[88:91], v[152:155], a[108:111], v[88:91]
    ds_read_b64_tr_b16 v[138:139], v25 offset:41984
    s_waitcnt lgkmcnt(6)
    v_mfma_f32_16x16x32_bf16 v[76:79], v[156:159], a[104:107], v[76:79]
    ds_read_b64_tr_b16 v[140:141], v26 offset:40960
    v_mfma_f32_16x16x32_bf16 v[92:95], v[156:159], a[108:111], v[92:95]
    ds_read_b64_tr_b16 v[142:143], v26 offset:41984
    s_waitcnt lgkmcnt(6)
    v_mfma_f32_16x16x32_bf16 v[80:83], v[160:163], a[104:107], v[80:83]
    ds_read_b64_tr_b16 v[144:145], v27 offset:40960
    v_mfma_f32_16x16x32_bf16 v[96:99], v[160:163], a[108:111], v[96:99]
    ds_read_b64_tr_b16 v[146:147], v27 offset:41984
    s_waitcnt lgkmcnt(6)
    v_mfma_f32_16x16x32_bf16 v[68:71], v[132:135], a[112:115], v[68:71]
    ds_read_b64_tr_b16 v[148:149], v24 offset:45056
    v_mfma_f32_16x16x32_bf16 v[84:87], v[132:135], a[116:119], v[84:87]
    ds_read_b64_tr_b16 v[150:151], v24 offset:46080
    s_waitcnt lgkmcnt(6)
    v_mfma_f32_16x16x32_bf16 v[72:75], v[136:139], a[112:115], v[72:75]
    ds_read_b64_tr_b16 v[152:153], v25 offset:45056
    v_mfma_f32_16x16x32_bf16 v[88:91], v[136:139], a[116:119], v[88:91]
    ds_read_b64_tr_b16 v[154:155], v25 offset:46080
    s_waitcnt lgkmcnt(6)
    v_mfma_f32_16x16x32_bf16 v[76:79], v[140:143], a[112:115], v[76:79]
    ds_read_b64_tr_b16 v[156:157], v26 offset:45056
    v_mfma_f32_16x16x32_bf16 v[92:95], v[140:143], a[116:119], v[92:95]
    ds_read_b64_tr_b16 v[158:159], v26 offset:46080
    s_waitcnt lgkmcnt(6)
    v_mfma_f32_16x16x32_bf16 v[80:83], v[144:147], a[112:115], v[80:83]
    ds_read_b64_tr_b16 v[160:161], v27 offset:45056
    v_mfma_f32_16x16x32_bf16 v[96:99], v[144:147], a[116:119], v[96:99]
    ds_read_b64_tr_b16 v[162:163], v27 offset:46080
    s_waitcnt lgkmcnt(6)
    v_mfma_f32_16x16x32_bf16 v[68:71], v[148:151], a[120:123], v[68:71]
    v_mfma_f32_16x16x32_bf16 v[84:87], v[148:151], a[124:127], v[84:87]
    s_waitcnt lgkmcnt(4)
    v_mfma_f32_16x16x32_bf16 v[72:75], v[152:155], a[120:123], v[72:75]
    v_mfma_f32_16x16x32_bf16 v[88:91], v[152:155], a[124:127], v[88:91]
    s_waitcnt lgkmcnt(0)
    s_barrier
    v_mfma_f32_16x16x32_bf16 v[76:79], v[156:159], a[120:123], v[76:79]
H_S1_3:
    s_cbranch_execz L_hopret
    s_add_u32 m0, s56, 32768
    s_add_u32 s58, s95, 896
    buffer_load_dwordx4 v12, s[8:11], s58 offen lds
    v_mfma_f32_16x16x32_bf16 v[92:95], v[156:159], a[124:127], v[92:95]
    buffer_load_dwordx4 v13, s[8:11], s58 offen offset:1024 lds
    v_mfma_f32_16x16x32_bf16 v[80:83], v[160:163], a[120:123], v[80:83]
    buffer_load_dwordx4 v14, s[8:11], s58 offen offset:2048 lds
    v_mfma_f32_16x16x32_bf16 v[96:99], v[160:163], a[124:127], v[96:99]
    buffer_load_dwordx4 v15, s[8:11], s58 offen offset:3072 lds
    v_pk_mul_f32 v[196:197], v[68:69], v[58:59]
    v_pk_mul_f32 v[198:199], v[70:71], v[58:59]
    v_pk_mul_f32 v[200:201], v[72:73], v[58:59]
    v_pk_mul_f32 v[202:203], v[74:75], v[58:59]
    v_exp_f32_e64 v196, v196 clamp
    v_exp_f32_e64 v197, v197 clamp
    v_exp_f32_e64 v198, v198 clamp
    v_exp_f32_e64 v199, v199 clamp
    v_exp_f32_e64 v200, v200 clamp
    v_exp_f32_e64 v201, v201 clamp
    v_exp_f32_e64 v202, v202 clamp
    v_exp_f32_e64 v203, v203 clamp
    v_lshrrev_b32 v39, 2, v1
    v_and_b32 v40, 3, v1
    v_lshlrev_b32 v40, 7, v40
    v_lshl_add_u32 v39, v39, 10, v40
    s_and_b32 s59, s57, 15
    s_lshl_b32 s59, s59, 14
    s_add_u32 s59, s59, 512
    v_add_u32 v39, s59, v39
    s_lshr_b32 s59, s45, 2
    s_add_u32 s59, s59, 0
    s_and_b32 s59, s59, 3
    s_lshl_b32 s59, s59, 18
    buffer_load_dword v38, v39, s[28:31], s59 offen
    v_max_f32 v68, 0, v68
    v_max_f32 v69, 0, v69
    v_max_f32 v70, 0, v70
    v_max_f32 v71, 0, v71
    v_max_f32 v72, 0, v72
    v_max_f32 v73, 0, v73
    v_max_f32 v74, 0, v74
    v_max_f32 v75, 0, v75
    v_pk_add_f32 v[68:69], v[68:69], v[196:197]
    v_pk_add_f32 v[70:71], v[70:71], v[198:199]
    v_pk_add_f32 v[72:73], v[72:73], v[200:201]
    v_pk_add_f32 v[74:75], v[74:75], v[202:203]
    v_pk_add_f32 v[68:69], v[68:69], v[60:61]
    v_pk_add_f32 v[70:71], v[70:71], v[60:61]
    v_pk_add_f32 v[72:73], v[72:73], v[60:61]
    v_pk_add_f32 v[74:75], v[74:75], v[60:61]
    v_pk_mul_f32 v[196:197], v[76:77], v[58:59]
    v_pk_mul_f32 v[198:199], v[78:79], v[58:59]
    v_pk_mul_f32 v[200:201], v[80:81], v[58:59]
    v_pk_mul_f32 v[202:203], v[82:83], v[58:59]
    v_exp_f32_e64 v196, v196 clamp
    v_exp_f32_e64 v197, v197 clamp
    v_exp_f32_e64 v198, v198 clamp
    v_exp_f32_e64 v199, v199 clamp
    v_exp_f32_e64 v200, v200 clamp
    v_exp_f32_e64 v201, v201 clamp
    v_exp_f32_e64 v202, v202 clamp
    v_exp_f32_e64 v203, v203 clamp
    v_max_f32 v76, 0, v76
    v_max_f32 v77, 0, v77
    v_max_f32 v78, 0, v78
    v_max_f32 v79, 0, v79
    v_max_f32 v80, 0, v80
    v_max_f32 v81, 0, v81
    v_max_f32 v82, 0, v82
    v_max_f32 v83, 0, v83
    v_pk_add_f32 v[76:77], v[76:77], v[196:197]
    v_pk_add_f32 v[78:79], v[78:79], v[198:199]
    v_pk_add_f32 v[80:81], v[80:81], v[200:201]
    v_pk_add_f32 v[82:83], v[82:83], v[202:203]
    v_pk_add_f32 v[76:77], v[76:77], v[60:61]
    v_pk_add_f32 v[78:79], v[78:79], v[60:61]
    v_pk_add_f32 v[80:81], v[80:81], v[60:61]
    v_pk_add_f32 v[82:83], v[82:83], v[60:61]
    v_pk_mul_f32 v[196:197], v[84:85], v[58:59]
    v_pk_mul_f32 v[198:199], v[86:87], v[58:59]
    v_pk_mul_f32 v[200:201], v[88:89], v[58:59]
    v_pk_mul_f32 v[202:203], v[90:91], v[58:59]
    v_exp_f32_e64 v196, v196 clamp
    v_exp_f32_e64 v197, v197 clamp
    v_exp_f32_e64 v198, v198 clamp
    v_exp_f32_e64 v199, v199 clamp
    v_exp_f32_e64 v200, v200 clamp
    v_exp_f32_e64 v201, v201 clamp
    v_exp_f32_e64 v202, v202 clamp
    v_exp_f32_e64 v203, v203 clamp
    v_max_f32 v84, 0, v84
    v_max_f32 v85, 0, v85
    v_max_f32 v86, 0, v86
    v_max_f32 v87, 0, v87
    v_max_f32 v88, 0, v88
    v_max_f32 v89, 0, v89
    v_max_f32 v90, 0, v90
    v_max_f32 v91, 0, v91
    v_pk_add_f32 v[84:85], v[84:85], v[196:197]
    v_pk_add_f32 v[86:87], v[86:87], v[198:199]
    v_pk_add_f32 v[88:89], v[88:89], v[200:201]
    v_pk_add_f32 v[90:91], v[90:91], v[202:203]
    v_pk_add_f32 v[84:85], v[84:85], v[60:61]
    v_pk_add_f32 v[86:87], v[86:87], v[60:61]
    v_pk_add_f32 v[88:89], v[88:89], v[60:61]
    v_pk_add_f32 v[90:91], v[90:91], v[60:61]
    v_pk_mul_f32 v[196:197], v[92:93], v[58:59]
    v_pk_mul_f32 v[198:199], v[94:95], v[58:59]
    v_pk_mul_f32 v[200:201], v[96:97], v[58:59]
    v_pk_mul_f32 v[202:203], v[98:99], v[58:59]
    v_exp_f32_e64 v196, v196 clamp
    v_exp_f32_e64 v197, v197 clamp
    v_exp_f32_e64 v198, v198 clamp
    v_exp_f32_e64 v199, v199 clamp
    v_exp_f32_e64 v200, v200 clamp
    v_exp_f32_e64 v201, v201 clamp
    v_exp_f32_e64 v202, v202 clamp
    v_exp_f32_e64 v203, v203 clamp
    v_max_f32 v92, 0, v92
    v_max_f32 v93, 0, v93
    v_max_f32 v94, 0, v94
    v_max_f32 v95, 0, v95
    v_max_f32 v96, 0, v96
    v_max_f32 v97, 0, v97
    v_max_f32 v98, 0, v98
    v_max_f32 v99, 0, v99
    v_pk_add_f32 v[92:93], v[92:93], v[196:197]
    v_pk_add_f32 v[94:95], v[94:95], v[198:199]
    v_pk_add_f32 v[96:97], v[96:97], v[200:201]
    v_pk_add_f32 v[98:99], v[98:99], v[202:203]
    v_pk_add_f32 v[92:93], v[92:93], v[60:61]
    v_pk_add_f32 v[94:95], v[94:95], v[60:61]
    v_pk_add_f32 v[96:97], v[96:97], v[60:61]
    v_pk_add_f32 v[98:99], v[98:99], v[60:61]
    s_lshr_b32 s59, s45, 2
    s_add_u32 s59, s59, 1
    s_and_b32 s59, s59, 3
    s_lshl_b32 s59, s59, 18
    buffer_load_dword v38, v39, s[28:31], s59 offen
    v_cvt_pk_bf16_f32 v204, v68, v69
    v_cvt_pk_bf16_f32 v205, v70, v71
    v_cvt_pk_bf16_f32 v206, v72, v73
    v_cvt_pk_bf16_f32 v207, v74, v75
    v_cvt_pk_bf16_f32 v208, v76, v77
    v_cvt_pk_bf16_f32 v209, v78, v79
    v_cvt_pk_bf16_f32 v210, v80, v81
    v_cvt_pk_bf16_f32 v211, v82, v83
    v_cvt_pk_bf16_f32 v212, v84, v85
    v_cvt_pk_bf16_f32 v213, v86, v87
    v_cvt_pk_bf16_f32 v214, v88, v89
    v_cvt_pk_bf16_f32 v215, v90, v91
    v_cvt_pk_bf16_f32 v216, v92, v93
    v_cvt_pk_bf16_f32 v217, v94, v95
    v_cvt_pk_bf16_f32 v218, v96, v97
    v_cvt_pk_bf16_f32 v219, v98, v99
    v_accvgpr_write_b32 a160, v204
    v_accvgpr_write_b32 a161, v205
    v_accvgpr_write_b32 a162, v206
    v_accvgpr_write_b32 a163, v207
    v_accvgpr_write_b32 a164, v208
    v_accvgpr_write_b32 a165, v209
    v_accvgpr_write_b32 a166, v210
    v_accvgpr_write_b32 a167, v211
    v_accvgpr_write_b32 a168, v212
    v_accvgpr_write_b32 a169, v213
    v_accvgpr_write_b32 a170, v214
    v_accvgpr_write_b32 a171, v215
    v_accvgpr_write_b32 a172, v216
    v_accvgpr_write_b32 a173, v217
    v_accvgpr_write_b32 a174, v218
    v_accvgpr_write_b32 a175, v219
    s_waitcnt vmcnt(30)
    s_barrier
    ds_read_b64_tr_b16 v[132:133], v28 offset:16384
    ds_read_b64_tr_b16 v[134:135], v28 offset:17408
    ds_read_b64_tr_b16 v[136:137], v29 offset:16384
    ds_read_b64_tr_b16 v[138:139], v29 offset:17408
    ds_read_b64_tr_b16 v[140:141], v30 offset:16384
    ds_read_b64_tr_b16 v[142:143], v30 offset:17408
    ds_read_b64_tr_b16 v[144:145], v31 offset:16384
    ds_read_b64_tr_b16 v[146:147], v31 offset:17408
    s_waitcnt lgkmcnt(6)
    v_mfma_f32_16x16x32_bf16 v[68:71], v[132:135], a[0:3], 0
    ds_read_b64_tr_b16 v[148:149], v28 offset:20480
    v_mfma_f32_16x16x32_bf16 v[84:87], v[132:135], a[4:7], 0
    ds_read_b64_tr_b16 v[150:151], v28 offset:21504
    s_waitcnt lgkmcnt(6)
    v_mfma_f32_16x16x32_bf16 v[72:75], v[136:139], a[0:3], 0
    ds_read_b64_tr_b16 v[152:153], v29 offset:20480
    v_mfma_f32_16x16x32_bf16 v[88:91], v[136:139], a[4:7], 0
    ds_read_b64_tr_b16 v[154:155], v29 offset:21504
    s_waitcnt lgkmcnt(6)
    v_mfma_f32_16x16x32_bf16 v[76:79], v[140:143], a[0:3], 0
    ds_read_b64_tr_b16 v[156:157], v30 offset:20480
    v_mfma_f32_16x16x32_bf16 v[92:95], v[140:143], a[4:7], 0
    ds_read_b64_tr_b16 v[158:159], v30 offset:21504
    s_waitcnt lgkmcnt(6)
    v_mfma_f32_16x16x32_bf16 v[80:83], v[144:147], a[0:3], 0
    ds_read_b64_tr_b16 v[160:161], v31 offset:20480
    v_mfma_f32_16x16x32_bf16 v[96:99], v[144:147], a[4:7], 0
    ds_read_b64_tr_b16 v[162:163], v31 offset:21504
    s_waitcnt lgkmcnt(6)
    v_mfma_f32_16x16x32_bf16 v[68:71], v[148:151], a[8:11], v[68:71]
    ds_read_b64_tr_b16 v[132:133], v28 offset:24576
    v_mfma_f32_16x16x32_bf16 v[84:87], v[148:151], a[12:15], v[84:87]
    ds_read_b64_tr_b16 v[134:135], v28 offset:25600
    s_waitcnt lgkmcnt(6)
    v_mfma_f32_16x16x32_bf16 v[72:75], v[152:155], a[8:11], v[72:75]
    ds_read_b64_tr_b16 v[136:137], v29 offset:24576
    v_mfma_f32_16x16x32_bf16 v[88:91], v[152:155], a[12:15], v[88:91]
    ds_read_b64_tr_b16 v[138:139], v29 offset:25600
    s_waitcnt lgkmcnt(6)
    v_mfma_f32_16x16x32_bf16 v[76:79], v[156:159], a[8:11], v[76:79]
    ds_read_b64_tr_b16 v[140:141], v30 offset:24576
    v_mfma_f32_16x16x32_bf16 v[92:95], v[156:159], a[12:15], v[92:95]
    ds_read_b64_tr_b16 v[142:143], v30 offset:25600
    s_waitcnt lgkmcnt(6)
    v_mfma_f32_16x16x32_bf16 v[80:83], v[160:163], a[8:11], v[80:83]
    ds_read_b64_tr_b16 v[144:145], v31 offset:24576
    v_mfma_f32_16x16x32_bf16 v[96:99], v[160:163], a[12:15], v[96:99]
    ds_read_b64_tr_b16 v[146:147], v31 offset:25600
    s_waitcnt lgkmcnt(6)
    v_mfma_f32_16x16x32_bf16 v[68:71], v[132:135], a[16:19], v[68:71]
    ds_read_b64_tr_b16 v[148:149], v28 offset:28672
    v_mfma_f32_16x16x32_bf16 v[84:87], v[132:135], a[20:23], v[84:87]
    ds_read_b64_tr_b16 v[150:151], v28 offset:29696
    s_waitcnt lgkmcnt(6)
    v_mfma_f32_16x16x32_bf16 v[72:75], v[136:139], a[16:19], v[72:75]
    ds_read_b64_tr_b16 v[152:153], v29 offset:28672
    v_mfma_f32_16x16x32_bf16 v[88:91], v[136:139], a[20:23], v[88:91]
    ds_read_b64_tr_b16 v[154:155], v29 offset:29696
    s_waitcnt lgkmcnt(6)
    v_mfma_f32_16x16x32_bf16 v[76:79], v[140:143], a[16:19], v[76:79]
    ds_read_b64_tr_b16 v[156:157], v30 offset:28672
    v_mfma_f32_16x16x32_bf16 v[92:95], v[140:143], a[20:23], v[92:95]
    ds_read_b64_tr_b16 v[158:159], v30 offset:29696
    s_waitcnt lgkmcnt(6)
    v_mfma_f32_16x16x32_bf16 v[80:83], v[144:147], a[16:19], v[80:83]
    ds_read_b64_tr_b16 v[160:161], v31 offset:28672
    v_mfma_f32_16x16x32_bf16 v[96:99], v[144:147], a[20:23], v[96:99]
    ds_read_b64_tr_b16 v[162:163], v31 offset:29696
    s_waitcnt lgkmcnt(6)
    v_mfma_f32_16x16x32_bf16 v[68:71], v[148:151], a[24:27], v[68:71]
    v_mfma_f32_16x16x32_bf16 v[84:87], v[148:151], a[28:31], v[84:87]
    s_waitcnt lgkmcnt(4)
    v_mfma_f32_16x16x32_bf16 v[72:75], v[152:155], a[24:27], v[72:75]
    v_mfma_f32_16x16x32_bf16 v[88:91], v[152:155], a[28:31], v[88:91]
    s_waitcnt vmcnt(26) lgkmcnt(0)
    s_barrier
    v_mfma_f32_16x16x32_bf16 v[76:79], v[156:159], a[24:27], v[76:79]
    ds_read_b64_tr_b16 v[132:133], v24 offset:49152
    ds_read_b64_tr_b16 v[134:135], v24 offset:50176
    v_mfma_f32_16x16x32_bf16 v[92:95], v[156:159], a[28:31], v[92:95]
    ds_read_b64_tr_b16 v[136:137], v25 offset:49152
    ds_read_b64_tr_b16 v[138:139], v25 offset:50176
    v_mfma_f32_16x16x32_bf16 v[80:83], v[160:163], a[24:27], v[80:83]
    ds_read_b64_tr_b16 v[140:141], v26 offset:49152
    ds_read_b64_tr_b16 v[142:143], v26 offset:50176
    v_mfma_f32_16x16x32_bf16 v[96:99], v[160:163], a[28:31], v[96:99]
    ds_read_b64_tr_b16 v[144:145], v27 offset:49152
    ds_read_b64_tr_b16 v[146:147], v27 offset:50176
    s_lshr_b32 s59, s45, 2
    s_add_u32 s59, s59, 2
    s_and_b32 s59, s59, 3
    s_lshl_b32 s59, s59, 18
    buffer_load_dword v38, v39, s[28:31], s59 offen
    s_waitcnt lgkmcnt(6)
    v_mfma_f32_16x16x32_bf16 v[68:71], v[132:135], a[32:35], v[68:71]
    ds_read_b64_tr_b16 v[148:149], v24 offset:53248
    v_mfma_f32_16x16x32_bf16 v[84:87], v[132:135], a[36:39], v[84:87]
    ds_read_b64_tr_b16 v[150:151], v24 offset:54272
    s_waitcnt lgkmcnt(6)
    v_mfma_f32_16x16x32_bf16 v[72:75], v[136:139], a[32:35], v[72:75]
    ds_read_b64_tr_b16 v[152:153], v25 offset:53248
    v_mfma_f32_16x16x32_bf16 v[88:91], v[136:139], a[36:39], v[88:91]
    ds_read_b64_tr_b16 v[154:155], v25 offset:54272
    s_waitcnt lgkmcnt(6)
    v_mfma_f32_16x16x32_bf16 v[76:79], v[140:143], a[32:35], v[76:79]
    ds_read_b64_tr_b16 v[156:157], v26 offset:53248
    v_mfma_f32_16x16x32_bf16 v[92:95], v[140:143], a[36:39], v[92:95]
    ds_read_b64_tr_b16 v[158:159], v26 offset:54272
    s_waitcnt lgkmcnt(6)
    v_mfma_f32_16x16x32_bf16 v[80:83], v[144:147], a[32:35], v[80:83]
    ds_read_b64_tr_b16 v[160:161], v27 offset:53248
    v_mfma_f32_16x16x32_bf16 v[96:99], v[144:147], a[36:39], v[96:99]
    ds_read_b64_tr_b16 v[162:163], v27 offset:54272
    s_waitcnt lgkmcnt(6)
    v_mfma_f32_16x16x32_bf16 v[68:71], v[148:151], a[40:43], v[68:71]
    ds_read_b64_tr_b16 v[132:133], v24 offset:57344
    v_mfma_f32_16x16x32_bf16 v[84:87], v[148:151], a[44:47], v[84:87]
    ds_read_b64_tr_b16 v[134:135], v24 offset:58368
    s_waitcnt lgkmcnt(6)
    v_mfma_f32_16x16x32_bf16 v[72:75], v[152:155], a[40:43], v[72:75]
    ds_read_b64_tr_b16 v[136:137], v25 offset:57344
    v_mfma_f32_16x16x32_bf16 v[88:91], v[152:155], a[44:47], v[88:91]
    ds_read_b64_tr_b16 v[138:139], v25 offset:58368
    s_waitcnt lgkmcnt(6)
    v_mfma_f32_16x16x32_bf16 v[76:79], v[156:159], a[40:43], v[76:79]
    ds_read_b64_tr_b16 v[140:141], v26 offset:57344
    v_mfma_f32_16x16x32_bf16 v[92:95], v[156:159], a[44:47], v[92:95]
    ds_read_b64_tr_b16 v[142:143], v26 offset:58368
    s_waitcnt lgkmcnt(6)
    v_mfma_f32_16x16x32_bf16 v[80:83], v[160:163], a[40:43], v[80:83]
    ds_read_b64_tr_b16 v[144:145], v27 offset:57344
    v_mfma_f32_16x16x32_bf16 v[96:99], v[160:163], a[44:47], v[96:99]
    ds_read_b64_tr_b16 v[146:147], v27 offset:58368
    s_waitcnt lgkmcnt(6)
    v_mfma_f32_16x16x32_bf16 v[68:71], v[132:135], a[48:51], v[68:71]
    ds_read_b64_tr_b16 v[148:149], v24 offset:61440
    v_mfma_f32_16x16x32_bf16 v[84:87], v[132:135], a[52:55], v[84:87]
    ds_read_b64_tr_b16 v[150:151], v24 offset:62464
    s_waitcnt lgkmcnt(6)
    v_mfma_f32_16x16x32_bf16 v[72:75], v[136:139], a[48:51], v[72:75]
    ds_read_b64_tr_b16 v[152:153], v25 offset:61440
    v_mfma_f32_16x16x32_bf16 v[88:91], v[136:139], a[52:55], v[88:91]
    ds_read_b64_tr_b16 v[154:155], v25 offset:62464
    s_waitcnt lgkmcnt(6)
    v_mfma_f32_16x16x32_bf16 v[76:79], v[140:143], a[48:51], v[76:79]
    ds_read_b64_tr_b16 v[156:157], v26 offset:61440
    v_mfma_f32_16x16x32_bf16 v[92:95], v[140:143], a[52:55], v[92:95]
    ds_read_b64_tr_b16 v[158:159], v26 offset:62464
    s_waitcnt lgkmcnt(6)
    v_mfma_f32_16x16x32_bf16 v[80:83], v[144:147], a[48:51], v[80:83]
    ds_read_b64_tr_b16 v[160:161], v27 offset:61440
    v_mfma_f32_16x16x32_bf16 v[96:99], v[144:147], a[52:55], v[96:99]
    ds_read_b64_tr_b16 v[162:163], v27 offset:62464
    s_waitcnt lgkmcnt(6)
    v_mfma_f32_16x16x32_bf16 v[68:71], v[148:151], a[56:59], v[68:71]
    v_mfma_f32_16x16x32_bf16 v[84:87], v[148:151], a[60:63], v[84:87]
    s_waitcnt lgkmcnt(4)
    v_mfma_f32_16x16x32_bf16 v[72:75], v[152:155], a[56:59], v[72:75]
    v_mfma_f32_16x16x32_bf16 v[88:91], v[152:155], a[60:63], v[88:91]
    s_waitcnt vmcnt(23) lgkmcnt(0)
    s_barrier
    v_mfma_f32_16x16x32_bf16 v[76:79], v[156:159], a[56:59], v[76:79]
    ds_read_b64_tr_b16 v[132:133], v28 offset:49152
    ds_read_b64_tr_b16 v[134:135], v28 offset:50176
    v_mfma_f32_16x16x32_bf16 v[92:95], v[156:159], a[60:63], v[92:95]
    ds_read_b64_tr_b16 v[136:137], v29 offset:49152
    ds_read_b64_tr_b16 v[138:139], v29 offset:50176
    v_mfma_f32_16x16x32_bf16 v[80:83], v[160:163], a[56:59], v[80:83]
    ds_read_b64_tr_b16 v[140:141], v30 offset:49152
    ds_read_b64_tr_b16 v[142:143], v30 offset:50176
    v_mfma_f32_16x16x32_bf16 v[96:99], v[160:163], a[60:63], v[96:99]
    ds_read_b64_tr_b16 v[144:145], v31 offset:49152
    ds_read_b64_tr_b16 v[146:147], v31 offset:50176
    s_waitcnt lgkmcnt(6)
    v_mfma_f32_16x16x32_bf16 v[68:71], v[132:135], a[64:67], v[68:71]
    ds_read_b64_tr_b16 v[148:149], v28 offset:53248
    v_mfma_f32_16x16x32_bf16 v[84:87], v[132:135], a[68:71], v[84:87]
    ds_read_b64_tr_b16 v[150:151], v28 offset:54272
    s_waitcnt lgkmcnt(6)
    v_mfma_f32_16x16x32_bf16 v[72:75], v[136:139], a[64:67], v[72:75]
    ds_read_b64_tr_b16 v[152:153], v29 offset:53248
    v_mfma_f32_16x16x32_bf16 v[88:91], v[136:139], a[68:71], v[88:91]
    ds_read_b64_tr_b16 v[154:155], v29 offset:54272
    s_waitcnt lgkmcnt(6)
    v_mfma_f32_16x16x32_bf16 v[76:79], v[140:143], a[64:67], v[76:79]
    ds_read_b64_tr_b16 v[156:157], v30 offset:53248
    v_mfma_f32_16x16x32_bf16 v[92:95], v[140:143], a[68:71], v[92:95]
    ds_read_b64_tr_b16 v[158:159], v30 offset:54272
    s_waitcnt lgkmcnt(6)
    v_mfma_f32_16x16x32_bf16 v[80:83], v[144:147], a[64:67], v[80:83]
    ds_read_b64_tr_b16 v[160:161], v31 offset:53248
    v_mfma_f32_16x16x32_bf16 v[96:99], v[144:147], a[68:71], v[96:99]
    ds_read_b64_tr_b16 v[162:163], v31 offset:54272
    s_waitcnt lgkmcnt(6)
    v_mfma_f32_16x16x32_bf16 v[68:71], v[148:151], a[72:75], v[68:71]
    ds_read_b64_tr_b16 v[132:133], v28 offset:57344
    v_mfma_f32_16x16x32_bf16 v[84:87], v[148:151], a[76:79], v[84:87]
    ds_read_b64_tr_b16 v[134:135], v28 offset:58368
    s_waitcnt lgkmcnt(6)
    v_mfma_f32_16x16x32_bf16 v[72:75], v[152:155], a[72:75], v[72:75]
    ds_read_b64_tr_b16 v[136:137], v29 offset:57344
    v_mfma_f32_16x16x32_bf16 v[88:91], v[152:155], a[76:79], v[88:91]
    ds_read_b64_tr_b16 v[138:139], v29 offset:58368
    s_lshr_b32 s59, s45, 2
    s_add_u32 s59, s59, 3
    s_and_b32 s59, s59, 3
    s_lshl_b32 s59, s59, 18
    buffer_load_dword v38, v39, s[28:31], s59 offen
    s_waitcnt lgkmcnt(6)
    v_mfma_f32_16x16x32_bf16 v[76:79], v[156:159], a[72:75], v[76:79]
    ds_read_b64_tr_b16 v[140:141], v30 offset:57344
    v_mfma_f32_16x16x32_bf16 v[92:95], v[156:159], a[76:79], v[92:95]
    ds_read_b64_tr_b16 v[142:143], v30 offset:58368
    s_waitcnt lgkmcnt(6)
    v_mfma_f32_16x16x32_bf16 v[80:83], v[160:163], a[72:75], v[80:83]
    ds_read_b64_tr_b16 v[144:145], v31 offset:57344
    v_mfma_f32_16x16x32_bf16 v[96:99], v[160:163], a[76:79], v[96:99]
    ds_read_b64_tr_b16 v[146:147], v31 offset:58368
    s_waitcnt lgkmcnt(6)
    v_mfma_f32_16x16x32_bf16 v[68:71], v[132:135], a[80:83], v[68:71]
    ds_read_b64_tr_b16 v[148:149], v28 offset:61440
    v_mfma_f32_16x16x32_bf16 v[84:87], v[132:135], a[84:87], v[84:87]
    ds_read_b64_tr_b16 v[150:151], v28 offset:62464
    s_waitcnt lgkmcnt(6)
    v_mfma_f32_16x16x32_bf16 v[72:75], v[136:139], a[80:83], v[72:75]
    ds_read_b64_tr_b16 v[152:153], v29 offset:61440
    v_mfma_f32_16x16x32_bf16 v[88:91], v[136:139], a[84:87], v[88:91]
    ds_read_b64_tr_b16 v[154:155], v29 offset:62464
    s_waitcnt lgkmcnt(6)
    v_mfma_f32_16x16x32_bf16 v[76:79], v[140:143], a[80:83], v[76:79]
    ds_read_b64_tr_b16 v[156:157], v30 offset:61440
    v_mfma_f32_16x16x32_bf16 v[92:95], v[140:143], a[84:87], v[92:95]
    ds_read_b64_tr_b16 v[158:159], v30 offset:62464
    s_waitcnt lgkmcnt(6)
    v_mfma_f32_16x16x32_bf16 v[80:83], v[144:147], a[80:83], v[80:83]
    ds_read_b64_tr_b16 v[160:161], v31 offset:61440
    v_mfma_f32_16x16x32_bf16 v[96:99], v[144:147], a[84:87], v[96:99]
    ds_read_b64_tr_b16 v[162:163], v31 offset:62464
    s_waitcnt lgkmcnt(6)
    v_mfma_f32_16x16x32_bf16 v[68:71], v[148:151], a[88:91], v[68:71]
    v_mfma_f32_16x16x32_bf16 v[84:87], v[148:151], a[92:95], v[84:87]
    s_waitcnt lgkmcnt(4)
    v_mfma_f32_16x16x32_bf16 v[72:75], v[152:155], a[88:91], v[72:75]
    v_mfma_f32_16x16x32_bf16 v[88:91], v[152:155], a[92:95], v[88:91]
    s_waitcnt vmcnt(20) lgkmcnt(0)
    s_barrier
    v_mfma_f32_16x16x32_bf16 v[76:79], v[156:159], a[88:91], v[76:79]
    ds_read_b64_tr_b16 v[132:133], v24 offset:0
    ds_read_b64_tr_b16 v[134:135], v24 offset:1024
    v_mfma_f32_16x16x32_bf16 v[92:95], v[156:159], a[92:95], v[92:95]
    ds_read_b64_tr_b16 v[136:137], v25 offset:0
    ds_read_b64_tr_b16 v[138:139], v25 offset:1024
    v_mfma_f32_16x16x32_bf16 v[80:83], v[160:163], a[88:91], v[80:83]
    ds_read_b64_tr_b16 v[140:141], v26 offset:0
    ds_read_b64_tr_b16 v[142:143], v26 offset:1024
    v_mfma_f32_16x16x32_bf16 v[96:99], v[160:163], a[92:95], v[96:99]
    ds_read_b64_tr_b16 v[144:145], v27 offset:0
    ds_read_b64_tr_b16 v[146:147], v27 offset:1024
    s_waitcnt lgkmcnt(6)
    v_mfma_f32_16x16x32_bf16 v[68:71], v[132:135], a[96:99], v[68:71]
    ds_read_b64_tr_b16 v[148:149], v24 offset:4096
    v_mfma_f32_16x16x32_bf16 v[84:87], v[132:135], a[100:103], v[84:87]
    ds_read_b64_tr_b16 v[150:151], v24 offset:5120
    s_waitcnt lgkmcnt(6)
    v_mfma_f32_16x16x32_bf16 v[72:75], v[136:139], a[96:99], v[72:75]
    ds_read_b64_tr_b16 v[152:153], v25 offset:4096
    v_mfma_f32_16x16x32_bf16 v[88:91], v[136:139], a[100:103], v[88:91]
    ds_read_b64_tr_b16 v[154:155], v25 offset:5120
    s_waitcnt lgkmcnt(6)
    v_mfma_f32_16x16x32_bf16 v[76:79], v[140:143], a[96:99], v[76:79]
    ds_read_b64_tr_b16 v[156:157], v26 offset:4096
    v_mfma_f32_16x16x32_bf16 v[92:95], v[140:143], a[100:103], v[92:95]
    ds_read_b64_tr_b16 v[158:159], v26 offset:5120
    s_waitcnt lgkmcnt(6)
    v_mfma_f32_16x16x32_bf16 v[80:83], v[144:147], a[96:99], v[80:83]
    ds_read_b64_tr_b16 v[160:161], v27 offset:4096
    v_mfma_f32_16x16x32_bf16 v[96:99], v[144:147], a[100:103], v[96:99]
    ds_read_b64_tr_b16 v[162:163], v27 offset:5120
    s_waitcnt lgkmcnt(6)
    v_mfma_f32_16x16x32_bf16 v[68:71], v[148:151], a[104:107], v[68:71]
    ds_read_b64_tr_b16 v[132:133], v24 offset:8192
    v_mfma_f32_16x16x32_bf16 v[84:87], v[148:151], a[108:111], v[84:87]
    ds_read_b64_tr_b16 v[134:135], v24 offset:9216
    s_waitcnt lgkmcnt(6)
    v_mfma_f32_16x16x32_bf16 v[72:75], v[152:155], a[104:107], v[72:75]
    ds_read_b64_tr_b16 v[136:137], v25 offset:8192
    v_mfma_f32_16x16x32_bf16 v[88:91], v[152:155], a[108:111], v[88:91]
    ds_read_b64_tr_b16 v[138:139], v25 offset:9216
    s_waitcnt lgkmcnt(6)
    v_mfma_f32_16x16x32_bf16 v[76:79], v[156:159], a[104:107], v[76:79]
    ds_read_b64_tr_b16 v[140:141], v26 offset:8192
    v_mfma_f32_16x16x32_bf16 v[92:95], v[156:159], a[108:111], v[92:95]
    ds_read_b64_tr_b16 v[142:143], v26 offset:9216
    s_waitcnt lgkmcnt(6)
    v_mfma_f32_16x16x32_bf16 v[80:83], v[160:163], a[104:107], v[80:83]
    ds_read_b64_tr_b16 v[144:145], v27 offset:8192
    v_mfma_f32_16x16x32_bf16 v[96:99], v[160:163], a[108:111], v[96:99]
    ds_read_b64_tr_b16 v[146:147], v27 offset:9216
    s_waitcnt lgkmcnt(6)
    v_mfma_f32_16x16x32_bf16 v[68:71], v[132:135], a[112:115], v[68:71]
    ds_read_b64_tr_b16 v[148:149], v24 offset:12288
    v_mfma_f32_16x16x32_bf16 v[84:87], v[132:135], a[116:119], v[84:87]
    ds_read_b64_tr_b16 v[150:151], v24 offset:13312
    s_waitcnt lgkmcnt(6)
    v_mfma_f32_16x16x32_bf16 v[72:75], v[136:139], a[112:115], v[72:75]
    ds_read_b64_tr_b16 v[152:153], v25 offset:12288
    v_mfma_f32_16x16x32_bf16 v[88:91], v[136:139], a[116:119], v[88:91]
    ds_read_b64_tr_b16 v[154:155], v25 offset:13312
    s_waitcnt lgkmcnt(6)
    v_mfma_f32_16x16x32_bf16 v[76:79], v[140:143], a[112:115], v[76:79]
    ds_read_b64_tr_b16 v[156:157], v26 offset:12288
    v_mfma_f32_16x16x32_bf16 v[92:95], v[140:143], a[116:119], v[92:95]
    ds_read_b64_tr_b16 v[158:159], v26 offset:13312
    s_waitcnt lgkmcnt(6)
    v_mfma_f32_16x16x32_bf16 v[80:83], v[144:147], a[112:115], v[80:83]
    ds_read_b64_tr_b16 v[160:161], v27 offset:12288
    v_mfma_f32_16x16x32_bf16 v[96:99], v[144:147], a[116:119], v[96:99]
    ds_read_b64_tr_b16 v[162:163], v27 offset:13312
    s_lshr_b32 s59, s45, 2
    s_add_u32 s59, s59, 0
    s_and_b32 s59, s59, 1
    s_lshl_b32 s59, s59, 18
    buffer_load_dword v38, v39, s[12:15], s59 offen
    s_waitcnt lgkmcnt(6)
    v_mfma_f32_16x16x32_bf16 v[68:71], v[148:151], a[120:123], v[68:71]
    v_mfma_f32_16x16x32_bf16 v[84:87], v[148:151], a[124:127], v[84:87]
    s_waitcnt lgkmcnt(4)
    v_mfma_f32_16x16x32_bf16 v[72:75], v[152:155], a[120:123], v[72:75]
    v_mfma_f32_16x16x32_bf16 v[88:91], v[152:155], a[124:127], v[88:91]
    s_waitcnt lgkmcnt(0)
    s_barrier
    v_mfma_f32_16x16x32_bf16 v[76:79], v[156:159], a[120:123], v[76:79]
    v_mfma_f32_16x16x32_bf16 v[92:95], v[156:159], a[124:127], v[92:95]
    v_mfma_f32_16x16x32_bf16 v[80:83], v[160:163], a[120:123], v[80:83]
    v_mfma_f32_16x16x32_bf16 v[96:99], v[160:163], a[124:127], v[96:99]
    v_pk_mul_f32 v[196:197], v[68:69], v[58:59]
    v_pk_mul_f32 v[198:199], v[70:71], v[58:59]
    v_pk_mul_f32 v[200:201], v[72:73], v[58:59]
    v_pk_mul_f32 v[202:203], v[74:75], v[58:59]
    v_exp_f32_e64 v196, v196 clamp
    v_exp_f32_e64 v197, v197 clamp
    v_exp_f32_e64 v198, v198 clamp
    v_exp_f32_e64 v199, v199 clamp
    v_exp_f32_e64 v200, v200 clamp
    v_exp_f32_e64 v201, v201 clamp
    v_exp_f32_e64 v202, v202 clamp
    v_exp_f32_e64 v203, v203 clamp
    v_max_f32 v68, 0, v68
    v_max_f32 v69, 0, v69
    v_max_f32 v70, 0, v70
    v_max_f32 v71, 0, v71
    v_max_f32 v72, 0, v72
    v_max_f32 v73, 0, v73
    v_max_f32 v74, 0, v74
    v_max_f32 v75, 0, v75
    v_pk_add_f32 v[68:69], v[68:69], v[196:197]
    v_pk_add_f32 v[70:71], v[70:71], v[198:199]
    v_pk_add_f32 v[72:73], v[72:73], v[200:201]
    v_pk_add_f32 v[74:75], v[74:75], v[202:203]
    v_pk_add_f32 v[68:69], v[68:69], v[60:61]
    v_pk_add_f32 v[70:71], v[70:71], v[60:61]
    v_pk_add_f32 v[72:73], v[72:73], v[60:61]
    v_pk_add_f32 v[74:75], v[74:75], v[60:61]
    v_pk_mul_f32 v[196:197], v[76:77], v[58:59]
    v_pk_mul_f32 v[198:199], v[78:79], v[58:59]
    v_pk_mul_f32 v[200:201], v[80:81], v[58:59]
    v_pk_mul_f32 v[202:203], v[82:83], v[58:59]
    v_exp_f32_e64 v196, v196 clamp
    v_exp_f32_e64 v197, v197 clamp
    v_exp_f32_e64 v198, v198 clamp
    v_exp_f32_e64 v199, v199 clamp
    v_exp_f32_e64 v200, v200 clamp
    v_exp_f32_e64 v201, v201 clamp
    v_exp_f32_e64 v202, v202 clamp
    v_exp_f32_e64 v203, v203 clamp
    v_max_f32 v76, 0, v76
    v_max_f32 v77, 0, v77
    v_max_f32 v78, 0, v78
    v_max_f32 v79, 0, v79
    v_max_f32 v80, 0, v80
    v_max_f32 v81, 0, v81
    v_max_f32 v82, 0, v82
    v_max_f32 v83, 0, v83
    v_pk_add_f32 v[76:77], v[76:77], v[196:197]
    v_pk_add_f32 v[78:79], v[78:79], v[198:199]
    v_pk_add_f32 v[80:81], v[80:81], v[200:201]
    v_pk_add_f32 v[82:83], v[82:83], v[202:203]
    v_pk_add_f32 v[76:77], v[76:77], v[60:61]
    v_pk_add_f32 v[78:79], v[78:79], v[60:61]
    v_pk_add_f32 v[80:81], v[80:81], v[60:61]
    v_pk_add_f32 v[82:83], v[82:83], v[60:61]
    v_pk_mul_f32 v[196:197], v[84:85], v[58:59]
    v_pk_mul_f32 v[198:199], v[86:87], v[58:59]
    v_pk_mul_f32 v[200:201], v[88:89], v[58:59]
    v_pk_mul_f32 v[202:203], v[90:91], v[58:59]
    v_exp_f32_e64 v196, v196 clamp
    v_exp_f32_e64 v197, v197 clamp
    v_exp_f32_e64 v198, v198 clamp
    v_exp_f32_e64 v199, v199 clamp
    v_exp_f32_e64 v200, v200 clamp
    v_exp_f32_e64 v201, v201 clamp
    v_exp_f32_e64 v202, v202 clamp
    v_exp_f32_e64 v203, v203 clamp
    v_max_f32 v84, 0, v84
    v_max_f32 v85, 0, v85
    v_max_f32 v86, 0, v86
    v_max_f32 v87, 0, v87
    v_max_f32 v88, 0, v88
    v_max_f32 v89, 0, v89
    v_max_f32 v90, 0, v90
    v_max_f32 v91, 0, v91
    v_pk_add_f32 v[84:85], v[84:85], v[196:197]
H_S1_4:
    s_cbranch_execz H_S_0
    v_pk_add_f32 v[86:87], v[86:87], v[198:199]
    v_pk_add_f32 v[88:89], v[88:89], v[200:201]
    v_pk_add_f32 v[90:91], v[90:91], v[202:203]
    v_pk_add_f32 v[84:85], v[84:85], v[60:61]
    v_pk_add_f32 v[86:87], v[86:87], v[60:61]
    v_pk_add_f32 v[88:89], v[88:89], v[60:61]
    v_pk_add_f32 v[90:91], v[90:91], v[60:61]
    v_pk_mul_f32 v[196:197], v[92:93], v[58:59]
    v_pk_mul_f32 v[198:199], v[94:95], v[58:59]
    v_pk_mul_f32 v[200:201], v[96:97], v[58:59]
    v_pk_mul_f32 v[202:203], v[98:99], v[58:59]
    v_exp_f32_e64 v196, v196 clamp
    v_exp_f32_e64 v197, v197 clamp
    v_exp_f32_e64 v198, v198 clamp
    v_exp_f32_e64 v199, v199 clamp
    v_exp_f32_e64 v200, v200 clamp
    v_exp_f32_e64 v201, v201 clamp
    v_exp_f32_e64 v202, v202 clamp
    v_exp_f32_e64 v203, v203 clamp
    v_max_f32 v92, 0, v92
    v_max_f32 v93, 0, v93
    v_max_f32 v94, 0, v94
    v_max_f32 v95, 0, v95
    v_max_f32 v96, 0, v96
    v_max_f32 v97, 0, v97
    v_max_f32 v98, 0, v98
    v_max_f32 v99, 0, v99
    v_pk_add_f32 v[92:93], v[92:93], v[196:197]
    v_pk_add_f32 v[94:95], v[94:95], v[198:199]
    v_pk_add_f32 v[96:97], v[96:97], v[200:201]
    v_pk_add_f32 v[98:99], v[98:99], v[202:203]
    v_pk_add_f32 v[92:93], v[92:93], v[60:61]
    v_pk_add_f32 v[94:95], v[94:95], v[60:61]
    v_pk_add_f32 v[96:97], v[96:97], v[60:61]
    v_pk_add_f32 v[98:99], v[98:99], v[60:61]
    v_cvt_pk_bf16_f32 v204, v68, v69
    v_cvt_pk_bf16_f32 v205, v70, v71
    v_cvt_pk_bf16_f32 v206, v72, v73
    v_cvt_pk_bf16_f32 v207, v74, v75
    v_cvt_pk_bf16_f32 v208, v76, v77
    v_cvt_pk_bf16_f32 v209, v78, v79
    v_cvt_pk_bf16_f32 v210, v80, v81
    v_cvt_pk_bf16_f32 v211, v82, v83
    v_cvt_pk_bf16_f32 v212, v84, v85
    v_cvt_pk_bf16_f32 v213, v86, v87
    v_cvt_pk_bf16_f32 v214, v88, v89
    v_cvt_pk_bf16_f32 v215, v90, v91
    v_cvt_pk_bf16_f32 v216, v92, v93
    v_cvt_pk_bf16_f32 v217, v94, v95
    v_cvt_pk_bf16_f32 v218, v96, v97
    v_cvt_pk_bf16_f32 v219, v98, v99
    v_accvgpr_write_b32 a176, v204
    v_accvgpr_write_b32 a177, v205
    v_accvgpr_write_b32 a178, v206
    v_accvgpr_write_b32 a179, v207
    v_accvgpr_write_b32 a180, v208
    v_accvgpr_write_b32 a181, v209
    v_accvgpr_write_b32 a182, v210
    v_accvgpr_write_b32 a183, v211
    v_accvgpr_write_b32 a184, v212
    v_accvgpr_write_b32 a185, v213
    v_accvgpr_write_b32 a186, v214
    v_accvgpr_write_b32 a187, v215
    v_accvgpr_write_b32 a188, v216
    v_accvgpr_write_b32 a189, v217
    v_accvgpr_write_b32 a190, v218
    v_accvgpr_write_b32 a191, v219
    s_waitcnt vmcnt(17)
    s_barrier
    ds_read_b64_tr_b16 v[132:133], v28 offset:32768
    ds_read_b64_tr_b16 v[134:135], v28 offset:33792
    ds_read_b64_tr_b16 v[136:137], v29 offset:32768
    ds_read_b64_tr_b16 v[138:139], v29 offset:33792
    ds_read_b64_tr_b16 v[140:141], v30 offset:32768
    ds_read_b64_tr_b16 v[142:143], v30 offset:33792
    ds_read_b64_tr_b16 v[144:145], v31 offset:32768
    ds_read_b64_tr_b16 v[146:147], v31 offset:33792
    s_waitcnt lgkmcnt(6)
    v_mfma_f32_16x16x32_bf16 v[68:71], v[132:135], a[0:3], 0
    ds_read_b64_tr_b16 v[148:149], v28 offset:36864
    s_lshr_b32 s59, s45, 2
    s_add_u32 s59, s59, 1
    s_and_b32 s59, s59, 1
    s_lshl_b32 s59, s59, 18
    buffer_load_dword v38, v39, s[12:15], s59 offen
    v_mfma_f32_16x16x32_bf16 v[84:87], v[132:135], a[4:7], 0
    ds_read_b64_tr_b16 v[150:151], v28 offset:37888
    s_waitcnt lgkmcnt(6)
    v_mfma_f32_16x16x32_bf16 v[72:75], v[136:139], a[0:3], 0
    ds_read_b64_tr_b16 v[152:153], v29 offset:36864
    v_mfma_f32_16x16x32_bf16 v[88:91], v[136:139], a[4:7], 0
    ds_read_b64_tr_b16 v[154:155], v29 offset:37888
    s_waitcnt lgkmcnt(6)
    v_mfma_f32_16x16x32_bf16 v[76:79], v[140:143], a[0:3], 0
    ds_read_b64_tr_b16 v[156:157], v30 offset:36864
    v_mfma_f32_16x16x32_bf16 v[92:95], v[140:143], a[4:7], 0
    ds_read_b64_tr_b16 v[158:159], v30 offset:37888
    s_waitcnt lgkmcnt(6)
    v_mfma_f32_16x16x32_bf16 v[80:83], v[144:147], a[0:3], 0
    ds_read_b64_tr_b16 v[160:161], v31 offset:36864
    v_mfma_f32_16x16x32_bf16 v[96:99], v[144:147], a[4:7], 0
    ds_read_b64_tr_b16 v[162:163], v31 offset:37888
    s_waitcnt lgkmcnt(6)
    v_mfma_f32_16x16x32_bf16 v[68:71], v[148:151], a[8:11], v[68:71]
    ds_read_b64_tr_b16 v[132:133], v28 offset:40960
    v_mfma_f32_16x16x32_bf16 v[84:87], v[148:151], a[12:15], v[84:87]
    ds_read_b64_tr_b16 v[134:135], v28 offset:41984
    s_waitcnt lgkmcnt(6)
    v_mfma_f32_16x16x32_bf16 v[72:75], v[152:155], a[8:11], v[72:75]
    ds_read_b64_tr_b16 v[136:137], v29 offset:40960
    v_mfma_f32_16x16x32_bf16 v[88:91], v[152:155], a[12:15], v[88:91]
    ds_read_b64_tr_b16 v[138:139], v29 offset:41984
    s_waitcnt lgkmcnt(6)
    v_mfma_f32_16x16x32_bf16 v[76:79], v[156:159], a[8:11], v[76:79]
    ds_read_b64_tr_b16 v[140:141], v30 offset:40960
    v_mfma_f32_16x16x32_bf16 v[92:95], v[156:159], a[12:15], v[92:95]
    ds_read_b64_tr_b16 v[142:143], v30 offset:41984
    s_waitcnt lgkmcnt(6)
    v_mfma_f32_16x16x32_bf16 v[80:83], v[160:163], a[8:11], v[80:83]
    ds_read_b64_tr_b16 v[144:145], v31 offset:40960
    v_mfma_f32_16x16x32_bf16 v[96:99], v[160:163], a[12:15], v[96:99]
    ds_read_b64_tr_b16 v[146:147], v31 offset:41984
    s_waitcnt lgkmcnt(6)
    v_mfma_f32_16x16x32_bf16 v[68:71], v[132:135], a[16:19], v[68:71]
    ds_read_b64_tr_b16 v[148:149], v28 offset:45056
    v_mfma_f32_16x16x32_bf16 v[84:87], v[132:135], a[20:23], v[84:87]
    ds_read_b64_tr_b16 v[150:151], v28 offset:46080
    s_waitcnt lgkmcnt(6)
    v_mfma_f32_16x16x32_bf16 v[72:75], v[136:139], a[16:19], v[72:75]
    ds_read_b64_tr_b16 v[152:153], v29 offset:45056
    v_mfma_f32_16x16x32_bf16 v[88:91], v[136:139], a[20:23], v[88:91]
    ds_read_b64_tr_b16 v[154:155], v29 offset:46080
    s_waitcnt lgkmcnt(6)
    v_mfma_f32_16x16x32_bf16 v[76:79], v[140:143], a[16:19], v[76:79]
    ds_read_b64_tr_b16 v[156:157], v30 offset:45056
    v_mfma_f32_16x16x32_bf16 v[92:95], v[140:143], a[20:23], v[92:95]
    ds_read_b64_tr_b16 v[158:159], v30 offset:46080
    s_waitcnt lgkmcnt(6)
    v_mfma_f32_16x16x32_bf16 v[80:83], v[144:147], a[16:19], v[80:83]
    ds_read_b64_tr_b16 v[160:161], v31 offset:45056
    v_mfma_f32_16x16x32_bf16 v[96:99], v[144:147], a[20:23], v[96:99]
    ds_read_b64_tr_b16 v[162:163], v31 offset:46080
    s_waitcnt lgkmcnt(6)
    v_mfma_f32_16x16x32_bf16 v[68:71], v[148:151], a[24:27], v[68:71]
    v_mfma_f32_16x16x32_bf16 v[84:87], v[148:151], a[28:31], v[84:87]
    s_waitcnt lgkmcnt(4)
    v_mfma_f32_16x16x32_bf16 v[72:75], v[152:155], a[24:27], v[72:75]
    v_mfma_f32_16x16x32_bf16 v[88:91], v[152:155], a[28:31], v[88:91]
    s_waitcnt vmcnt(14) lgkmcnt(0)
    s_barrier
    v_mfma_f32_16x16x32_bf16 v[76:79], v[156:159], a[24:27], v[76:79]
    ds_read_b64_tr_b16 v[132:133], v24 offset:16384
    ds_read_b64_tr_b16 v[134:135], v24 offset:17408
    v_mfma_f32_16x16x32_bf16 v[92:95], v[156:159], a[28:31], v[92:95]
    ds_read_b64_tr_b16 v[136:137], v25 offset:16384
    ds_read_b64_tr_b16 v[138:139], v25 offset:17408
    v_mfma_f32_16x16x32_bf16 v[80:83], v[160:163], a[24:27], v[80:83]
    ds_read_b64_tr_b16 v[140:141], v26 offset:16384
    ds_read_b64_tr_b16 v[142:143], v26 offset:17408
    v_mfma_f32_16x16x32_bf16 v[96:99], v[160:163], a[28:31], v[96:99]
    ds_read_b64_tr_b16 v[144:145], v27 offset:16384
    ds_read_b64_tr_b16 v[146:147], v27 offset:17408
    s_waitcnt lgkmcnt(6)
    v_mfma_f32_16x16x32_bf16 v[68:71], v[132:135], a[32:35], v[68:71]
    ds_read_b64_tr_b16 v[148:149], v24 offset:20480
    v_mfma_f32_16x16x32_bf16 v[84:87], v[132:135], a[36:39], v[84:87]
    ds_read_b64_tr_b16 v[150:151], v24 offset:21504
    s_waitcnt lgkmcnt(6)
    v_mfma_f32_16x16x32_bf16 v[72:75], v[136:139], a[32:35], v[72:75]
    ds_read_b64_tr_b16 v[152:153], v25 offset:20480
    v_mfma_f32_16x16x32_bf16 v[88:91], v[136:139], a[36:39], v[88:91]
    ds_read_b64_tr_b16 v[154:155], v25 offset:21504
    s_waitcnt lgkmcnt(6)
    v_mfma_f32_16x16x32_bf16 v[76:79], v[140:143], a[32:35], v[76:79]
    ds_read_b64_tr_b16 v[156:157], v26 offset:20480
    v_mfma_f32_16x16x32_bf16 v[92:95], v[140:143], a[36:39], v[92:95]
    ds_read_b64_tr_b16 v[158:159], v26 offset:21504
    s_waitcnt lgkmcnt(6)
    v_mfma_f32_16x16x32_bf16 v[80:83], v[144:147], a[32:35], v[80:83]
    ds_read_b64_tr_b16 v[160:161], v27 offset:20480
    v_mfma_f32_16x16x32_bf16 v[96:99], v[144:147], a[36:39], v[96:99]
    ds_read_b64_tr_b16 v[162:163], v27 offset:21504
    s_waitcnt lgkmcnt(6)
    v_mfma_f32_16x16x32_bf16 v[68:71], v[148:151], a[40:43], v[68:71]
    ds_read_b64_tr_b16 v[132:133], v24 offset:24576
    v_mfma_f32_16x16x32_bf16 v[84:87], v[148:151], a[44:47], v[84:87]
    ds_read_b64_tr_b16 v[134:135], v24 offset:25600
    s_waitcnt lgkmcnt(6)
    v_mfma_f32_16x16x32_bf16 v[72:75], v[152:155], a[40:43], v[72:75]
    ds_read_b64_tr_b16 v[136:137], v25 offset:24576
    v_mfma_f32_16x16x32_bf16 v[88:91], v[152:155], a[44:47], v[88:91]
    ds_read_b64_tr_b16 v[138:139], v25 offset:25600
    s_waitcnt lgkmcnt(6)
    v_mfma_f32_16x16x32_bf16 v[76:79], v[156:159], a[40:43], v[76:79]
    ds_read_b64_tr_b16 v[140:141], v26 offset:24576
    v_mfma_f32_16x16x32_bf16 v[92:95], v[156:159], a[44:47], v[92:95]
    ds_read_b64_tr_b16 v[142:143], v26 offset:25600
    s_waitcnt lgkmcnt(6)
    v_mfma_f32_16x16x32_bf16 v[80:83], v[160:163], a[40:43], v[80:83]
    ds_read_b64_tr_b16 v[144:145], v27 offset:24576
    v_mfma_f32_16x16x32_bf16 v[96:99], v[160:163], a[44:47], v[96:99]
    ds_read_b64_tr_b16 v[146:147], v27 offset:25600
    s_waitcnt lgkmcnt(6)
    v_mfma_f32_16x16x32_bf16 v[68:71], v[132:135], a[48:51], v[68:71]
    ds_read_b64_tr_b16 v[148:149], v24 offset:28672
    v_mfma_f32_16x16x32_bf16 v[84:87], v[132:135], a[52:55], v[84:87]
    ds_read_b64_tr_b16 v[150:151], v24 offset:29696
    s_waitcnt lgkmcnt(6)
    v_mfma_f32_16x16x32_bf16 v[72:75], v[136:139], a[48:51], v[72:75]
    ds_read_b64_tr_b16 v[152:153], v25 offset:28672
    v_mfma_f32_16x16x32_bf16 v[88:91], v[136:139], a[52:55], v[88:91]
    ds_read_b64_tr_b16 v[154:155], v25 offset:29696
    s_waitcnt lgkmcnt(6)
    v_mfma_f32_16x16x32_bf16 v[76:79], v[140:143], a[48:51], v[76:79]
    ds_read_b64_tr_b16 v[156:157], v26 offset:28672
    v_mfma_f32_16x16x32_bf16 v[92:95], v[140:143], a[52:55], v[92:95]
    ds_read_b64_tr_b16 v[158:159], v26 offset:29696
    s_waitcnt lgkmcnt(6)
    v_mfma_f32_16x16x32_bf16 v[80:83], v[144:147], a[48:51], v[80:83]
    ds_read_b64_tr_b16 v[160:161], v27 offset:28672
    v_mfma_f32_16x16x32_bf16 v[96:99], v[144:147], a[52:55], v[96:99]
    ds_read_b64_tr_b16 v[162:163], v27 offset:29696
    s_waitcnt lgkmcnt(6)
    v_mfma_f32_16x16x32_bf16 v[68:71], v[148:151], a[56:59], v[68:71]
    v_mfma_f32_16x16x32_bf16 v[84:87], v[148:151], a[60:63], v[84:87]
    s_waitcnt lgkmcnt(4)
    v_mfma_f32_16x16x32_bf16 v[72:75], v[152:155], a[56:59], v[72:75]
    v_mfma_f32_16x16x32_bf16 v[88:91], v[152:155], a[60:63], v[88:91]
    s_waitcnt vmcnt(10) lgkmcnt(0)
    s_barrier
    v_mfma_f32_16x16x32_bf16 v[76:79], v[156:159], a[56:59], v[76:79]
    ds_read_b64_tr_b16 v[132:133], v28 offset:0
    ds_read_b64_tr_b16 v[134:135], v28 offset:1024
    v_mfma_f32_16x16x32_bf16 v[92:95], v[156:159], a[60:63], v[92:95]
    ds_read_b64_tr_b16 v[136:137], v29 offset:0
    ds_read_b64_tr_b16 v[138:139], v29 offset:1024
    v_mfma_f32_16x16x32_bf16 v[80:83], v[160:163], a[56:59], v[80:83]
    ds_read_b64_tr_b16 v[140:141], v30 offset:0
    ds_read_b64_tr_b16 v[142:143], v30 offset:1024
    v_mfma_f32_16x16x32_bf16 v[96:99], v[160:163], a[60:63], v[96:99]
    ds_read_b64_tr_b16 v[144:145], v31 offset:0
    ds_read_b64_tr_b16 v[146:147], v31 offset:1024
    s_waitcnt lgkmcnt(6)
    v_mfma_f32_16x16x32_bf16 v[68:71], v[132:135], a[64:67], v[68:71]
    ds_read_b64_tr_b16 v[148:149], v28 offset:4096
    v_mfma_f32_16x16x32_bf16 v[84:87], v[132:135], a[68:71], v[84:87]
    ds_read_b64_tr_b16 v[150:151], v28 offset:5120
    s_waitcnt lgkmcnt(6)
    v_mfma_f32_16x16x32_bf16 v[72:75], v[136:139], a[64:67], v[72:75]
    ds_read_b64_tr_b16 v[152:153], v29 offset:4096
    v_mfma_f32_16x16x32_bf16 v[88:91], v[136:139], a[68:71], v[88:91]
    ds_read_b64_tr_b16 v[154:155], v29 offset:5120
    s_waitcnt lgkmcnt(6)
    v_mfma_f32_16x16x32_bf16 v[76:79], v[140:143], a[64:67], v[76:79]
    ds_read_b64_tr_b16 v[156:157], v30 offset:4096
    v_mfma_f32_16x16x32_bf16 v[92:95], v[140:143], a[68:71], v[92:95]
    ds_read_b64_tr_b16 v[158:159], v30 offset:5120
    s_waitcnt lgkmcnt(6)
    v_mfma_f32_16x16x32_bf16 v[80:83], v[144:147], a[64:67], v[80:83]
    ds_read_b64_tr_b16 v[160:161], v31 offset:4096
    v_mfma_f32_16x16x32_bf16 v[96:99], v[144:147], a[68:71], v[96:99]
    ds_read_b64_tr_b16 v[162:163], v31 offset:5120
    s_waitcnt lgkmcnt(6)
    v_mfma_f32_16x16x32_bf16 v[68:71], v[148:151], a[72:75], v[68:71]
    ds_read_b64_tr_b16 v[132:133], v28 offset:8192
    v_mfma_f32_16x16x32_bf16 v[84:87], v[148:151], a[76:79], v[84:87]
    ds_read_b64_tr_b16 v[134:135], v28 offset:9216
    s_waitcnt lgkmcnt(6)
    v_mfma_f32_16x16x32_bf16 v[72:75], v[152:155], a[72:75], v[72:75]
    ds_read_b64_tr_b16 v[136:137], v29 offset:8192
    v_mfma_f32_16x16x32_bf16 v[88:91], v[152:155], a[76:79], v[88:91]
    ds_read_b64_tr_b16 v[138:139], v29 offset:9216
    s_waitcnt lgkmcnt(6)
    v_mfma_f32_16x16x32_bf16 v[76:79], v[156:159], a[72:75], v[76:79]
    ds_read_b64_tr_b16 v[140:141], v30 offset:8192
    v_mfma_f32_16x16x32_bf16 v[92:95], v[156:159], a[76:79], v[92:95]
    ds_read_b64_tr_b16 v[142:143], v30 offset:9216
    s_waitcnt lgkmcnt(6)
    v_mfma_f32_16x16x32_bf16 v[80:83], v[160:163], a[72:75], v[80:83]
    ds_read_b64_tr_b16 v[144:145], v31 offset:8192
    v_mfma_f32_16x16x32_bf16 v[96:99], v[160:163], a[76:79], v[96:99]
    ds_read_b64_tr_b16 v[146:147], v31 offset:9216
    s_waitcnt lgkmcnt(6)
    v_mfma_f32_16x16x32_bf16 v[68:71], v[132:135], a[80:83], v[68:71]
    ds_read_b64_tr_b16 v[148:149], v28 offset:12288
    v_mfma_f32_16x16x32_bf16 v[84:87], v[132:135], a[84:87], v[84:87]
    ds_read_b64_tr_b16 v[150:151], v28 offset:13312
    s_waitcnt lgkmcnt(6)
    v_mfma_f32_16x16x32_bf16 v[72:75], v[136:139], a[80:83], v[72:75]
    ds_read_b64_tr_b16 v[152:153], v29 offset:12288
    v_mfma_f32_16x16x32_bf16 v[88:91], v[136:139], a[84:87], v[88:91]
    ds_read_b64_tr_b16 v[154:155], v29 offset:13312
    s_waitcnt lgkmcnt(6)
    v_mfma_f32_16x16x32_bf16 v[76:79], v[140:143], a[80:83], v[76:79]
    ds_read_b64_tr_b16 v[156:157], v30 offset:12288
    v_mfma_f32_16x16x32_bf16 v[92:95], v[140:143], a[84:87], v[92:95]
    ds_read_b64_tr_b16 v[158:159], v30 offset:13312
    s_waitcnt lgkmcnt(6)
    v_mfma_f32_16x16x32_bf16 v[80:83], v[144:147], a[80:83], v[80:83]
    ds_read_b64_tr_b16 v[160:161], v31 offset:12288
    v_mfma_f32_16x16x32_bf16 v[96:99], v[144:147], a[84:87], v[96:99]
    ds_read_b64_tr_b16 v[162:163], v31 offset:13312
    s_waitcnt lgkmcnt(6)
    v_mfma_f32_16x16x32_bf16 v[68:71], v[148:151], a[88:91], v[68:71]
    v_mfma_f32_16x16x32_bf16 v[84:87], v[148:151], a[92:95], v[84:87]
    s_waitcnt lgkmcnt(4)
    v_mfma_f32_16x16x32_bf16 v[72:75], v[152:155], a[88:91], v[72:75]
    v_mfma_f32_16x16x32_bf16 v[88:91], v[152:155], a[92:95], v[88:91]
    s_waitcnt vmcnt(6) lgkmcnt(0)
    s_barrier
    v_mfma_f32_16x16x32_bf16 v[76:79], v[156:159], a[88:91], v[76:79]
    ds_read_b64_tr_b16 v[132:133], v24 offset:32768
    ds_read_b64_tr_b16 v[134:135], v24 offset:33792
    v_mfma_f32_16x16x32_bf16 v[92:95], v[156:159], a[92:95], v[92:95]
    ds_read_b64_tr_b16 v[136:137], v25 offset:32768
    ds_read_b64_tr_b16 v[138:139], v25 offset:33792
    v_mfma_f32_16x16x32_bf16 v[80:83], v[160:163], a[88:91], v[80:83]
    ds_read_b64_tr_b16 v[140:141], v26 offset:32768
    ds_read_b64_tr_b16 v[142:143], v26 offset:33792
    v_mfma_f32_16x16x32_bf16 v[96:99], v[160:163], a[92:95], v[96:99]
    ds_read_b64_tr_b16 v[144:145], v27 offset:32768
    ds_read_b64_tr_b16 v[146:147], v27 offset:33792
    s_waitcnt lgkmcnt(6)
    v_mfma_f32_16x16x32_bf16 v[68:71], v[132:135], a[96:99], v[68:71]
    ds_read_b64_tr_b16 v[148:149], v24 offset:36864
    v_mfma_f32_16x16x32_bf16 v[84:87], v[132:135], a[100:103], v[84:87]
    ds_read_b64_tr_b16 v[150:151], v24 offset:37888
    s_waitcnt lgkmcnt(6)
    v_mfma_f32_16x16x32_bf16 v[72:75], v[136:139], a[96:99], v[72:75]
    ds_read_b64_tr_b16 v[152:153], v25 offset:36864
    v_mfma_f32_16x16x32_bf16 v[88:91], v[136:139], a[100:103], v[88:91]
    ds_read_b64_tr_b16 v[154:155], v25 offset:37888
    s_waitcnt lgkmcnt(6)
    v_mfma_f32_16x16x32_bf16 v[76:79], v[140:143], a[96:99], v[76:79]
    ds_read_b64_tr_b16 v[156:157], v26 offset:36864
    v_mfma_f32_16x16x32_bf16 v[92:95], v[140:143], a[100:103], v[92:95]
    ds_read_b64_tr_b16 v[158:159], v26 offset:37888
    s_waitcnt lgkmcnt(6)
    v_mfma_f32_16x16x32_bf16 v[80:83], v[144:147], a[96:99], v[80:83]
    ds_read_b64_tr_b16 v[160:161], v27 offset:36864
    v_mfma_f32_16x16x32_bf16 v[96:99], v[144:147], a[100:103], v[96:99]
    ds_read_b64_tr_b16 v[162:163], v27 offset:37888
    s_waitcnt lgkmcnt(6)
    v_mfma_f32_16x16x32_bf16 v[68:71], v[148:151], a[104:107], v[68:71]
    ds_read_b64_tr_b16 v[132:133], v24 offset:40960
    v_mfma_f32_16x16x32_bf16 v[84:87], v[148:151], a[108:111], v[84:87]
    ds_read_b64_tr_b16 v[134:135], v24 offset:41984
    s_waitcnt lgkmcnt(6)
    v_mfma_f32_16x16x32_bf16 v[72:75], v[152:155], a[104:107], v[72:75]
    ds_read_b64_tr_b16 v[136:137], v25 offset:40960
    v_mfma_f32_16x16x32_bf16 v[88:91], v[152:155], a[108:111], v[88:91]
    ds_read_b64_tr_b16 v[138:139], v25 offset:41984
    s_waitcnt lgkmcnt(6)
    v_mfma_f32_16x16x32_bf16 v[76:79], v[156:159], a[104:107], v[76:79]
    ds_read_b64_tr_b16 v[140:141], v26 offset:40960
    v_mfma_f32_16x16x32_bf16 v[92:95], v[156:159], a[108:111], v[92:95]
    ds_read_b64_tr_b16 v[142:143], v26 offset:41984
    s_waitcnt lgkmcnt(6)
    v_mfma_f32_16x16x32_bf16 v[80:83], v[160:163], a[104:107], v[80:83]
    ds_read_b64_tr_b16 v[144:145], v27 offset:40960
    v_mfma_f32_16x16x32_bf16 v[96:99], v[160:163], a[108:111], v[96:99]
    ds_read_b64_tr_b16 v[146:147], v27 offset:41984
    s_waitcnt lgkmcnt(6)
    v_mfma_f32_16x16x32_bf16 v[68:71], v[132:135], a[112:115], v[68:71]
    ds_read_b64_tr_b16 v[148:149], v24 offset:45056
    v_mfma_f32_16x16x32_bf16 v[84:87], v[132:135], a[116:119], v[84:87]
    ds_read_b64_tr_b16 v[150:151], v24 offset:46080
    s_waitcnt lgkmcnt(6)
    v_mfma_f32_16x16x32_bf16 v[72:75], v[136:139], a[112:115], v[72:75]
    ds_read_b64_tr_b16 v[152:153], v25 offset:45056
    v_mfma_f32_16x16x32_bf16 v[88:91], v[136:139], a[116:119], v[88:91]
    ds_read_b64_tr_b16 v[154:155], v25 offset:46080
    s_waitcnt lgkmcnt(6)
    v_mfma_f32_16x16x32_bf16 v[76:79], v[140:143], a[112:115], v[76:79]
    ds_read_b64_tr_b16 v[156:157], v26 offset:45056
    v_mfma_f32_16x16x32_bf16 v[92:95], v[140:143], a[116:119], v[92:95]
    ds_read_b64_tr_b16 v[158:159], v26 offset:46080
    s_waitcnt lgkmcnt(6)
    v_mfma_f32_16x16x32_bf16 v[80:83], v[144:147], a[112:115], v[80:83]
    ds_read_b64_tr_b16 v[160:161], v27 offset:45056
    v_mfma_f32_16x16x32_bf16 v[96:99], v[144:147], a[116:119], v[96:99]
    ds_read_b64_tr_b16 v[162:163], v27 offset:46080
    s_waitcnt lgkmcnt(6)
    v_mfma_f32_16x16x32_bf16 v[68:71], v[148:151], a[120:123], v[68:71]
    v_mfma_f32_16x16x32_bf16 v[84:87], v[148:151], a[124:127], v[84:87]
    s_waitcnt lgkmcnt(4)
    v_mfma_f32_16x16x32_bf16 v[72:75], v[152:155], a[120:123], v[72:75]
    v_mfma_f32_16x16x32_bf16 v[88:91], v[152:155], a[124:127], v[88:91]
    s_waitcnt lgkmcnt(0)
    s_barrier
    v_mfma_f32_16x16x32_bf16 v[76:79], v[156:159], a[120:123], v[76:79]
    v_mfma_f32_16x16x32_bf16 v[92:95], v[156:159], a[124:127], v[92:95]
    v_mfma_f32_16x16x32_bf16 v[80:83], v[160:163], a[120:123], v[80:83]
    v_mfma_f32_16x16x32_bf16 v[96:99], v[160:163], a[124:127], v[96:99]
    v_mov_b32 v248, v51
    v_add_u32 v249, 2048, v51
    v_min_u32 v248, 2456, v248
    v_add_u32 v248, 34304, v248
    buffer_load_dwordx2 v[244:245], v248, s[40:43], 0 offen sc1
    v_min_u32 v249, 2456, v249
    v_add_u32 v249, 34304, v249
    buffer_load_dwordx2 v[246:247], v249, s[40:43], 0 offen sc1
    v_pk_mul_f32 v[196:197], v[68:69], v[58:59]
    v_pk_mul_f32 v[198:199], v[70:71], v[58:59]
    v_pk_mul_f32 v[200:201], v[72:73], v[58:59]
    v_pk_mul_f32 v[202:203], v[74:75], v[58:59]
    v_exp_f32_e64 v196, v196 clamp
    v_exp_f32_e64 v197, v197 clamp
    v_exp_f32_e64 v198, v198 clamp
    v_exp_f32_e64 v199, v199 clamp
    v_exp_f32_e64 v200, v200 clamp
    v_exp_f32_e64 v201, v201 clamp
    v_exp_f32_e64 v202, v202 clamp
    v_exp_f32_e64 v203, v203 clamp
    v_max_f32 v68, 0, v68
    v_max_f32 v69, 0, v69
    v_max_f32 v70, 0, v70
    v_max_f32 v71, 0, v71
    v_max_f32 v72, 0, v72
    v_max_f32 v73, 0, v73
    v_max_f32 v74, 0, v74
    v_max_f32 v75, 0, v75
    v_pk_add_f32 v[68:69], v[68:69], v[196:197]
    v_pk_add_f32 v[70:71], v[70:71], v[198:199]
    v_pk_add_f32 v[72:73], v[72:73], v[200:201]
    v_pk_add_f32 v[74:75], v[74:75], v[202:203]
    v_pk_add_f32 v[68:69], v[68:69], v[60:61]
    v_pk_add_f32 v[70:71], v[70:71], v[60:61]
    v_pk_add_f32 v[72:73], v[72:73], v[60:61]
    v_pk_add_f32 v[74:75], v[74:75], v[60:61]
    v_pk_mul_f32 v[196:197], v[76:77], v[58:59]
    v_pk_mul_f32 v[198:199], v[78:79], v[58:59]
    v_pk_mul_f32 v[200:201], v[80:81], v[58:59]
    v_pk_mul_f32 v[202:203], v[82:83], v[58:59]
    v_exp_f32_e64 v196, v196 clamp
    v_exp_f32_e64 v197, v197 clamp
    v_exp_f32_e64 v198, v198 clamp
    v_exp_f32_e64 v199, v199 clamp
    v_exp_f32_e64 v200, v200 clamp
    v_exp_f32_e64 v201, v201 clamp
    v_exp_f32_e64 v202, v202 clamp
    v_exp_f32_e64 v203, v203 clamp
    v_max_f32 v76, 0, v76
    v_max_f32 v77, 0, v77
    v_max_f32 v78, 0, v78
    v_max_f32 v79, 0, v79
    v_max_f32 v80, 0, v80
    v_max_f32 v81, 0, v81
    v_max_f32 v82, 0, v82
    v_max_f32 v83, 0, v83
    v_pk_add_f32 v[76:77], v[76:77], v[196:197]
    v_pk_add_f32 v[78:79], v[78:79], v[198:199]
    v_pk_add_f32 v[80:81], v[80:81], v[200:201]
    v_pk_add_f32 v[82:83], v[82:83], v[202:203]
    v_pk_add_f32 v[76:77], v[76:77], v[60:61]
    v_pk_add_f32 v[78:79], v[78:79], v[60:61]
    v_pk_add_f32 v[80:81], v[80:81], v[60:61]
    v_pk_add_f32 v[82:83], v[82:83], v[60:61]
    v_pk_mul_f32 v[196:197], v[84:85], v[58:59]
    v_pk_mul_f32 v[198:199], v[86:87], v[58:59]
    v_pk_mul_f32 v[200:201], v[88:89], v[58:59]
    v_pk_mul_f32 v[202:203], v[90:91], v[58:59]
    v_exp_f32_e64 v196, v196 clamp
    v_exp_f32_e64 v197, v197 clamp
    v_exp_f32_e64 v198, v198 clamp
    v_exp_f32_e64 v199, v199 clamp
    v_exp_f32_e64 v200, v200 clamp
    v_exp_f32_e64 v201, v201 clamp
    v_exp_f32_e64 v202, v202 clamp
    v_exp_f32_e64 v203, v203 clamp
    v_max_f32 v84, 0, v84
    v_max_f32 v85, 0, v85
    v_max_f32 v86, 0, v86
    v_max_f32 v87, 0, v87
    v_max_f32 v88, 0, v88
    v_max_f32 v89, 0, v89
    v_max_f32 v90, 0, v90
    v_max_f32 v91, 0, v91
    v_pk_add_f32 v[84:85], v[84:85], v[196:197]
    v_pk_add_f32 v[86:87], v[86:87], v[198:199]
    v_pk_add_f32 v[88:89], v[88:89], v[200:201]
    v_pk_add_f32 v[90:91], v[90:91], v[202:203]
    v_pk_add_f32 v[84:85], v[84:85], v[60:61]
    v_pk_add_f32 v[86:87], v[86:87], v[60:61]
    v_pk_add_f32 v[88:89], v[88:89], v[60:61]
    v_pk_add_f32 v[90:91], v[90:91], v[60:61]
    v_pk_mul_f32 v[196:197], v[92:93], v[58:59]
    v_pk_mul_f32 v[198:199], v[94:95], v[58:59]
    v_pk_mul_f32 v[200:201], v[96:97], v[58:59]
    v_pk_mul_f32 v[202:203], v[98:99], v[58:59]
    v_exp_f32_e64 v196, v196 clamp
    v_exp_f32_e64 v197, v197 clamp
    v_exp_f32_e64 v198, v198 clamp
    v_exp_f32_e64 v199, v199 clamp
    v_exp_f32_e64 v200, v200 clamp
    v_exp_f32_e64 v201, v201 clamp
    v_exp_f32_e64 v202, v202 clamp
    v_exp_f32_e64 v203, v203 clamp
    v_max_f32 v92, 0, v92
    v_max_f32 v93, 0, v93
    v_max_f32 v94, 0, v94
    v_max_f32 v95, 0, v95
    v_max_f32 v96, 0, v96
    v_max_f32 v97, 0, v97
    v_max_f32 v98, 0, v98
    v_max_f32 v99, 0, v99
    v_pk_add_f32 v[92:93], v[92:93], v[196:197]
    v_pk_add_f32 v[94:95], v[94:95], v[198:199]
    v_pk_add_f32 v[96:97], v[96:97], v[200:201]
    v_pk_add_f32 v[98:99], v[98:99], v[202:203]
    v_pk_add_f32 v[92:93], v[92:93], v[60:61]
    v_pk_add_f32 v[94:95], v[94:95], v[60:61]
    v_pk_add_f32 v[96:97], v[96:97], v[60:61]
    v_pk_add_f32 v[98:99], v[98:99], v[60:61]
    v_cvt_pk_bf16_f32 v204, v68, v69
    v_cvt_pk_bf16_f32 v205, v70, v71
    v_cvt_pk_bf16_f32 v206, v72, v73
    v_cvt_pk_bf16_f32 v207, v74, v75
    v_cvt_pk_bf16_f32 v208, v76, v77
    v_cvt_pk_bf16_f32 v209, v78, v79
    v_cvt_pk_bf16_f32 v210, v80, v81
    v_cvt_pk_bf16_f32 v211, v82, v83
    v_cvt_pk_bf16_f32 v212, v84, v85
    v_cvt_pk_bf16_f32 v213, v86, v87
    v_cvt_pk_bf16_f32 v214, v88, v89
    v_cvt_pk_bf16_f32 v215, v90, v91
    v_cvt_pk_bf16_f32 v216, v92, v93
    v_cvt_pk_bf16_f32 v217, v94, v95
    v_cvt_pk_bf16_f32 v218, v96, v97
    v_cvt_pk_bf16_f32 v219, v98, v99
    v_accvgpr_write_b32 a192, v204
    v_accvgpr_write_b32 a193, v205
    v_accvgpr_write_b32 a194, v206
    v_accvgpr_write_b32 a195, v207
    v_accvgpr_write_b32 a196, v208
    v_accvgpr_write_b32 a197, v209
    v_accvgpr_write_b32 a198, v210
    v_accvgpr_write_b32 a199, v211
    v_accvgpr_write_b32 a200, v212
    v_accvgpr_write_b32 a201, v213
    v_accvgpr_write_b32 a202, v214
    v_accvgpr_write_b32 a203, v215
    v_accvgpr_write_b32 a204, v216
    v_accvgpr_write_b32 a205, v217
    v_accvgpr_write_b32 a206, v218
    v_accvgpr_write_b32 a207, v219
    s_waitcnt vmcnt(0)
L_chk_2698:
    v_xor_b32 v62, s50, v244
    v_bitop3_b32 v62, v245, s51, v62 bitop3:0xbe
    v_bitop3_b32 v62, v246, s50, v62 bitop3:0xbe
    v_bitop3_b32 v62, v247, s51, v62 bitop3:0xbe
    v_cmp_ne_u32 vcc, 0, v62
    s_nop 0
    s_cbranch_vccnz L_retry_2699
L_cont_2700:
    v_lshlrev_b32 v248, 4, v3
    v_lshl_add_u32 v248, v2, 6, v248
    s_mov_b32 s59, 590592
    buffer_load_dwordx4 v[220:223], v248, s[40:43], s59 offen sc1
    buffer_load_dwordx4 v[224:227], v248, s[40:43], s59 offen offset:1024 sc1
    s_mov_b32 s59, 733184
    buffer_load_dwordx4 v[100:103], v48, s[40:43], s59 offen sc1
    buffer_load_dwordx4 v[104:107], v48, s[40:43], s59 offen offset:1024 sc1
    buffer_load_dwordx4 v[108:111], v48, s[40:43], s59 offen offset:2048 sc1
    buffer_load_dwordx4 v[112:115], v48, s[40:43], s59 offen offset:3072 sc1
    s_mov_b32 s59, 737280
    buffer_load_dwordx4 v[116:119], v48, s[40:43], s59 offen sc1
    buffer_load_dwordx4 v[120:123], v48, s[40:43], s59 offen offset:1024 sc1
    buffer_load_dwordx4 v[124:127], v48, s[40:43], s59 offen offset:2048 sc1
    buffer_load_dwordx4 v[128:131], v48, s[40:43], s59 offen offset:3072 sc1
    s_mov_b32 s59, 741376
H_S1_5:
    s_cbranch_execz H_S_1
    buffer_load_dwordx4 v[164:167], v48, s[40:43], s59 offen sc1
    buffer_load_dwordx4 v[168:171], v48, s[40:43], s59 offen offset:1024 sc1
    buffer_load_dwordx4 v[172:175], v48, s[40:43], s59 offen offset:2048 sc1
    buffer_load_dwordx4 v[176:179], v48, s[40:43], s59 offen offset:3072 sc1
    s_mov_b32 s59, 745472
    buffer_load_dwordx4 v[180:183], v48, s[40:43], s59 offen sc1
    buffer_load_dwordx4 v[184:187], v48, s[40:43], s59 offen offset:1024 sc1
    buffer_load_dwordx4 v[188:191], v48, s[40:43], s59 offen offset:2048 sc1
    buffer_load_dwordx4 v[192:195], v48, s[40:43], s59 offen offset:3072 sc1
    s_mov_b32 s59, 749568
    buffer_load_dwordx4 v[228:231], v48, s[40:43], s59 offen sc1
    buffer_load_dwordx4 v[232:235], v48, s[40:43], s59 offen offset:1024 sc1
    buffer_load_dwordx4 v[236:239], v48, s[40:43], s59 offen offset:2048 sc1
    buffer_load_dwordx4 v[240:243], v48, s[40:43], s59 offen offset:3072 sc1
    s_mul_i32 s65, s57, 90112
    s_add_u32 s65, s65, 12582912
    s_waitcnt vmcnt(20)
    v_cvt_pk_bf16_f32 v220, v220, v221
    v_cvt_pk_bf16_f32 v221, v222, v223
    v_cvt_pk_bf16_f32 v224, v224, v225
    v_cvt_pk_bf16_f32 v225, v226, v227
    v_mov_b32_dpp v212, v220 row_newbcast:0 row_mask:0xf bank_mask:0xf
    v_mov_b32_dpp v213, v221 row_newbcast:0 row_mask:0xf bank_mask:0xf
    v_mov_b32_dpp v214, v220 row_newbcast:1 row_mask:0xf bank_mask:0xf
    v_mov_b32_dpp v215, v221 row_newbcast:1 row_mask:0xf bank_mask:0xf
    v_mov_b32_dpp v216, v220 row_newbcast:2 row_mask:0xf bank_mask:0xf
    v_mov_b32_dpp v217, v221 row_newbcast:2 row_mask:0xf bank_mask:0xf
    v_mov_b32_dpp v218, v220 row_newbcast:3 row_mask:0xf bank_mask:0xf
    v_mov_b32_dpp v219, v221 row_newbcast:3 row_mask:0xf bank_mask:0xf
    v_mfma_f32_16x16x16_bf16 v[132:135], v[212:213], a[128:129], 0
    v_mfma_f32_16x16x16_bf16 v[136:139], v[214:215], a[130:131], 0
    v_mfma_f32_16x16x16_bf16 v[140:143], v[216:217], a[132:133], 0
    v_mfma_f32_16x16x16_bf16 v[144:147], v[218:219], a[134:135], 0
    v_mfma_f32_16x16x16_bf16 v[148:151], v[212:213], a[136:137], 0
    v_mfma_f32_16x16x16_bf16 v[152:155], v[214:215], a[138:139], 0
    v_mfma_f32_16x16x16_bf16 v[156:159], v[216:217], a[140:141], 0
    v_mfma_f32_16x16x16_bf16 v[160:163], v[218:219], a[142:143], 0
    s_waitcnt vmcnt(16)
    v_cvt_pk_bf16_f32 v100, v100, v101
    v_cvt_pk_bf16_f32 v101, v102, v103
    v_cvt_pk_bf16_f32 v104, v104, v105
    v_cvt_pk_bf16_f32 v105, v106, v107
    v_cvt_pk_bf16_f32 v108, v108, v109
    v_cvt_pk_bf16_f32 v109, v110, v111
    v_cvt_pk_bf16_f32 v112, v112, v113
    v_cvt_pk_bf16_f32 v113, v114, v115
    v_mfma_f32_16x16x16_bf16 v[68:71], v[100:101], a[128:129], 0
    v_add_f32 v196, v60, v132
    v_mfma_f32_16x16x16_bf16 v[72:75], v[104:105], a[130:131], 0
    v_add_f32 v198, v60, v136
    v_mfma_f32_16x16x16_bf16 v[76:79], v[108:109], a[132:133], 0
    v_add_f32 v200, v60, v140
    v_mfma_f32_16x16x16_bf16 v[80:83], v[112:113], a[134:135], 0
    v_add_f32 v202, v60, v144
    v_mfma_f32_16x16x16_bf16 v[84:87], v[100:101], a[136:137], 0
    v_add_f32 v204, v60, v148
    v_mfma_f32_16x16x16_bf16 v[88:91], v[104:105], a[138:139], 0
    v_add_f32 v206, v60, v152
    v_mfma_f32_16x16x16_bf16 v[92:95], v[108:109], a[140:141], 0
    v_add_f32 v208, v60, v156
    v_mfma_f32_16x16x16_bf16 v[96:99], v[112:113], a[142:143], 0
    v_add_f32 v210, v60, v160
    v_rcp_f32 v196, v196
    v_rcp_f32 v198, v198
    v_rcp_f32 v200, v200
    v_rcp_f32 v202, v202
    v_rcp_f32 v204, v204
    v_rcp_f32 v206, v206
    v_rcp_f32 v208, v208
    v_rcp_f32 v210, v210
    v_pk_mul_f32 v[68:69], v[68:69], v[196:197] op_sel_hi:[1,0]
    v_pk_mul_f32 v[70:71], v[70:71], v[196:197] op_sel_hi:[1,0]
    v_pk_mul_f32 v[72:73], v[72:73], v[198:199] op_sel_hi:[1,0]
    v_pk_mul_f32 v[74:75], v[74:75], v[198:199] op_sel_hi:[1,0]
    v_pk_mul_f32 v[76:77], v[76:77], v[200:201] op_sel_hi:[1,0]
    v_pk_mul_f32 v[78:79], v[78:79], v[200:201] op_sel_hi:[1,0]
    v_pk_mul_f32 v[80:81], v[80:81], v[202:203] op_sel_hi:[1,0]
    v_pk_mul_f32 v[82:83], v[82:83], v[202:203] op_sel_hi:[1,0]
    v_pk_mul_f32 v[84:85], v[84:85], v[204:205] op_sel_hi:[1,0]
    v_pk_mul_f32 v[86:87], v[86:87], v[204:205] op_sel_hi:[1,0]
    v_pk_mul_f32 v[88:89], v[88:89], v[206:207] op_sel_hi:[1,0]
    v_pk_mul_f32 v[90:91], v[90:91], v[206:207] op_sel_hi:[1,0]
    v_pk_mul_f32 v[92:93], v[92:93], v[208:209] op_sel_hi:[1,0]
    v_pk_mul_f32 v[94:95], v[94:95], v[208:209] op_sel_hi:[1,0]
    v_pk_mul_f32 v[96:97], v[96:97], v[210:211] op_sel_hi:[1,0]
    v_pk_mul_f32 v[98:99], v[98:99], v[210:211] op_sel_hi:[1,0]
    v_cvt_pk_bf16_f32 v100, v68, v69
    v_cvt_pk_bf16_f32 v101, v70, v71
    v_cvt_pk_bf16_f32 v102, v72, v73
    v_cvt_pk_bf16_f32 v103, v74, v75
    v_cvt_pk_bf16_f32 v104, v76, v77
    v_cvt_pk_bf16_f32 v105, v78, v79
    v_cvt_pk_bf16_f32 v106, v80, v81
    v_cvt_pk_bf16_f32 v107, v82, v83
    v_cvt_pk_bf16_f32 v108, v84, v85
    v_cvt_pk_bf16_f32 v109, v86, v87
    v_cvt_pk_bf16_f32 v110, v88, v89
    v_cvt_pk_bf16_f32 v111, v90, v91
    v_cvt_pk_bf16_f32 v112, v92, v93
    v_cvt_pk_bf16_f32 v113, v94, v95
    v_cvt_pk_bf16_f32 v114, v96, v97
    v_cvt_pk_bf16_f32 v115, v98, v99
    s_add_u32 s59, s65, 12288
    buffer_store_dwordx4 v[100:103], v36, s[40:43], s59 offen sc1
    buffer_store_dwordx4 v[104:107], v36, s[40:43], s59 offen offset:2048 sc1
    buffer_store_dwordx4 v[108:111], v36, s[40:43], s59 offen offset:256 sc1
    buffer_store_dwordx4 v[112:115], v36, s[40:43], s59 offen offset:2304 sc1
    v_mov_b32_dpp v212, v220 row_newbcast:4 row_mask:0xf bank_mask:0xf
    v_mov_b32_dpp v213, v221 row_newbcast:4 row_mask:0xf bank_mask:0xf
    v_mov_b32_dpp v214, v220 row_newbcast:5 row_mask:0xf bank_mask:0xf
    v_mov_b32_dpp v215, v221 row_newbcast:5 row_mask:0xf bank_mask:0xf
    v_mov_b32_dpp v216, v220 row_newbcast:6 row_mask:0xf bank_mask:0xf
    v_mov_b32_dpp v217, v221 row_newbcast:6 row_mask:0xf bank_mask:0xf
    v_mov_b32_dpp v218, v220 row_newbcast:7 row_mask:0xf bank_mask:0xf
    v_mov_b32_dpp v219, v221 row_newbcast:7 row_mask:0xf bank_mask:0xf
    v_mfma_f32_16x16x16_bf16 v[132:135], v[212:213], a[144:145], 0
    v_mfma_f32_16x16x16_bf16 v[136:139], v[214:215], a[146:147], 0
    v_mfma_f32_16x16x16_bf16 v[140:143], v[216:217], a[148:149], 0
    v_mfma_f32_16x16x16_bf16 v[144:147], v[218:219], a[150:151], 0
    v_mfma_f32_16x16x16_bf16 v[148:151], v[212:213], a[152:153], 0
    v_mfma_f32_16x16x16_bf16 v[152:155], v[214:215], a[154:155], 0
    v_mfma_f32_16x16x16_bf16 v[156:159], v[216:217], a[156:157], 0
    v_mfma_f32_16x16x16_bf16 v[160:163], v[218:219], a[158:159], 0
    s_waitcnt vmcnt(16)
    v_cvt_pk_bf16_f32 v116, v116, v117
    v_cvt_pk_bf16_f32 v117, v118, v119
    v_cvt_pk_bf16_f32 v120, v120, v121
    v_cvt_pk_bf16_f32 v121, v122, v123
    v_cvt_pk_bf16_f32 v124, v124, v125
    v_cvt_pk_bf16_f32 v125, v126, v127
    v_cvt_pk_bf16_f32 v128, v128, v129
    v_cvt_pk_bf16_f32 v129, v130, v131
    v_mfma_f32_16x16x16_bf16 v[68:71], v[116:117], a[144:145], 0
    v_add_f32 v196, v60, v132
    v_mfma_f32_16x16x16_bf16 v[72:75], v[120:121], a[146:147], 0
    v_add_f32 v198, v60, v136
    v_mfma_f32_16x16x16_bf16 v[76:79], v[124:125], a[148:149], 0
    v_add_f32 v200, v60, v140
    v_mfma_f32_16x16x16_bf16 v[80:83], v[128:129], a[150:151], 0
    v_add_f32 v202, v60, v144
    v_mfma_f32_16x16x16_bf16 v[84:87], v[116:117], a[152:153], 0
    v_add_f32 v204, v60, v148
    v_mfma_f32_16x16x16_bf16 v[88:91], v[120:121], a[154:155], 0
    v_add_f32 v206, v60, v152
    v_mfma_f32_16x16x16_bf16 v[92:95], v[124:125], a[156:157], 0
    v_add_f32 v208, v60, v156
    v_mfma_f32_16x16x16_bf16 v[96:99], v[128:129], a[158:159], 0
    v_add_f32 v210, v60, v160
    v_rcp_f32 v196, v196
    v_rcp_f32 v198, v198
    v_rcp_f32 v200, v200
    v_rcp_f32 v202, v202
    v_rcp_f32 v204, v204
    v_rcp_f32 v206, v206
    v_rcp_f32 v208, v208
    v_rcp_f32 v210, v210
    v_pk_mul_f32 v[68:69], v[68:69], v[196:197] op_sel_hi:[1,0]
    v_pk_mul_f32 v[70:71], v[70:71], v[196:197] op_sel_hi:[1,0]
    v_pk_mul_f32 v[72:73], v[72:73], v[198:199] op_sel_hi:[1,0]
    v_pk_mul_f32 v[74:75], v[74:75], v[198:199] op_sel_hi:[1,0]
    v_pk_mul_f32 v[76:77], v[76:77], v[200:201] op_sel_hi:[1,0]
    v_pk_mul_f32 v[78:79], v[78:79], v[200:201] op_sel_hi:[1,0]
    v_pk_mul_f32 v[80:81], v[80:81], v[202:203] op_sel_hi:[1,0]
    v_pk_mul_f32 v[82:83], v[82:83], v[202:203] op_sel_hi:[1,0]
    v_pk_mul_f32 v[84:85], v[84:85], v[204:205] op_sel_hi:[1,0]
    v_pk_mul_f32 v[86:87], v[86:87], v[204:205] op_sel_hi:[1,0]
    v_pk_mul_f32 v[88:89], v[88:89], v[206:207] op_sel_hi:[1,0]
    v_pk_mul_f32 v[90:91], v[90:91], v[206:207] op_sel_hi:[1,0]
    v_pk_mul_f32 v[92:93], v[92:93], v[208:209] op_sel_hi:[1,0]
    v_pk_mul_f32 v[94:95], v[94:95], v[208:209] op_sel_hi:[1,0]
    v_pk_mul_f32 v[96:97], v[96:97], v[210:211] op_sel_hi:[1,0]
    v_pk_mul_f32 v[98:99], v[98:99], v[210:211] op_sel_hi:[1,0]
    v_cvt_pk_bf16_f32 v116, v68, v69
    v_cvt_pk_bf16_f32 v117, v70, v71
    v_cvt_pk_bf16_f32 v118, v72, v73
    v_cvt_pk_bf16_f32 v119, v74, v75
    v_cvt_pk_bf16_f32 v120, v76, v77
    v_cvt_pk_bf16_f32 v121, v78, v79
    v_cvt_pk_bf16_f32 v122, v80, v81
    v_cvt_pk_bf16_f32 v123, v82, v83
    v_cvt_pk_bf16_f32 v124, v84, v85
    v_cvt_pk_bf16_f32 v125, v86, v87
    v_cvt_pk_bf16_f32 v126, v88, v89
    v_cvt_pk_bf16_f32 v127, v90, v91
    v_cvt_pk_bf16_f32 v128, v92, v93
    v_cvt_pk_bf16_f32 v129, v94, v95
    v_cvt_pk_bf16_f32 v130, v96, v97
    v_cvt_pk_bf16_f32 v131, v98, v99
    s_add_u32 s59, s65, 16384
    buffer_store_dwordx4 v[116:119], v36, s[40:43], s59 offen sc1
    buffer_store_dwordx4 v[120:123], v36, s[40:43], s59 offen offset:2048 sc1
    buffer_store_dwordx4 v[124:127], v36, s[40:43], s59 offen offset:256 sc1
    buffer_store_dwordx4 v[128:131], v36, s[40:43], s59 offen offset:2304 sc1
    v_mov_b32_dpp v212, v220 row_newbcast:8 row_mask:0xf bank_mask:0xf
    v_mov_b32_dpp v213, v221 row_newbcast:8 row_mask:0xf bank_mask:0xf
    v_mov_b32_dpp v214, v220 row_newbcast:9 row_mask:0xf bank_mask:0xf
    v_mov_b32_dpp v215, v221 row_newbcast:9 row_mask:0xf bank_mask:0xf
    v_mov_b32_dpp v216, v220 row_newbcast:10 row_mask:0xf bank_mask:0xf
    v_mov_b32_dpp v217, v221 row_newbcast:10 row_mask:0xf bank_mask:0xf
    v_mov_b32_dpp v218, v220 row_newbcast:11 row_mask:0xf bank_mask:0xf
    v_mov_b32_dpp v219, v221 row_newbcast:11 row_mask:0xf bank_mask:0xf
    v_mfma_f32_16x16x16_bf16 v[132:135], v[212:213], a[160:161], 0
    v_mfma_f32_16x16x16_bf16 v[136:139], v[214:215], a[162:163], 0
    v_mfma_f32_16x16x16_bf16 v[140:143], v[216:217], a[164:165], 0
    v_mfma_f32_16x16x16_bf16 v[144:147], v[218:219], a[166:167], 0
    v_mfma_f32_16x16x16_bf16 v[148:151], v[212:213], a[168:169], 0
    v_mfma_f32_16x16x16_bf16 v[152:155], v[214:215], a[170:171], 0
    v_mfma_f32_16x16x16_bf16 v[156:159], v[216:217], a[172:173], 0
    v_mfma_f32_16x16x16_bf16 v[160:163], v[218:219], a[174:175], 0
    s_waitcnt vmcnt(16)
    v_cvt_pk_bf16_f32 v164, v164, v165
    v_cvt_pk_bf16_f32 v165, v166, v167
    v_cvt_pk_bf16_f32 v168, v168, v169
    v_cvt_pk_bf16_f32 v169, v170, v171
    v_cvt_pk_bf16_f32 v172, v172, v173
    v_cvt_pk_bf16_f32 v173, v174, v175
    v_cvt_pk_bf16_f32 v176, v176, v177
    v_cvt_pk_bf16_f32 v177, v178, v179
    v_mfma_f32_16x16x16_bf16 v[68:71], v[164:165], a[160:161], 0
    v_add_f32 v196, v60, v132
    v_mfma_f32_16x16x16_bf16 v[72:75], v[168:169], a[162:163], 0
    v_add_f32 v198, v60, v136
    v_mfma_f32_16x16x16_bf16 v[76:79], v[172:173], a[164:165], 0
    v_add_f32 v200, v60, v140
    v_mfma_f32_16x16x16_bf16 v[80:83], v[176:177], a[166:167], 0
    v_add_f32 v202, v60, v144
    v_mfma_f32_16x16x16_bf16 v[84:87], v[164:165], a[168:169], 0
    v_add_f32 v204, v60, v148
    v_mfma_f32_16x16x16_bf16 v[88:91], v[168:169], a[170:171], 0
    v_add_f32 v206, v60, v152
    v_mfma_f32_16x16x16_bf16 v[92:95], v[172:173], a[172:173], 0
    v_add_f32 v208, v60, v156
    v_mfma_f32_16x16x16_bf16 v[96:99], v[176:177], a[174:175], 0
    v_add_f32 v210, v60, v160
    v_rcp_f32 v196, v196
    v_rcp_f32 v198, v198
    v_rcp_f32 v200, v200
    v_rcp_f32 v202, v202
    v_rcp_f32 v204, v204
    v_rcp_f32 v206, v206
    v_rcp_f32 v208, v208
    v_rcp_f32 v210, v210
    v_pk_mul_f32 v[68:69], v[68:69], v[196:197] op_sel_hi:[1,0]
    v_pk_mul_f32 v[70:71], v[70:71], v[196:197] op_sel_hi:[1,0]
    v_pk_mul_f32 v[72:73], v[72:73], v[198:199] op_sel_hi:[1,0]
    v_pk_mul_f32 v[74:75], v[74:75], v[198:199] op_sel_hi:[1,0]
    v_pk_mul_f32 v[76:77], v[76:77], v[200:201] op_sel_hi:[1,0]
    v_pk_mul_f32 v[78:79], v[78:79], v[200:201] op_sel_hi:[1,0]
    v_pk_mul_f32 v[80:81], v[80:81], v[202:203] op_sel_hi:[1,0]
    v_pk_mul_f32 v[82:83], v[82:83], v[202:203] op_sel_hi:[1,0]
    v_pk_mul_f32 v[84:85], v[84:85], v[204:205] op_sel_hi:[1,0]
    v_pk_mul_f32 v[86:87], v[86:87], v[204:205] op_sel_hi:[1,0]
    v_pk_mul_f32 v[88:89], v[88:89], v[206:207] op_sel_hi:[1,0]
    v_pk_mul_f32 v[90:91], v[90:91], v[206:207] op_sel_hi:[1,0]
    v_pk_mul_f32 v[92:93], v[92:93], v[208:209] op_sel_hi:[1,0]
    v_pk_mul_f32 v[94:95], v[94:95], v[208:209] op_sel_hi:[1,0]
    v_pk_mul_f32 v[96:97], v[96:97], v[210:211] op_sel_hi:[1,0]
    v_pk_mul_f32 v[98:99], v[98:99], v[210:211] op_sel_hi:[1,0]
    v_cvt_pk_bf16_f32 v164, v68, v69
    v_cvt_pk_bf16_f32 v165, v70, v71
    v_cvt_pk_bf16_f32 v166, v72, v73
    v_cvt_pk_bf16_f32 v167, v74, v75
    v_cvt_pk_bf16_f32 v168, v76, v77
    v_cvt_pk_bf16_f32 v169, v78, v79
    v_cvt_pk_bf16_f32 v170, v80, v81
    v_cvt_pk_bf16_f32 v171, v82, v83
    v_cvt_pk_bf16_f32 v172, v84, v85
    v_cvt_pk_bf16_f32 v173, v86, v87
    v_cvt_pk_bf16_f32 v174, v88, v89
    v_cvt_pk_bf16_f32 v175, v90, v91
    v_cvt_pk_bf16_f32 v176, v92, v93
    v_cvt_pk_bf16_f32 v177, v94, v95
    v_cvt_pk_bf16_f32 v178, v96, v97
    v_cvt_pk_bf16_f32 v179, v98, v99
    s_add_u32 s59, s65, 20480
    buffer_store_dwordx4 v[164:167], v36, s[40:43], s59 offen sc1
    buffer_store_dwordx4 v[168:171], v36, s[40:43], s59 offen offset:2048 sc1
    buffer_store_dwordx4 v[172:175], v36, s[40:43], s59 offen offset:256 sc1
    buffer_store_dwordx4 v[176:179], v36, s[40:43], s59 offen offset:2304 sc1
    v_mov_b32_dpp v212, v220 row_newbcast:12 row_mask:0xf bank_mask:0xf
    v_mov_b32_dpp v213, v221 row_newbcast:12 row_mask:0xf bank_mask:0xf
    v_mov_b32_dpp v214, v220 row_newbcast:13 row_mask:0xf bank_mask:0xf
    v_mov_b32_dpp v215, v221 row_newbcast:13 row_mask:0xf bank_mask:0xf
    v_mov_b32_dpp v216, v220 row_newbcast:14 row_mask:0xf bank_mask:0xf
    v_mov_b32_dpp v217, v221 row_newbcast:14 row_mask:0xf bank_mask:0xf
    v_mov_b32_dpp v218, v220 row_newbcast:15 row_mask:0xf bank_mask:0xf
    v_mov_b32_dpp v219, v221 row_newbcast:15 row_mask:0xf bank_mask:0xf
    v_mfma_f32_16x16x16_bf16 v[132:135], v[212:213], a[176:177], 0
    v_mfma_f32_16x16x16_bf16 v[136:139], v[214:215], a[178:179], 0
    v_mfma_f32_16x16x16_bf16 v[140:143], v[216:217], a[180:181], 0
    v_mfma_f32_16x16x16_bf16 v[144:147], v[218:219], a[182:183], 0
    v_mfma_f32_16x16x16_bf16 v[148:151], v[212:213], a[184:185], 0
    v_mfma_f32_16x16x16_bf16 v[152:155], v[214:215], a[186:187], 0
    v_mfma_f32_16x16x16_bf16 v[156:159], v[216:217], a[188:189], 0
    v_mfma_f32_16x16x16_bf16 v[160:163], v[218:219], a[190:191], 0
    s_waitcnt vmcnt(16)
    v_cvt_pk_bf16_f32 v180, v180, v181
    v_cvt_pk_bf16_f32 v181, v182, v183
    v_cvt_pk_bf16_f32 v184, v184, v185
    v_cvt_pk_bf16_f32 v185, v186, v187
    v_cvt_pk_bf16_f32 v188, v188, v189
    v_cvt_pk_bf16_f32 v189, v190, v191
    v_cvt_pk_bf16_f32 v192, v192, v193
    v_cvt_pk_bf16_f32 v193, v194, v195
    v_mfma_f32_16x16x16_bf16 v[68:71], v[180:181], a[176:177], 0
    v_add_f32 v196, v60, v132
    v_mfma_f32_16x16x16_bf16 v[72:75], v[184:185], a[178:179], 0
    v_add_f32 v198, v60, v136
    v_mfma_f32_16x16x16_bf16 v[76:79], v[188:189], a[180:181], 0
    v_add_f32 v200, v60, v140
    v_mfma_f32_16x16x16_bf16 v[80:83], v[192:193], a[182:183], 0
    v_add_f32 v202, v60, v144
    v_mfma_f32_16x16x16_bf16 v[84:87], v[180:181], a[184:185], 0
    v_add_f32 v204, v60, v148
    v_mfma_f32_16x16x16_bf16 v[88:91], v[184:185], a[186:187], 0
    v_add_f32 v206, v60, v152
    v_mfma_f32_16x16x16_bf16 v[92:95], v[188:189], a[188:189], 0
    v_add_f32 v208, v60, v156
    v_mfma_f32_16x16x16_bf16 v[96:99], v[192:193], a[190:191], 0
    v_add_f32 v210, v60, v160
    v_rcp_f32 v196, v196
    v_rcp_f32 v198, v198
    v_rcp_f32 v200, v200
    v_rcp_f32 v202, v202
    v_rcp_f32 v204, v204
    v_rcp_f32 v206, v206
    v_rcp_f32 v208, v208
    v_rcp_f32 v210, v210
    v_pk_mul_f32 v[68:69], v[68:69], v[196:197] op_sel_hi:[1,0]
    v_pk_mul_f32 v[70:71], v[70:71], v[196:197] op_sel_hi:[1,0]
    v_pk_mul_f32 v[72:73], v[72:73], v[198:199] op_sel_hi:[1,0]
    v_pk_mul_f32 v[74:75], v[74:75], v[198:199] op_sel_hi:[1,0]
    v_pk_mul_f32 v[76:77], v[76:77], v[200:201] op_sel_hi:[1,0]
    v_pk_mul_f32 v[78:79], v[78:79], v[200:201] op_sel_hi:[1,0]
    v_pk_mul_f32 v[80:81], v[80:81], v[202:203] op_sel_hi:[1,0]
    v_pk_mul_f32 v[82:83], v[82:83], v[202:203] op_sel_hi:[1,0]
    v_pk_mul_f32 v[84:85], v[84:85], v[204:205] op_sel_hi:[1,0]
    v_pk_mul_f32 v[86:87], v[86:87], v[204:205] op_sel_hi:[1,0]
    v_pk_mul_f32 v[88:89], v[88:89], v[206:207] op_sel_hi:[1,0]
    v_pk_mul_f32 v[90:91], v[90:91], v[206:207] op_sel_hi:[1,0]
    v_pk_mul_f32 v[92:93], v[92:93], v[208:209] op_sel_hi:[1,0]
    v_pk_mul_f32 v[94:95], v[94:95], v[208:209] op_sel_hi:[1,0]
    v_pk_mul_f32 v[96:97], v[96:97], v[210:211] op_sel_hi:[1,0]
    v_pk_mul_f32 v[98:99], v[98:99], v[210:211] op_sel_hi:[1,0]
    v_cvt_pk_bf16_f32 v180, v68, v69
    v_cvt_pk_bf16_f32 v181, v70, v71
    v_cvt_pk_bf16_f32 v182, v72, v73
    v_cvt_pk_bf16_f32 v183, v74, v75
    v_cvt_pk_bf16_f32 v184, v76, v77
    v_cvt_pk_bf16_f32 v185, v78, v79
    v_cvt_pk_bf16_f32 v186, v80, v81
    v_cvt_pk_bf16_f32 v187, v82, v83
    v_cvt_pk_bf16_f32 v188, v84, v85
    v_cvt_pk_bf16_f32 v189, v86, v87
    v_cvt_pk_bf16_f32 v190, v88, v89
    v_cvt_pk_bf16_f32 v191, v90, v91
    v_cvt_pk_bf16_f32 v192, v92, v93
    v_cvt_pk_bf16_f32 v193, v94, v95
    v_cvt_pk_bf16_f32 v194, v96, v97
    v_cvt_pk_bf16_f32 v195, v98, v99
    s_add_u32 s59, s65, 24576
    buffer_store_dwordx4 v[180:183], v36, s[40:43], s59 offen sc1
    buffer_store_dwordx4 v[184:187], v36, s[40:43], s59 offen offset:2048 sc1
    buffer_store_dwordx4 v[188:191], v36, s[40:43], s59 offen offset:256 sc1
    buffer_store_dwordx4 v[192:195], v36, s[40:43], s59 offen offset:2304 sc1
    v_mov_b32_dpp v212, v224 row_newbcast:0 row_mask:0xf bank_mask:0xf
    v_mov_b32_dpp v213, v225 row_newbcast:0 row_mask:0xf bank_mask:0xf
    v_mov_b32_dpp v214, v224 row_newbcast:1 row_mask:0xf bank_mask:0xf
    v_mov_b32_dpp v215, v225 row_newbcast:1 row_mask:0xf bank_mask:0xf
    v_mov_b32_dpp v216, v224 row_newbcast:2 row_mask:0xf bank_mask:0xf
    v_mov_b32_dpp v217, v225 row_newbcast:2 row_mask:0xf bank_mask:0xf
    v_mov_b32_dpp v218, v224 row_newbcast:3 row_mask:0xf bank_mask:0xf
    v_mov_b32_dpp v219, v225 row_newbcast:3 row_mask:0xf bank_mask:0xf
    v_mfma_f32_16x16x16_bf16 v[132:135], v[212:213], a[192:193], 0
    v_mfma_f32_16x16x16_bf16 v[136:139], v[214:215], a[194:195], 0
    v_mfma_f32_16x16x16_bf16 v[140:143], v[216:217], a[196:197], 0
    v_mfma_f32_16x16x16_bf16 v[144:147], v[218:219], a[198:199], 0
    v_mfma_f32_16x16x16_bf16 v[148:151], v[212:213], a[200:201], 0
    v_mfma_f32_16x16x16_bf16 v[152:155], v[214:215], a[202:203], 0
    v_mfma_f32_16x16x16_bf16 v[156:159], v[216:217], a[204:205], 0
    v_mfma_f32_16x16x16_bf16 v[160:163], v[218:219], a[206:207], 0
    s_waitcnt vmcnt(16)
    v_cvt_pk_bf16_f32 v228, v228, v229
    v_cvt_pk_bf16_f32 v229, v230, v231
    v_cvt_pk_bf16_f32 v232, v232, v233
    v_cvt_pk_bf16_f32 v233, v234, v235
    v_cvt_pk_bf16_f32 v236, v236, v237
    v_cvt_pk_bf16_f32 v237, v238, v239
    v_cvt_pk_bf16_f32 v240, v240, v241
    v_cvt_pk_bf16_f32 v241, v242, v243
    v_mfma_f32_16x16x16_bf16 v[68:71], v[228:229], a[192:193], 0
    v_add_f32 v196, v60, v132
    v_mfma_f32_16x16x16_bf16 v[72:75], v[232:233], a[194:195], 0
    v_add_f32 v198, v60, v136
    v_mfma_f32_16x16x16_bf16 v[76:79], v[236:237], a[196:197], 0
    v_add_f32 v200, v60, v140
    v_mfma_f32_16x16x16_bf16 v[80:83], v[240:241], a[198:199], 0
    v_add_f32 v202, v60, v144
    v_mfma_f32_16x16x16_bf16 v[84:87], v[228:229], a[200:201], 0
    v_add_f32 v204, v60, v148
    v_mfma_f32_16x16x16_bf16 v[88:91], v[232:233], a[202:203], 0
    v_add_f32 v206, v60, v152
    v_mfma_f32_16x16x16_bf16 v[92:95], v[236:237], a[204:205], 0
    v_add_f32 v208, v60, v156
    v_mfma_f32_16x16x16_bf16 v[96:99], v[240:241], a[206:207], 0
    v_add_f32 v210, v60, v160
    v_rcp_f32 v196, v196
    v_rcp_f32 v198, v198
    v_rcp_f32 v200, v200
    v_rcp_f32 v202, v202
    v_rcp_f32 v204, v204
    v_rcp_f32 v206, v206
    v_rcp_f32 v208, v208
    v_rcp_f32 v210, v210
    v_pk_mul_f32 v[68:69], v[68:69], v[196:197] op_sel_hi:[1,0]
    v_pk_mul_f32 v[70:71], v[70:71], v[196:197] op_sel_hi:[1,0]
    v_pk_mul_f32 v[72:73], v[72:73], v[198:199] op_sel_hi:[1,0]
    v_pk_mul_f32 v[74:75], v[74:75], v[198:199] op_sel_hi:[1,0]
    v_pk_mul_f32 v[76:77], v[76:77], v[200:201] op_sel_hi:[1,0]
    v_pk_mul_f32 v[78:79], v[78:79], v[200:201] op_sel_hi:[1,0]
    v_pk_mul_f32 v[80:81], v[80:81], v[202:203] op_sel_hi:[1,0]
    v_pk_mul_f32 v[82:83], v[82:83], v[202:203] op_sel_hi:[1,0]
    v_pk_mul_f32 v[84:85], v[84:85], v[204:205] op_sel_hi:[1,0]
    v_pk_mul_f32 v[86:87], v[86:87], v[204:205] op_sel_hi:[1,0]
    v_pk_mul_f32 v[88:89], v[88:89], v[206:207] op_sel_hi:[1,0]
    v_pk_mul_f32 v[90:91], v[90:91], v[206:207] op_sel_hi:[1,0]
    v_pk_mul_f32 v[92:93], v[92:93], v[208:209] op_sel_hi:[1,0]
    v_pk_mul_f32 v[94:95], v[94:95], v[208:209] op_sel_hi:[1,0]
    v_pk_mul_f32 v[96:97], v[96:97], v[210:211] op_sel_hi:[1,0]
    v_pk_mul_f32 v[98:99], v[98:99], v[210:211] op_sel_hi:[1,0]
    v_cvt_pk_bf16_f32 v228, v68, v69
    v_cvt_pk_bf16_f32 v229, v70, v71
    v_cvt_pk_bf16_f32 v230, v72, v73
    v_cvt_pk_bf16_f32 v231, v74, v75
    v_cvt_pk_bf16_f32 v232, v76, v77
    v_cvt_pk_bf16_f32 v233, v78, v79
    v_cvt_pk_bf16_f32 v234, v80, v81
    v_cvt_pk_bf16_f32 v235, v82, v83
    v_cvt_pk_bf16_f32 v236, v84, v85
    v_cvt_pk_bf16_f32 v237, v86, v87
    v_cvt_pk_bf16_f32 v238, v88, v89
    v_cvt_pk_bf16_f32 v239, v90, v91
    v_cvt_pk_bf16_f32 v240, v92, v93
    v_cvt_pk_bf16_f32 v241, v94, v95
    v_cvt_pk_bf16_f32 v242, v96, v97
    v_cvt_pk_bf16_f32 v243, v98, v99
    s_add_u32 s59, s65, 28672
    buffer_store_dwordx4 v[228:231], v36, s[40:43], s59 offen sc1
    buffer_store_dwordx4 v[232:235], v36, s[40:43], s59 offen offset:2048 sc1
    buffer_store_dwordx4 v[236:239], v36, s[40:43], s59 offen offset:256 sc1
    buffer_store_dwordx4 v[240:243], v36, s[40:43], s59 offen offset:2304 sc1
    s_lshr_b32 s64, s57, 1
    s_lshl_b32 s64, s64, 10
    s_and_b32 s60, s44, 1
    s_lshl_b32 s60, s60, 3
    s_add_u32 s64, s64, s60
    s_add_u32 s64, s64, 50064
    s_nop 7
L_P3s:
H_S_0:
    s_cbranch_execz H_T_0
    s_add_u32 m0, s56, 81920
    s_mov_b32 s58, 0
    buffer_load_dwordx4 v20, s[12:15], s58 offen lds
    buffer_load_dwordx4 v21, s[12:15], s58 offen offset:1024 lds
    buffer_load_dwordx4 v22, s[12:15], s58 offen offset:2048 lds
    buffer_load_dwordx4 v23, s[12:15], s58 offen offset:3072 lds
    s_and_b32 s1, s44, 1
    s_lshl_b32 s92, s1, 13
    v_lshrrev_b32 v42, 5, v1
    v_bfe_u32 v43, v1, 2, 2
    v_lshl_add_u32 v42, v42, 3, v43
    v_lshlrev_b32 v42, 7, v42
    v_and_b32 v43, 8, v1
    v_lshl_add_u32 v42, v43, 3, v42
    v_and_b32 v43, 16, v1
    v_lshl_add_u32 v42, v43, 1, v42
    v_and_b32 v43, 3, v1
    v_lshl_add_u32 v42, v43, 3, v42
    v_add_u32 v24, s92, v42
    v_xor_b32 v25, 64, v24
    v_add_u32 v26, 0x10000, v24
    v_add_u32 v27, 0x10000, v25
    v_add_u32 v28, 0x20000, v24
    v_add_u32 v29, 0x20000, v25
    s_lshl_b32 s65, s96, 1
    s_lshr_b32 s92, s44, 1
    s_add_u32 s65, s65, s92
    v_and_b32 v42, 31, v1
    s_lshl_b32 s95, s65, 7
    s_add_u32 s95, s95, 102400
    v_lshl_add_u32 v34, v42, 2, s95
    v_mul_u32_u24 v35, 272, v42
    v_lshrrev_b32 v43, 5, v1
    v_lshl_add_u32 v35, v43, 4, v35
    s_mul_i32 s95, s44, 8704
    v_add_u32 v35, s95, v35
    v_lshrrev_b32 v43, 3, v1
    v_and_b32 v42, 7, v1
    v_mul_u32_u24 v47, 272, v43
    v_lshl_add_u32 v47, v42, 5, v47
    s_mul_i32 s92, s92, 17408
    s_mul_i32 s95, s1, 4352
    s_add_u32 s92, s92, s95
    v_add_u32 v47, s92, v47
    v_lshrrev_b32 v40, 2, v43
    v_and_b32 v43, 3, v43
    v_lshl_add_u32 v40, v40, 3, v43
    v_lshlrev_b32 v40, 10, v40
    v_lshl_add_u32 v40, v42, 4, v40
    s_lshl_b32 s92, s65, 15
    s_lshl_b32 s1, s1, 12
    s_add_u32 s92, s92, s1
    s_lshl_b32 s95, s97, 7
    s_add_u32 s92, s92, s95
    v_add_u32 v40, s92, v40
    v_add_u32 v41, 16384, v40
    s_mul_i32 s65, s65, 90112
    s_add_u32 s65, s65, s1
    s_add_u32 s65, s65, 12582912
    s_waitcnt vmcnt(4)
    buffer_store_dwordx2 v[66:67], v50, s[40:43], s64 offen sc1
    s_add_u32 m0, s56, 49152
    s_mov_b32 s58, 131072
    buffer_load_dwordx4 v20, s[12:15], s58 offen lds
    buffer_load_dwordx4 v21, s[12:15], s58 offen offset:1024 lds
    buffer_load_dwordx4 v22, s[12:15], s58 offen offset:2048 lds
    buffer_load_dwordx4 v23, s[12:15], s58 offen offset:3072 lds
    s_add_u32 m0, s56, 114688
    s_mov_b32 s58, 262144
    buffer_load_dwordx4 v20, s[12:15], s58 offen lds
    buffer_load_dwordx4 v21, s[12:15], s58 offen offset:1024 lds
    buffer_load_dwordx4 v22, s[12:15], s58 offen offset:2048 lds
    buffer_load_dwordx4 v23, s[12:15], s58 offen offset:3072 lds
    s_add_u32 m0, s56, 0
    s_mov_b32 s58, 393216
    buffer_load_dwordx4 v20, s[12:15], s58 offen lds
    buffer_load_dwordx4 v21, s[12:15], s58 offen offset:1024 lds
    buffer_load_dwordx4 v22, s[12:15], s58 offen offset:2048 lds
    buffer_load_dwordx4 v23, s[12:15], s58 offen offset:3072 lds
    s_add_u32 m0, s56, 98304
    s_mov_b32 s58, 0
    buffer_load_dwordx4 v20, s[28:31], s58 offen lds
    buffer_load_dwordx4 v21, s[28:31], s58 offen offset:1024 lds
    buffer_load_dwordx4 v22, s[28:31], s58 offen offset:2048 lds
    buffer_load_dwordx4 v23, s[28:31], s58 offen offset:3072 lds
    s_add_u32 m0, s56, 16384
    s_mov_b32 s58, 131072
    buffer_load_dwordx4 v20, s[28:31], s58 offen lds
    buffer_load_dwordx4 v21, s[28:31], s58 offen offset:1024 lds
    buffer_load_dwordx4 v22, s[28:31], s58 offen offset:2048 lds
    buffer_load_dwordx4 v23, s[28:31], s58 offen offset:3072 lds
    s_add_u32 m0, s56, 65536
    s_mov_b32 s58, 262144
    buffer_load_dwordx4 v20, s[28:31], s58 offen lds
    buffer_load_dwordx4 v21, s[28:31], s58 offen offset:1024 lds
    buffer_load_dwordx4 v22, s[28:31], s58 offen offset:2048 lds
    buffer_load_dwordx4 v23, s[28:31], s58 offen offset:3072 lds
    s_lshl_b32 s61, s96, 10
    s_add_u32 s61, s61, 50048
    v_and_b32 v46, 24, v51
    v_add_u32 v46, s61, v46
    buffer_load_dwordx2 v[44:45], v46, s[40:43], 0 offen sc1
    s_add_u32 m0, s56, 32768
    s_mov_b32 s58, 393216
    buffer_load_dwordx4 v20, s[28:31], s58 offen lds
    buffer_load_dwordx4 v21, s[28:31], s58 offen offset:1024 lds
    buffer_load_dwordx4 v22, s[28:31], s58 offen offset:2048 lds
    buffer_load_dwordx4 v23, s[28:31], s58 offen offset:3072 lds
    s_add_u32 m0, s56, 147456
    s_mov_b32 s58, 524288
    buffer_load_dwordx4 v20, s[28:31], s58 offen lds
    buffer_load_dwordx4 v21, s[28:31], s58 offen offset:1024 lds
    buffer_load_dwordx4 v22, s[28:31], s58 offen offset:2048 lds
    buffer_load_dwordx4 v23, s[28:31], s58 offen offset:3072 lds
    s_waitcnt vmcnt(8)
L_chk_2701:
    v_xor_b32 v62, s50, v44
    v_bitop3_b32 v62, v45, s51, v62 bitop3:0xbe
    v_cmp_ne_u32 vcc, 0, v62
    s_nop 0
    s_cbranch_vccnz L_retry_2702
L_cont_2703:
H_S_1:
    s_cbranch_execz H_T_1
    buffer_load_dword v30, v34, s[40:43], 0 offen sc1
    s_add_u32 s63, s65, 0
    buffer_load_dwordx4 a[128:131], v48, s[40:43], s63 offen sc1
    buffer_load_dwordx4 a[132:135], v48, s[40:43], s63 offen offset:1024 sc1
    buffer_load_dwordx4 a[136:139], v48, s[40:43], s63 offen offset:2048 sc1
    buffer_load_dwordx4 a[140:143], v48, s[40:43], s63 offen offset:3072 sc1
    s_add_u32 s63, s65, 8192
    buffer_load_dwordx4 a[144:147], v48, s[40:43], s63 offen sc1
    buffer_load_dwordx4 a[148:151], v48, s[40:43], s63 offen offset:1024 sc1
    buffer_load_dwordx4 a[152:155], v48, s[40:43], s63 offen offset:2048 sc1
    buffer_load_dwordx4 a[156:159], v48, s[40:43], s63 offen offset:3072 sc1
    s_add_u32 s63, s65, 16384
    buffer_load_dwordx4 a[160:163], v48, s[40:43], s63 offen sc1
    buffer_load_dwordx4 a[164:167], v48, s[40:43], s63 offen offset:1024 sc1
    buffer_load_dwordx4 a[168:171], v48, s[40:43], s63 offen offset:2048 sc1
    buffer_load_dwordx4 a[172:175], v48, s[40:43], s63 offen offset:3072 sc1
    s_add_u32 s63, s65, 24576
    buffer_load_dwordx4 a[176:179], v48, s[40:43], s63 offen sc1
    buffer_load_dwordx4 a[180:183], v48, s[40:43], s63 offen offset:1024 sc1
    buffer_load_dwordx4 a[184:187], v48, s[40:43], s63 offen offset:2048 sc1
    buffer_load_dwordx4 a[188:191], v48, s[40:43], s63 offen offset:3072 sc1
    s_barrier
    ds_read_b64_tr_b16 v[132:133], v26 offset:16384
    ds_read_b64_tr_b16 v[134:135], v26 offset:16896
    ds_read_b64_tr_b16 v[136:137], v27 offset:16384
    ds_read_b64_tr_b16 v[138:139], v27 offset:16896
    ds_read_b64_tr_b16 v[140:141], v26 offset:18432
    ds_read_b64_tr_b16 v[142:143], v26 offset:18944
    ds_read_b64_tr_b16 v[144:145], v27 offset:18432
    ds_read_b64_tr_b16 v[146:147], v27 offset:18944
    s_waitcnt vmcnt(14)
    s_waitcnt lgkmcnt(6)
    v_mfma_f32_32x32x16_bf16 v[68:83], v[132:135], a[128:131], 0
    ds_read_b64_tr_b16 v[148:149], v26 offset:20480
    ds_read_b64_tr_b16 v[150:151], v26 offset:20992
    s_add_u32 m0, s56, 131072
    s_mov_b32 s58, 655360
    buffer_load_dwordx4 v20, s[28:31], s58 offen lds
    s_waitcnt lgkmcnt(6)
    v_mfma_f32_32x32x16_bf16 v[84:99], v[136:139], a[128:131], 0
    ds_read_b64_tr_b16 v[152:153], v27 offset:20480
    ds_read_b64_tr_b16 v[154:155], v27 offset:20992
    buffer_load_dwordx4 v21, s[28:31], s58 offen offset:1024 lds
    s_waitcnt lgkmcnt(6)
    v_mfma_f32_32x32x16_bf16 v[68:83], v[140:143], a[132:135], v[68:83]
    ds_read_b64_tr_b16 v[156:157], v26 offset:22528
    ds_read_b64_tr_b16 v[158:159], v26 offset:23040
    buffer_load_dwordx4 v22, s[28:31], s58 offen offset:2048 lds
    s_waitcnt lgkmcnt(6)
    v_mfma_f32_32x32x16_bf16 v[84:99], v[144:147], a[132:135], v[84:99]
    ds_read_b64_tr_b16 v[160:161], v27 offset:22528
    ds_read_b64_tr_b16 v[162:163], v27 offset:23040
    buffer_load_dwordx4 v23, s[28:31], s58 offen offset:3072 lds
    s_waitcnt vmcnt(16)
    s_waitcnt lgkmcnt(6)
    v_mfma_f32_32x32x16_bf16 v[68:83], v[148:151], a[136:139], v[68:83]
    s_waitcnt lgkmcnt(4)
    v_mfma_f32_32x32x16_bf16 v[84:99], v[152:155], a[136:139], v[84:99]
    s_waitcnt lgkmcnt(0)
    s_barrier
    v_mfma_f32_32x32x16_bf16 v[68:83], v[156:159], a[140:143], v[68:83]
    ds_read_b64_tr_b16 v[132:133], v24 offset:49152
    ds_read_b64_tr_b16 v[134:135], v24 offset:49664
    ds_read_b64_tr_b16 v[136:137], v25 offset:49152
    ds_read_b64_tr_b16 v[138:139], v25 offset:49664
    s_add_u32 m0, s56, 81920
    s_mov_b32 s58, 786432
    buffer_load_dwordx4 v20, s[28:31], s58 offen lds
    v_mfma_f32_32x32x16_bf16 v[84:99], v[160:163], a[140:143], v[84:99]
    ds_read_b64_tr_b16 v[140:141], v24 offset:51200
    ds_read_b64_tr_b16 v[142:143], v24 offset:51712
    ds_read_b64_tr_b16 v[144:145], v25 offset:51200
    ds_read_b64_tr_b16 v[146:147], v25 offset:51712
    buffer_load_dwordx4 v21, s[28:31], s58 offen offset:1024 lds
    s_waitcnt vmcnt(16)
    s_waitcnt lgkmcnt(6)
    v_mfma_f32_32x32x16_bf16 v[68:83], v[132:135], a[144:147], v[68:83]
    ds_read_b64_tr_b16 v[148:149], v24 offset:53248
    ds_read_b64_tr_b16 v[150:151], v24 offset:53760
    buffer_load_dwordx4 v22, s[28:31], s58 offen offset:2048 lds
    s_waitcnt lgkmcnt(6)
    v_mfma_f32_32x32x16_bf16 v[84:99], v[136:139], a[144:147], v[84:99]
    ds_read_b64_tr_b16 v[152:153], v25 offset:53248
    ds_read_b64_tr_b16 v[154:155], v25 offset:53760
    buffer_load_dwordx4 v23, s[28:31], s58 offen offset:3072 lds
    s_waitcnt lgkmcnt(6)
    v_mfma_f32_32x32x16_bf16 v[68:83], v[140:143], a[148:151], v[68:83]
    ds_read_b64_tr_b16 v[156:157], v24 offset:55296
    ds_read_b64_tr_b16 v[158:159], v24 offset:55808
    s_waitcnt lgkmcnt(6)
    v_mfma_f32_32x32x16_bf16 v[84:99], v[144:147], a[148:151], v[84:99]
    ds_read_b64_tr_b16 v[160:161], v25 offset:55296
    ds_read_b64_tr_b16 v[162:163], v25 offset:55808
    s_waitcnt vmcnt(16)
    s_waitcnt lgkmcnt(6)
    v_mfma_f32_32x32x16_bf16 v[68:83], v[148:151], a[152:155], v[68:83]
    ds_read_b64_tr_b16 v[132:133], v26 offset:49152
    ds_read_b64_tr_b16 v[134:135], v26 offset:49664
    s_waitcnt lgkmcnt(6)
    v_mfma_f32_32x32x16_bf16 v[84:99], v[152:155], a[152:155], v[84:99]
    ds_read_b64_tr_b16 v[136:137], v27 offset:49152
    ds_read_b64_tr_b16 v[138:139], v27 offset:49664
    s_waitcnt lgkmcnt(6)
    v_mfma_f32_32x32x16_bf16 v[68:83], v[156:159], a[156:159], v[68:83]
    ds_read_b64_tr_b16 v[140:141], v26 offset:51200
    ds_read_b64_tr_b16 v[142:143], v26 offset:51712
    s_waitcnt lgkmcnt(6)
    v_mfma_f32_32x32x16_bf16 v[84:99], v[160:163], a[156:159], v[84:99]
    ds_read_b64_tr_b16 v[144:145], v27 offset:51200
    ds_read_b64_tr_b16 v[146:147], v27 offset:51712
    s_waitcnt vmcnt(14)
    s_waitcnt lgkmcnt(6)
    v_mfma_f32_32x32x16_bf16 v[68:83], v[132:135], a[160:163], v[68:83]
    ds_read_b64_tr_b16 v[148:149], v26 offset:53248
    ds_read_b64_tr_b16 v[150:151], v26 offset:53760
    s_waitcnt lgkmcnt(6)
    v_mfma_f32_32x32x16_bf16 v[84:99], v[136:139], a[160:163], v[84:99]
    ds_read_b64_tr_b16 v[152:153], v27 offset:53248
    ds_read_b64_tr_b16 v[154:155], v27 offset:53760
    s_waitcnt lgkmcnt(6)
    v_mfma_f32_32x32x16_bf16 v[68:83], v[140:143], a[164:167], v[68:83]
    ds_read_b64_tr_b16 v[156:157], v26 offset:55296
    ds_read_b64_tr_b16 v[158:159], v26 offset:55808
    s_waitcnt lgkmcnt(6)
    v_mfma_f32_32x32x16_bf16 v[84:99], v[144:147], a[164:167], v[84:99]
    ds_read_b64_tr_b16 v[160:161], v27 offset:55296
    ds_read_b64_tr_b16 v[162:163], v27 offset:55808
    s_lshl_b32 s61, s96, 10
    s_add_u32 s61, s61, 49152
    v_and_b32 v254, 0x3ff, v51
    v_add_u32 v254, s61, v254
    buffer_load_dwordx2 v[252:253], v254, s[40:43], 0 offen sc1
    s_waitcnt vmcnt(13)
    s_waitcnt lgkmcnt(6)
    v_mfma_f32_32x32x16_bf16 v[68:83], v[148:151], a[168:171], v[68:83]
    ds_read_b64_tr_b16 v[132:133], v24 offset:0
    ds_read_b64_tr_b16 v[134:135], v24 offset:512
    s_waitcnt lgkmcnt(6)
    v_mfma_f32_32x32x16_bf16 v[84:99], v[152:155], a[168:171], v[84:99]
    ds_read_b64_tr_b16 v[136:137], v25 offset:0
    ds_read_b64_tr_b16 v[138:139], v25 offset:512
    s_waitcnt lgkmcnt(6)
    v_mfma_f32_32x32x16_bf16 v[68:83], v[156:159], a[172:175], v[68:83]
    ds_read_b64_tr_b16 v[140:141], v24 offset:2048
    ds_read_b64_tr_b16 v[142:143], v24 offset:2560
    s_waitcnt lgkmcnt(6)
    v_mfma_f32_32x32x16_bf16 v[84:99], v[160:163], a[172:175], v[84:99]
    ds_read_b64_tr_b16 v[144:145], v25 offset:2048
    ds_read_b64_tr_b16 v[146:147], v25 offset:2560
    s_waitcnt vmcnt(11)
    s_waitcnt lgkmcnt(6)
    v_mfma_f32_32x32x16_bf16 v[68:83], v[132:135], a[176:179], v[68:83]
    ds_read_b64_tr_b16 v[148:149], v24 offset:4096
    ds_read_b64_tr_b16 v[150:151], v24 offset:4608
    s_waitcnt lgkmcnt(6)
    v_mfma_f32_32x32x16_bf16 v[84:99], v[136:139], a[176:179], v[84:99]
    ds_read_b64_tr_b16 v[152:153], v25 offset:4096
    ds_read_b64_tr_b16 v[154:155], v25 offset:4608
    s_waitcnt lgkmcnt(6)
    v_mfma_f32_32x32x16_bf16 v[68:83], v[140:143], a[180:183], v[68:83]
    ds_read_b64_tr_b16 v[156:157], v24 offset:6144
    ds_read_b64_tr_b16 v[158:159], v24 offset:6656
    s_waitcnt lgkmcnt(6)
    v_mfma_f32_32x32x16_bf16 v[84:99], v[144:147], a[180:183], v[84:99]
    ds_read_b64_tr_b16 v[160:161], v25 offset:6144
    ds_read_b64_tr_b16 v[162:163], v25 offset:6656
    s_waitcnt vmcnt(0)
L_chk_2768:
    v_xor_b32 v62, s50, v252
    v_bitop3_b32 v62, v253, s51, v62 bitop3:0xbe
    v_cmp_ne_u32 vcc, 0, v62
    s_nop 0
    s_and_b32 s62, vcc_lo, 0x1111111
    s_cbranch_scc1 L_retry_2769
L_cont_2770:
    s_add_u32 s63, s65, 32768
    buffer_load_dwordx4 a[0:3], v48, s[40:43], s63 offen sc1
    buffer_load_dwordx4 a[4:7], v48, s[40:43], s63 offen offset:1024 sc1
    buffer_load_dwordx4 a[8:11], v48, s[40:43], s63 offen offset:2048 sc1
    buffer_load_dwordx4 a[12:15], v48, s[40:43], s63 offen offset:3072 sc1
    s_add_u32 s63, s65, 40960
    buffer_load_dwordx4 a[16:19], v48, s[40:43], s63 offen sc1
    buffer_load_dwordx4 a[20:23], v48, s[40:43], s63 offen offset:1024 sc1
    buffer_load_dwordx4 a[24:27], v48, s[40:43], s63 offen offset:2048 sc1
    buffer_load_dwordx4 a[28:31], v48, s[40:43], s63 offen offset:3072 sc1
    s_add_u32 s63, s65, 49152
    buffer_load_dwordx4 a[32:35], v48, s[40:43], s63 offen sc1
    buffer_load_dwordx4 a[36:39], v48, s[40:43], s63 offen offset:1024 sc1
    buffer_load_dwordx4 a[40:43], v48, s[40:43], s63 offen offset:2048 sc1
    buffer_load_dwordx4 a[44:47], v48, s[40:43], s63 offen offset:3072 sc1
    s_waitcnt lgkmcnt(6)
    v_mfma_f32_32x32x16_bf16 v[68:83], v[148:151], a[184:187], v[68:83]
    ds_read_b64_tr_b16 v[132:133], v26 offset:32768
    ds_read_b64_tr_b16 v[134:135], v26 offset:33280
    s_waitcnt lgkmcnt(6)
    v_mfma_f32_32x32x16_bf16 v[84:99], v[152:155], a[184:187], v[84:99]
    ds_read_b64_tr_b16 v[136:137], v27 offset:32768
    ds_read_b64_tr_b16 v[138:139], v27 offset:33280
    s_waitcnt lgkmcnt(6)
    v_mfma_f32_32x32x16_bf16 v[68:83], v[156:159], a[188:191], v[68:83]
    ds_read_b64_tr_b16 v[140:141], v26 offset:34816
    ds_read_b64_tr_b16 v[142:143], v26 offset:35328
    s_waitcnt lgkmcnt(6)
    v_mfma_f32_32x32x16_bf16 v[84:99], v[160:163], a[188:191], v[84:99]
    ds_read_b64_tr_b16 v[144:145], v27 offset:34816
    ds_read_b64_tr_b16 v[146:147], v27 offset:35328
    s_waitcnt vmcnt(10)
    s_waitcnt lgkmcnt(6)
    v_mfma_f32_32x32x16_bf16 v[100:115], v[132:135], a[0:3], 0
    ds_read_b64_tr_b16 v[148:149], v26 offset:36864
    ds_read_b64_tr_b16 v[150:151], v26 offset:37376
    s_add_u32 s63, s65, 57344
    buffer_load_dwordx4 a[48:51], v48, s[40:43], s63 offen sc1
    buffer_load_dwordx4 a[52:55], v48, s[40:43], s63 offen offset:1024 sc1
    buffer_load_dwordx4 a[56:59], v48, s[40:43], s63 offen offset:2048 sc1
    buffer_load_dwordx4 a[60:63], v48, s[40:43], s63 offen offset:3072 sc1
    s_waitcnt lgkmcnt(6)
    v_mfma_f32_32x32x16_bf16 v[116:131], v[136:139], a[0:3], 0
    ds_read_b64_tr_b16 v[152:153], v27 offset:36864
    ds_read_b64_tr_b16 v[154:155], v27 offset:37376
    s_waitcnt lgkmcnt(6)
    v_mfma_f32_32x32x16_bf16 v[100:115], v[140:143], a[4:7], v[100:115]
    ds_read_b64_tr_b16 v[156:157], v26 offset:38912
    ds_read_b64_tr_b16 v[158:159], v26 offset:39424
    s_waitcnt lgkmcnt(6)
    v_mfma_f32_32x32x16_bf16 v[116:131], v[144:147], a[4:7], v[116:131]
    ds_read_b64_tr_b16 v[160:161], v27 offset:38912
    ds_read_b64_tr_b16 v[162:163], v27 offset:39424
    s_waitcnt vmcnt(12)
    s_waitcnt lgkmcnt(6)
    v_mfma_f32_32x32x16_bf16 v[100:115], v[148:151], a[8:11], v[100:115]
    ds_read_b64_tr_b16 v[132:133], v24 offset:16384
    ds_read_b64_tr_b16 v[134:135], v24 offset:16896
    s_waitcnt lgkmcnt(6)
    v_mfma_f32_32x32x16_bf16 v[116:131], v[152:155], a[8:11], v[116:131]
    ds_read_b64_tr_b16 v[136:137], v25 offset:16384
    ds_read_b64_tr_b16 v[138:139], v25 offset:16896
    s_waitcnt lgkmcnt(6)
    v_mfma_f32_32x32x16_bf16 v[100:115], v[156:159], a[12:15], v[100:115]
    ds_read_b64_tr_b16 v[140:141], v24 offset:18432
    ds_read_b64_tr_b16 v[142:143], v24 offset:18944
    s_waitcnt lgkmcnt(6)
    v_mfma_f32_32x32x16_bf16 v[116:131], v[160:163], a[12:15], v[116:131]
    ds_read_b64_tr_b16 v[144:145], v25 offset:18432
    ds_read_b64_tr_b16 v[146:147], v25 offset:18944
    s_waitcnt vmcnt(10)
    s_waitcnt lgkmcnt(6)
    v_mfma_f32_32x32x16_bf16 v[100:115], v[132:135], a[16:19], v[100:115]
    ds_read_b64_tr_b16 v[148:149], v24 offset:20480
    ds_read_b64_tr_b16 v[150:151], v24 offset:20992
    s_add_u32 s63, s65, 65536
    buffer_load_dwordx4 a[64:67], v48, s[40:43], s63 offen sc1
    buffer_load_dwordx4 a[68:71], v48, s[40:43], s63 offen offset:1024 sc1
    buffer_load_dwordx4 a[72:75], v48, s[40:43], s63 offen offset:2048 sc1
    buffer_load_dwordx4 a[76:79], v48, s[40:43], s63 offen offset:3072 sc1
    s_waitcnt lgkmcnt(6)
    v_mfma_f32_32x32x16_bf16 v[116:131], v[136:139], a[16:19], v[116:131]
    ds_read_b64_tr_b16 v[152:153], v25 offset:20480
    ds_read_b64_tr_b16 v[154:155], v25 offset:20992
    s_waitcnt lgkmcnt(6)
    v_mfma_f32_32x32x16_bf16 v[100:115], v[140:143], a[20:23], v[100:115]
    ds_read_b64_tr_b16 v[156:157], v24 offset:22528
    ds_read_b64_tr_b16 v[158:159], v24 offset:23040
    s_waitcnt lgkmcnt(6)
    v_mfma_f32_32x32x16_bf16 v[116:131], v[144:147], a[20:23], v[116:131]
    ds_read_b64_tr_b16 v[160:161], v25 offset:22528
    ds_read_b64_tr_b16 v[162:163], v25 offset:23040
    s_waitcnt vmcnt(12)
    s_waitcnt lgkmcnt(6)
    v_mfma_f32_32x32x16_bf16 v[100:115], v[148:151], a[24:27], v[100:115]
    ds_read_b64_tr_b16 v[132:133], v26 offset:0
    ds_read_b64_tr_b16 v[134:135], v26 offset:512
    s_waitcnt lgkmcnt(6)
    v_mfma_f32_32x32x16_bf16 v[116:131], v[152:155], a[24:27], v[116:131]
    ds_read_b64_tr_b16 v[136:137], v27 offset:0
    ds_read_b64_tr_b16 v[138:139], v27 offset:512
    s_waitcnt lgkmcnt(6)
    v_mfma_f32_32x32x16_bf16 v[100:115], v[156:159], a[28:31], v[100:115]
    ds_read_b64_tr_b16 v[140:141], v26 offset:2048
    ds_read_b64_tr_b16 v[142:143], v26 offset:2560
    s_waitcnt lgkmcnt(6)
    v_mfma_f32_32x32x16_bf16 v[116:131], v[160:163], a[28:31], v[116:131]
    ds_read_b64_tr_b16 v[144:145], v27 offset:2048
    ds_read_b64_tr_b16 v[146:147], v27 offset:2560
    s_waitcnt vmcnt(10)
    s_waitcnt lgkmcnt(6)
    v_mfma_f32_32x32x16_bf16 v[100:115], v[132:135], a[32:35], v[100:115]
    ds_read_b64_tr_b16 v[148:149], v26 offset:4096
    ds_read_b64_tr_b16 v[150:151], v26 offset:4608
    s_add_u32 s63, s65, 73728
    buffer_load_dwordx4 a[80:83], v48, s[40:43], s63 offen sc1
    buffer_load_dwordx4 a[84:87], v48, s[40:43], s63 offen offset:1024 sc1
    buffer_load_dwordx4 a[88:91], v48, s[40:43], s63 offen offset:2048 sc1
    buffer_load_dwordx4 a[92:95], v48, s[40:43], s63 offen offset:3072 sc1
    s_waitcnt lgkmcnt(6)
    v_mfma_f32_32x32x16_bf16 v[116:131], v[136:139], a[32:35], v[116:131]
    ds_read_b64_tr_b16 v[152:153], v27 offset:4096
    ds_read_b64_tr_b16 v[154:155], v27 offset:4608
    s_waitcnt lgkmcnt(6)
    v_mfma_f32_32x32x16_bf16 v[100:115], v[140:143], a[36:39], v[100:115]
    ds_read_b64_tr_b16 v[156:157], v26 offset:6144
    ds_read_b64_tr_b16 v[158:159], v26 offset:6656
    s_waitcnt lgkmcnt(6)
    v_mfma_f32_32x32x16_bf16 v[116:131], v[144:147], a[36:39], v[116:131]
    ds_read_b64_tr_b16 v[160:161], v27 offset:6144
    ds_read_b64_tr_b16 v[162:163], v27 offset:6656
    s_waitcnt vmcnt(12)
    s_waitcnt lgkmcnt(6)
    v_mfma_f32_32x32x16_bf16 v[100:115], v[148:151], a[40:43], v[100:115]
    ds_read_b64_tr_b16 v[132:133], v24 offset:32768
    ds_read_b64_tr_b16 v[134:135], v24 offset:33280
    s_waitcnt lgkmcnt(6)
    v_mfma_f32_32x32x16_bf16 v[116:131], v[152:155], a[40:43], v[116:131]
    ds_read_b64_tr_b16 v[136:137], v25 offset:32768
    ds_read_b64_tr_b16 v[138:139], v25 offset:33280
    s_waitcnt lgkmcnt(6)
    v_mfma_f32_32x32x16_bf16 v[100:115], v[156:159], a[44:47], v[100:115]
    ds_read_b64_tr_b16 v[140:141], v24 offset:34816
    ds_read_b64_tr_b16 v[142:143], v24 offset:35328
    s_waitcnt lgkmcnt(6)
    v_mfma_f32_32x32x16_bf16 v[116:131], v[160:163], a[44:47], v[116:131]
    ds_read_b64_tr_b16 v[144:145], v25 offset:34816
    ds_read_b64_tr_b16 v[146:147], v25 offset:35328
    s_waitcnt vmcnt(10)
    s_waitcnt lgkmcnt(6)
    v_mfma_f32_32x32x16_bf16 v[100:115], v[132:135], a[48:51], v[100:115]
    ds_read_b64_tr_b16 v[148:149], v24 offset:36864
    ds_read_b64_tr_b16 v[150:151], v24 offset:37376
    s_add_u32 s63, s65, 81920
    buffer_load_dwordx4 a[96:99], v48, s[40:43], s63 offen sc1
    buffer_load_dwordx4 a[100:103], v48, s[40:43], s63 offen offset:1024 sc1
    buffer_load_dwordx4 a[104:107], v48, s[40:43], s63 offen offset:2048 sc1
    buffer_load_dwordx4 a[108:111], v48, s[40:43], s63 offen offset:3072 sc1
    s_waitcnt lgkmcnt(6)
    v_mfma_f32_32x32x16_bf16 v[116:131], v[136:139], a[48:51], v[116:131]
    ds_read_b64_tr_b16 v[152:153], v25 offset:36864
    ds_read_b64_tr_b16 v[154:155], v25 offset:37376
    s_waitcnt lgkmcnt(6)
    v_mfma_f32_32x32x16_bf16 v[100:115], v[140:143], a[52:55], v[100:115]
    ds_read_b64_tr_b16 v[156:157], v24 offset:38912
    ds_read_b64_tr_b16 v[158:159], v24 offset:39424
    s_waitcnt lgkmcnt(6)
    v_mfma_f32_32x32x16_bf16 v[116:131], v[144:147], a[52:55], v[116:131]
    ds_read_b64_tr_b16 v[160:161], v25 offset:38912
    ds_read_b64_tr_b16 v[162:163], v25 offset:39424
    s_waitcnt vmcnt(12)
    s_waitcnt lgkmcnt(6)
    v_mfma_f32_32x32x16_bf16 v[100:115], v[148:151], a[56:59], v[100:115]
    ds_read_b64_tr_b16 v[132:133], v28 offset:16384
    ds_read_b64_tr_b16 v[134:135], v28 offset:16896
    s_waitcnt lgkmcnt(6)
    v_mfma_f32_32x32x16_bf16 v[116:131], v[152:155], a[56:59], v[116:131]
    ds_read_b64_tr_b16 v[136:137], v29 offset:16384
    ds_read_b64_tr_b16 v[138:139], v29 offset:16896
    v_sub_f32 v32, 1.0, v30
    v_mov_b32 v33, v32
    s_waitcnt lgkmcnt(6)
    v_mfma_f32_32x32x16_bf16 v[100:115], v[156:159], a[60:63], v[100:115]
    ds_read_b64_tr_b16 v[140:141], v28 offset:18432
    ds_read_b64_tr_b16 v[142:143], v28 offset:18944
    s_waitcnt lgkmcnt(6)
    v_mfma_f32_32x32x16_bf16 v[116:131], v[160:163], a[60:63], v[116:131]
    ds_read_b64_tr_b16 v[144:145], v29 offset:18432
    ds_read_b64_tr_b16 v[146:147], v29 offset:18944
    s_waitcnt vmcnt(10)
    s_waitcnt lgkmcnt(6)
    v_mfma_f32_32x32x16_bf16 v[100:115], v[132:135], a[64:67], v[100:115]
    ds_read_b64_tr_b16 v[148:149], v28 offset:20480
    ds_read_b64_tr_b16 v[150:151], v28 offset:20992
    v_mul_f32 v68, v30, v68
    v_mul_f32 v69, v30, v69
    s_waitcnt lgkmcnt(6)
    v_mfma_f32_32x32x16_bf16 v[116:131], v[136:139], a[64:67], v[116:131]
    ds_read_b64_tr_b16 v[152:153], v29 offset:20480
    ds_read_b64_tr_b16 v[154:155], v29 offset:20992
    v_mul_f32 v70, v30, v70
    v_mul_f32 v71, v30, v71
    s_waitcnt lgkmcnt(6)
    v_mfma_f32_32x32x16_bf16 v[100:115], v[140:143], a[68:71], v[100:115]
    ds_read_b64_tr_b16 v[156:157], v28 offset:22528
    ds_read_b64_tr_b16 v[158:159], v28 offset:23040
    v_mul_f32 v72, v30, v72
    v_mul_f32 v73, v30, v73
    s_waitcnt lgkmcnt(6)
    v_mfma_f32_32x32x16_bf16 v[116:131], v[144:147], a[68:71], v[116:131]
    ds_read_b64_tr_b16 v[160:161], v29 offset:22528
    ds_read_b64_tr_b16 v[162:163], v29 offset:23040
    v_mul_f32 v74, v30, v74
    v_mul_f32 v75, v30, v75
    s_waitcnt vmcnt(8)
    s_waitcnt lgkmcnt(6)
    v_mfma_f32_32x32x16_bf16 v[100:115], v[148:151], a[72:75], v[100:115]
    v_mul_f32 v76, v30, v76
    v_mul_f32 v77, v30, v77
    s_waitcnt lgkmcnt(4)
    v_mfma_f32_32x32x16_bf16 v[116:131], v[152:155], a[72:75], v[116:131]
    v_mul_f32 v78, v30, v78
    v_mul_f32 v79, v30, v79
    s_waitcnt lgkmcnt(0)
    s_barrier
    v_mfma_f32_32x32x16_bf16 v[100:115], v[156:159], a[76:79], v[100:115]
    ds_read_b64_tr_b16 v[132:133], v28 offset:0
    ds_read_b64_tr_b16 v[134:135], v28 offset:512
    ds_read_b64_tr_b16 v[136:137], v29 offset:0
    ds_read_b64_tr_b16 v[138:139], v29 offset:512
    v_mul_f32 v80, v30, v80
    v_mul_f32 v81, v30, v81
    v_mfma_f32_32x32x16_bf16 v[116:131], v[160:163], a[76:79], v[116:131]
    ds_read_b64_tr_b16 v[140:141], v28 offset:2048
    ds_read_b64_tr_b16 v[142:143], v28 offset:2560
    ds_read_b64_tr_b16 v[144:145], v29 offset:2048
    ds_read_b64_tr_b16 v[146:147], v29 offset:2560
    v_mul_f32 v82, v30, v82
    v_mul_f32 v83, v30, v83
    s_waitcnt vmcnt(6)
    s_waitcnt lgkmcnt(6)
    v_mfma_f32_32x32x16_bf16 v[100:115], v[132:135], a[80:83], v[100:115]
    ds_read_b64_tr_b16 v[148:149], v28 offset:4096
    ds_read_b64_tr_b16 v[150:151], v28 offset:4608
    v_mul_f32 v84, v30, v84
    v_mul_f32 v85, v30, v85
    s_waitcnt lgkmcnt(6)
    v_mfma_f32_32x32x16_bf16 v[116:131], v[136:139], a[80:83], v[116:131]
    ds_read_b64_tr_b16 v[152:153], v29 offset:4096
    ds_read_b64_tr_b16 v[154:155], v29 offset:4608
    v_mul_f32 v86, v30, v86
    v_mul_f32 v87, v30, v87
    s_waitcnt lgkmcnt(6)
    v_mfma_f32_32x32x16_bf16 v[100:115], v[140:143], a[84:87], v[100:115]
    ds_read_b64_tr_b16 v[156:157], v28 offset:6144
    ds_read_b64_tr_b16 v[158:159], v28 offset:6656
    v_mul_f32 v88, v30, v88
    v_mul_f32 v89, v30, v89
    s_waitcnt lgkmcnt(6)
    v_mfma_f32_32x32x16_bf16 v[116:131], v[144:147], a[84:87], v[116:131]
    ds_read_b64_tr_b16 v[160:161], v29 offset:6144
    ds_read_b64_tr_b16 v[162:163], v29 offset:6656
    v_mul_f32 v90, v30, v90
    v_mul_f32 v91, v30, v91
    s_waitcnt vmcnt(4)
    s_waitcnt lgkmcnt(6)
    v_mfma_f32_32x32x16_bf16 v[100:115], v[148:151], a[88:91], v[100:115]
    ds_read_b64_tr_b16 v[132:133], v26 offset:16384
    ds_read_b64_tr_b16 v[134:135], v26 offset:16896
    v_mul_f32 v92, v30, v92
    v_mul_f32 v93, v30, v93
    s_waitcnt lgkmcnt(6)
    v_mfma_f32_32x32x16_bf16 v[116:131], v[152:155], a[88:91], v[116:131]
    ds_read_b64_tr_b16 v[136:137], v27 offset:16384
    ds_read_b64_tr_b16 v[138:139], v27 offset:16896
    v_mul_f32 v94, v30, v94
    v_mul_f32 v95, v30, v95
    s_waitcnt lgkmcnt(6)
    v_mfma_f32_32x32x16_bf16 v[100:115], v[156:159], a[92:95], v[100:115]
    ds_read_b64_tr_b16 v[140:141], v26 offset:18432
    ds_read_b64_tr_b16 v[142:143], v26 offset:18944
    v_mul_f32 v96, v30, v96
    v_mul_f32 v97, v30, v97
    s_waitcnt lgkmcnt(6)
    v_mfma_f32_32x32x16_bf16 v[116:131], v[160:163], a[92:95], v[116:131]
    ds_read_b64_tr_b16 v[144:145], v27 offset:18432
    ds_read_b64_tr_b16 v[146:147], v27 offset:18944
    v_mul_f32 v98, v30, v98
    v_mul_f32 v99, v30, v99
    s_waitcnt vmcnt(2)
    s_waitcnt lgkmcnt(6)
    v_mfma_f32_32x32x16_bf16 v[100:115], v[132:135], a[96:99], v[100:115]
    ds_read_b64_tr_b16 v[148:149], v26 offset:20480
    ds_read_b64_tr_b16 v[150:151], v26 offset:20992
    s_waitcnt lgkmcnt(6)
    v_mfma_f32_32x32x16_bf16 v[116:131], v[136:139], a[96:99], v[116:131]
    ds_read_b64_tr_b16 v[152:153], v27 offset:20480
    ds_read_b64_tr_b16 v[154:155], v27 offset:20992
    s_waitcnt lgkmcnt(6)
    v_mfma_f32_32x32x16_bf16 v[100:115], v[140:143], a[100:103], v[100:115]
    ds_read_b64_tr_b16 v[156:157], v26 offset:22528
    ds_read_b64_tr_b16 v[158:159], v26 offset:23040
    s_waitcnt lgkmcnt(6)
    v_mfma_f32_32x32x16_bf16 v[116:131], v[144:147], a[100:103], v[116:131]
    ds_read_b64_tr_b16 v[160:161], v27 offset:22528
    ds_read_b64_tr_b16 v[162:163], v27 offset:23040
    s_waitcnt vmcnt(0)
    s_waitcnt lgkmcnt(6)
    v_mfma_f32_32x32x16_bf16 v[100:115], v[148:151], a[104:107], v[100:115]
    s_waitcnt lgkmcnt(4)
    v_mfma_f32_32x32x16_bf16 v[116:131], v[152:155], a[104:107], v[116:131]
    s_waitcnt lgkmcnt(2)
    v_mfma_f32_32x32x16_bf16 v[100:115], v[156:159], a[108:111], v[100:115]
    s_waitcnt lgkmcnt(0)
    v_mfma_f32_32x32x16_bf16 v[116:131], v[160:163], a[108:111], v[116:131]
    s_barrier
    s_nop 8
    v_pk_fma_f32 v[68:69], v[100:101], v[32:33], v[68:69]
    v_pk_fma_f32 v[70:71], v[102:103], v[32:33], v[70:71]
    ds_write_b128 v35, v[68:71] offset:0
    v_pk_fma_f32 v[72:73], v[104:105], v[32:33], v[72:73]
    v_pk_fma_f32 v[74:75], v[106:107], v[32:33], v[74:75]
    ds_write_b128 v35, v[72:75] offset:32
    v_pk_fma_f32 v[76:77], v[108:109], v[32:33], v[76:77]
    v_pk_fma_f32 v[78:79], v[110:111], v[32:33], v[78:79]
    ds_write_b128 v35, v[76:79] offset:64
    v_pk_fma_f32 v[80:81], v[112:113], v[32:33], v[80:81]
    v_pk_fma_f32 v[82:83], v[114:115], v[32:33], v[82:83]
    ds_write_b128 v35, v[80:83] offset:96
    v_pk_fma_f32 v[84:85], v[116:117], v[32:33], v[84:85]
    v_pk_fma_f32 v[86:87], v[118:119], v[32:33], v[86:87]
    ds_write_b128 v35, v[84:87] offset:128
    v_pk_fma_f32 v[88:89], v[120:121], v[32:33], v[88:89]
    v_pk_fma_f32 v[90:91], v[122:123], v[32:33], v[90:91]
    ds_write_b128 v35, v[88:91] offset:160
    v_pk_fma_f32 v[92:93], v[124:125], v[32:33], v[92:93]
    v_pk_fma_f32 v[94:95], v[126:127], v[32:33], v[94:95]
    ds_write_b128 v35, v[92:95] offset:192
    v_pk_fma_f32 v[96:97], v[128:129], v[32:33], v[96:97]
    v_pk_fma_f32 v[98:99], v[130:131], v[32:33], v[98:99]
    ds_write_b128 v35, v[96:99] offset:224
    s_waitcnt lgkmcnt(0)
    s_barrier
    ds_read_b128 v[164:167], v47 offset:0
    ds_read_b128 v[168:171], v47 offset:16
    ds_read_b128 v[172:175], v47 offset:8704
    ds_read_b128 v[176:179], v47 offset:8720
    ds_read_b128 v[180:183], v47 offset:2176
    ds_read_b128 v[184:187], v47 offset:2192
    ds_read_b128 v[188:191], v47 offset:10880
    ds_read_b128 v[192:195], v47 offset:10896
    s_waitcnt lgkmcnt(4)
    v_pk_add_f32 v[164:165], v[164:165], v[172:173]
    v_pk_add_f32 v[166:167], v[166:167], v[174:175]
    v_pk_add_f32 v[168:169], v[168:169], v[176:177]
    v_pk_add_f32 v[170:171], v[170:171], v[178:179]
    v_cvt_pk_bf16_f32 v172, v164, v165
    v_cvt_pk_bf16_f32 v173, v166, v167
    v_cvt_pk_bf16_f32 v174, v168, v169
    v_cvt_pk_bf16_f32 v175, v170, v171
    buffer_store_dwordx4 v[172:175], v40, s[36:39], 0 offen sc1
    s_waitcnt lgkmcnt(0)
    v_pk_add_f32 v[180:181], v[180:181], v[188:189]
    v_pk_add_f32 v[182:183], v[182:183], v[190:191]
    v_pk_add_f32 v[184:185], v[184:185], v[192:193]
    v_pk_add_f32 v[186:187], v[186:187], v[194:195]
    v_cvt_pk_bf16_f32 v188, v180, v181
    v_cvt_pk_bf16_f32 v189, v182, v183
    v_cvt_pk_bf16_f32 v190, v184, v185
    v_cvt_pk_bf16_f32 v191, v186, v187
    buffer_store_dwordx4 v[188:191], v41, s[36:39], 0 offen sc1
L_end:
    s_endpgm
L_retry_251:
H_T_0:
    s_cbranch_execz L_hopret
    s_cmp_eq_u32 s3, 0
    s_cbranch_scc1 L_cont_252
    s_sub_u32 s3, s3, 1
    s_sleep 2
    buffer_load_dwordx4 v[220:223], v248, s[40:43], s65 offen sc1
    buffer_load_dwordx4 v[224:227], v248, s[40:43], s65 offen offset:1024 sc1
    buffer_load_dwordx4 v[228:231], v248, s[40:43], s65 offen offset:2048 sc1
    buffer_load_dwordx4 v[232:235], v248, s[40:43], s65 offen offset:3072 sc1
    buffer_load_dwordx4 v[236:239], v249, s[40:43], s65 offen sc1
    buffer_load_dwordx4 v[240:243], v249, s[40:43], s65 offen offset:1024 sc1
    buffer_load_dwordx4 v[244:247], v249, s[40:43], s65 offen offset:2048 sc1
    s_waitcnt vmcnt(0)
    s_branch L_chk_250
L_retry_398:
    s_cmp_eq_u32 s3, 0
    s_cbranch_scc1 L_cont_399
    s_sub_u32 s3, s3, 1
    s_sleep 2
    buffer_load_dwordx2 v[252:253], v254, s[40:43], 0 offen sc1
    s_waitcnt vmcnt(0)
    s_branch L_chk_397
L_retry_430:
    s_cmp_eq_u32 s3, 0
    s_cbranch_scc1 L_cont_431
    s_sub_u32 s3, s3, 1
    s_sleep 2
    buffer_load_dwordx2 v[44:45], v46, s[40:43], 0 offen sc1
    s_waitcnt vmcnt(0)
    s_branch L_chk_429
L_retry_691:
    s_cmp_eq_u32 s3, 0
    s_cbranch_scc1 L_cont_692
    s_sub_u32 s3, s3, 1
    s_sleep 2
    buffer_load_dwordx4 v[220:223], v248, s[40:43], s65 offen sc1
    buffer_load_dwordx4 v[224:227], v248, s[40:43], s65 offen offset:1024 sc1
    buffer_load_dwordx4 v[228:231], v248, s[40:43], s65 offen offset:2048 sc1
    buffer_load_dwordx4 v[232:235], v248, s[40:43], s65 offen offset:3072 sc1
    buffer_load_dwordx4 v[236:239], v249, s[40:43], s65 offen sc1
    buffer_load_dwordx4 v[240:243], v249, s[40:43], s65 offen offset:1024 sc1
    buffer_load_dwordx4 v[244:247], v249, s[40:43], s65 offen offset:2048 sc1
    s_waitcnt vmcnt(0)
    s_branch L_chk_690
L_retry_838:
    s_cmp_eq_u32 s3, 0
    s_cbranch_scc1 L_cont_839
    s_sub_u32 s3, s3, 1
    s_sleep 2
    buffer_load_dwordx2 v[252:253], v254, s[40:43], 0 offen sc1
    s_waitcnt vmcnt(0)
    s_branch L_chk_837
L_retry_1006:
    s_cmp_eq_u32 s3, 0
    s_cbranch_scc1 L_cont_1007
    s_sub_u32 s3, s3, 1
    s_sleep 2
    buffer_load_dwordx2 v[252:253], v254, s[40:43], 0 offen sc1
    s_waitcnt vmcnt(0)
    s_branch L_chk_1005
L_retry_1105:
    s_cmp_eq_u32 s3, 0
    s_cbranch_scc1 L_cont_1106
    s_sub_u32 s3, s3, 1
    s_sleep 2
    buffer_load_dwordx2 v[252:253], v254, s[40:43], 0 offen sc1
    s_waitcnt vmcnt(0)
    s_branch L_chk_1104
L_retry_1136:
    s_cmp_eq_u32 s3, 0
    s_cbranch_scc1 L_cont_1137
    s_sub_u32 s3, s3, 1
    s_sleep 2
    buffer_load_dwordx2 v[44:45], v46, s[40:43], 0 offen sc1
    s_waitcnt vmcnt(0)
    s_branch L_chk_1135
L_retry_1203:
    s_cmp_eq_u32 s3, 0
    s_cbranch_scc1 L_cont_1204
    s_sub_u32 s3, s3, 1
H_T_1:
    s_cbranch_execz L_hopret
    s_sleep 2
    buffer_load_dwordx2 v[252:253], v254, s[40:43], 0 offen sc1
    s_waitcnt vmcnt(0)
    s_branch L_chk_1202
L_retry_1627:
    s_cmp_eq_u32 s3, 0
    s_cbranch_scc1 L_cont_1628
    s_sub_u32 s3, s3, 1
    s_sleep 2
    buffer_load_dwordx2 v[44:45], v46, s[40:43], 0 offen sc1
    s_waitcnt vmcnt(0)
    s_branch L_chk_1626
L_retry_2024:
    s_cmp_eq_u32 s3, 0
    s_cbranch_scc1 L_cont_2025
    s_sub_u32 s3, s3, 1
    s_sleep 2
    buffer_load_dwordx2 v[244:245], v248, s[40:43], 0 offen sc1
    buffer_load_dwordx2 v[246:247], v249, s[40:43], 0 offen sc1
    s_waitcnt vmcnt(0)
    s_branch L_chk_2023
L_retry_2699:
    s_cmp_eq_u32 s3, 0
    s_cbranch_scc1 L_cont_2700
    s_sub_u32 s3, s3, 1
    s_sleep 2
    buffer_load_dwordx2 v[244:245], v248, s[40:43], 0 offen sc1
    buffer_load_dwordx2 v[246:247], v249, s[40:43], 0 offen sc1
    s_waitcnt vmcnt(0)
    s_branch L_chk_2698
L_retry_2702:
    s_cmp_eq_u32 s3, 0
    s_cbranch_scc1 L_cont_2703
    s_sub_u32 s3, s3, 1
    s_sleep 2
    buffer_load_dwordx2 v[44:45], v46, s[40:43], 0 offen sc1
    s_waitcnt vmcnt(0)
    s_branch L_chk_2701
L_retry_2769:
    s_cmp_eq_u32 s3, 0
    s_cbranch_scc1 L_cont_2770
    s_sub_u32 s3, s3, 1
    s_sleep 2
    buffer_load_dwordx2 v[252:253], v254, s[40:43], 0 offen sc1
    s_waitcnt vmcnt(0)
    s_branch L_chk_2768
L_code_end:
    s_endpgm
.if (L_code_end - L_body) > 98304
.warning "code larger than the prefetched range"
.else
.fill (98304 - (L_code_end - L_body)) / 4 + 16, 4, 0xbf810000
.endif
.section .rodata,"a"
.p2align 6
.amdhsa_kernel gated_mix__linear_attn_block__mixer_gmlp__prompt_kernel
  .amdhsa_next_free_vgpr 512
  .amdhsa_next_free_sgpr 102
  .amdhsa_accum_offset 256
  .amdhsa_group_segment_fixed_size 0
  .amdhsa_kernarg_size 96
  .amdhsa_user_sgpr_count 2
  .amdhsa_user_sgpr_kernarg_segment_ptr 1
  .amdhsa_system_sgpr_workgroup_id_x 1
.end_amdhsa_kernel
```
